```python
import torch

def _softmax(x, axis=-1):
    return torch.softmax(x, dim=axis)
def _gelu(x):
    return torch.nn.functional.gelu(x, approximate="tanh")
def _silu(x):
    return torch.nn.functional.silu(x)
def _sigmoid(x):
    return torch.sigmoid(x)
def _layernorm(x, axis=-1, eps=1e-5):
    m = x.mean(dim=axis, keepdim=True)
    v = x.var(dim=axis, keepdim=True, unbiased=False)
    return (x - m) / torch.sqrt(v + eps)
def _scatter_add(tgt, idx, src, axis=0):
    return tgt.clone().index_add_(axis, idx, src)
def _segment_sum(src, seg, n):
    out = torch.zeros((n,) + src.shape[1:], dtype=src.dtype)
    return out.index_add_(0, seg, src)
def _pad(x, pw):
    flat = tuple(v for pair in reversed(pw) for v in pair)
    return torch.nn.functional.pad(x, flat)

kernel_name = 'sequential_preLN__sliding_local_dilated__glu_gated_geglu__prompt'

def setup_inputs():

    _w = (lambda a: (lambda t: t.to(torch.bfloat16) if t.is_floating_point() else t)(torch.as_tensor(a)))
    def _A_setup():
        B, S, D = 1, 2048, 576
        return {
            "x": _w((lambda *s: torch.randn(*s, dtype=torch.bfloat16) * 0.05)(B, S, D)),
            "wqkv": _w((lambda *s: torch.randn(*s, dtype=torch.bfloat16) * 0.05)(D, 3 * D)),
            "wo": _w((lambda *s: torch.randn(*s, dtype=torch.bfloat16) * 0.05)(D, D)),
        }
    _A_in = _A_setup()

    def _B_setup():
        B, S, Dm, Df = 1, 2048, 576, 4608
        return {
            "x": _w((lambda *s: torch.randn(*s, dtype=torch.bfloat16) * 0.05)(B, S, Dm)),
            "w_gate": _w((lambda *s: torch.randn(*s, dtype=torch.bfloat16) * 0.8)(Dm, Df) * (Dm ** -0.5)),
            "w_up": _w((lambda *s: torch.randn(*s, dtype=torch.bfloat16) * 0.8)(Dm, Df) * (Dm ** -0.5)),
            "w_down": _w((lambda *s: torch.randn(*s, dtype=torch.bfloat16) * 0.8)(Df, Dm) * (Df ** -0.5)),
        }
    _B_in = _B_setup()

    return {
        "A_x": _A_in["x"],
        "A_wqkv": _A_in["wqkv"],
        "A_wo": _A_in["wo"],
        "B_x": _B_in["x"],
        "B_w_gate": _B_in["w_gate"],
        "B_w_up": _B_in["w_up"],
        "B_w_down": _B_in["w_down"],
    }

def reference(A_x, A_wqkv, A_wo, B_x, B_w_gate, B_w_up, B_w_down):
    def _A_ref(x, wqkv, wo):
        B, S, D = x.shape
        H = 32; Dh = D // H
        W, dil = 8, 2
        qkv = (lambda x, *d: x.permute(*d))((x @ wqkv).reshape(B, S, 3, H, Dh), 2, 0, 3, 1, 4)
        q, k, v = qkv[0], qkv[1], qkv[2]
        scale = Dh ** -0.5
        pos = torch.arange(S)
        off = torch.arange(W) * dil
        idx = pos[:, None] - off[None, :]
        mask = idx >= 0
        idx_c = torch.where(mask, idx, 0).reshape(-1)
        kg = k[:, :, idx_c, :].reshape(B, H, S, W, Dh)
        vg = v[:, :, idx_c, :].reshape(B, H, S, W, Dh)
        logits = torch.einsum("bhsd,bhswd->bhsw", q, kg) * scale
        logits = torch.where(mask[None, None, :, :], logits, -1e9)
        attn = _softmax(logits, axis=-1)
        o = torch.einsum("bhsw,bhswd->bhsd", attn, vg)
        return (lambda x, *d: x.permute(*d))(o, 0, 2, 1, 3).reshape(B, S, D) @ wo

    def _B_ref(x, w_gate, w_up, w_down):
        g = torch.einsum("bsd,df->bsf", x, w_gate)
        u = torch.einsum("bsd,df->bsf", x, w_up)
        h = _gelu(g) * u
        return torch.einsum("bsf,fd->bsd", h, w_down)

    x = A_x
    h = x + _A_ref(_layernorm(x, axis=-1), A_wqkv, A_wo)
    h2 = h + _B_ref(_layernorm(h, axis=-1), B_w_gate, B_w_up, B_w_down)
    return h2
```

```asm
; @launch kernel=attn_kernel grid=(256,1,1) block=(512,1,1) lds=155648
; @launch kernel=ffn_kernel grid=(256,1,1) block=(512,1,1) lds=161792
.amdgcn_target "amdgcn-amd-amdhsa--gfx950"
.text
.globl attn_kernel
.p2align 8
.type attn_kernel,@function
attn_kernel:
s_cmp_ge_u32 s2,256
s_cbranch_scc1 attn_kernel_done
s_load_dwordx4 s[20:23],s[0:1],0
s_getpc_b64 s[72:73]
attn_kernel_pc:
v_lshrrev_b32 v236,4,v0
s_lshr_b32 s3,s2,3
s_lshl_b32 s3,s3,5
v_add_lshl_u32 v236,s3,v236,7
v_min_u32 v236,text_end_label-attn_kernel-4,v236
s_sub_u32 s72,s72,attn_kernel_pc-attn_kernel
s_subb_u32 s73,s73,0
v_mov_b32 v237,s73
v_add_co_u32 v236,vcc,s72,v236
s_nop 1
v_addc_co_u32 v237,vcc,0,v237,vcc
global_load_dword v238,v[236:237],off
s_load_dwordx2 s[24:25],s[0:1],16
s_load_dwordx2 s[26:27],s[0:1],72
v_lshrrev_b32 v1,6,v0
v_and_b32 v252,63,v0
v_readfirstlane_b32 s34,v1
s_lshr_b32 s37,s2,3
s_and_b32 s35,s2,3
s_lshl_b32 s35,s35,1
s_and_b32 s38,s37,1
s_add_u32 s35,s35,s38
s_lshr_b32 s36,s37,1
s_and_b32 s38,s2,4
s_lshl_b32 s38,s38,2
s_add_u32 s36,s36,s38
v_lshrrev_b32 v253,4,v252
s_mul_i32 s37,s36,57
s_lshr_b32 s37,s37,9
s_mul_i32 s37,s37,9
s_sub_u32 s44,s36,s37
s_cmp_eq_u32 s34,7
s_cbranch_scc1 attn_kernel_ld1
s_cmp_eq_u32 s34,6
s_cbranch_scc1 attn_kernel_ld0
s_cmp_eq_u32 s34,5
s_cbranch_scc1 attn_kernel_a1
s_cmp_eq_u32 s34,4
s_cbranch_scc1 attn_kernel_a0
s_bitcmp1_b32 s34,0
s_cbranch_scc1 attn_kernel_m0
s_lshr_b32 s43,s34,1
s_lshl_b32 s43,s43,1
s_add_u32 s43,s43,1
v_and_b32 v59,15,v252
s_lshl_b32 s38,s43,4
v_add_u32 v70,s38,v59
v_lshlrev_b32 v71,7,v70
v_add_u32 v71,122880,v71
v_and_b32 v72,7,v59
v_add_u32 v73,0,v253
v_xor_b32 v73,v73,v72
v_lshl_add_u32 v254,v73,4,v71
v_add_u32 v73,4,v253
v_xor_b32 v73,v73,v72
v_lshl_add_u32 v255,v73,4,v71
v_bfe_u32 v61,v252,2,2
v_lshl_add_u32 v62,v253,3,v61
v_lshlrev_b32 v62,8,v62
v_and_b32 v63,1,v253
v_lshl_or_b32 v63,v63,2,v61
v_lshlrev_b32 v63,1,v63
v_and_b32 v64,3,v252
s_lshl_b32 s37,s35,4
v_add_u32 v65,0,v64
v_mul_u32_u24 v66,52,v65
v_lshrrev_b32 v66,8,v66
v_mul_u32_u24 v67,5,v66
v_sub_u32 v67,v65,v67
v_mul_u32_u24 v68,36,v66
v_and_b32 v66,1,v66
v_lshlrev_b32 v66,2,v66
v_sub_u32 v68,v68,v66
v_lshl_add_u32 v68,v67,3,v68
v_add_u32 v68,s37,v68
v_lshrrev_b32 v67,4,v68
v_xor_b32 v67,v67,v63
v_and_b32 v68,8,v68
v_lshl_add_u32 v67,v67,4,v68
v_add_u32 v232,v67,v62
v_add_u32 v65,4,v64
v_mul_u32_u24 v66,52,v65
v_lshrrev_b32 v66,8,v66
v_mul_u32_u24 v67,5,v66
v_sub_u32 v67,v65,v67
v_mul_u32_u24 v68,36,v66
v_and_b32 v66,1,v66
v_lshlrev_b32 v66,2,v66
v_sub_u32 v68,v68,v66
v_lshl_add_u32 v68,v67,3,v68
v_add_u32 v68,s37,v68
v_lshrrev_b32 v67,4,v68
v_xor_b32 v67,v67,v63
v_and_b32 v68,8,v68
v_lshl_add_u32 v67,v67,4,v68
v_add_u32 v233,v67,v62
v_add_u32 v65,8,v64
v_mul_u32_u24 v66,52,v65
v_lshrrev_b32 v66,8,v66
v_mul_u32_u24 v67,5,v66
v_sub_u32 v67,v65,v67
v_mul_u32_u24 v68,36,v66
v_and_b32 v66,1,v66
v_lshlrev_b32 v66,2,v66
v_sub_u32 v68,v68,v66
v_lshl_add_u32 v68,v67,3,v68
v_add_u32 v68,s37,v68
v_lshrrev_b32 v67,4,v68
v_xor_b32 v67,v67,v63
v_and_b32 v68,8,v68
v_lshl_add_u32 v67,v67,4,v68
v_add_u32 v234,v67,v62
v_add_u32 v65,12,v64
v_mul_u32_u24 v66,52,v65
v_lshrrev_b32 v66,8,v66
v_mul_u32_u24 v67,5,v66
v_sub_u32 v67,v65,v67
v_mul_u32_u24 v68,36,v66
v_and_b32 v66,1,v66
v_lshlrev_b32 v66,2,v66
v_sub_u32 v68,v68,v66
v_lshl_add_u32 v68,v67,3,v68
v_add_u32 v68,s37,v68
v_lshrrev_b32 v67,4,v68
v_xor_b32 v67,v67,v63
v_and_b32 v68,8,v68
v_lshl_add_u32 v67,v67,4,v68
v_add_u32 v235,v67,v62
v_add_u32 v65,16,v64
v_mul_u32_u24 v66,52,v65
v_lshrrev_b32 v66,8,v66
v_mul_u32_u24 v67,5,v66
v_sub_u32 v67,v65,v67
v_mul_u32_u24 v68,36,v66
v_and_b32 v66,1,v66
v_lshlrev_b32 v66,2,v66
v_sub_u32 v68,v68,v66
v_lshl_add_u32 v68,v67,3,v68
v_add_u32 v68,s37,v68
v_lshrrev_b32 v67,4,v68
v_xor_b32 v67,v67,v63
v_and_b32 v68,8,v68
v_lshl_add_u32 v67,v67,4,v68
v_add_u32 v236,v67,v62
v_mov_b32 v240,0x3f803f80
v_mov_b32 v241,0x3f803f80
v_mov_b32 v242,0x3f803f80
v_mov_b32 v243,0x3f803f80
v_mul_u32_u24 v61,48,v70
v_mul_u32_u24 v62,80,v70
v_add_u32 v63,0,v253
v_mul_u32_u24 v64,52,v63
v_lshrrev_b32 v64,8,v64
v_mul_u32_u24 v65,5,v64
v_sub_u32 v65,v63,v65
v_mul_u32_u24 v66,3840,v64
v_lshl_add_u32 v66,v65,3,v66
v_add_u32 v40,v66,v61
v_mul_u32_u24 v66,6400,v64
v_lshl_add_u32 v66,v65,4,v66
v_add_u32 v48,v66,v62
v_add_u32 v63,4,v253
v_mul_u32_u24 v64,52,v63
v_lshrrev_b32 v64,8,v64
v_mul_u32_u24 v65,5,v64
v_sub_u32 v65,v63,v65
v_mul_u32_u24 v66,3840,v64
v_lshl_add_u32 v66,v65,3,v66
v_add_u32 v41,v66,v61
v_mul_u32_u24 v66,6400,v64
v_lshl_add_u32 v66,v65,4,v66
v_add_u32 v49,v66,v62
v_add_u32 v63,8,v253
v_mul_u32_u24 v64,52,v63
v_lshrrev_b32 v64,8,v64
v_mul_u32_u24 v65,5,v64
v_sub_u32 v65,v63,v65
v_mul_u32_u24 v66,3840,v64
v_lshl_add_u32 v66,v65,3,v66
v_add_u32 v42,v66,v61
v_mul_u32_u24 v66,6400,v64
v_lshl_add_u32 v66,v65,4,v66
v_add_u32 v50,v66,v62
v_add_u32 v63,12,v253
v_mul_u32_u24 v64,52,v63
v_lshrrev_b32 v64,8,v64
v_mul_u32_u24 v65,5,v64
v_sub_u32 v65,v63,v65
v_mul_u32_u24 v66,3840,v64
v_lshl_add_u32 v66,v65,3,v66
v_add_u32 v43,v66,v61
v_mul_u32_u24 v66,6400,v64
v_lshl_add_u32 v66,v65,4,v66
v_add_u32 v51,v66,v62
v_add_u32 v63,16,v253
v_mul_u32_u24 v64,52,v63
v_lshrrev_b32 v64,8,v64
v_mul_u32_u24 v65,5,v64
v_sub_u32 v65,v63,v65
v_mul_u32_u24 v66,3840,v64
v_lshl_add_u32 v66,v65,3,v66
v_add_u32 v44,v66,v61
v_mul_u32_u24 v66,6400,v64
v_lshl_add_u32 v66,v65,4,v66
v_add_u32 v52,v66,v62
v_lshlrev_b32 v56,3,v70
v_add_u32 v56,154624,v56
v_lshlrev_b32 v57,4,v253
v_add_u32 v57,153600,v57
s_waitcnt lgkmcnt(0)
s_barrier
ds_read_b128 v[0:3],v254 offset:0
ds_read_b128 v[4:7],v254 offset:2048
ds_read_b64_tr_b16 v[100:101],v235 offset:8192
ds_read_b64_tr_b16 v[102:103],v235 offset:9216
ds_read_b64_tr_b16 v[104:105],v236 offset:8192
ds_read_b64_tr_b16 v[106:107],v236 offset:9216
ds_read_b64_tr_b16 v[108:109],v232 offset:16384
ds_read_b64_tr_b16 v[110:111],v232 offset:17408
ds_read_b64_tr_b16 v[112:113],v233 offset:16384
ds_read_b64_tr_b16 v[114:115],v233 offset:17408
ds_read_b64_tr_b16 v[116:117],v234 offset:16384
ds_read_b64_tr_b16 v[118:119],v234 offset:17408
ds_read_b64_tr_b16 v[120:121],v235 offset:16384
ds_read_b64_tr_b16 v[122:123],v235 offset:17408
s_waitcnt lgkmcnt(12)
s_waitcnt lgkmcnt(10)
v_mfma_f32_16x16x32_bf16 v[244:247],v[240:243],v[4:7],0
v_mfma_f32_16x16x32_bf16 v[248:251],v[4:7],v[4:7],0
v_mfma_f32_16x16x32_bf16 v[144:147],v[100:103],v[0:3],0
ds_read_b64_tr_b16 v[124:125],v236 offset:16384
v_mfma_f32_16x16x32_bf16 v[148:151],v[100:103],v[4:7],0
ds_read_b64_tr_b16 v[126:127],v236 offset:17408
s_waitcnt lgkmcnt(10)
v_mfma_f32_16x16x32_bf16 v[152:155],v[104:107],v[0:3],0
s_barrier
ds_read_b128 v[8:11],v255 offset:0
ds_read_b128 v[12:15],v255 offset:2048
v_add_u32 v235,24576,v235
ds_read_b64_tr_b16 v[128:129],v235 offset:8192
v_mfma_f32_16x16x32_bf16 v[156:159],v[104:107],v[4:7],0
ds_read_b64_tr_b16 v[130:131],v235 offset:9216
s_waitcnt lgkmcnt(12)
v_mfma_f32_16x16x32_bf16 v[160:163],v[108:111],v[0:3],0
v_add_u32 v236,24576,v236
ds_read_b64_tr_b16 v[100:101],v236 offset:8192
v_mfma_f32_16x16x32_bf16 v[164:167],v[108:111],v[4:7],0
ds_read_b64_tr_b16 v[102:103],v236 offset:9216
s_waitcnt lgkmcnt(12)
v_mfma_f32_16x16x32_bf16 v[168:171],v[112:115],v[0:3],0
v_add_u32 v232,24576,v232
ds_read_b64_tr_b16 v[104:105],v232 offset:16384
v_mfma_f32_16x16x32_bf16 v[172:175],v[112:115],v[4:7],0
ds_read_b64_tr_b16 v[106:107],v232 offset:17408
s_waitcnt lgkmcnt(12)
v_mfma_f32_16x16x32_bf16 v[176:179],v[116:119],v[0:3],0
v_add_u32 v233,24576,v233
ds_read_b64_tr_b16 v[108:109],v233 offset:16384
v_mfma_f32_16x16x32_bf16 v[180:183],v[116:119],v[4:7],0
ds_read_b64_tr_b16 v[110:111],v233 offset:17408
s_waitcnt lgkmcnt(12)
v_mfma_f32_16x16x32_bf16 v[184:187],v[120:123],v[0:3],0
v_add_u32 v234,24576,v234
ds_read_b64_tr_b16 v[112:113],v234 offset:16384
v_mfma_f32_16x16x32_bf16 v[188:191],v[120:123],v[4:7],0
ds_read_b64_tr_b16 v[114:115],v234 offset:17408
s_waitcnt lgkmcnt(12)
v_mfma_f32_16x16x32_bf16 v[192:195],v[124:127],v[0:3],0
ds_read_b64_tr_b16 v[116:117],v235 offset:16384
v_mfma_f32_16x16x32_bf16 v[196:199],v[124:127],v[4:7],0
ds_read_b64_tr_b16 v[118:119],v235 offset:17408
s_waitcnt lgkmcnt(12)
s_waitcnt lgkmcnt(10)
v_mfma_f32_16x16x32_bf16 v[244:247],v[240:243],v[12:15],v[244:247]
v_mfma_f32_16x16x32_bf16 v[248:251],v[12:15],v[12:15],v[248:251]
v_mfma_f32_16x16x32_bf16 v[144:147],v[128:131],v[8:11],v[144:147]
ds_read_b64_tr_b16 v[120:121],v236 offset:16384
v_mfma_f32_16x16x32_bf16 v[148:151],v[128:131],v[12:15],v[148:151]
ds_read_b64_tr_b16 v[122:123],v236 offset:17408
s_waitcnt lgkmcnt(10)
v_mfma_f32_16x16x32_bf16 v[152:155],v[100:103],v[8:11],v[152:155]
s_barrier
ds_read_b128 v[16:19],v254 offset:10240
ds_read_b128 v[20:23],v254 offset:12288
v_add_u32 v235,24576,v235
ds_read_b64_tr_b16 v[124:125],v235 offset:8192
v_mfma_f32_16x16x32_bf16 v[156:159],v[100:103],v[12:15],v[156:159]
ds_read_b64_tr_b16 v[126:127],v235 offset:9216
s_waitcnt lgkmcnt(12)
v_mfma_f32_16x16x32_bf16 v[160:163],v[104:107],v[8:11],v[160:163]
v_add_u32 v236,24576,v236
ds_read_b64_tr_b16 v[128:129],v236 offset:8192
v_mfma_f32_16x16x32_bf16 v[164:167],v[104:107],v[12:15],v[164:167]
ds_read_b64_tr_b16 v[130:131],v236 offset:9216
s_waitcnt lgkmcnt(12)
v_mfma_f32_16x16x32_bf16 v[168:171],v[108:111],v[8:11],v[168:171]
v_add_u32 v232,24576,v232
ds_read_b64_tr_b16 v[100:101],v232 offset:16384
v_mfma_f32_16x16x32_bf16 v[172:175],v[108:111],v[12:15],v[172:175]
ds_read_b64_tr_b16 v[102:103],v232 offset:17408
s_waitcnt lgkmcnt(12)
v_mfma_f32_16x16x32_bf16 v[176:179],v[112:115],v[8:11],v[176:179]
v_add_u32 v233,24576,v233
ds_read_b64_tr_b16 v[104:105],v233 offset:16384
v_mfma_f32_16x16x32_bf16 v[180:183],v[112:115],v[12:15],v[180:183]
ds_read_b64_tr_b16 v[106:107],v233 offset:17408
s_waitcnt lgkmcnt(12)
v_mfma_f32_16x16x32_bf16 v[184:187],v[116:119],v[8:11],v[184:187]
v_add_u32 v234,24576,v234
ds_read_b64_tr_b16 v[108:109],v234 offset:16384
v_mfma_f32_16x16x32_bf16 v[188:191],v[116:119],v[12:15],v[188:191]
ds_read_b64_tr_b16 v[110:111],v234 offset:17408
s_waitcnt lgkmcnt(12)
v_mfma_f32_16x16x32_bf16 v[192:195],v[120:123],v[8:11],v[192:195]
ds_read_b64_tr_b16 v[112:113],v235 offset:16384
v_mfma_f32_16x16x32_bf16 v[196:199],v[120:123],v[12:15],v[196:199]
ds_read_b64_tr_b16 v[114:115],v235 offset:17408
s_waitcnt lgkmcnt(12)
s_waitcnt lgkmcnt(10)
v_mfma_f32_16x16x32_bf16 v[244:247],v[240:243],v[20:23],v[244:247]
v_mfma_f32_16x16x32_bf16 v[248:251],v[20:23],v[20:23],v[248:251]
v_mfma_f32_16x16x32_bf16 v[144:147],v[124:127],v[16:19],v[144:147]
ds_read_b64_tr_b16 v[116:117],v236 offset:16384
v_mfma_f32_16x16x32_bf16 v[148:151],v[124:127],v[20:23],v[148:151]
ds_read_b64_tr_b16 v[118:119],v236 offset:17408
s_waitcnt lgkmcnt(10)
v_mfma_f32_16x16x32_bf16 v[152:155],v[128:131],v[16:19],v[152:155]
s_barrier
ds_read_b128 v[0:3],v255 offset:10240
ds_read_b128 v[4:7],v255 offset:12288
v_add_u32 v235,24576,v235
ds_read_b64_tr_b16 v[120:121],v235 offset:8192
v_mfma_f32_16x16x32_bf16 v[156:159],v[128:131],v[20:23],v[156:159]
ds_read_b64_tr_b16 v[122:123],v235 offset:9216
s_waitcnt lgkmcnt(12)
v_mfma_f32_16x16x32_bf16 v[160:163],v[100:103],v[16:19],v[160:163]
v_add_u32 v236,24576,v236
ds_read_b64_tr_b16 v[124:125],v236 offset:8192
v_mfma_f32_16x16x32_bf16 v[164:167],v[100:103],v[20:23],v[164:167]
ds_read_b64_tr_b16 v[126:127],v236 offset:9216
s_waitcnt lgkmcnt(12)
v_mfma_f32_16x16x32_bf16 v[168:171],v[104:107],v[16:19],v[168:171]
v_add_u32 v232,24576,v232
ds_read_b64_tr_b16 v[128:129],v232 offset:16384
v_mfma_f32_16x16x32_bf16 v[172:175],v[104:107],v[20:23],v[172:175]
ds_read_b64_tr_b16 v[130:131],v232 offset:17408
s_waitcnt lgkmcnt(12)
v_mfma_f32_16x16x32_bf16 v[176:179],v[108:111],v[16:19],v[176:179]
v_add_u32 v233,24576,v233
ds_read_b64_tr_b16 v[100:101],v233 offset:16384
v_mfma_f32_16x16x32_bf16 v[180:183],v[108:111],v[20:23],v[180:183]
ds_read_b64_tr_b16 v[102:103],v233 offset:17408
s_waitcnt lgkmcnt(12)
v_mfma_f32_16x16x32_bf16 v[184:187],v[112:115],v[16:19],v[184:187]
v_add_u32 v234,24576,v234
ds_read_b64_tr_b16 v[104:105],v234 offset:16384
v_mfma_f32_16x16x32_bf16 v[188:191],v[112:115],v[20:23],v[188:191]
ds_read_b64_tr_b16 v[106:107],v234 offset:17408
s_waitcnt lgkmcnt(12)
v_mfma_f32_16x16x32_bf16 v[192:195],v[116:119],v[16:19],v[192:195]
ds_read_b64_tr_b16 v[108:109],v235 offset:16384
v_mfma_f32_16x16x32_bf16 v[196:199],v[116:119],v[20:23],v[196:199]
ds_read_b64_tr_b16 v[110:111],v235 offset:17408
s_waitcnt lgkmcnt(12)
s_waitcnt lgkmcnt(10)
v_mfma_f32_16x16x32_bf16 v[244:247],v[240:243],v[4:7],v[244:247]
v_mfma_f32_16x16x32_bf16 v[248:251],v[4:7],v[4:7],v[248:251]
v_mfma_f32_16x16x32_bf16 v[144:147],v[120:123],v[0:3],v[144:147]
ds_read_b64_tr_b16 v[112:113],v236 offset:16384
v_mfma_f32_16x16x32_bf16 v[148:151],v[120:123],v[4:7],v[148:151]
ds_read_b64_tr_b16 v[114:115],v236 offset:17408
s_waitcnt lgkmcnt(10)
v_mfma_f32_16x16x32_bf16 v[152:155],v[124:127],v[0:3],v[152:155]
s_barrier
ds_read_b128 v[8:11],v254 offset:20480
ds_read_b128 v[12:15],v254 offset:22528
v_add_u32 v235,24576,v235
ds_read_b64_tr_b16 v[116:117],v235 offset:8192
v_mfma_f32_16x16x32_bf16 v[156:159],v[124:127],v[4:7],v[156:159]
ds_read_b64_tr_b16 v[118:119],v235 offset:9216
s_waitcnt lgkmcnt(12)
v_mfma_f32_16x16x32_bf16 v[160:163],v[128:131],v[0:3],v[160:163]
v_add_u32 v236,24576,v236
ds_read_b64_tr_b16 v[120:121],v236 offset:8192
v_mfma_f32_16x16x32_bf16 v[164:167],v[128:131],v[4:7],v[164:167]
ds_read_b64_tr_b16 v[122:123],v236 offset:9216
s_waitcnt lgkmcnt(12)
v_mfma_f32_16x16x32_bf16 v[168:171],v[100:103],v[0:3],v[168:171]
v_add_u32 v232,24576,v232
ds_read_b64_tr_b16 v[124:125],v232 offset:16384
v_mfma_f32_16x16x32_bf16 v[172:175],v[100:103],v[4:7],v[172:175]
ds_read_b64_tr_b16 v[126:127],v232 offset:17408
s_waitcnt lgkmcnt(12)
v_mfma_f32_16x16x32_bf16 v[176:179],v[104:107],v[0:3],v[176:179]
v_add_u32 v233,24576,v233
ds_read_b64_tr_b16 v[128:129],v233 offset:16384
v_mfma_f32_16x16x32_bf16 v[180:183],v[104:107],v[4:7],v[180:183]
ds_read_b64_tr_b16 v[130:131],v233 offset:17408
s_waitcnt lgkmcnt(12)
v_mfma_f32_16x16x32_bf16 v[184:187],v[108:111],v[0:3],v[184:187]
v_add_u32 v234,24576,v234
ds_read_b64_tr_b16 v[100:101],v234 offset:16384
v_mfma_f32_16x16x32_bf16 v[188:191],v[108:111],v[4:7],v[188:191]
ds_read_b64_tr_b16 v[102:103],v234 offset:17408
s_waitcnt lgkmcnt(12)
v_mfma_f32_16x16x32_bf16 v[192:195],v[112:115],v[0:3],v[192:195]
ds_read_b64_tr_b16 v[104:105],v235 offset:16384
v_mfma_f32_16x16x32_bf16 v[196:199],v[112:115],v[4:7],v[196:199]
ds_read_b64_tr_b16 v[106:107],v235 offset:17408
s_waitcnt lgkmcnt(12)
s_waitcnt lgkmcnt(10)
v_mfma_f32_16x16x32_bf16 v[244:247],v[240:243],v[12:15],v[244:247]
v_mfma_f32_16x16x32_bf16 v[248:251],v[12:15],v[12:15],v[248:251]
v_mfma_f32_16x16x32_bf16 v[144:147],v[116:119],v[8:11],v[144:147]
ds_read_b64_tr_b16 v[108:109],v236 offset:16384
v_mfma_f32_16x16x32_bf16 v[148:151],v[116:119],v[12:15],v[148:151]
ds_read_b64_tr_b16 v[110:111],v236 offset:17408
s_waitcnt lgkmcnt(10)
v_mfma_f32_16x16x32_bf16 v[152:155],v[120:123],v[8:11],v[152:155]
s_barrier
ds_read_b128 v[16:19],v255 offset:20480
ds_read_b128 v[20:23],v255 offset:22528
v_subrev_u32 v235,98304,v235
ds_read_b64_tr_b16 v[112:113],v235 offset:8192
v_mfma_f32_16x16x32_bf16 v[156:159],v[120:123],v[12:15],v[156:159]
ds_read_b64_tr_b16 v[114:115],v235 offset:9216
s_waitcnt lgkmcnt(12)
v_mfma_f32_16x16x32_bf16 v[160:163],v[124:127],v[8:11],v[160:163]
v_subrev_u32 v236,98304,v236
ds_read_b64_tr_b16 v[116:117],v236 offset:8192
v_mfma_f32_16x16x32_bf16 v[164:167],v[124:127],v[12:15],v[164:167]
ds_read_b64_tr_b16 v[118:119],v236 offset:9216
s_waitcnt lgkmcnt(12)
v_mfma_f32_16x16x32_bf16 v[168:171],v[128:131],v[8:11],v[168:171]
v_subrev_u32 v232,98304,v232
ds_read_b64_tr_b16 v[120:121],v232 offset:16384
v_mfma_f32_16x16x32_bf16 v[172:175],v[128:131],v[12:15],v[172:175]
ds_read_b64_tr_b16 v[122:123],v232 offset:17408
s_waitcnt lgkmcnt(12)
v_mfma_f32_16x16x32_bf16 v[176:179],v[100:103],v[8:11],v[176:179]
v_subrev_u32 v233,98304,v233
ds_read_b64_tr_b16 v[124:125],v233 offset:16384
v_mfma_f32_16x16x32_bf16 v[180:183],v[100:103],v[12:15],v[180:183]
ds_read_b64_tr_b16 v[126:127],v233 offset:17408
s_waitcnt lgkmcnt(12)
v_mfma_f32_16x16x32_bf16 v[184:187],v[104:107],v[8:11],v[184:187]
v_subrev_u32 v234,98304,v234
ds_read_b64_tr_b16 v[128:129],v234 offset:16384
v_mfma_f32_16x16x32_bf16 v[188:191],v[104:107],v[12:15],v[188:191]
ds_read_b64_tr_b16 v[130:131],v234 offset:17408
s_waitcnt lgkmcnt(12)
v_mfma_f32_16x16x32_bf16 v[192:195],v[108:111],v[8:11],v[192:195]
ds_read_b64_tr_b16 v[100:101],v235 offset:16384
v_mfma_f32_16x16x32_bf16 v[196:199],v[108:111],v[12:15],v[196:199]
ds_read_b64_tr_b16 v[102:103],v235 offset:17408
s_waitcnt lgkmcnt(12)
s_waitcnt lgkmcnt(10)
v_mfma_f32_16x16x32_bf16 v[244:247],v[240:243],v[20:23],v[244:247]
v_mfma_f32_16x16x32_bf16 v[248:251],v[20:23],v[20:23],v[248:251]
v_mfma_f32_16x16x32_bf16 v[144:147],v[112:115],v[16:19],v[144:147]
ds_read_b64_tr_b16 v[104:105],v236 offset:16384
v_mfma_f32_16x16x32_bf16 v[148:151],v[112:115],v[20:23],v[148:151]
ds_read_b64_tr_b16 v[106:107],v236 offset:17408
s_waitcnt lgkmcnt(10)
v_mfma_f32_16x16x32_bf16 v[152:155],v[116:119],v[16:19],v[152:155]
s_barrier
ds_read_b128 v[0:3],v254 offset:0
ds_read_b128 v[4:7],v254 offset:2048
v_add_u32 v235,24576,v235
ds_read_b64_tr_b16 v[108:109],v235 offset:8192
v_mfma_f32_16x16x32_bf16 v[156:159],v[116:119],v[20:23],v[156:159]
ds_read_b64_tr_b16 v[110:111],v235 offset:9216
s_waitcnt lgkmcnt(12)
v_mfma_f32_16x16x32_bf16 v[160:163],v[120:123],v[16:19],v[160:163]
v_add_u32 v236,24576,v236
ds_read_b64_tr_b16 v[112:113],v236 offset:8192
v_mfma_f32_16x16x32_bf16 v[164:167],v[120:123],v[20:23],v[164:167]
ds_read_b64_tr_b16 v[114:115],v236 offset:9216
s_waitcnt lgkmcnt(12)
v_mfma_f32_16x16x32_bf16 v[168:171],v[124:127],v[16:19],v[168:171]
v_add_u32 v232,24576,v232
ds_read_b64_tr_b16 v[116:117],v232 offset:16384
v_mfma_f32_16x16x32_bf16 v[172:175],v[124:127],v[20:23],v[172:175]
ds_read_b64_tr_b16 v[118:119],v232 offset:17408
s_waitcnt lgkmcnt(12)
v_mfma_f32_16x16x32_bf16 v[176:179],v[128:131],v[16:19],v[176:179]
v_add_u32 v233,24576,v233
ds_read_b64_tr_b16 v[120:121],v233 offset:16384
v_mfma_f32_16x16x32_bf16 v[180:183],v[128:131],v[20:23],v[180:183]
ds_read_b64_tr_b16 v[122:123],v233 offset:17408
s_waitcnt lgkmcnt(12)
v_mfma_f32_16x16x32_bf16 v[184:187],v[100:103],v[16:19],v[184:187]
v_add_u32 v234,24576,v234
ds_read_b64_tr_b16 v[124:125],v234 offset:16384
v_mfma_f32_16x16x32_bf16 v[188:191],v[100:103],v[20:23],v[188:191]
ds_read_b64_tr_b16 v[126:127],v234 offset:17408
s_waitcnt lgkmcnt(12)
v_mfma_f32_16x16x32_bf16 v[192:195],v[104:107],v[16:19],v[192:195]
ds_read_b64_tr_b16 v[128:129],v235 offset:16384
v_mfma_f32_16x16x32_bf16 v[196:199],v[104:107],v[20:23],v[196:199]
ds_read_b64_tr_b16 v[130:131],v235 offset:17408
s_waitcnt lgkmcnt(12)
s_waitcnt lgkmcnt(10)
v_mfma_f32_16x16x32_bf16 v[244:247],v[240:243],v[4:7],v[244:247]
v_mfma_f32_16x16x32_bf16 v[248:251],v[4:7],v[4:7],v[248:251]
v_mfma_f32_16x16x32_bf16 v[144:147],v[108:111],v[0:3],v[144:147]
ds_read_b64_tr_b16 v[100:101],v236 offset:16384
v_mfma_f32_16x16x32_bf16 v[148:151],v[108:111],v[4:7],v[148:151]
ds_read_b64_tr_b16 v[102:103],v236 offset:17408
s_waitcnt lgkmcnt(10)
v_mfma_f32_16x16x32_bf16 v[152:155],v[112:115],v[0:3],v[152:155]
s_barrier
ds_read_b128 v[8:11],v255 offset:0
ds_read_b128 v[12:15],v255 offset:2048
v_add_u32 v235,24576,v235
ds_read_b64_tr_b16 v[104:105],v235 offset:8192
v_mfma_f32_16x16x32_bf16 v[156:159],v[112:115],v[4:7],v[156:159]
ds_read_b64_tr_b16 v[106:107],v235 offset:9216
s_waitcnt lgkmcnt(12)
v_mfma_f32_16x16x32_bf16 v[160:163],v[116:119],v[0:3],v[160:163]
v_add_u32 v236,24576,v236
ds_read_b64_tr_b16 v[108:109],v236 offset:8192
v_mfma_f32_16x16x32_bf16 v[164:167],v[116:119],v[4:7],v[164:167]
ds_read_b64_tr_b16 v[110:111],v236 offset:9216
s_waitcnt lgkmcnt(12)
v_mfma_f32_16x16x32_bf16 v[168:171],v[120:123],v[0:3],v[168:171]
v_add_u32 v232,24576,v232
ds_read_b64_tr_b16 v[112:113],v232 offset:16384
v_mfma_f32_16x16x32_bf16 v[172:175],v[120:123],v[4:7],v[172:175]
ds_read_b64_tr_b16 v[114:115],v232 offset:17408
s_waitcnt lgkmcnt(12)
v_mfma_f32_16x16x32_bf16 v[176:179],v[124:127],v[0:3],v[176:179]
v_add_u32 v233,24576,v233
ds_read_b64_tr_b16 v[116:117],v233 offset:16384
v_mfma_f32_16x16x32_bf16 v[180:183],v[124:127],v[4:7],v[180:183]
ds_read_b64_tr_b16 v[118:119],v233 offset:17408
s_waitcnt lgkmcnt(12)
v_mfma_f32_16x16x32_bf16 v[184:187],v[128:131],v[0:3],v[184:187]
v_add_u32 v234,24576,v234
ds_read_b64_tr_b16 v[120:121],v234 offset:16384
v_mfma_f32_16x16x32_bf16 v[188:191],v[128:131],v[4:7],v[188:191]
ds_read_b64_tr_b16 v[122:123],v234 offset:17408
s_waitcnt lgkmcnt(12)
v_mfma_f32_16x16x32_bf16 v[192:195],v[100:103],v[0:3],v[192:195]
ds_read_b64_tr_b16 v[124:125],v235 offset:16384
v_mfma_f32_16x16x32_bf16 v[196:199],v[100:103],v[4:7],v[196:199]
ds_read_b64_tr_b16 v[126:127],v235 offset:17408
s_waitcnt lgkmcnt(12)
s_waitcnt lgkmcnt(10)
v_mfma_f32_16x16x32_bf16 v[244:247],v[240:243],v[12:15],v[244:247]
v_mfma_f32_16x16x32_bf16 v[248:251],v[12:15],v[12:15],v[248:251]
v_mfma_f32_16x16x32_bf16 v[144:147],v[104:107],v[8:11],v[144:147]
ds_read_b64_tr_b16 v[128:129],v236 offset:16384
v_mfma_f32_16x16x32_bf16 v[148:151],v[104:107],v[12:15],v[148:151]
ds_read_b64_tr_b16 v[130:131],v236 offset:17408
s_waitcnt lgkmcnt(10)
v_mfma_f32_16x16x32_bf16 v[152:155],v[108:111],v[8:11],v[152:155]
s_barrier
ds_read_b128 v[16:19],v254 offset:10240
ds_read_b128 v[20:23],v254 offset:12288
v_add_u32 v235,24576,v235
ds_read_b64_tr_b16 v[100:101],v235 offset:8192
v_mfma_f32_16x16x32_bf16 v[156:159],v[108:111],v[12:15],v[156:159]
ds_read_b64_tr_b16 v[102:103],v235 offset:9216
s_waitcnt lgkmcnt(12)
v_mfma_f32_16x16x32_bf16 v[160:163],v[112:115],v[8:11],v[160:163]
v_add_u32 v236,24576,v236
ds_read_b64_tr_b16 v[104:105],v236 offset:8192
v_mfma_f32_16x16x32_bf16 v[164:167],v[112:115],v[12:15],v[164:167]
ds_read_b64_tr_b16 v[106:107],v236 offset:9216
s_waitcnt lgkmcnt(12)
v_mfma_f32_16x16x32_bf16 v[168:171],v[116:119],v[8:11],v[168:171]
v_add_u32 v232,24576,v232
ds_read_b64_tr_b16 v[108:109],v232 offset:16384
v_mfma_f32_16x16x32_bf16 v[172:175],v[116:119],v[12:15],v[172:175]
ds_read_b64_tr_b16 v[110:111],v232 offset:17408
s_waitcnt lgkmcnt(12)
v_mfma_f32_16x16x32_bf16 v[176:179],v[120:123],v[8:11],v[176:179]
v_add_u32 v233,24576,v233
ds_read_b64_tr_b16 v[112:113],v233 offset:16384
v_mfma_f32_16x16x32_bf16 v[180:183],v[120:123],v[12:15],v[180:183]
ds_read_b64_tr_b16 v[114:115],v233 offset:17408
s_waitcnt lgkmcnt(12)
v_mfma_f32_16x16x32_bf16 v[184:187],v[124:127],v[8:11],v[184:187]
v_add_u32 v234,24576,v234
ds_read_b64_tr_b16 v[116:117],v234 offset:16384
v_mfma_f32_16x16x32_bf16 v[188:191],v[124:127],v[12:15],v[188:191]
ds_read_b64_tr_b16 v[118:119],v234 offset:17408
s_waitcnt lgkmcnt(12)
v_mfma_f32_16x16x32_bf16 v[192:195],v[128:131],v[8:11],v[192:195]
ds_read_b64_tr_b16 v[120:121],v235 offset:16384
v_mfma_f32_16x16x32_bf16 v[196:199],v[128:131],v[12:15],v[196:199]
ds_read_b64_tr_b16 v[122:123],v235 offset:17408
s_waitcnt lgkmcnt(12)
s_waitcnt lgkmcnt(10)
v_mfma_f32_16x16x32_bf16 v[244:247],v[240:243],v[20:23],v[244:247]
v_mfma_f32_16x16x32_bf16 v[248:251],v[20:23],v[20:23],v[248:251]
v_mfma_f32_16x16x32_bf16 v[144:147],v[100:103],v[16:19],v[144:147]
ds_read_b64_tr_b16 v[124:125],v236 offset:16384
v_mfma_f32_16x16x32_bf16 v[148:151],v[100:103],v[20:23],v[148:151]
ds_read_b64_tr_b16 v[126:127],v236 offset:17408
s_waitcnt lgkmcnt(10)
v_mfma_f32_16x16x32_bf16 v[152:155],v[104:107],v[16:19],v[152:155]
s_barrier
ds_read_b128 v[0:3],v255 offset:10240
ds_read_b128 v[4:7],v255 offset:12288
v_add_u32 v235,24576,v235
ds_read_b64_tr_b16 v[128:129],v235 offset:8192
v_mfma_f32_16x16x32_bf16 v[156:159],v[104:107],v[20:23],v[156:159]
ds_read_b64_tr_b16 v[130:131],v235 offset:9216
s_waitcnt lgkmcnt(12)
v_mfma_f32_16x16x32_bf16 v[160:163],v[108:111],v[16:19],v[160:163]
v_add_u32 v236,24576,v236
ds_read_b64_tr_b16 v[100:101],v236 offset:8192
v_mfma_f32_16x16x32_bf16 v[164:167],v[108:111],v[20:23],v[164:167]
ds_read_b64_tr_b16 v[102:103],v236 offset:9216
s_waitcnt lgkmcnt(12)
v_mfma_f32_16x16x32_bf16 v[168:171],v[112:115],v[16:19],v[168:171]
v_add_u32 v232,24576,v232
ds_read_b64_tr_b16 v[104:105],v232 offset:16384
v_mfma_f32_16x16x32_bf16 v[172:175],v[112:115],v[20:23],v[172:175]
ds_read_b64_tr_b16 v[106:107],v232 offset:17408
s_waitcnt lgkmcnt(12)
v_mfma_f32_16x16x32_bf16 v[176:179],v[116:119],v[16:19],v[176:179]
v_add_u32 v233,24576,v233
ds_read_b64_tr_b16 v[108:109],v233 offset:16384
v_mfma_f32_16x16x32_bf16 v[180:183],v[116:119],v[20:23],v[180:183]
ds_read_b64_tr_b16 v[110:111],v233 offset:17408
s_waitcnt lgkmcnt(12)
v_mfma_f32_16x16x32_bf16 v[184:187],v[120:123],v[16:19],v[184:187]
v_add_u32 v234,24576,v234
ds_read_b64_tr_b16 v[112:113],v234 offset:16384
v_mfma_f32_16x16x32_bf16 v[188:191],v[120:123],v[20:23],v[188:191]
ds_read_b64_tr_b16 v[114:115],v234 offset:17408
s_waitcnt lgkmcnt(12)
v_mfma_f32_16x16x32_bf16 v[192:195],v[124:127],v[16:19],v[192:195]
ds_read_b64_tr_b16 v[116:117],v235 offset:16384
v_mfma_f32_16x16x32_bf16 v[196:199],v[124:127],v[20:23],v[196:199]
ds_read_b64_tr_b16 v[118:119],v235 offset:17408
s_waitcnt lgkmcnt(12)
s_waitcnt lgkmcnt(10)
v_mfma_f32_16x16x32_bf16 v[244:247],v[240:243],v[4:7],v[244:247]
v_mfma_f32_16x16x32_bf16 v[248:251],v[4:7],v[4:7],v[248:251]
v_mfma_f32_16x16x32_bf16 v[144:147],v[128:131],v[0:3],v[144:147]
ds_read_b64_tr_b16 v[120:121],v236 offset:16384
v_mfma_f32_16x16x32_bf16 v[148:151],v[128:131],v[4:7],v[148:151]
ds_read_b64_tr_b16 v[122:123],v236 offset:17408
s_waitcnt lgkmcnt(10)
v_mfma_f32_16x16x32_bf16 v[152:155],v[100:103],v[0:3],v[152:155]
s_barrier
ds_read_b128 v[8:11],v254 offset:20480
ds_read_b128 v[12:15],v254 offset:22528
v_subrev_u32 v235,98304,v235
ds_read_b64_tr_b16 v[124:125],v235 offset:8192
v_mfma_f32_16x16x32_bf16 v[156:159],v[100:103],v[4:7],v[156:159]
ds_read_b64_tr_b16 v[126:127],v235 offset:9216
s_waitcnt lgkmcnt(12)
v_mfma_f32_16x16x32_bf16 v[160:163],v[104:107],v[0:3],v[160:163]
v_subrev_u32 v236,98304,v236
ds_read_b64_tr_b16 v[128:129],v236 offset:8192
v_mfma_f32_16x16x32_bf16 v[164:167],v[104:107],v[4:7],v[164:167]
ds_read_b64_tr_b16 v[130:131],v236 offset:9216
s_waitcnt lgkmcnt(12)
v_mfma_f32_16x16x32_bf16 v[168:171],v[108:111],v[0:3],v[168:171]
v_subrev_u32 v232,98304,v232
ds_read_b64_tr_b16 v[100:101],v232 offset:16384
v_mfma_f32_16x16x32_bf16 v[172:175],v[108:111],v[4:7],v[172:175]
ds_read_b64_tr_b16 v[102:103],v232 offset:17408
s_waitcnt lgkmcnt(12)
v_mfma_f32_16x16x32_bf16 v[176:179],v[112:115],v[0:3],v[176:179]
v_subrev_u32 v233,98304,v233
ds_read_b64_tr_b16 v[104:105],v233 offset:16384
v_mfma_f32_16x16x32_bf16 v[180:183],v[112:115],v[4:7],v[180:183]
ds_read_b64_tr_b16 v[106:107],v233 offset:17408
s_waitcnt lgkmcnt(12)
v_mfma_f32_16x16x32_bf16 v[184:187],v[116:119],v[0:3],v[184:187]
v_subrev_u32 v234,98304,v234
ds_read_b64_tr_b16 v[108:109],v234 offset:16384
v_mfma_f32_16x16x32_bf16 v[188:191],v[116:119],v[4:7],v[188:191]
ds_read_b64_tr_b16 v[110:111],v234 offset:17408
s_waitcnt lgkmcnt(12)
v_mfma_f32_16x16x32_bf16 v[192:195],v[120:123],v[0:3],v[192:195]
ds_read_b64_tr_b16 v[112:113],v235 offset:16384
v_mfma_f32_16x16x32_bf16 v[196:199],v[120:123],v[4:7],v[196:199]
ds_read_b64_tr_b16 v[114:115],v235 offset:17408
s_waitcnt lgkmcnt(12)
s_waitcnt lgkmcnt(10)
v_mfma_f32_16x16x32_bf16 v[244:247],v[240:243],v[12:15],v[244:247]
v_mfma_f32_16x16x32_bf16 v[248:251],v[12:15],v[12:15],v[248:251]
v_mfma_f32_16x16x32_bf16 v[144:147],v[124:127],v[8:11],v[144:147]
ds_read_b64_tr_b16 v[116:117],v236 offset:16384
v_mfma_f32_16x16x32_bf16 v[148:151],v[124:127],v[12:15],v[148:151]
ds_read_b64_tr_b16 v[118:119],v236 offset:17408
s_waitcnt lgkmcnt(10)
v_mfma_f32_16x16x32_bf16 v[152:155],v[128:131],v[8:11],v[152:155]
s_barrier
ds_read_b128 v[16:19],v255 offset:20480
ds_read_b128 v[20:23],v255 offset:22528
v_add_u32 v235,24576,v235
ds_read_b64_tr_b16 v[120:121],v235 offset:8192
v_mfma_f32_16x16x32_bf16 v[156:159],v[128:131],v[12:15],v[156:159]
ds_read_b64_tr_b16 v[122:123],v235 offset:9216
s_waitcnt lgkmcnt(12)
v_mfma_f32_16x16x32_bf16 v[160:163],v[100:103],v[8:11],v[160:163]
v_add_u32 v236,24576,v236
ds_read_b64_tr_b16 v[124:125],v236 offset:8192
v_mfma_f32_16x16x32_bf16 v[164:167],v[100:103],v[12:15],v[164:167]
ds_read_b64_tr_b16 v[126:127],v236 offset:9216
s_waitcnt lgkmcnt(12)
v_mfma_f32_16x16x32_bf16 v[168:171],v[104:107],v[8:11],v[168:171]
v_add_u32 v232,24576,v232
ds_read_b64_tr_b16 v[128:129],v232 offset:16384
v_mfma_f32_16x16x32_bf16 v[172:175],v[104:107],v[12:15],v[172:175]
ds_read_b64_tr_b16 v[130:131],v232 offset:17408
s_waitcnt lgkmcnt(12)
v_mfma_f32_16x16x32_bf16 v[176:179],v[108:111],v[8:11],v[176:179]
v_add_u32 v233,24576,v233
ds_read_b64_tr_b16 v[100:101],v233 offset:16384
v_mfma_f32_16x16x32_bf16 v[180:183],v[108:111],v[12:15],v[180:183]
ds_read_b64_tr_b16 v[102:103],v233 offset:17408
s_waitcnt lgkmcnt(12)
v_mfma_f32_16x16x32_bf16 v[184:187],v[112:115],v[8:11],v[184:187]
v_add_u32 v234,24576,v234
ds_read_b64_tr_b16 v[104:105],v234 offset:16384
v_mfma_f32_16x16x32_bf16 v[188:191],v[112:115],v[12:15],v[188:191]
ds_read_b64_tr_b16 v[106:107],v234 offset:17408
s_waitcnt lgkmcnt(12)
v_mfma_f32_16x16x32_bf16 v[192:195],v[116:119],v[8:11],v[192:195]
ds_read_b64_tr_b16 v[108:109],v235 offset:16384
v_mfma_f32_16x16x32_bf16 v[196:199],v[116:119],v[12:15],v[196:199]
ds_read_b64_tr_b16 v[110:111],v235 offset:17408
s_waitcnt lgkmcnt(12)
s_waitcnt lgkmcnt(10)
v_mfma_f32_16x16x32_bf16 v[244:247],v[240:243],v[20:23],v[244:247]
v_mfma_f32_16x16x32_bf16 v[248:251],v[20:23],v[20:23],v[248:251]
v_mfma_f32_16x16x32_bf16 v[144:147],v[120:123],v[16:19],v[144:147]
ds_read_b64_tr_b16 v[112:113],v236 offset:16384
v_mfma_f32_16x16x32_bf16 v[148:151],v[120:123],v[20:23],v[148:151]
ds_read_b64_tr_b16 v[114:115],v236 offset:17408
s_waitcnt lgkmcnt(10)
v_mfma_f32_16x16x32_bf16 v[152:155],v[124:127],v[16:19],v[152:155]
s_barrier
ds_read_b128 v[0:3],v254 offset:0
ds_read_b128 v[4:7],v254 offset:2048
v_add_u32 v235,24576,v235
ds_read_b64_tr_b16 v[116:117],v235 offset:8192
v_mfma_f32_16x16x32_bf16 v[156:159],v[124:127],v[20:23],v[156:159]
ds_read_b64_tr_b16 v[118:119],v235 offset:9216
s_waitcnt lgkmcnt(12)
v_mfma_f32_16x16x32_bf16 v[160:163],v[128:131],v[16:19],v[160:163]
v_add_u32 v236,24576,v236
ds_read_b64_tr_b16 v[120:121],v236 offset:8192
v_mfma_f32_16x16x32_bf16 v[164:167],v[128:131],v[20:23],v[164:167]
ds_read_b64_tr_b16 v[122:123],v236 offset:9216
s_waitcnt lgkmcnt(12)
v_mfma_f32_16x16x32_bf16 v[168:171],v[100:103],v[16:19],v[168:171]
v_add_u32 v232,24576,v232
ds_read_b64_tr_b16 v[124:125],v232 offset:16384
v_mfma_f32_16x16x32_bf16 v[172:175],v[100:103],v[20:23],v[172:175]
ds_read_b64_tr_b16 v[126:127],v232 offset:17408
s_waitcnt lgkmcnt(12)
v_mfma_f32_16x16x32_bf16 v[176:179],v[104:107],v[16:19],v[176:179]
v_add_u32 v233,24576,v233
ds_read_b64_tr_b16 v[128:129],v233 offset:16384
v_mfma_f32_16x16x32_bf16 v[180:183],v[104:107],v[20:23],v[180:183]
ds_read_b64_tr_b16 v[130:131],v233 offset:17408
s_waitcnt lgkmcnt(12)
v_mfma_f32_16x16x32_bf16 v[184:187],v[108:111],v[16:19],v[184:187]
v_add_u32 v234,24576,v234
ds_read_b64_tr_b16 v[100:101],v234 offset:16384
v_mfma_f32_16x16x32_bf16 v[188:191],v[108:111],v[20:23],v[188:191]
ds_read_b64_tr_b16 v[102:103],v234 offset:17408
s_waitcnt lgkmcnt(12)
v_mfma_f32_16x16x32_bf16 v[192:195],v[112:115],v[16:19],v[192:195]
ds_read_b64_tr_b16 v[104:105],v235 offset:16384
v_mfma_f32_16x16x32_bf16 v[196:199],v[112:115],v[20:23],v[196:199]
ds_read_b64_tr_b16 v[106:107],v235 offset:17408
s_waitcnt lgkmcnt(12)
s_waitcnt lgkmcnt(10)
v_mfma_f32_16x16x32_bf16 v[244:247],v[240:243],v[4:7],v[244:247]
v_mfma_f32_16x16x32_bf16 v[248:251],v[4:7],v[4:7],v[248:251]
v_mfma_f32_16x16x32_bf16 v[144:147],v[116:119],v[0:3],v[144:147]
ds_read_b64_tr_b16 v[108:109],v236 offset:16384
v_mfma_f32_16x16x32_bf16 v[148:151],v[116:119],v[4:7],v[148:151]
ds_read_b64_tr_b16 v[110:111],v236 offset:17408
s_waitcnt lgkmcnt(10)
v_mfma_f32_16x16x32_bf16 v[152:155],v[120:123],v[0:3],v[152:155]
s_barrier
ds_read_b128 v[8:11],v255 offset:0
ds_read_b128 v[12:15],v255 offset:2048
v_add_u32 v235,24576,v235
ds_read_b64_tr_b16 v[112:113],v235 offset:8192
v_mfma_f32_16x16x32_bf16 v[156:159],v[120:123],v[4:7],v[156:159]
ds_read_b64_tr_b16 v[114:115],v235 offset:9216
s_waitcnt lgkmcnt(12)
v_mfma_f32_16x16x32_bf16 v[160:163],v[124:127],v[0:3],v[160:163]
v_add_u32 v236,24576,v236
ds_read_b64_tr_b16 v[116:117],v236 offset:8192
v_mfma_f32_16x16x32_bf16 v[164:167],v[124:127],v[4:7],v[164:167]
ds_read_b64_tr_b16 v[118:119],v236 offset:9216
s_waitcnt lgkmcnt(12)
v_mfma_f32_16x16x32_bf16 v[168:171],v[128:131],v[0:3],v[168:171]
v_add_u32 v232,24576,v232
ds_read_b64_tr_b16 v[120:121],v232 offset:16384
v_mfma_f32_16x16x32_bf16 v[172:175],v[128:131],v[4:7],v[172:175]
ds_read_b64_tr_b16 v[122:123],v232 offset:17408
s_waitcnt lgkmcnt(12)
v_mfma_f32_16x16x32_bf16 v[176:179],v[100:103],v[0:3],v[176:179]
v_add_u32 v233,24576,v233
ds_read_b64_tr_b16 v[124:125],v233 offset:16384
v_mfma_f32_16x16x32_bf16 v[180:183],v[100:103],v[4:7],v[180:183]
ds_read_b64_tr_b16 v[126:127],v233 offset:17408
s_waitcnt lgkmcnt(12)
v_mfma_f32_16x16x32_bf16 v[184:187],v[104:107],v[0:3],v[184:187]
v_add_u32 v234,24576,v234
ds_read_b64_tr_b16 v[128:129],v234 offset:16384
v_mfma_f32_16x16x32_bf16 v[188:191],v[104:107],v[4:7],v[188:191]
ds_read_b64_tr_b16 v[130:131],v234 offset:17408
s_waitcnt lgkmcnt(12)
v_mfma_f32_16x16x32_bf16 v[192:195],v[108:111],v[0:3],v[192:195]
ds_read_b64_tr_b16 v[100:101],v235 offset:16384
v_mfma_f32_16x16x32_bf16 v[196:199],v[108:111],v[4:7],v[196:199]
ds_read_b64_tr_b16 v[102:103],v235 offset:17408
s_waitcnt lgkmcnt(12)
s_waitcnt lgkmcnt(10)
v_mfma_f32_16x16x32_bf16 v[244:247],v[240:243],v[12:15],v[244:247]
v_mfma_f32_16x16x32_bf16 v[248:251],v[12:15],v[12:15],v[248:251]
v_mfma_f32_16x16x32_bf16 v[144:147],v[112:115],v[8:11],v[144:147]
ds_read_b64_tr_b16 v[104:105],v236 offset:16384
v_mfma_f32_16x16x32_bf16 v[148:151],v[112:115],v[12:15],v[148:151]
ds_read_b64_tr_b16 v[106:107],v236 offset:17408
s_waitcnt lgkmcnt(10)
v_mfma_f32_16x16x32_bf16 v[152:155],v[116:119],v[8:11],v[152:155]
s_barrier
ds_read_b128 v[16:19],v254 offset:10240
ds_read_b128 v[20:23],v254 offset:12288
v_add_u32 v235,24576,v235
ds_read_b64_tr_b16 v[108:109],v235 offset:8192
v_mfma_f32_16x16x32_bf16 v[156:159],v[116:119],v[12:15],v[156:159]
ds_read_b64_tr_b16 v[110:111],v235 offset:9216
s_waitcnt lgkmcnt(12)
v_mfma_f32_16x16x32_bf16 v[160:163],v[120:123],v[8:11],v[160:163]
v_add_u32 v236,24576,v236
ds_read_b64_tr_b16 v[112:113],v236 offset:8192
v_mfma_f32_16x16x32_bf16 v[164:167],v[120:123],v[12:15],v[164:167]
ds_read_b64_tr_b16 v[114:115],v236 offset:9216
s_waitcnt lgkmcnt(12)
v_mfma_f32_16x16x32_bf16 v[168:171],v[124:127],v[8:11],v[168:171]
v_add_u32 v232,24576,v232
ds_read_b64_tr_b16 v[116:117],v232 offset:16384
v_mfma_f32_16x16x32_bf16 v[172:175],v[124:127],v[12:15],v[172:175]
ds_read_b64_tr_b16 v[118:119],v232 offset:17408
s_waitcnt lgkmcnt(12)
v_mfma_f32_16x16x32_bf16 v[176:179],v[128:131],v[8:11],v[176:179]
v_add_u32 v233,24576,v233
ds_read_b64_tr_b16 v[120:121],v233 offset:16384
v_mfma_f32_16x16x32_bf16 v[180:183],v[128:131],v[12:15],v[180:183]
ds_read_b64_tr_b16 v[122:123],v233 offset:17408
s_waitcnt lgkmcnt(12)
v_mfma_f32_16x16x32_bf16 v[184:187],v[100:103],v[8:11],v[184:187]
v_add_u32 v234,24576,v234
ds_read_b64_tr_b16 v[124:125],v234 offset:16384
v_mfma_f32_16x16x32_bf16 v[188:191],v[100:103],v[12:15],v[188:191]
ds_read_b64_tr_b16 v[126:127],v234 offset:17408
s_waitcnt lgkmcnt(12)
v_mfma_f32_16x16x32_bf16 v[192:195],v[104:107],v[8:11],v[192:195]
ds_read_b64_tr_b16 v[128:129],v235 offset:16384
v_mfma_f32_16x16x32_bf16 v[196:199],v[104:107],v[12:15],v[196:199]
ds_read_b64_tr_b16 v[130:131],v235 offset:17408
s_waitcnt lgkmcnt(12)
s_waitcnt lgkmcnt(10)
v_mfma_f32_16x16x32_bf16 v[244:247],v[240:243],v[20:23],v[244:247]
v_mfma_f32_16x16x32_bf16 v[248:251],v[20:23],v[20:23],v[248:251]
v_mfma_f32_16x16x32_bf16 v[144:147],v[108:111],v[16:19],v[144:147]
ds_read_b64_tr_b16 v[100:101],v236 offset:16384
v_mfma_f32_16x16x32_bf16 v[148:151],v[108:111],v[20:23],v[148:151]
ds_read_b64_tr_b16 v[102:103],v236 offset:17408
s_waitcnt lgkmcnt(10)
v_mfma_f32_16x16x32_bf16 v[152:155],v[112:115],v[16:19],v[152:155]
s_barrier
ds_read_b128 v[0:3],v255 offset:10240
ds_read_b128 v[4:7],v255 offset:12288
v_subrev_u32 v235,98304,v235
ds_read_b64_tr_b16 v[104:105],v235 offset:8192
v_mfma_f32_16x16x32_bf16 v[156:159],v[112:115],v[20:23],v[156:159]
ds_read_b64_tr_b16 v[106:107],v235 offset:9216
s_waitcnt lgkmcnt(12)
v_mfma_f32_16x16x32_bf16 v[160:163],v[116:119],v[16:19],v[160:163]
v_subrev_u32 v236,98304,v236
ds_read_b64_tr_b16 v[108:109],v236 offset:8192
v_mfma_f32_16x16x32_bf16 v[164:167],v[116:119],v[20:23],v[164:167]
ds_read_b64_tr_b16 v[110:111],v236 offset:9216
s_waitcnt lgkmcnt(12)
v_mfma_f32_16x16x32_bf16 v[168:171],v[120:123],v[16:19],v[168:171]
v_subrev_u32 v232,98304,v232
ds_read_b64_tr_b16 v[112:113],v232 offset:16384
v_mfma_f32_16x16x32_bf16 v[172:175],v[120:123],v[20:23],v[172:175]
ds_read_b64_tr_b16 v[114:115],v232 offset:17408
s_waitcnt lgkmcnt(12)
v_mfma_f32_16x16x32_bf16 v[176:179],v[124:127],v[16:19],v[176:179]
v_subrev_u32 v233,98304,v233
ds_read_b64_tr_b16 v[116:117],v233 offset:16384
v_mfma_f32_16x16x32_bf16 v[180:183],v[124:127],v[20:23],v[180:183]
ds_read_b64_tr_b16 v[118:119],v233 offset:17408
s_waitcnt lgkmcnt(12)
v_mfma_f32_16x16x32_bf16 v[184:187],v[128:131],v[16:19],v[184:187]
v_subrev_u32 v234,98304,v234
ds_read_b64_tr_b16 v[120:121],v234 offset:16384
v_mfma_f32_16x16x32_bf16 v[188:191],v[128:131],v[20:23],v[188:191]
ds_read_b64_tr_b16 v[122:123],v234 offset:17408
s_waitcnt lgkmcnt(12)
v_mfma_f32_16x16x32_bf16 v[192:195],v[100:103],v[16:19],v[192:195]
ds_read_b64_tr_b16 v[124:125],v235 offset:16384
v_mfma_f32_16x16x32_bf16 v[196:199],v[100:103],v[20:23],v[196:199]
ds_read_b64_tr_b16 v[126:127],v235 offset:17408
s_waitcnt lgkmcnt(12)
s_waitcnt lgkmcnt(10)
v_mfma_f32_16x16x32_bf16 v[244:247],v[240:243],v[4:7],v[244:247]
v_mfma_f32_16x16x32_bf16 v[248:251],v[4:7],v[4:7],v[248:251]
v_mfma_f32_16x16x32_bf16 v[144:147],v[104:107],v[0:3],v[144:147]
ds_read_b64_tr_b16 v[128:129],v236 offset:16384
v_mfma_f32_16x16x32_bf16 v[148:151],v[104:107],v[4:7],v[148:151]
ds_read_b64_tr_b16 v[130:131],v236 offset:17408
s_waitcnt lgkmcnt(10)
v_mfma_f32_16x16x32_bf16 v[152:155],v[108:111],v[0:3],v[152:155]
s_barrier
ds_read_b128 v[8:11],v254 offset:20480
ds_read_b128 v[12:15],v254 offset:22528
v_add_u32 v235,24576,v235
ds_read_b64_tr_b16 v[100:101],v235 offset:8192
v_mfma_f32_16x16x32_bf16 v[156:159],v[108:111],v[4:7],v[156:159]
ds_read_b64_tr_b16 v[102:103],v235 offset:9216
s_waitcnt lgkmcnt(12)
v_mfma_f32_16x16x32_bf16 v[160:163],v[112:115],v[0:3],v[160:163]
v_add_u32 v236,24576,v236
ds_read_b64_tr_b16 v[104:105],v236 offset:8192
v_mfma_f32_16x16x32_bf16 v[164:167],v[112:115],v[4:7],v[164:167]
ds_read_b64_tr_b16 v[106:107],v236 offset:9216
s_waitcnt lgkmcnt(12)
v_mfma_f32_16x16x32_bf16 v[168:171],v[116:119],v[0:3],v[168:171]
v_add_u32 v232,24576,v232
ds_read_b64_tr_b16 v[108:109],v232 offset:16384
v_mfma_f32_16x16x32_bf16 v[172:175],v[116:119],v[4:7],v[172:175]
ds_read_b64_tr_b16 v[110:111],v232 offset:17408
s_waitcnt lgkmcnt(12)
v_mfma_f32_16x16x32_bf16 v[176:179],v[120:123],v[0:3],v[176:179]
v_add_u32 v233,24576,v233
ds_read_b64_tr_b16 v[112:113],v233 offset:16384
v_mfma_f32_16x16x32_bf16 v[180:183],v[120:123],v[4:7],v[180:183]
ds_read_b64_tr_b16 v[114:115],v233 offset:17408
s_waitcnt lgkmcnt(12)
v_mfma_f32_16x16x32_bf16 v[184:187],v[124:127],v[0:3],v[184:187]
v_add_u32 v234,24576,v234
ds_read_b64_tr_b16 v[116:117],v234 offset:16384
v_mfma_f32_16x16x32_bf16 v[188:191],v[124:127],v[4:7],v[188:191]
ds_read_b64_tr_b16 v[118:119],v234 offset:17408
s_waitcnt lgkmcnt(12)
v_mfma_f32_16x16x32_bf16 v[192:195],v[128:131],v[0:3],v[192:195]
ds_read_b64_tr_b16 v[120:121],v235 offset:16384
v_mfma_f32_16x16x32_bf16 v[196:199],v[128:131],v[4:7],v[196:199]
ds_read_b64_tr_b16 v[122:123],v235 offset:17408
s_waitcnt lgkmcnt(12)
s_waitcnt lgkmcnt(10)
v_mfma_f32_16x16x32_bf16 v[244:247],v[240:243],v[12:15],v[244:247]
v_mfma_f32_16x16x32_bf16 v[248:251],v[12:15],v[12:15],v[248:251]
v_mfma_f32_16x16x32_bf16 v[144:147],v[100:103],v[8:11],v[144:147]
ds_read_b64_tr_b16 v[124:125],v236 offset:16384
v_mfma_f32_16x16x32_bf16 v[148:151],v[100:103],v[12:15],v[148:151]
ds_read_b64_tr_b16 v[126:127],v236 offset:17408
s_waitcnt lgkmcnt(10)
v_mfma_f32_16x16x32_bf16 v[152:155],v[104:107],v[8:11],v[152:155]
s_barrier
ds_read_b128 v[16:19],v255 offset:20480
ds_read_b128 v[20:23],v255 offset:22528
v_add_u32 v235,24576,v235
ds_read_b64_tr_b16 v[128:129],v235 offset:8192
v_mfma_f32_16x16x32_bf16 v[156:159],v[104:107],v[12:15],v[156:159]
ds_read_b64_tr_b16 v[130:131],v235 offset:9216
s_waitcnt lgkmcnt(12)
v_mfma_f32_16x16x32_bf16 v[160:163],v[108:111],v[8:11],v[160:163]
v_add_u32 v236,24576,v236
ds_read_b64_tr_b16 v[100:101],v236 offset:8192
v_mfma_f32_16x16x32_bf16 v[164:167],v[108:111],v[12:15],v[164:167]
ds_read_b64_tr_b16 v[102:103],v236 offset:9216
s_waitcnt lgkmcnt(12)
v_mfma_f32_16x16x32_bf16 v[168:171],v[112:115],v[8:11],v[168:171]
v_add_u32 v232,24576,v232
ds_read_b64_tr_b16 v[104:105],v232 offset:16384
v_mfma_f32_16x16x32_bf16 v[172:175],v[112:115],v[12:15],v[172:175]
ds_read_b64_tr_b16 v[106:107],v232 offset:17408
s_waitcnt lgkmcnt(12)
v_mfma_f32_16x16x32_bf16 v[176:179],v[116:119],v[8:11],v[176:179]
v_add_u32 v233,24576,v233
ds_read_b64_tr_b16 v[108:109],v233 offset:16384
v_mfma_f32_16x16x32_bf16 v[180:183],v[116:119],v[12:15],v[180:183]
ds_read_b64_tr_b16 v[110:111],v233 offset:17408
s_waitcnt lgkmcnt(12)
v_mfma_f32_16x16x32_bf16 v[184:187],v[120:123],v[8:11],v[184:187]
v_add_u32 v234,24576,v234
ds_read_b64_tr_b16 v[112:113],v234 offset:16384
v_mfma_f32_16x16x32_bf16 v[188:191],v[120:123],v[12:15],v[188:191]
ds_read_b64_tr_b16 v[114:115],v234 offset:17408
s_waitcnt lgkmcnt(12)
v_mfma_f32_16x16x32_bf16 v[192:195],v[124:127],v[8:11],v[192:195]
ds_read_b64_tr_b16 v[116:117],v235 offset:16384
v_mfma_f32_16x16x32_bf16 v[196:199],v[124:127],v[12:15],v[196:199]
ds_read_b64_tr_b16 v[118:119],v235 offset:17408
s_waitcnt lgkmcnt(12)
s_waitcnt lgkmcnt(10)
v_mfma_f32_16x16x32_bf16 v[244:247],v[240:243],v[20:23],v[244:247]
v_mfma_f32_16x16x32_bf16 v[248:251],v[20:23],v[20:23],v[248:251]
v_mfma_f32_16x16x32_bf16 v[144:147],v[128:131],v[16:19],v[144:147]
ds_read_b64_tr_b16 v[120:121],v236 offset:16384
v_mfma_f32_16x16x32_bf16 v[148:151],v[128:131],v[20:23],v[148:151]
ds_read_b64_tr_b16 v[122:123],v236 offset:17408
s_waitcnt lgkmcnt(10)
v_mfma_f32_16x16x32_bf16 v[152:155],v[100:103],v[16:19],v[152:155]
v_mfma_f32_16x16x32_bf16 v[156:159],v[100:103],v[20:23],v[156:159]
s_waitcnt lgkmcnt(8)
v_mfma_f32_16x16x32_bf16 v[160:163],v[104:107],v[16:19],v[160:163]
v_mfma_f32_16x16x32_bf16 v[164:167],v[104:107],v[20:23],v[164:167]
s_waitcnt lgkmcnt(6)
v_mfma_f32_16x16x32_bf16 v[168:171],v[108:111],v[16:19],v[168:171]
v_mfma_f32_16x16x32_bf16 v[172:175],v[108:111],v[20:23],v[172:175]
v_and_b32 v25,3,v59
v_lshrrev_b32 v26,2,v59
v_cmp_eq_u32 s[56:57],1,v25
v_cmp_eq_u32 s[58:59],2,v25
v_cmp_eq_u32 s[60:61],3,v25
v_cmp_eq_u32 s[62:63],v26,v253
s_nop 0
s_waitcnt lgkmcnt(4)
v_mfma_f32_16x16x32_bf16 v[176:179],v[112:115],v[16:19],v[176:179]
v_mfma_f32_16x16x32_bf16 v[180:183],v[112:115],v[20:23],v[180:183]
v_cndmask_b32 v27,v248,v249,s[56:57]
v_cndmask_b32 v27,v27,v250,s[58:59]
v_cndmask_b32 v27,v27,v251,s[60:61]
v_cndmask_b32 v27,0,v27,s[62:63]
v_mov_b32 v28,v27
s_nop 1
v_permlane16_swap_b32 v27,v28
s_nop 0
s_waitcnt lgkmcnt(2)
v_mfma_f32_16x16x32_bf16 v[184:187],v[116:119],v[16:19],v[184:187]
v_mfma_f32_16x16x32_bf16 v[188:191],v[116:119],v[20:23],v[188:191]
v_add_f32 v27,v27,v28
v_mov_b32 v28,v27
s_nop 1
v_permlane32_swap_b32 v27,v28
s_nop 0
v_add_f32 v27,v27,v28
s_mov_b32 s37,987991609
v_mul_f32 v29,s37,v244
s_waitcnt lgkmcnt(0)
v_mfma_f32_16x16x32_bf16 v[192:195],v[120:123],v[16:19],v[192:195]
v_mfma_f32_16x16x32_bf16 v[196:199],v[120:123],v[20:23],v[196:199]
v_mul_f32 v27,s37,v27
v_fma_f32 v27,-v29,v29,v27
v_max_f32 v27,0,v27
v_add_f32 v27,925353388,v27
v_rsq_f32 v31,v27
v_add_u32 v33,128,v56
v_mul_f32 v30,v29,v31
ds_write_b64 v33,v[30:31]
s_cmp_lg_u32 s35,0
s_cbranch_scc1 attn_kernel_noxm_m1
s_add_u32 s16,s26,4849664
s_addc_u32 s17,s27,0
s_mov_b32 s18,8192
s_mov_b32 s19,0x20000
s_lshl_b32 s38,s36,6
s_add_u32 s39,s43,1
s_lshl_b32 s39,s39,4
s_add_u32 s38,s38,s39
s_sub_u32 s38,s38,16
v_add_u32 v32,s38,v59
v_lshlrev_b32 v32,2,v32
buffer_store_dword v29,v32,s[16:19],0 offen
attn_kernel_noxm_m1:
s_nop 5
s_waitcnt lgkmcnt(0)
s_barrier
ds_read_b64 v[4:5],v56 offset:0
ds_read_b64 v[6:7],v56 offset:128
ds_read_b128 v[64:67],v57 offset:512
ds_read_b128 v[68:71],v57 offset:576
ds_read_b128 v[72:75],v57 offset:640
ds_read_b128 v[76:79],v57 offset:704
ds_read_b128 v[80:83],v57 offset:768
ds_read_b128 v[84:87],v57 offset:832
ds_read_b128 v[88:91],v57 offset:896
s_waitcnt lgkmcnt(7)
s_waitcnt lgkmcnt(6)
v_pk_mul_f32 v[8:9],v[64:65],v[4:5] op_sel_hi:[1,0]
v_pk_mul_f32 v[10:11],v[66:67],v[4:5] op_sel_hi:[1,0]
v_pk_fma_f32 v[144:145],v[144:145],v[4:5],v[8:9] op_sel:[0,1,0] op_sel_hi:[1,1,1] neg_lo:[0,0,1] neg_hi:[0,0,1]
v_pk_fma_f32 v[146:147],v[146:147],v[4:5],v[10:11] op_sel:[0,1,0] op_sel_hi:[1,1,1] neg_lo:[0,0,1] neg_hi:[0,0,1]
v_cvt_pk_bf16_f32 v16,v144,v145
v_cvt_pk_bf16_f32 v17,v146,v147
ds_write_b64 v43,v[16:17] offset:15360
v_pk_mul_f32 v[12:13],v[64:65],v[6:7] op_sel_hi:[1,0]
v_pk_mul_f32 v[14:15],v[66:67],v[6:7] op_sel_hi:[1,0]
v_pk_fma_f32 v[148:149],v[148:149],v[6:7],v[12:13] op_sel:[0,1,0] op_sel_hi:[1,1,1] neg_lo:[0,0,1] neg_hi:[0,0,1]
v_pk_fma_f32 v[150:151],v[150:151],v[6:7],v[14:15] op_sel:[0,1,0] op_sel_hi:[1,1,1] neg_lo:[0,0,1] neg_hi:[0,0,1]
v_cvt_pk_bf16_f32 v18,v148,v149
v_cvt_pk_bf16_f32 v19,v150,v151
ds_write_b64 v43,v[18:19] offset:16128
s_waitcnt lgkmcnt(7)
v_pk_mul_f32 v[8:9],v[68:69],v[4:5] op_sel_hi:[1,0]
v_pk_mul_f32 v[10:11],v[70:71],v[4:5] op_sel_hi:[1,0]
v_pk_fma_f32 v[152:153],v[152:153],v[4:5],v[8:9] op_sel:[0,1,0] op_sel_hi:[1,1,1] neg_lo:[0,0,1] neg_hi:[0,0,1]
v_pk_fma_f32 v[154:155],v[154:155],v[4:5],v[10:11] op_sel:[0,1,0] op_sel_hi:[1,1,1] neg_lo:[0,0,1] neg_hi:[0,0,1]
v_cvt_pk_bf16_f32 v16,v152,v153
v_cvt_pk_bf16_f32 v17,v154,v155
ds_write_b64 v44,v[16:17] offset:15360
v_pk_mul_f32 v[12:13],v[68:69],v[6:7] op_sel_hi:[1,0]
v_pk_mul_f32 v[14:15],v[70:71],v[6:7] op_sel_hi:[1,0]
v_pk_fma_f32 v[156:157],v[156:157],v[6:7],v[12:13] op_sel:[0,1,0] op_sel_hi:[1,1,1] neg_lo:[0,0,1] neg_hi:[0,0,1]
v_pk_fma_f32 v[158:159],v[158:159],v[6:7],v[14:15] op_sel:[0,1,0] op_sel_hi:[1,1,1] neg_lo:[0,0,1] neg_hi:[0,0,1]
v_cvt_pk_bf16_f32 v18,v156,v157
v_cvt_pk_bf16_f32 v19,v158,v159
ds_write_b64 v44,v[18:19] offset:16128
s_waitcnt lgkmcnt(8)
v_pk_mul_f32 v[8:9],v[72:73],v[4:5] op_sel_hi:[1,0]
v_pk_mul_f32 v[10:11],v[74:75],v[4:5] op_sel_hi:[1,0]
v_pk_fma_f32 v[160:161],v[160:161],v[4:5],v[8:9] op_sel:[0,1,0] op_sel_hi:[1,1,1] neg_lo:[0,0,1] neg_hi:[0,0,1]
v_pk_fma_f32 v[162:163],v[162:163],v[4:5],v[10:11] op_sel:[0,1,0] op_sel_hi:[1,1,1] neg_lo:[0,0,1] neg_hi:[0,0,1]
ds_write_b128 v48,v[160:163] offset:30720
v_pk_mul_f32 v[12:13],v[72:73],v[6:7] op_sel_hi:[1,0]
v_pk_mul_f32 v[14:15],v[74:75],v[6:7] op_sel_hi:[1,0]
v_pk_fma_f32 v[164:165],v[164:165],v[6:7],v[12:13] op_sel:[0,1,0] op_sel_hi:[1,1,1] neg_lo:[0,0,1] neg_hi:[0,0,1]
v_pk_fma_f32 v[166:167],v[166:167],v[6:7],v[14:15] op_sel:[0,1,0] op_sel_hi:[1,1,1] neg_lo:[0,0,1] neg_hi:[0,0,1]
ds_write_b128 v48,v[164:167] offset:32000
s_waitcnt lgkmcnt(9)
v_pk_mul_f32 v[8:9],v[76:77],v[4:5] op_sel_hi:[1,0]
v_pk_mul_f32 v[10:11],v[78:79],v[4:5] op_sel_hi:[1,0]
v_pk_fma_f32 v[168:169],v[168:169],v[4:5],v[8:9] op_sel:[0,1,0] op_sel_hi:[1,1,1] neg_lo:[0,0,1] neg_hi:[0,0,1]
v_pk_fma_f32 v[170:171],v[170:171],v[4:5],v[10:11] op_sel:[0,1,0] op_sel_hi:[1,1,1] neg_lo:[0,0,1] neg_hi:[0,0,1]
ds_write_b128 v49,v[168:171] offset:30720
v_pk_mul_f32 v[12:13],v[76:77],v[6:7] op_sel_hi:[1,0]
v_pk_mul_f32 v[14:15],v[78:79],v[6:7] op_sel_hi:[1,0]
v_pk_fma_f32 v[172:173],v[172:173],v[6:7],v[12:13] op_sel:[0,1,0] op_sel_hi:[1,1,1] neg_lo:[0,0,1] neg_hi:[0,0,1]
v_pk_fma_f32 v[174:175],v[174:175],v[6:7],v[14:15] op_sel:[0,1,0] op_sel_hi:[1,1,1] neg_lo:[0,0,1] neg_hi:[0,0,1]
ds_write_b128 v49,v[172:175] offset:32000
s_waitcnt lgkmcnt(10)
v_pk_mul_f32 v[8:9],v[80:81],v[4:5] op_sel_hi:[1,0]
v_pk_mul_f32 v[10:11],v[82:83],v[4:5] op_sel_hi:[1,0]
v_pk_fma_f32 v[176:177],v[176:177],v[4:5],v[8:9] op_sel:[0,1,0] op_sel_hi:[1,1,1] neg_lo:[0,0,1] neg_hi:[0,0,1]
v_pk_fma_f32 v[178:179],v[178:179],v[4:5],v[10:11] op_sel:[0,1,0] op_sel_hi:[1,1,1] neg_lo:[0,0,1] neg_hi:[0,0,1]
ds_write_b128 v50,v[176:179] offset:30720
v_pk_mul_f32 v[12:13],v[80:81],v[6:7] op_sel_hi:[1,0]
v_pk_mul_f32 v[14:15],v[82:83],v[6:7] op_sel_hi:[1,0]
v_pk_fma_f32 v[180:181],v[180:181],v[6:7],v[12:13] op_sel:[0,1,0] op_sel_hi:[1,1,1] neg_lo:[0,0,1] neg_hi:[0,0,1]
v_pk_fma_f32 v[182:183],v[182:183],v[6:7],v[14:15] op_sel:[0,1,0] op_sel_hi:[1,1,1] neg_lo:[0,0,1] neg_hi:[0,0,1]
ds_write_b128 v50,v[180:183] offset:32000
s_waitcnt lgkmcnt(11)
v_pk_mul_f32 v[8:9],v[84:85],v[4:5] op_sel_hi:[1,0]
v_pk_mul_f32 v[10:11],v[86:87],v[4:5] op_sel_hi:[1,0]
v_pk_fma_f32 v[184:185],v[184:185],v[4:5],v[8:9] op_sel:[0,1,0] op_sel_hi:[1,1,1] neg_lo:[0,0,1] neg_hi:[0,0,1]
v_pk_fma_f32 v[186:187],v[186:187],v[4:5],v[10:11] op_sel:[0,1,0] op_sel_hi:[1,1,1] neg_lo:[0,0,1] neg_hi:[0,0,1]
ds_write_b128 v51,v[184:187] offset:30720
v_pk_mul_f32 v[12:13],v[84:85],v[6:7] op_sel_hi:[1,0]
v_pk_mul_f32 v[14:15],v[86:87],v[6:7] op_sel_hi:[1,0]
v_pk_fma_f32 v[188:189],v[188:189],v[6:7],v[12:13] op_sel:[0,1,0] op_sel_hi:[1,1,1] neg_lo:[0,0,1] neg_hi:[0,0,1]
v_pk_fma_f32 v[190:191],v[190:191],v[6:7],v[14:15] op_sel:[0,1,0] op_sel_hi:[1,1,1] neg_lo:[0,0,1] neg_hi:[0,0,1]
ds_write_b128 v51,v[188:191] offset:32000
s_waitcnt lgkmcnt(12)
v_pk_mul_f32 v[8:9],v[88:89],v[4:5] op_sel_hi:[1,0]
v_pk_mul_f32 v[10:11],v[90:91],v[4:5] op_sel_hi:[1,0]
v_pk_fma_f32 v[192:193],v[192:193],v[4:5],v[8:9] op_sel:[0,1,0] op_sel_hi:[1,1,1] neg_lo:[0,0,1] neg_hi:[0,0,1]
v_pk_fma_f32 v[194:195],v[194:195],v[4:5],v[10:11] op_sel:[0,1,0] op_sel_hi:[1,1,1] neg_lo:[0,0,1] neg_hi:[0,0,1]
ds_write_b128 v52,v[192:195] offset:30720
v_pk_mul_f32 v[12:13],v[88:89],v[6:7] op_sel_hi:[1,0]
v_pk_mul_f32 v[14:15],v[90:91],v[6:7] op_sel_hi:[1,0]
v_pk_fma_f32 v[196:197],v[196:197],v[6:7],v[12:13] op_sel:[0,1,0] op_sel_hi:[1,1,1] neg_lo:[0,0,1] neg_hi:[0,0,1]
v_pk_fma_f32 v[198:199],v[198:199],v[6:7],v[14:15] op_sel:[0,1,0] op_sel_hi:[1,1,1] neg_lo:[0,0,1] neg_hi:[0,0,1]
ds_write_b128 v52,v[196:199] offset:32000
s_waitcnt lgkmcnt(0)
s_barrier
s_mul_i32 s37,s34,3840
v_mul_u32_u24 v180,48,v252
v_add_u32 v180,s37,v180
v_add_u32 v181,96,v180
v_add_u32 v180,768,v180
v_mul_u32_u24 v182,80,v252
s_mul_i32 s37,s34,6400
s_add_u32 s37,s37,160
v_add_u32 v182,s37,v182
ds_read_b128 v[0:3],v180 offset:0
ds_read_b128 v[4:7],v180 offset:16
ds_read_b64 v[8:9],v180 offset:32
ds_read_b128 v[12:15],v181 offset:16032
ds_read_b128 v[16:19],v181 offset:16048
ds_read_b64 v[20:21],v181 offset:16064
ds_read_b128 v[22:25],v181 offset:15936
ds_read_b128 v[26:29],v181 offset:15952
ds_read_b64 v[30:31],v181 offset:15968
ds_read_b128 v[32:35],v181 offset:15840
ds_read_b128 v[36:39],v181 offset:15856
ds_read_b64 v[40:41],v181 offset:15872
ds_read_b128 v[42:45],v181 offset:15744
ds_read_b128 v[46:49],v181 offset:15760
ds_read_b64 v[50:51],v181 offset:15776
s_and_b32 s37,s34,1
s_sub_u32 s38,s37,1
s_not_b32 s39,s38
s_lshl_b32 s37,s36,6
v_add_u32 v183,s37,v252
v_cmp_le_u32 s[66:67],2,v183
v_cmp_le_u32 s[68:69],4,v183
v_cmp_le_u32 s[70:71],6,v183
v_cmp_le_u32 s[72:73],8,v183
v_cmp_le_u32 s[74:75],10,v183
v_cmp_le_u32 s[76:77],12,v183
v_cmp_le_u32 s[78:79],14,v183
s_waitcnt lgkmcnt(12)
v_and_b32 v0,s38,v0
v_and_b32 v9,s39,v9
ds_read_b128 v[52:55],v181 offset:15648
ds_read_b128 v[56:59],v181 offset:15664
ds_read_b64 v[60:61],v181 offset:15680
s_waitcnt lgkmcnt(12)
v_dot2_f32_bf16 v92,v0,v12,0
v_dot2_f32_bf16 v92,v1,v13,v92
v_dot2_f32_bf16 v92,v2,v14,v92
v_dot2_f32_bf16 v92,v3,v15,v92
v_dot2_f32_bf16 v92,v4,v16,v92
v_dot2_f32_bf16 v92,v5,v17,v92
v_dot2_f32_bf16 v92,v6,v18,v92
v_dot2_f32_bf16 v92,v7,v19,v92
v_dot2_f32_bf16 v92,v8,v20,v92
v_dot2_f32_bf16 v92,v9,v21,v92
ds_read_b128 v[62:65],v181 offset:15552
ds_read_b128 v[66:69],v181 offset:15568
ds_read_b64 v[70:71],v181 offset:15584
s_waitcnt lgkmcnt(12)
v_dot2_f32_bf16 v93,v0,v22,0
v_dot2_f32_bf16 v93,v1,v23,v93
v_dot2_f32_bf16 v93,v2,v24,v93
v_dot2_f32_bf16 v93,v3,v25,v93
v_dot2_f32_bf16 v93,v4,v26,v93
v_dot2_f32_bf16 v93,v5,v27,v93
v_dot2_f32_bf16 v93,v6,v28,v93
v_dot2_f32_bf16 v93,v7,v29,v93
v_dot2_f32_bf16 v93,v8,v30,v93
v_dot2_f32_bf16 v93,v9,v31,v93
ds_read_b128 v[72:75],v181 offset:15456
ds_read_b128 v[76:79],v181 offset:15472
ds_read_b64 v[80:81],v181 offset:15488
s_waitcnt lgkmcnt(12)
v_dot2_f32_bf16 v94,v0,v32,0
v_dot2_f32_bf16 v94,v1,v33,v94
v_dot2_f32_bf16 v94,v2,v34,v94
v_dot2_f32_bf16 v94,v3,v35,v94
v_dot2_f32_bf16 v94,v4,v36,v94
v_dot2_f32_bf16 v94,v5,v37,v94
v_dot2_f32_bf16 v94,v6,v38,v94
v_dot2_f32_bf16 v94,v7,v39,v94
v_dot2_f32_bf16 v94,v8,v40,v94
v_dot2_f32_bf16 v94,v9,v41,v94
ds_read_b128 v[82:85],v181 offset:15360
ds_read_b128 v[86:89],v181 offset:15376
ds_read_b64 v[90:91],v181 offset:15392
s_waitcnt lgkmcnt(12)
v_dot2_f32_bf16 v95,v0,v42,0
v_dot2_f32_bf16 v95,v1,v43,v95
v_dot2_f32_bf16 v95,v2,v44,v95
v_dot2_f32_bf16 v95,v3,v45,v95
v_dot2_f32_bf16 v95,v4,v46,v95
v_dot2_f32_bf16 v95,v5,v47,v95
v_dot2_f32_bf16 v95,v6,v48,v95
v_dot2_f32_bf16 v95,v7,v49,v95
v_dot2_f32_bf16 v95,v8,v50,v95
v_dot2_f32_bf16 v95,v9,v51,v95
s_waitcnt lgkmcnt(9)
v_dot2_f32_bf16 v96,v0,v52,0
v_dot2_f32_bf16 v96,v1,v53,v96
v_dot2_f32_bf16 v96,v2,v54,v96
v_dot2_f32_bf16 v96,v3,v55,v96
v_dot2_f32_bf16 v96,v4,v56,v96
v_dot2_f32_bf16 v96,v5,v57,v96
v_dot2_f32_bf16 v96,v6,v58,v96
v_dot2_f32_bf16 v96,v7,v59,v96
v_dot2_f32_bf16 v96,v8,v60,v96
v_dot2_f32_bf16 v96,v9,v61,v96
s_waitcnt lgkmcnt(6)
v_dot2_f32_bf16 v97,v0,v62,0
v_dot2_f32_bf16 v97,v1,v63,v97
v_dot2_f32_bf16 v97,v2,v64,v97
v_dot2_f32_bf16 v97,v3,v65,v97
v_dot2_f32_bf16 v97,v4,v66,v97
v_dot2_f32_bf16 v97,v5,v67,v97
v_dot2_f32_bf16 v97,v6,v68,v97
v_dot2_f32_bf16 v97,v7,v69,v97
v_dot2_f32_bf16 v97,v8,v70,v97
v_dot2_f32_bf16 v97,v9,v71,v97
ds_read_b128 v[100:103],v182 offset:31840
ds_read_b128 v[104:107],v182 offset:31856
ds_read_b128 v[108:111],v182 offset:31872
ds_read_b128 v[112:115],v182 offset:31888
ds_read_b128 v[116:119],v182 offset:31904
s_waitcnt lgkmcnt(8)
v_dot2_f32_bf16 v98,v0,v72,0
v_dot2_f32_bf16 v98,v1,v73,v98
v_dot2_f32_bf16 v98,v2,v74,v98
v_dot2_f32_bf16 v98,v3,v75,v98
v_dot2_f32_bf16 v98,v4,v76,v98
v_dot2_f32_bf16 v98,v5,v77,v98
v_dot2_f32_bf16 v98,v6,v78,v98
v_dot2_f32_bf16 v98,v7,v79,v98
v_dot2_f32_bf16 v98,v8,v80,v98
v_dot2_f32_bf16 v98,v9,v81,v98
ds_read_b128 v[120:123],v182 offset:31680
ds_read_b128 v[124:127],v182 offset:31696
ds_read_b128 v[128:131],v182 offset:31712
ds_read_b128 v[132:135],v182 offset:31728
ds_read_b128 v[136:139],v182 offset:31744
s_waitcnt lgkmcnt(10)
v_dot2_f32_bf16 v99,v0,v82,0
v_dot2_f32_bf16 v99,v1,v83,v99
v_dot2_f32_bf16 v99,v2,v84,v99
v_dot2_f32_bf16 v99,v3,v85,v99
v_dot2_f32_bf16 v99,v4,v86,v99
v_dot2_f32_bf16 v99,v5,v87,v99
v_dot2_f32_bf16 v99,v6,v88,v99
v_dot2_f32_bf16 v99,v7,v89,v99
v_dot2_f32_bf16 v99,v8,v90,v99
v_dot2_f32_bf16 v99,v9,v91,v99
v_mov_b32 v184,4048155338
s_nop 1
v_cndmask_b32 v93,v184,v93,s[66:67]
v_cndmask_b32 v94,v184,v94,s[68:69]
v_cndmask_b32 v95,v184,v95,s[70:71]
v_cndmask_b32 v96,v184,v96,s[72:73]
v_cndmask_b32 v97,v184,v97,s[74:75]
v_cndmask_b32 v98,v184,v98,s[76:77]
v_cndmask_b32 v99,v184,v99,s[78:79]
v_max3_f32 v185,v92,v93,v94
v_max3_f32 v185,v185,v95,v96
v_max3_f32 v185,v185,v97,v98
v_max_f32 v185,v185,v99
s_mov_b32 s37,1051597459
v_mul_f32 v185,s37,v185
v_fma_f32 v92,v92,s37,-v185
v_fma_f32 v93,v93,s37,-v185
v_fma_f32 v94,v94,s37,-v185
v_fma_f32 v95,v95,s37,-v185
v_fma_f32 v96,v96,s37,-v185
v_fma_f32 v97,v97,s37,-v185
v_fma_f32 v98,v98,s37,-v185
v_fma_f32 v99,v99,s37,-v185
v_exp_f32 v92,v92
v_exp_f32 v93,v93
v_exp_f32 v94,v94
v_exp_f32 v95,v95
v_exp_f32 v96,v96
v_exp_f32 v97,v97
v_exp_f32 v98,v98
v_exp_f32 v99,v99
s_nop 0
v_add_f32 v186,v92,v93
v_add_f32 v187,v94,v95
v_add_f32 v188,v96,v97
v_add_f32 v189,v98,v99
v_add_f32 v186,v186,v187
v_add_f32 v188,v188,v189
v_add_f32 v186,v186,v188
v_rcp_f32 v186,v186
s_nop 0
v_mul_f32 v92,v92,v186
v_mul_f32 v93,v93,v186
v_mul_f32 v94,v94,v186
v_mul_f32 v95,v95,v186
v_mul_f32 v96,v96,v186
v_mul_f32 v97,v97,v186
v_mul_f32 v98,v98,v186
v_mul_f32 v99,v99,v186
ds_read_b128 v[140:143],v182 offset:31520
ds_read_b128 v[144:147],v182 offset:31536
ds_read_b128 v[148:151],v182 offset:31552
ds_read_b128 v[152:155],v182 offset:31568
ds_read_b128 v[156:159],v182 offset:31584
s_waitcnt lgkmcnt(10)
v_pk_mul_f32 v[160:161],v[100:101],v[92:93] op_sel_hi:[1,0]
v_pk_mul_f32 v[162:163],v[102:103],v[92:93] op_sel_hi:[1,0]
v_pk_mul_f32 v[164:165],v[104:105],v[92:93] op_sel_hi:[1,0]
v_pk_mul_f32 v[166:167],v[106:107],v[92:93] op_sel_hi:[1,0]
v_pk_mul_f32 v[168:169],v[108:109],v[92:93] op_sel_hi:[1,0]
v_pk_mul_f32 v[170:171],v[110:111],v[92:93] op_sel_hi:[1,0]
v_pk_mul_f32 v[172:173],v[112:113],v[92:93] op_sel_hi:[1,0]
v_pk_mul_f32 v[174:175],v[114:115],v[92:93] op_sel_hi:[1,0]
v_pk_mul_f32 v[176:177],v[116:117],v[92:93] op_sel_hi:[1,0]
v_pk_mul_f32 v[178:179],v[118:119],v[92:93] op_sel_hi:[1,0]
ds_read_b128 v[100:103],v182 offset:31360
ds_read_b128 v[104:107],v182 offset:31376
ds_read_b128 v[108:111],v182 offset:31392
ds_read_b128 v[112:115],v182 offset:31408
ds_read_b128 v[116:119],v182 offset:31424
s_waitcnt lgkmcnt(10)
v_pk_fma_f32 v[160:161],v[120:121],v[92:93],v[160:161] op_sel:[0,1,0] op_sel_hi:[1,1,1]
v_pk_fma_f32 v[162:163],v[122:123],v[92:93],v[162:163] op_sel:[0,1,0] op_sel_hi:[1,1,1]
v_pk_fma_f32 v[164:165],v[124:125],v[92:93],v[164:165] op_sel:[0,1,0] op_sel_hi:[1,1,1]
v_pk_fma_f32 v[166:167],v[126:127],v[92:93],v[166:167] op_sel:[0,1,0] op_sel_hi:[1,1,1]
v_pk_fma_f32 v[168:169],v[128:129],v[92:93],v[168:169] op_sel:[0,1,0] op_sel_hi:[1,1,1]
v_pk_fma_f32 v[170:171],v[130:131],v[92:93],v[170:171] op_sel:[0,1,0] op_sel_hi:[1,1,1]
v_pk_fma_f32 v[172:173],v[132:133],v[92:93],v[172:173] op_sel:[0,1,0] op_sel_hi:[1,1,1]
v_pk_fma_f32 v[174:175],v[134:135],v[92:93],v[174:175] op_sel:[0,1,0] op_sel_hi:[1,1,1]
v_pk_fma_f32 v[176:177],v[136:137],v[92:93],v[176:177] op_sel:[0,1,0] op_sel_hi:[1,1,1]
v_pk_fma_f32 v[178:179],v[138:139],v[92:93],v[178:179] op_sel:[0,1,0] op_sel_hi:[1,1,1]
ds_read_b128 v[120:123],v182 offset:31200
ds_read_b128 v[124:127],v182 offset:31216
ds_read_b128 v[128:131],v182 offset:31232
ds_read_b128 v[132:135],v182 offset:31248
ds_read_b128 v[136:139],v182 offset:31264
s_waitcnt lgkmcnt(10)
v_pk_fma_f32 v[160:161],v[140:141],v[94:95],v[160:161] op_sel_hi:[1,0,1]
v_pk_fma_f32 v[162:163],v[142:143],v[94:95],v[162:163] op_sel_hi:[1,0,1]
v_pk_fma_f32 v[164:165],v[144:145],v[94:95],v[164:165] op_sel_hi:[1,0,1]
v_pk_fma_f32 v[166:167],v[146:147],v[94:95],v[166:167] op_sel_hi:[1,0,1]
v_pk_fma_f32 v[168:169],v[148:149],v[94:95],v[168:169] op_sel_hi:[1,0,1]
v_pk_fma_f32 v[170:171],v[150:151],v[94:95],v[170:171] op_sel_hi:[1,0,1]
v_pk_fma_f32 v[172:173],v[152:153],v[94:95],v[172:173] op_sel_hi:[1,0,1]
v_pk_fma_f32 v[174:175],v[154:155],v[94:95],v[174:175] op_sel_hi:[1,0,1]
v_pk_fma_f32 v[176:177],v[156:157],v[94:95],v[176:177] op_sel_hi:[1,0,1]
v_pk_fma_f32 v[178:179],v[158:159],v[94:95],v[178:179] op_sel_hi:[1,0,1]
ds_read_b128 v[140:143],v182 offset:31040
ds_read_b128 v[144:147],v182 offset:31056
ds_read_b128 v[148:151],v182 offset:31072
ds_read_b128 v[152:155],v182 offset:31088
ds_read_b128 v[156:159],v182 offset:31104
s_waitcnt lgkmcnt(10)
v_pk_fma_f32 v[160:161],v[100:101],v[94:95],v[160:161] op_sel:[0,1,0] op_sel_hi:[1,1,1]
v_pk_fma_f32 v[162:163],v[102:103],v[94:95],v[162:163] op_sel:[0,1,0] op_sel_hi:[1,1,1]
v_pk_fma_f32 v[164:165],v[104:105],v[94:95],v[164:165] op_sel:[0,1,0] op_sel_hi:[1,1,1]
v_pk_fma_f32 v[166:167],v[106:107],v[94:95],v[166:167] op_sel:[0,1,0] op_sel_hi:[1,1,1]
v_pk_fma_f32 v[168:169],v[108:109],v[94:95],v[168:169] op_sel:[0,1,0] op_sel_hi:[1,1,1]
v_pk_fma_f32 v[170:171],v[110:111],v[94:95],v[170:171] op_sel:[0,1,0] op_sel_hi:[1,1,1]
v_pk_fma_f32 v[172:173],v[112:113],v[94:95],v[172:173] op_sel:[0,1,0] op_sel_hi:[1,1,1]
v_pk_fma_f32 v[174:175],v[114:115],v[94:95],v[174:175] op_sel:[0,1,0] op_sel_hi:[1,1,1]
v_pk_fma_f32 v[176:177],v[116:117],v[94:95],v[176:177] op_sel:[0,1,0] op_sel_hi:[1,1,1]
v_pk_fma_f32 v[178:179],v[118:119],v[94:95],v[178:179] op_sel:[0,1,0] op_sel_hi:[1,1,1]
ds_read_b128 v[100:103],v182 offset:30880
ds_read_b128 v[104:107],v182 offset:30896
ds_read_b128 v[108:111],v182 offset:30912
ds_read_b128 v[112:115],v182 offset:30928
ds_read_b128 v[116:119],v182 offset:30944
s_waitcnt lgkmcnt(10)
v_pk_fma_f32 v[160:161],v[120:121],v[96:97],v[160:161] op_sel_hi:[1,0,1]
v_pk_fma_f32 v[162:163],v[122:123],v[96:97],v[162:163] op_sel_hi:[1,0,1]
v_pk_fma_f32 v[164:165],v[124:125],v[96:97],v[164:165] op_sel_hi:[1,0,1]
v_pk_fma_f32 v[166:167],v[126:127],v[96:97],v[166:167] op_sel_hi:[1,0,1]
v_pk_fma_f32 v[168:169],v[128:129],v[96:97],v[168:169] op_sel_hi:[1,0,1]
v_pk_fma_f32 v[170:171],v[130:131],v[96:97],v[170:171] op_sel_hi:[1,0,1]
v_pk_fma_f32 v[172:173],v[132:133],v[96:97],v[172:173] op_sel_hi:[1,0,1]
v_pk_fma_f32 v[174:175],v[134:135],v[96:97],v[174:175] op_sel_hi:[1,0,1]
v_pk_fma_f32 v[176:177],v[136:137],v[96:97],v[176:177] op_sel_hi:[1,0,1]
v_pk_fma_f32 v[178:179],v[138:139],v[96:97],v[178:179] op_sel_hi:[1,0,1]
ds_read_b128 v[120:123],v182 offset:30720
ds_read_b128 v[124:127],v182 offset:30736
ds_read_b128 v[128:131],v182 offset:30752
ds_read_b128 v[132:135],v182 offset:30768
ds_read_b128 v[136:139],v182 offset:30784
s_waitcnt lgkmcnt(10)
v_pk_fma_f32 v[160:161],v[140:141],v[96:97],v[160:161] op_sel:[0,1,0] op_sel_hi:[1,1,1]
v_pk_fma_f32 v[162:163],v[142:143],v[96:97],v[162:163] op_sel:[0,1,0] op_sel_hi:[1,1,1]
v_pk_fma_f32 v[164:165],v[144:145],v[96:97],v[164:165] op_sel:[0,1,0] op_sel_hi:[1,1,1]
v_pk_fma_f32 v[166:167],v[146:147],v[96:97],v[166:167] op_sel:[0,1,0] op_sel_hi:[1,1,1]
v_pk_fma_f32 v[168:169],v[148:149],v[96:97],v[168:169] op_sel:[0,1,0] op_sel_hi:[1,1,1]
v_pk_fma_f32 v[170:171],v[150:151],v[96:97],v[170:171] op_sel:[0,1,0] op_sel_hi:[1,1,1]
v_pk_fma_f32 v[172:173],v[152:153],v[96:97],v[172:173] op_sel:[0,1,0] op_sel_hi:[1,1,1]
v_pk_fma_f32 v[174:175],v[154:155],v[96:97],v[174:175] op_sel:[0,1,0] op_sel_hi:[1,1,1]
v_pk_fma_f32 v[176:177],v[156:157],v[96:97],v[176:177] op_sel:[0,1,0] op_sel_hi:[1,1,1]
v_pk_fma_f32 v[178:179],v[158:159],v[96:97],v[178:179] op_sel:[0,1,0] op_sel_hi:[1,1,1]
s_waitcnt lgkmcnt(5)
v_pk_fma_f32 v[160:161],v[100:101],v[98:99],v[160:161] op_sel_hi:[1,0,1]
v_pk_fma_f32 v[162:163],v[102:103],v[98:99],v[162:163] op_sel_hi:[1,0,1]
v_pk_fma_f32 v[164:165],v[104:105],v[98:99],v[164:165] op_sel_hi:[1,0,1]
v_pk_fma_f32 v[166:167],v[106:107],v[98:99],v[166:167] op_sel_hi:[1,0,1]
v_pk_fma_f32 v[168:169],v[108:109],v[98:99],v[168:169] op_sel_hi:[1,0,1]
v_pk_fma_f32 v[170:171],v[110:111],v[98:99],v[170:171] op_sel_hi:[1,0,1]
v_pk_fma_f32 v[172:173],v[112:113],v[98:99],v[172:173] op_sel_hi:[1,0,1]
v_pk_fma_f32 v[174:175],v[114:115],v[98:99],v[174:175] op_sel_hi:[1,0,1]
v_pk_fma_f32 v[176:177],v[116:117],v[98:99],v[176:177] op_sel_hi:[1,0,1]
v_pk_fma_f32 v[178:179],v[118:119],v[98:99],v[178:179] op_sel_hi:[1,0,1]
s_waitcnt lgkmcnt(0)
v_pk_fma_f32 v[160:161],v[120:121],v[98:99],v[160:161] op_sel:[0,1,0] op_sel_hi:[1,1,1]
v_pk_fma_f32 v[162:163],v[122:123],v[98:99],v[162:163] op_sel:[0,1,0] op_sel_hi:[1,1,1]
v_pk_fma_f32 v[164:165],v[124:125],v[98:99],v[164:165] op_sel:[0,1,0] op_sel_hi:[1,1,1]
v_pk_fma_f32 v[166:167],v[126:127],v[98:99],v[166:167] op_sel:[0,1,0] op_sel_hi:[1,1,1]
v_pk_fma_f32 v[168:169],v[128:129],v[98:99],v[168:169] op_sel:[0,1,0] op_sel_hi:[1,1,1]
v_pk_fma_f32 v[170:171],v[130:131],v[98:99],v[170:171] op_sel:[0,1,0] op_sel_hi:[1,1,1]
v_pk_fma_f32 v[172:173],v[132:133],v[98:99],v[172:173] op_sel:[0,1,0] op_sel_hi:[1,1,1]
v_pk_fma_f32 v[174:175],v[134:135],v[98:99],v[174:175] op_sel:[0,1,0] op_sel_hi:[1,1,1]
v_pk_fma_f32 v[176:177],v[136:137],v[98:99],v[176:177] op_sel:[0,1,0] op_sel_hi:[1,1,1]
v_pk_fma_f32 v[178:179],v[138:139],v[98:99],v[178:179] op_sel:[0,1,0] op_sel_hi:[1,1,1]
v_cvt_pk_bf16_f32 v0,v160,v161
v_cvt_pk_bf16_f32 v1,v162,v163
v_cvt_pk_bf16_f32 v2,v164,v165
v_cvt_pk_bf16_f32 v3,v166,v167
v_cvt_pk_bf16_f32 v4,v168,v169
v_cvt_pk_bf16_f32 v5,v170,v171
v_cvt_pk_bf16_f32 v6,v172,v173
v_cvt_pk_bf16_f32 v7,v174,v175
v_cvt_pk_bf16_f32 v8,v176,v177
v_mul_u32_u24 v184,144,v252
s_mul_i32 s37,s34,36
v_add_u32 v184,s37,v184
ds_write_b32 v184,v0 offset:56320
ds_write_b32 v184,v1 offset:56324
ds_write_b32 v184,v2 offset:56328
ds_write_b32 v184,v3 offset:56332
ds_write_b32 v184,v4 offset:56336
ds_write_b32 v184,v5 offset:56340
ds_write_b32 v184,v6 offset:56344
ds_write_b32 v184,v7 offset:56348
ds_write_b32 v184,v8 offset:56352
s_waitcnt lgkmcnt(0)
s_barrier
s_mov_b32 s12,s26
s_mov_b32 s13,s27
s_mov_b32 s14,2359296
s_mov_b32 s15,0x20000
s_lshl_b32 s37,s34,6
v_add_u32 v200,s37,v252
v_and_b32 v201,15,v200
v_lshrrev_b32 v200,4,v200
v_mul_u32_u24 v202,57,v200
v_lshrrev_b32 v202,9,v202
v_mul_u32_u24 v203,9,v202
v_sub_u32 v200,v200,v203
v_lshl_add_u32 v203,v202,4,v201
v_mul_u32_u24 v203,144,v203
v_lshl_add_u32 v203,v200,4,v203
ds_read_b128 v[204:207],v203 offset:56320
s_mul_i32 s38,s35,9
v_add_u32 v200,s38,v200
s_lshl_b32 s38,s36,2
v_add_u32 v202,s38,v202
v_mul_u32_u24 v202,72,v202
v_add_u32 v202,v202,v200
v_lshl_add_u32 v202,v202,4,v201
v_lshlrev_b32 v202,4,v202
s_waitcnt lgkmcnt(0)
buffer_store_dwordx4 v[204:207],v202,s[12:15],0 offen sc1
s_cmp_lg_u32 s34,0
s_cbranch_scc1 attn_kernel_nox2
s_lshl_b32 s37,s34,6
v_add_u32 v208,s37,v252
v_add_u32 v208,512,v208
v_and_b32 v209,15,v208
v_lshrrev_b32 v208,4,v208
v_mul_u32_u24 v210,57,v208
v_lshrrev_b32 v210,9,v210
v_mul_u32_u24 v211,9,v210
v_sub_u32 v208,v208,v211
v_lshl_add_u32 v211,v210,4,v209
v_mul_u32_u24 v211,144,v211
v_lshl_add_u32 v211,v208,4,v211
ds_read_b128 v[212:215],v211 offset:56320
s_mul_i32 s38,s35,9
v_add_u32 v208,s38,v208
s_lshl_b32 s38,s36,2
v_add_u32 v210,s38,v210
v_mul_u32_u24 v210,72,v210
v_add_u32 v210,v210,v208
v_lshl_add_u32 v210,v210,4,v209
v_lshlrev_b32 v210,4,v210
s_waitcnt lgkmcnt(0)
buffer_store_dwordx4 v[212:215],v210,s[12:15],0 offen sc1
attn_kernel_nox2:
s_endpgm
attn_kernel_m0:
s_lshr_b32 s43,s34,1
s_lshl_b32 s43,s43,1
s_add_u32 s43,s43,1
v_and_b32 v59,15,v252
s_lshl_b32 s38,s43,4
v_add_u32 v70,s38,v59
v_lshlrev_b32 v71,7,v70
v_add_u32 v71,122880,v71
v_and_b32 v72,7,v59
v_add_u32 v73,0,v253
v_xor_b32 v73,v73,v72
v_lshl_add_u32 v254,v73,4,v71
v_add_u32 v73,4,v253
v_xor_b32 v73,v73,v72
v_lshl_add_u32 v255,v73,4,v71
v_bfe_u32 v61,v252,2,2
v_lshl_add_u32 v62,v253,3,v61
v_lshlrev_b32 v62,8,v62
v_and_b32 v63,1,v253
v_lshl_or_b32 v63,v63,2,v61
v_lshlrev_b32 v63,1,v63
v_and_b32 v64,3,v252
s_lshl_b32 s37,s35,4
v_add_u32 v65,0,v64
v_mul_u32_u24 v66,52,v65
v_lshrrev_b32 v66,8,v66
v_mul_u32_u24 v67,5,v66
v_sub_u32 v67,v65,v67
v_mul_u32_u24 v68,36,v66
v_and_b32 v66,1,v66
v_lshlrev_b32 v66,2,v66
v_sub_u32 v68,v68,v66
v_lshl_add_u32 v68,v67,3,v68
v_add_u32 v68,s37,v68
v_lshrrev_b32 v67,4,v68
v_xor_b32 v67,v67,v63
v_and_b32 v68,8,v68
v_lshl_add_u32 v67,v67,4,v68
v_add_u32 v232,v67,v62
v_add_u32 v65,4,v64
v_mul_u32_u24 v66,52,v65
v_lshrrev_b32 v66,8,v66
v_mul_u32_u24 v67,5,v66
v_sub_u32 v67,v65,v67
v_mul_u32_u24 v68,36,v66
v_and_b32 v66,1,v66
v_lshlrev_b32 v66,2,v66
v_sub_u32 v68,v68,v66
v_lshl_add_u32 v68,v67,3,v68
v_add_u32 v68,s37,v68
v_lshrrev_b32 v67,4,v68
v_xor_b32 v67,v67,v63
v_and_b32 v68,8,v68
v_lshl_add_u32 v67,v67,4,v68
v_add_u32 v233,v67,v62
v_add_u32 v65,8,v64
v_mul_u32_u24 v66,52,v65
v_lshrrev_b32 v66,8,v66
v_mul_u32_u24 v67,5,v66
v_sub_u32 v67,v65,v67
v_mul_u32_u24 v68,36,v66
v_and_b32 v66,1,v66
v_lshlrev_b32 v66,2,v66
v_sub_u32 v68,v68,v66
v_lshl_add_u32 v68,v67,3,v68
v_add_u32 v68,s37,v68
v_lshrrev_b32 v67,4,v68
v_xor_b32 v67,v67,v63
v_and_b32 v68,8,v68
v_lshl_add_u32 v67,v67,4,v68
v_add_u32 v234,v67,v62
v_add_u32 v65,12,v64
v_mul_u32_u24 v66,52,v65
v_lshrrev_b32 v66,8,v66
v_mul_u32_u24 v67,5,v66
v_sub_u32 v67,v65,v67
v_mul_u32_u24 v68,36,v66
v_and_b32 v66,1,v66
v_lshlrev_b32 v66,2,v66
v_sub_u32 v68,v68,v66
v_lshl_add_u32 v68,v67,3,v68
v_add_u32 v68,s37,v68
v_lshrrev_b32 v67,4,v68
v_xor_b32 v67,v67,v63
v_and_b32 v68,8,v68
v_lshl_add_u32 v67,v67,4,v68
v_add_u32 v235,v67,v62
v_add_u32 v65,16,v64
v_mul_u32_u24 v66,52,v65
v_lshrrev_b32 v66,8,v66
v_mul_u32_u24 v67,5,v66
v_sub_u32 v67,v65,v67
v_mul_u32_u24 v68,36,v66
v_and_b32 v66,1,v66
v_lshlrev_b32 v66,2,v66
v_sub_u32 v68,v68,v66
v_lshl_add_u32 v68,v67,3,v68
v_add_u32 v68,s37,v68
v_lshrrev_b32 v67,4,v68
v_xor_b32 v67,v67,v63
v_and_b32 v68,8,v68
v_lshl_add_u32 v67,v67,4,v68
v_add_u32 v236,v67,v62
v_mov_b32 v240,0x3f803f80
v_mov_b32 v241,0x3f803f80
v_mov_b32 v242,0x3f803f80
v_mov_b32 v243,0x3f803f80
v_mul_u32_u24 v61,48,v70
v_mul_u32_u24 v62,80,v70
v_add_u32 v63,0,v253
v_mul_u32_u24 v64,52,v63
v_lshrrev_b32 v64,8,v64
v_mul_u32_u24 v65,5,v64
v_sub_u32 v65,v63,v65
v_mul_u32_u24 v66,3840,v64
v_lshl_add_u32 v66,v65,3,v66
v_add_u32 v40,v66,v61
v_mul_u32_u24 v66,6400,v64
v_lshl_add_u32 v66,v65,4,v66
v_add_u32 v48,v66,v62
v_add_u32 v63,4,v253
v_mul_u32_u24 v64,52,v63
v_lshrrev_b32 v64,8,v64
v_mul_u32_u24 v65,5,v64
v_sub_u32 v65,v63,v65
v_mul_u32_u24 v66,3840,v64
v_lshl_add_u32 v66,v65,3,v66
v_add_u32 v41,v66,v61
v_mul_u32_u24 v66,6400,v64
v_lshl_add_u32 v66,v65,4,v66
v_add_u32 v49,v66,v62
v_add_u32 v63,8,v253
v_mul_u32_u24 v64,52,v63
v_lshrrev_b32 v64,8,v64
v_mul_u32_u24 v65,5,v64
v_sub_u32 v65,v63,v65
v_mul_u32_u24 v66,3840,v64
v_lshl_add_u32 v66,v65,3,v66
v_add_u32 v42,v66,v61
v_mul_u32_u24 v66,6400,v64
v_lshl_add_u32 v66,v65,4,v66
v_add_u32 v50,v66,v62
v_add_u32 v63,12,v253
v_mul_u32_u24 v64,52,v63
v_lshrrev_b32 v64,8,v64
v_mul_u32_u24 v65,5,v64
v_sub_u32 v65,v63,v65
v_mul_u32_u24 v66,3840,v64
v_lshl_add_u32 v66,v65,3,v66
v_add_u32 v43,v66,v61
v_mul_u32_u24 v66,6400,v64
v_lshl_add_u32 v66,v65,4,v66
v_add_u32 v51,v66,v62
v_add_u32 v63,16,v253
v_mul_u32_u24 v64,52,v63
v_lshrrev_b32 v64,8,v64
v_mul_u32_u24 v65,5,v64
v_sub_u32 v65,v63,v65
v_mul_u32_u24 v66,3840,v64
v_lshl_add_u32 v66,v65,3,v66
v_add_u32 v44,v66,v61
v_mul_u32_u24 v66,6400,v64
v_lshl_add_u32 v66,v65,4,v66
v_add_u32 v52,v66,v62
v_lshlrev_b32 v56,3,v70
v_add_u32 v56,154624,v56
v_lshlrev_b32 v57,4,v253
v_add_u32 v57,153600,v57
s_waitcnt lgkmcnt(0)
s_barrier
ds_read_b128 v[0:3],v254 offset:0
ds_read_b128 v[4:7],v254 offset:2048
ds_read_b64_tr_b16 v[100:101],v232 offset:0
ds_read_b64_tr_b16 v[102:103],v232 offset:1024
ds_read_b64_tr_b16 v[104:105],v233 offset:0
ds_read_b64_tr_b16 v[106:107],v233 offset:1024
ds_read_b64_tr_b16 v[108:109],v234 offset:0
ds_read_b64_tr_b16 v[110:111],v234 offset:1024
ds_read_b64_tr_b16 v[112:113],v235 offset:0
ds_read_b64_tr_b16 v[114:115],v235 offset:1024
ds_read_b64_tr_b16 v[116:117],v236 offset:0
ds_read_b64_tr_b16 v[118:119],v236 offset:1024
ds_read_b64_tr_b16 v[120:121],v232 offset:8192
ds_read_b64_tr_b16 v[122:123],v232 offset:9216
s_waitcnt lgkmcnt(12)
s_waitcnt lgkmcnt(10)
v_mfma_f32_16x16x32_bf16 v[244:247],v[240:243],v[0:3],0
v_mfma_f32_16x16x32_bf16 v[248:251],v[0:3],v[0:3],0
v_mfma_f32_16x16x32_bf16 v[144:147],v[100:103],v[0:3],0
ds_read_b64_tr_b16 v[124:125],v233 offset:8192
v_mfma_f32_16x16x32_bf16 v[148:151],v[100:103],v[4:7],0
ds_read_b64_tr_b16 v[126:127],v233 offset:9216
s_waitcnt lgkmcnt(10)
v_mfma_f32_16x16x32_bf16 v[152:155],v[104:107],v[0:3],0
ds_read_b64_tr_b16 v[128:129],v234 offset:8192
v_mfma_f32_16x16x32_bf16 v[156:159],v[104:107],v[4:7],0
ds_read_b64_tr_b16 v[130:131],v234 offset:9216
s_waitcnt lgkmcnt(10)
v_mfma_f32_16x16x32_bf16 v[160:163],v[108:111],v[0:3],0
s_barrier
ds_read_b128 v[8:11],v255 offset:0
ds_read_b128 v[12:15],v255 offset:2048
v_add_u32 v232,24576,v232
ds_read_b64_tr_b16 v[100:101],v232 offset:0
v_mfma_f32_16x16x32_bf16 v[164:167],v[108:111],v[4:7],0
ds_read_b64_tr_b16 v[102:103],v232 offset:1024
s_waitcnt lgkmcnt(12)
v_mfma_f32_16x16x32_bf16 v[168:171],v[112:115],v[0:3],0
v_add_u32 v233,24576,v233
ds_read_b64_tr_b16 v[104:105],v233 offset:0
v_mfma_f32_16x16x32_bf16 v[172:175],v[112:115],v[4:7],0
ds_read_b64_tr_b16 v[106:107],v233 offset:1024
s_waitcnt lgkmcnt(12)
v_mfma_f32_16x16x32_bf16 v[176:179],v[116:119],v[0:3],0
v_add_u32 v234,24576,v234
ds_read_b64_tr_b16 v[108:109],v234 offset:0
v_mfma_f32_16x16x32_bf16 v[180:183],v[116:119],v[4:7],0
ds_read_b64_tr_b16 v[110:111],v234 offset:1024
s_waitcnt lgkmcnt(12)
v_mfma_f32_16x16x32_bf16 v[184:187],v[120:123],v[0:3],0
v_add_u32 v235,24576,v235
ds_read_b64_tr_b16 v[112:113],v235 offset:0
v_mfma_f32_16x16x32_bf16 v[188:191],v[120:123],v[4:7],0
ds_read_b64_tr_b16 v[114:115],v235 offset:1024
s_waitcnt lgkmcnt(12)
v_mfma_f32_16x16x32_bf16 v[192:195],v[124:127],v[0:3],0
v_add_u32 v236,24576,v236
ds_read_b64_tr_b16 v[116:117],v236 offset:0
v_mfma_f32_16x16x32_bf16 v[196:199],v[124:127],v[4:7],0
ds_read_b64_tr_b16 v[118:119],v236 offset:1024
s_waitcnt lgkmcnt(12)
v_mfma_f32_16x16x32_bf16 v[200:203],v[128:131],v[0:3],0
ds_read_b64_tr_b16 v[120:121],v232 offset:8192
v_mfma_f32_16x16x32_bf16 v[204:207],v[128:131],v[4:7],0
ds_read_b64_tr_b16 v[122:123],v232 offset:9216
s_waitcnt lgkmcnt(12)
s_waitcnt lgkmcnt(10)
v_mfma_f32_16x16x32_bf16 v[244:247],v[240:243],v[8:11],v[244:247]
v_mfma_f32_16x16x32_bf16 v[248:251],v[8:11],v[8:11],v[248:251]
v_mfma_f32_16x16x32_bf16 v[144:147],v[100:103],v[8:11],v[144:147]
ds_read_b64_tr_b16 v[124:125],v233 offset:8192
v_mfma_f32_16x16x32_bf16 v[148:151],v[100:103],v[12:15],v[148:151]
ds_read_b64_tr_b16 v[126:127],v233 offset:9216
s_waitcnt lgkmcnt(10)
v_mfma_f32_16x16x32_bf16 v[152:155],v[104:107],v[8:11],v[152:155]
ds_read_b64_tr_b16 v[128:129],v234 offset:8192
v_mfma_f32_16x16x32_bf16 v[156:159],v[104:107],v[12:15],v[156:159]
ds_read_b64_tr_b16 v[130:131],v234 offset:9216
s_waitcnt lgkmcnt(10)
v_mfma_f32_16x16x32_bf16 v[160:163],v[108:111],v[8:11],v[160:163]
s_barrier
ds_read_b128 v[16:19],v254 offset:10240
ds_read_b128 v[20:23],v254 offset:12288
v_add_u32 v232,24576,v232
ds_read_b64_tr_b16 v[100:101],v232 offset:0
v_mfma_f32_16x16x32_bf16 v[164:167],v[108:111],v[12:15],v[164:167]
ds_read_b64_tr_b16 v[102:103],v232 offset:1024
s_waitcnt lgkmcnt(12)
v_mfma_f32_16x16x32_bf16 v[168:171],v[112:115],v[8:11],v[168:171]
v_add_u32 v233,24576,v233
ds_read_b64_tr_b16 v[104:105],v233 offset:0
v_mfma_f32_16x16x32_bf16 v[172:175],v[112:115],v[12:15],v[172:175]
ds_read_b64_tr_b16 v[106:107],v233 offset:1024
s_waitcnt lgkmcnt(12)
v_mfma_f32_16x16x32_bf16 v[176:179],v[116:119],v[8:11],v[176:179]
v_add_u32 v234,24576,v234
ds_read_b64_tr_b16 v[108:109],v234 offset:0
v_mfma_f32_16x16x32_bf16 v[180:183],v[116:119],v[12:15],v[180:183]
ds_read_b64_tr_b16 v[110:111],v234 offset:1024
s_waitcnt lgkmcnt(12)
v_mfma_f32_16x16x32_bf16 v[184:187],v[120:123],v[8:11],v[184:187]
v_add_u32 v235,24576,v235
ds_read_b64_tr_b16 v[112:113],v235 offset:0
v_mfma_f32_16x16x32_bf16 v[188:191],v[120:123],v[12:15],v[188:191]
ds_read_b64_tr_b16 v[114:115],v235 offset:1024
s_waitcnt lgkmcnt(12)
v_mfma_f32_16x16x32_bf16 v[192:195],v[124:127],v[8:11],v[192:195]
v_add_u32 v236,24576,v236
ds_read_b64_tr_b16 v[116:117],v236 offset:0
v_mfma_f32_16x16x32_bf16 v[196:199],v[124:127],v[12:15],v[196:199]
ds_read_b64_tr_b16 v[118:119],v236 offset:1024
s_waitcnt lgkmcnt(12)
v_mfma_f32_16x16x32_bf16 v[200:203],v[128:131],v[8:11],v[200:203]
ds_read_b64_tr_b16 v[120:121],v232 offset:8192
v_mfma_f32_16x16x32_bf16 v[204:207],v[128:131],v[12:15],v[204:207]
ds_read_b64_tr_b16 v[122:123],v232 offset:9216
s_waitcnt lgkmcnt(12)
s_waitcnt lgkmcnt(10)
v_mfma_f32_16x16x32_bf16 v[244:247],v[240:243],v[16:19],v[244:247]
v_mfma_f32_16x16x32_bf16 v[248:251],v[16:19],v[16:19],v[248:251]
v_mfma_f32_16x16x32_bf16 v[144:147],v[100:103],v[16:19],v[144:147]
ds_read_b64_tr_b16 v[124:125],v233 offset:8192
v_mfma_f32_16x16x32_bf16 v[148:151],v[100:103],v[20:23],v[148:151]
ds_read_b64_tr_b16 v[126:127],v233 offset:9216
s_waitcnt lgkmcnt(10)
v_mfma_f32_16x16x32_bf16 v[152:155],v[104:107],v[16:19],v[152:155]
ds_read_b64_tr_b16 v[128:129],v234 offset:8192
v_mfma_f32_16x16x32_bf16 v[156:159],v[104:107],v[20:23],v[156:159]
ds_read_b64_tr_b16 v[130:131],v234 offset:9216
s_waitcnt lgkmcnt(10)
v_mfma_f32_16x16x32_bf16 v[160:163],v[108:111],v[16:19],v[160:163]
s_barrier
ds_read_b128 v[0:3],v255 offset:10240
ds_read_b128 v[4:7],v255 offset:12288
v_add_u32 v232,24576,v232
ds_read_b64_tr_b16 v[100:101],v232 offset:0
v_mfma_f32_16x16x32_bf16 v[164:167],v[108:111],v[20:23],v[164:167]
ds_read_b64_tr_b16 v[102:103],v232 offset:1024
s_waitcnt lgkmcnt(12)
v_mfma_f32_16x16x32_bf16 v[168:171],v[112:115],v[16:19],v[168:171]
v_add_u32 v233,24576,v233
ds_read_b64_tr_b16 v[104:105],v233 offset:0
v_mfma_f32_16x16x32_bf16 v[172:175],v[112:115],v[20:23],v[172:175]
ds_read_b64_tr_b16 v[106:107],v233 offset:1024
s_waitcnt lgkmcnt(12)
v_mfma_f32_16x16x32_bf16 v[176:179],v[116:119],v[16:19],v[176:179]
v_add_u32 v234,24576,v234
ds_read_b64_tr_b16 v[108:109],v234 offset:0
v_mfma_f32_16x16x32_bf16 v[180:183],v[116:119],v[20:23],v[180:183]
ds_read_b64_tr_b16 v[110:111],v234 offset:1024
s_waitcnt lgkmcnt(12)
v_mfma_f32_16x16x32_bf16 v[184:187],v[120:123],v[16:19],v[184:187]
v_add_u32 v235,24576,v235
ds_read_b64_tr_b16 v[112:113],v235 offset:0
v_mfma_f32_16x16x32_bf16 v[188:191],v[120:123],v[20:23],v[188:191]
ds_read_b64_tr_b16 v[114:115],v235 offset:1024
s_waitcnt lgkmcnt(12)
v_mfma_f32_16x16x32_bf16 v[192:195],v[124:127],v[16:19],v[192:195]
v_add_u32 v236,24576,v236
ds_read_b64_tr_b16 v[116:117],v236 offset:0
v_mfma_f32_16x16x32_bf16 v[196:199],v[124:127],v[20:23],v[196:199]
ds_read_b64_tr_b16 v[118:119],v236 offset:1024
s_waitcnt lgkmcnt(12)
v_mfma_f32_16x16x32_bf16 v[200:203],v[128:131],v[16:19],v[200:203]
ds_read_b64_tr_b16 v[120:121],v232 offset:8192
v_mfma_f32_16x16x32_bf16 v[204:207],v[128:131],v[20:23],v[204:207]
ds_read_b64_tr_b16 v[122:123],v232 offset:9216
s_waitcnt lgkmcnt(12)
s_waitcnt lgkmcnt(10)
v_mfma_f32_16x16x32_bf16 v[244:247],v[240:243],v[0:3],v[244:247]
v_mfma_f32_16x16x32_bf16 v[248:251],v[0:3],v[0:3],v[248:251]
v_mfma_f32_16x16x32_bf16 v[144:147],v[100:103],v[0:3],v[144:147]
ds_read_b64_tr_b16 v[124:125],v233 offset:8192
v_mfma_f32_16x16x32_bf16 v[148:151],v[100:103],v[4:7],v[148:151]
ds_read_b64_tr_b16 v[126:127],v233 offset:9216
s_waitcnt lgkmcnt(10)
v_mfma_f32_16x16x32_bf16 v[152:155],v[104:107],v[0:3],v[152:155]
ds_read_b64_tr_b16 v[128:129],v234 offset:8192
v_mfma_f32_16x16x32_bf16 v[156:159],v[104:107],v[4:7],v[156:159]
ds_read_b64_tr_b16 v[130:131],v234 offset:9216
s_waitcnt lgkmcnt(10)
v_mfma_f32_16x16x32_bf16 v[160:163],v[108:111],v[0:3],v[160:163]
s_barrier
ds_read_b128 v[8:11],v254 offset:20480
ds_read_b128 v[12:15],v254 offset:22528
v_add_u32 v232,24576,v232
ds_read_b64_tr_b16 v[100:101],v232 offset:0
v_mfma_f32_16x16x32_bf16 v[164:167],v[108:111],v[4:7],v[164:167]
ds_read_b64_tr_b16 v[102:103],v232 offset:1024
s_waitcnt lgkmcnt(12)
v_mfma_f32_16x16x32_bf16 v[168:171],v[112:115],v[0:3],v[168:171]
v_add_u32 v233,24576,v233
ds_read_b64_tr_b16 v[104:105],v233 offset:0
v_mfma_f32_16x16x32_bf16 v[172:175],v[112:115],v[4:7],v[172:175]
ds_read_b64_tr_b16 v[106:107],v233 offset:1024
s_waitcnt lgkmcnt(12)
v_mfma_f32_16x16x32_bf16 v[176:179],v[116:119],v[0:3],v[176:179]
v_add_u32 v234,24576,v234
ds_read_b64_tr_b16 v[108:109],v234 offset:0
v_mfma_f32_16x16x32_bf16 v[180:183],v[116:119],v[4:7],v[180:183]
ds_read_b64_tr_b16 v[110:111],v234 offset:1024
s_waitcnt lgkmcnt(12)
v_mfma_f32_16x16x32_bf16 v[184:187],v[120:123],v[0:3],v[184:187]
v_add_u32 v235,24576,v235
ds_read_b64_tr_b16 v[112:113],v235 offset:0
v_mfma_f32_16x16x32_bf16 v[188:191],v[120:123],v[4:7],v[188:191]
ds_read_b64_tr_b16 v[114:115],v235 offset:1024
s_waitcnt lgkmcnt(12)
v_mfma_f32_16x16x32_bf16 v[192:195],v[124:127],v[0:3],v[192:195]
v_add_u32 v236,24576,v236
ds_read_b64_tr_b16 v[116:117],v236 offset:0
v_mfma_f32_16x16x32_bf16 v[196:199],v[124:127],v[4:7],v[196:199]
ds_read_b64_tr_b16 v[118:119],v236 offset:1024
s_waitcnt lgkmcnt(12)
v_mfma_f32_16x16x32_bf16 v[200:203],v[128:131],v[0:3],v[200:203]
ds_read_b64_tr_b16 v[120:121],v232 offset:8192
v_mfma_f32_16x16x32_bf16 v[204:207],v[128:131],v[4:7],v[204:207]
ds_read_b64_tr_b16 v[122:123],v232 offset:9216
s_waitcnt lgkmcnt(12)
s_waitcnt lgkmcnt(10)
v_mfma_f32_16x16x32_bf16 v[244:247],v[240:243],v[8:11],v[244:247]
v_mfma_f32_16x16x32_bf16 v[248:251],v[8:11],v[8:11],v[248:251]
v_mfma_f32_16x16x32_bf16 v[144:147],v[100:103],v[8:11],v[144:147]
ds_read_b64_tr_b16 v[124:125],v233 offset:8192
v_mfma_f32_16x16x32_bf16 v[148:151],v[100:103],v[12:15],v[148:151]
ds_read_b64_tr_b16 v[126:127],v233 offset:9216
s_waitcnt lgkmcnt(10)
v_mfma_f32_16x16x32_bf16 v[152:155],v[104:107],v[8:11],v[152:155]
ds_read_b64_tr_b16 v[128:129],v234 offset:8192
v_mfma_f32_16x16x32_bf16 v[156:159],v[104:107],v[12:15],v[156:159]
ds_read_b64_tr_b16 v[130:131],v234 offset:9216
s_waitcnt lgkmcnt(10)
v_mfma_f32_16x16x32_bf16 v[160:163],v[108:111],v[8:11],v[160:163]
s_barrier
ds_read_b128 v[16:19],v255 offset:20480
ds_read_b128 v[20:23],v255 offset:22528
v_subrev_u32 v232,98304,v232
ds_read_b64_tr_b16 v[100:101],v232 offset:0
v_mfma_f32_16x16x32_bf16 v[164:167],v[108:111],v[12:15],v[164:167]
ds_read_b64_tr_b16 v[102:103],v232 offset:1024
s_waitcnt lgkmcnt(12)
v_mfma_f32_16x16x32_bf16 v[168:171],v[112:115],v[8:11],v[168:171]
v_subrev_u32 v233,98304,v233
ds_read_b64_tr_b16 v[104:105],v233 offset:0
v_mfma_f32_16x16x32_bf16 v[172:175],v[112:115],v[12:15],v[172:175]
ds_read_b64_tr_b16 v[106:107],v233 offset:1024
s_waitcnt lgkmcnt(12)
v_mfma_f32_16x16x32_bf16 v[176:179],v[116:119],v[8:11],v[176:179]
v_subrev_u32 v234,98304,v234
ds_read_b64_tr_b16 v[108:109],v234 offset:0
v_mfma_f32_16x16x32_bf16 v[180:183],v[116:119],v[12:15],v[180:183]
ds_read_b64_tr_b16 v[110:111],v234 offset:1024
s_waitcnt lgkmcnt(12)
v_mfma_f32_16x16x32_bf16 v[184:187],v[120:123],v[8:11],v[184:187]
v_subrev_u32 v235,98304,v235
ds_read_b64_tr_b16 v[112:113],v235 offset:0
v_mfma_f32_16x16x32_bf16 v[188:191],v[120:123],v[12:15],v[188:191]
ds_read_b64_tr_b16 v[114:115],v235 offset:1024
s_waitcnt lgkmcnt(12)
v_mfma_f32_16x16x32_bf16 v[192:195],v[124:127],v[8:11],v[192:195]
v_subrev_u32 v236,98304,v236
ds_read_b64_tr_b16 v[116:117],v236 offset:0
v_mfma_f32_16x16x32_bf16 v[196:199],v[124:127],v[12:15],v[196:199]
ds_read_b64_tr_b16 v[118:119],v236 offset:1024
s_waitcnt lgkmcnt(12)
v_mfma_f32_16x16x32_bf16 v[200:203],v[128:131],v[8:11],v[200:203]
ds_read_b64_tr_b16 v[120:121],v232 offset:8192
v_mfma_f32_16x16x32_bf16 v[204:207],v[128:131],v[12:15],v[204:207]
ds_read_b64_tr_b16 v[122:123],v232 offset:9216
s_waitcnt lgkmcnt(12)
s_waitcnt lgkmcnt(10)
v_mfma_f32_16x16x32_bf16 v[244:247],v[240:243],v[16:19],v[244:247]
v_mfma_f32_16x16x32_bf16 v[248:251],v[16:19],v[16:19],v[248:251]
v_mfma_f32_16x16x32_bf16 v[144:147],v[100:103],v[16:19],v[144:147]
ds_read_b64_tr_b16 v[124:125],v233 offset:8192
v_mfma_f32_16x16x32_bf16 v[148:151],v[100:103],v[20:23],v[148:151]
ds_read_b64_tr_b16 v[126:127],v233 offset:9216
s_waitcnt lgkmcnt(10)
v_mfma_f32_16x16x32_bf16 v[152:155],v[104:107],v[16:19],v[152:155]
ds_read_b64_tr_b16 v[128:129],v234 offset:8192
v_mfma_f32_16x16x32_bf16 v[156:159],v[104:107],v[20:23],v[156:159]
ds_read_b64_tr_b16 v[130:131],v234 offset:9216
s_waitcnt lgkmcnt(10)
v_mfma_f32_16x16x32_bf16 v[160:163],v[108:111],v[16:19],v[160:163]
s_barrier
ds_read_b128 v[0:3],v254 offset:0
ds_read_b128 v[4:7],v254 offset:2048
v_add_u32 v232,24576,v232
ds_read_b64_tr_b16 v[100:101],v232 offset:0
v_mfma_f32_16x16x32_bf16 v[164:167],v[108:111],v[20:23],v[164:167]
ds_read_b64_tr_b16 v[102:103],v232 offset:1024
s_waitcnt lgkmcnt(12)
v_mfma_f32_16x16x32_bf16 v[168:171],v[112:115],v[16:19],v[168:171]
v_add_u32 v233,24576,v233
ds_read_b64_tr_b16 v[104:105],v233 offset:0
v_mfma_f32_16x16x32_bf16 v[172:175],v[112:115],v[20:23],v[172:175]
ds_read_b64_tr_b16 v[106:107],v233 offset:1024
s_waitcnt lgkmcnt(12)
v_mfma_f32_16x16x32_bf16 v[176:179],v[116:119],v[16:19],v[176:179]
v_add_u32 v234,24576,v234
ds_read_b64_tr_b16 v[108:109],v234 offset:0
v_mfma_f32_16x16x32_bf16 v[180:183],v[116:119],v[20:23],v[180:183]
ds_read_b64_tr_b16 v[110:111],v234 offset:1024
s_waitcnt lgkmcnt(12)
v_mfma_f32_16x16x32_bf16 v[184:187],v[120:123],v[16:19],v[184:187]
v_add_u32 v235,24576,v235
ds_read_b64_tr_b16 v[112:113],v235 offset:0
v_mfma_f32_16x16x32_bf16 v[188:191],v[120:123],v[20:23],v[188:191]
ds_read_b64_tr_b16 v[114:115],v235 offset:1024
s_waitcnt lgkmcnt(12)
v_mfma_f32_16x16x32_bf16 v[192:195],v[124:127],v[16:19],v[192:195]
v_add_u32 v236,24576,v236
ds_read_b64_tr_b16 v[116:117],v236 offset:0
v_mfma_f32_16x16x32_bf16 v[196:199],v[124:127],v[20:23],v[196:199]
ds_read_b64_tr_b16 v[118:119],v236 offset:1024
s_waitcnt lgkmcnt(12)
v_mfma_f32_16x16x32_bf16 v[200:203],v[128:131],v[16:19],v[200:203]
ds_read_b64_tr_b16 v[120:121],v232 offset:8192
v_mfma_f32_16x16x32_bf16 v[204:207],v[128:131],v[20:23],v[204:207]
ds_read_b64_tr_b16 v[122:123],v232 offset:9216
s_waitcnt lgkmcnt(12)
s_waitcnt lgkmcnt(10)
v_mfma_f32_16x16x32_bf16 v[244:247],v[240:243],v[0:3],v[244:247]
v_mfma_f32_16x16x32_bf16 v[248:251],v[0:3],v[0:3],v[248:251]
v_mfma_f32_16x16x32_bf16 v[144:147],v[100:103],v[0:3],v[144:147]
ds_read_b64_tr_b16 v[124:125],v233 offset:8192
v_mfma_f32_16x16x32_bf16 v[148:151],v[100:103],v[4:7],v[148:151]
ds_read_b64_tr_b16 v[126:127],v233 offset:9216
s_waitcnt lgkmcnt(10)
v_mfma_f32_16x16x32_bf16 v[152:155],v[104:107],v[0:3],v[152:155]
ds_read_b64_tr_b16 v[128:129],v234 offset:8192
v_mfma_f32_16x16x32_bf16 v[156:159],v[104:107],v[4:7],v[156:159]
ds_read_b64_tr_b16 v[130:131],v234 offset:9216
s_waitcnt lgkmcnt(10)
v_mfma_f32_16x16x32_bf16 v[160:163],v[108:111],v[0:3],v[160:163]
s_barrier
ds_read_b128 v[8:11],v255 offset:0
ds_read_b128 v[12:15],v255 offset:2048
v_add_u32 v232,24576,v232
ds_read_b64_tr_b16 v[100:101],v232 offset:0
v_mfma_f32_16x16x32_bf16 v[164:167],v[108:111],v[4:7],v[164:167]
ds_read_b64_tr_b16 v[102:103],v232 offset:1024
s_waitcnt lgkmcnt(12)
v_mfma_f32_16x16x32_bf16 v[168:171],v[112:115],v[0:3],v[168:171]
v_add_u32 v233,24576,v233
ds_read_b64_tr_b16 v[104:105],v233 offset:0
v_mfma_f32_16x16x32_bf16 v[172:175],v[112:115],v[4:7],v[172:175]
ds_read_b64_tr_b16 v[106:107],v233 offset:1024
s_waitcnt lgkmcnt(12)
v_mfma_f32_16x16x32_bf16 v[176:179],v[116:119],v[0:3],v[176:179]
v_add_u32 v234,24576,v234
ds_read_b64_tr_b16 v[108:109],v234 offset:0
v_mfma_f32_16x16x32_bf16 v[180:183],v[116:119],v[4:7],v[180:183]
ds_read_b64_tr_b16 v[110:111],v234 offset:1024
s_waitcnt lgkmcnt(12)
v_mfma_f32_16x16x32_bf16 v[184:187],v[120:123],v[0:3],v[184:187]
v_add_u32 v235,24576,v235
ds_read_b64_tr_b16 v[112:113],v235 offset:0
v_mfma_f32_16x16x32_bf16 v[188:191],v[120:123],v[4:7],v[188:191]
ds_read_b64_tr_b16 v[114:115],v235 offset:1024
s_waitcnt lgkmcnt(12)
v_mfma_f32_16x16x32_bf16 v[192:195],v[124:127],v[0:3],v[192:195]
v_add_u32 v236,24576,v236
ds_read_b64_tr_b16 v[116:117],v236 offset:0
v_mfma_f32_16x16x32_bf16 v[196:199],v[124:127],v[4:7],v[196:199]
ds_read_b64_tr_b16 v[118:119],v236 offset:1024
s_waitcnt lgkmcnt(12)
v_mfma_f32_16x16x32_bf16 v[200:203],v[128:131],v[0:3],v[200:203]
ds_read_b64_tr_b16 v[120:121],v232 offset:8192
v_mfma_f32_16x16x32_bf16 v[204:207],v[128:131],v[4:7],v[204:207]
ds_read_b64_tr_b16 v[122:123],v232 offset:9216
s_waitcnt lgkmcnt(12)
s_waitcnt lgkmcnt(10)
v_mfma_f32_16x16x32_bf16 v[244:247],v[240:243],v[8:11],v[244:247]
v_mfma_f32_16x16x32_bf16 v[248:251],v[8:11],v[8:11],v[248:251]
v_mfma_f32_16x16x32_bf16 v[144:147],v[100:103],v[8:11],v[144:147]
ds_read_b64_tr_b16 v[124:125],v233 offset:8192
v_mfma_f32_16x16x32_bf16 v[148:151],v[100:103],v[12:15],v[148:151]
ds_read_b64_tr_b16 v[126:127],v233 offset:9216
s_waitcnt lgkmcnt(10)
v_mfma_f32_16x16x32_bf16 v[152:155],v[104:107],v[8:11],v[152:155]
ds_read_b64_tr_b16 v[128:129],v234 offset:8192
v_mfma_f32_16x16x32_bf16 v[156:159],v[104:107],v[12:15],v[156:159]
ds_read_b64_tr_b16 v[130:131],v234 offset:9216
s_waitcnt lgkmcnt(10)
v_mfma_f32_16x16x32_bf16 v[160:163],v[108:111],v[8:11],v[160:163]
s_barrier
ds_read_b128 v[16:19],v254 offset:10240
ds_read_b128 v[20:23],v254 offset:12288
v_add_u32 v232,24576,v232
ds_read_b64_tr_b16 v[100:101],v232 offset:0
v_mfma_f32_16x16x32_bf16 v[164:167],v[108:111],v[12:15],v[164:167]
ds_read_b64_tr_b16 v[102:103],v232 offset:1024
s_waitcnt lgkmcnt(12)
v_mfma_f32_16x16x32_bf16 v[168:171],v[112:115],v[8:11],v[168:171]
v_add_u32 v233,24576,v233
ds_read_b64_tr_b16 v[104:105],v233 offset:0
v_mfma_f32_16x16x32_bf16 v[172:175],v[112:115],v[12:15],v[172:175]
ds_read_b64_tr_b16 v[106:107],v233 offset:1024
s_waitcnt lgkmcnt(12)
v_mfma_f32_16x16x32_bf16 v[176:179],v[116:119],v[8:11],v[176:179]
v_add_u32 v234,24576,v234
ds_read_b64_tr_b16 v[108:109],v234 offset:0
v_mfma_f32_16x16x32_bf16 v[180:183],v[116:119],v[12:15],v[180:183]
ds_read_b64_tr_b16 v[110:111],v234 offset:1024
s_waitcnt lgkmcnt(12)
v_mfma_f32_16x16x32_bf16 v[184:187],v[120:123],v[8:11],v[184:187]
v_add_u32 v235,24576,v235
ds_read_b64_tr_b16 v[112:113],v235 offset:0
v_mfma_f32_16x16x32_bf16 v[188:191],v[120:123],v[12:15],v[188:191]
ds_read_b64_tr_b16 v[114:115],v235 offset:1024
s_waitcnt lgkmcnt(12)
v_mfma_f32_16x16x32_bf16 v[192:195],v[124:127],v[8:11],v[192:195]
v_add_u32 v236,24576,v236
ds_read_b64_tr_b16 v[116:117],v236 offset:0
v_mfma_f32_16x16x32_bf16 v[196:199],v[124:127],v[12:15],v[196:199]
ds_read_b64_tr_b16 v[118:119],v236 offset:1024
s_waitcnt lgkmcnt(12)
v_mfma_f32_16x16x32_bf16 v[200:203],v[128:131],v[8:11],v[200:203]
ds_read_b64_tr_b16 v[120:121],v232 offset:8192
v_mfma_f32_16x16x32_bf16 v[204:207],v[128:131],v[12:15],v[204:207]
ds_read_b64_tr_b16 v[122:123],v232 offset:9216
s_waitcnt lgkmcnt(12)
s_waitcnt lgkmcnt(10)
v_mfma_f32_16x16x32_bf16 v[244:247],v[240:243],v[16:19],v[244:247]
v_mfma_f32_16x16x32_bf16 v[248:251],v[16:19],v[16:19],v[248:251]
v_mfma_f32_16x16x32_bf16 v[144:147],v[100:103],v[16:19],v[144:147]
ds_read_b64_tr_b16 v[124:125],v233 offset:8192
v_mfma_f32_16x16x32_bf16 v[148:151],v[100:103],v[20:23],v[148:151]
ds_read_b64_tr_b16 v[126:127],v233 offset:9216
s_waitcnt lgkmcnt(10)
v_mfma_f32_16x16x32_bf16 v[152:155],v[104:107],v[16:19],v[152:155]
ds_read_b64_tr_b16 v[128:129],v234 offset:8192
v_mfma_f32_16x16x32_bf16 v[156:159],v[104:107],v[20:23],v[156:159]
ds_read_b64_tr_b16 v[130:131],v234 offset:9216
s_waitcnt lgkmcnt(10)
v_mfma_f32_16x16x32_bf16 v[160:163],v[108:111],v[16:19],v[160:163]
s_barrier
ds_read_b128 v[0:3],v255 offset:10240
ds_read_b128 v[4:7],v255 offset:12288
v_add_u32 v232,24576,v232
ds_read_b64_tr_b16 v[100:101],v232 offset:0
v_mfma_f32_16x16x32_bf16 v[164:167],v[108:111],v[20:23],v[164:167]
ds_read_b64_tr_b16 v[102:103],v232 offset:1024
s_waitcnt lgkmcnt(12)
v_mfma_f32_16x16x32_bf16 v[168:171],v[112:115],v[16:19],v[168:171]
v_add_u32 v233,24576,v233
ds_read_b64_tr_b16 v[104:105],v233 offset:0
v_mfma_f32_16x16x32_bf16 v[172:175],v[112:115],v[20:23],v[172:175]
ds_read_b64_tr_b16 v[106:107],v233 offset:1024
s_waitcnt lgkmcnt(12)
v_mfma_f32_16x16x32_bf16 v[176:179],v[116:119],v[16:19],v[176:179]
v_add_u32 v234,24576,v234
ds_read_b64_tr_b16 v[108:109],v234 offset:0
v_mfma_f32_16x16x32_bf16 v[180:183],v[116:119],v[20:23],v[180:183]
ds_read_b64_tr_b16 v[110:111],v234 offset:1024
s_waitcnt lgkmcnt(12)
v_mfma_f32_16x16x32_bf16 v[184:187],v[120:123],v[16:19],v[184:187]
v_add_u32 v235,24576,v235
ds_read_b64_tr_b16 v[112:113],v235 offset:0
v_mfma_f32_16x16x32_bf16 v[188:191],v[120:123],v[20:23],v[188:191]
ds_read_b64_tr_b16 v[114:115],v235 offset:1024
s_waitcnt lgkmcnt(12)
v_mfma_f32_16x16x32_bf16 v[192:195],v[124:127],v[16:19],v[192:195]
v_add_u32 v236,24576,v236
ds_read_b64_tr_b16 v[116:117],v236 offset:0
v_mfma_f32_16x16x32_bf16 v[196:199],v[124:127],v[20:23],v[196:199]
ds_read_b64_tr_b16 v[118:119],v236 offset:1024
s_waitcnt lgkmcnt(12)
v_mfma_f32_16x16x32_bf16 v[200:203],v[128:131],v[16:19],v[200:203]
ds_read_b64_tr_b16 v[120:121],v232 offset:8192
v_mfma_f32_16x16x32_bf16 v[204:207],v[128:131],v[20:23],v[204:207]
ds_read_b64_tr_b16 v[122:123],v232 offset:9216
s_waitcnt lgkmcnt(12)
s_waitcnt lgkmcnt(10)
v_mfma_f32_16x16x32_bf16 v[244:247],v[240:243],v[0:3],v[244:247]
v_mfma_f32_16x16x32_bf16 v[248:251],v[0:3],v[0:3],v[248:251]
v_mfma_f32_16x16x32_bf16 v[144:147],v[100:103],v[0:3],v[144:147]
ds_read_b64_tr_b16 v[124:125],v233 offset:8192
v_mfma_f32_16x16x32_bf16 v[148:151],v[100:103],v[4:7],v[148:151]
ds_read_b64_tr_b16 v[126:127],v233 offset:9216
s_waitcnt lgkmcnt(10)
v_mfma_f32_16x16x32_bf16 v[152:155],v[104:107],v[0:3],v[152:155]
ds_read_b64_tr_b16 v[128:129],v234 offset:8192
v_mfma_f32_16x16x32_bf16 v[156:159],v[104:107],v[4:7],v[156:159]
ds_read_b64_tr_b16 v[130:131],v234 offset:9216
s_waitcnt lgkmcnt(10)
v_mfma_f32_16x16x32_bf16 v[160:163],v[108:111],v[0:3],v[160:163]
s_barrier
ds_read_b128 v[8:11],v254 offset:20480
ds_read_b128 v[12:15],v254 offset:22528
v_subrev_u32 v232,98304,v232
ds_read_b64_tr_b16 v[100:101],v232 offset:0
v_mfma_f32_16x16x32_bf16 v[164:167],v[108:111],v[4:7],v[164:167]
ds_read_b64_tr_b16 v[102:103],v232 offset:1024
s_waitcnt lgkmcnt(12)
v_mfma_f32_16x16x32_bf16 v[168:171],v[112:115],v[0:3],v[168:171]
v_subrev_u32 v233,98304,v233
ds_read_b64_tr_b16 v[104:105],v233 offset:0
v_mfma_f32_16x16x32_bf16 v[172:175],v[112:115],v[4:7],v[172:175]
ds_read_b64_tr_b16 v[106:107],v233 offset:1024
s_waitcnt lgkmcnt(12)
v_mfma_f32_16x16x32_bf16 v[176:179],v[116:119],v[0:3],v[176:179]
v_subrev_u32 v234,98304,v234
ds_read_b64_tr_b16 v[108:109],v234 offset:0
v_mfma_f32_16x16x32_bf16 v[180:183],v[116:119],v[4:7],v[180:183]
ds_read_b64_tr_b16 v[110:111],v234 offset:1024
s_waitcnt lgkmcnt(12)
v_mfma_f32_16x16x32_bf16 v[184:187],v[120:123],v[0:3],v[184:187]
v_subrev_u32 v235,98304,v235
ds_read_b64_tr_b16 v[112:113],v235 offset:0
v_mfma_f32_16x16x32_bf16 v[188:191],v[120:123],v[4:7],v[188:191]
ds_read_b64_tr_b16 v[114:115],v235 offset:1024
s_waitcnt lgkmcnt(12)
v_mfma_f32_16x16x32_bf16 v[192:195],v[124:127],v[0:3],v[192:195]
v_subrev_u32 v236,98304,v236
ds_read_b64_tr_b16 v[116:117],v236 offset:0
v_mfma_f32_16x16x32_bf16 v[196:199],v[124:127],v[4:7],v[196:199]
ds_read_b64_tr_b16 v[118:119],v236 offset:1024
s_waitcnt lgkmcnt(12)
v_mfma_f32_16x16x32_bf16 v[200:203],v[128:131],v[0:3],v[200:203]
ds_read_b64_tr_b16 v[120:121],v232 offset:8192
v_mfma_f32_16x16x32_bf16 v[204:207],v[128:131],v[4:7],v[204:207]
ds_read_b64_tr_b16 v[122:123],v232 offset:9216
s_waitcnt lgkmcnt(12)
s_waitcnt lgkmcnt(10)
v_mfma_f32_16x16x32_bf16 v[244:247],v[240:243],v[8:11],v[244:247]
v_mfma_f32_16x16x32_bf16 v[248:251],v[8:11],v[8:11],v[248:251]
v_mfma_f32_16x16x32_bf16 v[144:147],v[100:103],v[8:11],v[144:147]
ds_read_b64_tr_b16 v[124:125],v233 offset:8192
v_mfma_f32_16x16x32_bf16 v[148:151],v[100:103],v[12:15],v[148:151]
ds_read_b64_tr_b16 v[126:127],v233 offset:9216
s_waitcnt lgkmcnt(10)
v_mfma_f32_16x16x32_bf16 v[152:155],v[104:107],v[8:11],v[152:155]
ds_read_b64_tr_b16 v[128:129],v234 offset:8192
v_mfma_f32_16x16x32_bf16 v[156:159],v[104:107],v[12:15],v[156:159]
ds_read_b64_tr_b16 v[130:131],v234 offset:9216
s_waitcnt lgkmcnt(10)
v_mfma_f32_16x16x32_bf16 v[160:163],v[108:111],v[8:11],v[160:163]
s_barrier
ds_read_b128 v[16:19],v255 offset:20480
ds_read_b128 v[20:23],v255 offset:22528
v_add_u32 v232,24576,v232
ds_read_b64_tr_b16 v[100:101],v232 offset:0
v_mfma_f32_16x16x32_bf16 v[164:167],v[108:111],v[12:15],v[164:167]
ds_read_b64_tr_b16 v[102:103],v232 offset:1024
s_waitcnt lgkmcnt(12)
v_mfma_f32_16x16x32_bf16 v[168:171],v[112:115],v[8:11],v[168:171]
v_add_u32 v233,24576,v233
ds_read_b64_tr_b16 v[104:105],v233 offset:0
v_mfma_f32_16x16x32_bf16 v[172:175],v[112:115],v[12:15],v[172:175]
ds_read_b64_tr_b16 v[106:107],v233 offset:1024
s_waitcnt lgkmcnt(12)
v_mfma_f32_16x16x32_bf16 v[176:179],v[116:119],v[8:11],v[176:179]
v_add_u32 v234,24576,v234
ds_read_b64_tr_b16 v[108:109],v234 offset:0
v_mfma_f32_16x16x32_bf16 v[180:183],v[116:119],v[12:15],v[180:183]
ds_read_b64_tr_b16 v[110:111],v234 offset:1024
s_waitcnt lgkmcnt(12)
v_mfma_f32_16x16x32_bf16 v[184:187],v[120:123],v[8:11],v[184:187]
v_add_u32 v235,24576,v235
ds_read_b64_tr_b16 v[112:113],v235 offset:0
v_mfma_f32_16x16x32_bf16 v[188:191],v[120:123],v[12:15],v[188:191]
ds_read_b64_tr_b16 v[114:115],v235 offset:1024
s_waitcnt lgkmcnt(12)
v_mfma_f32_16x16x32_bf16 v[192:195],v[124:127],v[8:11],v[192:195]
v_add_u32 v236,24576,v236
ds_read_b64_tr_b16 v[116:117],v236 offset:0
v_mfma_f32_16x16x32_bf16 v[196:199],v[124:127],v[12:15],v[196:199]
ds_read_b64_tr_b16 v[118:119],v236 offset:1024
s_waitcnt lgkmcnt(12)
v_mfma_f32_16x16x32_bf16 v[200:203],v[128:131],v[8:11],v[200:203]
ds_read_b64_tr_b16 v[120:121],v232 offset:8192
v_mfma_f32_16x16x32_bf16 v[204:207],v[128:131],v[12:15],v[204:207]
ds_read_b64_tr_b16 v[122:123],v232 offset:9216
s_waitcnt lgkmcnt(12)
s_waitcnt lgkmcnt(10)
v_mfma_f32_16x16x32_bf16 v[244:247],v[240:243],v[16:19],v[244:247]
v_mfma_f32_16x16x32_bf16 v[248:251],v[16:19],v[16:19],v[248:251]
v_mfma_f32_16x16x32_bf16 v[144:147],v[100:103],v[16:19],v[144:147]
ds_read_b64_tr_b16 v[124:125],v233 offset:8192
v_mfma_f32_16x16x32_bf16 v[148:151],v[100:103],v[20:23],v[148:151]
ds_read_b64_tr_b16 v[126:127],v233 offset:9216
s_waitcnt lgkmcnt(10)
v_mfma_f32_16x16x32_bf16 v[152:155],v[104:107],v[16:19],v[152:155]
ds_read_b64_tr_b16 v[128:129],v234 offset:8192
v_mfma_f32_16x16x32_bf16 v[156:159],v[104:107],v[20:23],v[156:159]
ds_read_b64_tr_b16 v[130:131],v234 offset:9216
s_waitcnt lgkmcnt(10)
v_mfma_f32_16x16x32_bf16 v[160:163],v[108:111],v[16:19],v[160:163]
s_barrier
ds_read_b128 v[0:3],v254 offset:0
ds_read_b128 v[4:7],v254 offset:2048
v_add_u32 v232,24576,v232
ds_read_b64_tr_b16 v[100:101],v232 offset:0
v_mfma_f32_16x16x32_bf16 v[164:167],v[108:111],v[20:23],v[164:167]
ds_read_b64_tr_b16 v[102:103],v232 offset:1024
s_waitcnt lgkmcnt(12)
v_mfma_f32_16x16x32_bf16 v[168:171],v[112:115],v[16:19],v[168:171]
v_add_u32 v233,24576,v233
ds_read_b64_tr_b16 v[104:105],v233 offset:0
v_mfma_f32_16x16x32_bf16 v[172:175],v[112:115],v[20:23],v[172:175]
ds_read_b64_tr_b16 v[106:107],v233 offset:1024
s_waitcnt lgkmcnt(12)
v_mfma_f32_16x16x32_bf16 v[176:179],v[116:119],v[16:19],v[176:179]
v_add_u32 v234,24576,v234
ds_read_b64_tr_b16 v[108:109],v234 offset:0
v_mfma_f32_16x16x32_bf16 v[180:183],v[116:119],v[20:23],v[180:183]
ds_read_b64_tr_b16 v[110:111],v234 offset:1024
s_waitcnt lgkmcnt(12)
v_mfma_f32_16x16x32_bf16 v[184:187],v[120:123],v[16:19],v[184:187]
v_add_u32 v235,24576,v235
ds_read_b64_tr_b16 v[112:113],v235 offset:0
v_mfma_f32_16x16x32_bf16 v[188:191],v[120:123],v[20:23],v[188:191]
ds_read_b64_tr_b16 v[114:115],v235 offset:1024
s_waitcnt lgkmcnt(12)
v_mfma_f32_16x16x32_bf16 v[192:195],v[124:127],v[16:19],v[192:195]
v_add_u32 v236,24576,v236
ds_read_b64_tr_b16 v[116:117],v236 offset:0
v_mfma_f32_16x16x32_bf16 v[196:199],v[124:127],v[20:23],v[196:199]
ds_read_b64_tr_b16 v[118:119],v236 offset:1024
s_waitcnt lgkmcnt(12)
v_mfma_f32_16x16x32_bf16 v[200:203],v[128:131],v[16:19],v[200:203]
ds_read_b64_tr_b16 v[120:121],v232 offset:8192
v_mfma_f32_16x16x32_bf16 v[204:207],v[128:131],v[20:23],v[204:207]
ds_read_b64_tr_b16 v[122:123],v232 offset:9216
s_waitcnt lgkmcnt(12)
s_waitcnt lgkmcnt(10)
v_mfma_f32_16x16x32_bf16 v[244:247],v[240:243],v[0:3],v[244:247]
v_mfma_f32_16x16x32_bf16 v[248:251],v[0:3],v[0:3],v[248:251]
v_mfma_f32_16x16x32_bf16 v[144:147],v[100:103],v[0:3],v[144:147]
ds_read_b64_tr_b16 v[124:125],v233 offset:8192
v_mfma_f32_16x16x32_bf16 v[148:151],v[100:103],v[4:7],v[148:151]
ds_read_b64_tr_b16 v[126:127],v233 offset:9216
s_waitcnt lgkmcnt(10)
v_mfma_f32_16x16x32_bf16 v[152:155],v[104:107],v[0:3],v[152:155]
ds_read_b64_tr_b16 v[128:129],v234 offset:8192
v_mfma_f32_16x16x32_bf16 v[156:159],v[104:107],v[4:7],v[156:159]
ds_read_b64_tr_b16 v[130:131],v234 offset:9216
s_waitcnt lgkmcnt(10)
v_mfma_f32_16x16x32_bf16 v[160:163],v[108:111],v[0:3],v[160:163]
s_barrier
ds_read_b128 v[8:11],v255 offset:0
ds_read_b128 v[12:15],v255 offset:2048
v_add_u32 v232,24576,v232
ds_read_b64_tr_b16 v[100:101],v232 offset:0
v_mfma_f32_16x16x32_bf16 v[164:167],v[108:111],v[4:7],v[164:167]
ds_read_b64_tr_b16 v[102:103],v232 offset:1024
s_waitcnt lgkmcnt(12)
v_mfma_f32_16x16x32_bf16 v[168:171],v[112:115],v[0:3],v[168:171]
v_add_u32 v233,24576,v233
ds_read_b64_tr_b16 v[104:105],v233 offset:0
v_mfma_f32_16x16x32_bf16 v[172:175],v[112:115],v[4:7],v[172:175]
ds_read_b64_tr_b16 v[106:107],v233 offset:1024
s_waitcnt lgkmcnt(12)
v_mfma_f32_16x16x32_bf16 v[176:179],v[116:119],v[0:3],v[176:179]
v_add_u32 v234,24576,v234
ds_read_b64_tr_b16 v[108:109],v234 offset:0
v_mfma_f32_16x16x32_bf16 v[180:183],v[116:119],v[4:7],v[180:183]
ds_read_b64_tr_b16 v[110:111],v234 offset:1024
s_waitcnt lgkmcnt(12)
v_mfma_f32_16x16x32_bf16 v[184:187],v[120:123],v[0:3],v[184:187]
v_add_u32 v235,24576,v235
ds_read_b64_tr_b16 v[112:113],v235 offset:0
v_mfma_f32_16x16x32_bf16 v[188:191],v[120:123],v[4:7],v[188:191]
ds_read_b64_tr_b16 v[114:115],v235 offset:1024
s_waitcnt lgkmcnt(12)
v_mfma_f32_16x16x32_bf16 v[192:195],v[124:127],v[0:3],v[192:195]
v_add_u32 v236,24576,v236
ds_read_b64_tr_b16 v[116:117],v236 offset:0
v_mfma_f32_16x16x32_bf16 v[196:199],v[124:127],v[4:7],v[196:199]
ds_read_b64_tr_b16 v[118:119],v236 offset:1024
s_waitcnt lgkmcnt(12)
v_mfma_f32_16x16x32_bf16 v[200:203],v[128:131],v[0:3],v[200:203]
ds_read_b64_tr_b16 v[120:121],v232 offset:8192
v_mfma_f32_16x16x32_bf16 v[204:207],v[128:131],v[4:7],v[204:207]
ds_read_b64_tr_b16 v[122:123],v232 offset:9216
s_waitcnt lgkmcnt(12)
s_waitcnt lgkmcnt(10)
v_mfma_f32_16x16x32_bf16 v[244:247],v[240:243],v[8:11],v[244:247]
v_mfma_f32_16x16x32_bf16 v[248:251],v[8:11],v[8:11],v[248:251]
v_mfma_f32_16x16x32_bf16 v[144:147],v[100:103],v[8:11],v[144:147]
ds_read_b64_tr_b16 v[124:125],v233 offset:8192
v_mfma_f32_16x16x32_bf16 v[148:151],v[100:103],v[12:15],v[148:151]
ds_read_b64_tr_b16 v[126:127],v233 offset:9216
s_waitcnt lgkmcnt(10)
v_mfma_f32_16x16x32_bf16 v[152:155],v[104:107],v[8:11],v[152:155]
ds_read_b64_tr_b16 v[128:129],v234 offset:8192
v_mfma_f32_16x16x32_bf16 v[156:159],v[104:107],v[12:15],v[156:159]
ds_read_b64_tr_b16 v[130:131],v234 offset:9216
s_waitcnt lgkmcnt(10)
v_mfma_f32_16x16x32_bf16 v[160:163],v[108:111],v[8:11],v[160:163]
s_barrier
ds_read_b128 v[16:19],v254 offset:10240
ds_read_b128 v[20:23],v254 offset:12288
v_add_u32 v232,24576,v232
ds_read_b64_tr_b16 v[100:101],v232 offset:0
v_mfma_f32_16x16x32_bf16 v[164:167],v[108:111],v[12:15],v[164:167]
ds_read_b64_tr_b16 v[102:103],v232 offset:1024
s_waitcnt lgkmcnt(12)
v_mfma_f32_16x16x32_bf16 v[168:171],v[112:115],v[8:11],v[168:171]
v_add_u32 v233,24576,v233
ds_read_b64_tr_b16 v[104:105],v233 offset:0
v_mfma_f32_16x16x32_bf16 v[172:175],v[112:115],v[12:15],v[172:175]
ds_read_b64_tr_b16 v[106:107],v233 offset:1024
s_waitcnt lgkmcnt(12)
v_mfma_f32_16x16x32_bf16 v[176:179],v[116:119],v[8:11],v[176:179]
v_add_u32 v234,24576,v234
ds_read_b64_tr_b16 v[108:109],v234 offset:0
v_mfma_f32_16x16x32_bf16 v[180:183],v[116:119],v[12:15],v[180:183]
ds_read_b64_tr_b16 v[110:111],v234 offset:1024
s_waitcnt lgkmcnt(12)
v_mfma_f32_16x16x32_bf16 v[184:187],v[120:123],v[8:11],v[184:187]
v_add_u32 v235,24576,v235
ds_read_b64_tr_b16 v[112:113],v235 offset:0
v_mfma_f32_16x16x32_bf16 v[188:191],v[120:123],v[12:15],v[188:191]
ds_read_b64_tr_b16 v[114:115],v235 offset:1024
s_waitcnt lgkmcnt(12)
v_mfma_f32_16x16x32_bf16 v[192:195],v[124:127],v[8:11],v[192:195]
v_add_u32 v236,24576,v236
ds_read_b64_tr_b16 v[116:117],v236 offset:0
v_mfma_f32_16x16x32_bf16 v[196:199],v[124:127],v[12:15],v[196:199]
ds_read_b64_tr_b16 v[118:119],v236 offset:1024
s_waitcnt lgkmcnt(12)
v_mfma_f32_16x16x32_bf16 v[200:203],v[128:131],v[8:11],v[200:203]
ds_read_b64_tr_b16 v[120:121],v232 offset:8192
v_mfma_f32_16x16x32_bf16 v[204:207],v[128:131],v[12:15],v[204:207]
ds_read_b64_tr_b16 v[122:123],v232 offset:9216
s_waitcnt lgkmcnt(12)
s_waitcnt lgkmcnt(10)
v_mfma_f32_16x16x32_bf16 v[244:247],v[240:243],v[16:19],v[244:247]
v_mfma_f32_16x16x32_bf16 v[248:251],v[16:19],v[16:19],v[248:251]
v_mfma_f32_16x16x32_bf16 v[144:147],v[100:103],v[16:19],v[144:147]
ds_read_b64_tr_b16 v[124:125],v233 offset:8192
v_mfma_f32_16x16x32_bf16 v[148:151],v[100:103],v[20:23],v[148:151]
ds_read_b64_tr_b16 v[126:127],v233 offset:9216
s_waitcnt lgkmcnt(10)
v_mfma_f32_16x16x32_bf16 v[152:155],v[104:107],v[16:19],v[152:155]
ds_read_b64_tr_b16 v[128:129],v234 offset:8192
v_mfma_f32_16x16x32_bf16 v[156:159],v[104:107],v[20:23],v[156:159]
ds_read_b64_tr_b16 v[130:131],v234 offset:9216
s_waitcnt lgkmcnt(10)
v_mfma_f32_16x16x32_bf16 v[160:163],v[108:111],v[16:19],v[160:163]
s_barrier
ds_read_b128 v[0:3],v255 offset:10240
ds_read_b128 v[4:7],v255 offset:12288
v_subrev_u32 v232,98304,v232
ds_read_b64_tr_b16 v[100:101],v232 offset:0
v_mfma_f32_16x16x32_bf16 v[164:167],v[108:111],v[20:23],v[164:167]
ds_read_b64_tr_b16 v[102:103],v232 offset:1024
s_waitcnt lgkmcnt(12)
v_mfma_f32_16x16x32_bf16 v[168:171],v[112:115],v[16:19],v[168:171]
v_subrev_u32 v233,98304,v233
ds_read_b64_tr_b16 v[104:105],v233 offset:0
v_mfma_f32_16x16x32_bf16 v[172:175],v[112:115],v[20:23],v[172:175]
ds_read_b64_tr_b16 v[106:107],v233 offset:1024
s_waitcnt lgkmcnt(12)
v_mfma_f32_16x16x32_bf16 v[176:179],v[116:119],v[16:19],v[176:179]
v_subrev_u32 v234,98304,v234
ds_read_b64_tr_b16 v[108:109],v234 offset:0
v_mfma_f32_16x16x32_bf16 v[180:183],v[116:119],v[20:23],v[180:183]
ds_read_b64_tr_b16 v[110:111],v234 offset:1024
s_waitcnt lgkmcnt(12)
v_mfma_f32_16x16x32_bf16 v[184:187],v[120:123],v[16:19],v[184:187]
v_subrev_u32 v235,98304,v235
ds_read_b64_tr_b16 v[112:113],v235 offset:0
v_mfma_f32_16x16x32_bf16 v[188:191],v[120:123],v[20:23],v[188:191]
ds_read_b64_tr_b16 v[114:115],v235 offset:1024
s_waitcnt lgkmcnt(12)
v_mfma_f32_16x16x32_bf16 v[192:195],v[124:127],v[16:19],v[192:195]
v_subrev_u32 v236,98304,v236
ds_read_b64_tr_b16 v[116:117],v236 offset:0
v_mfma_f32_16x16x32_bf16 v[196:199],v[124:127],v[20:23],v[196:199]
ds_read_b64_tr_b16 v[118:119],v236 offset:1024
s_waitcnt lgkmcnt(12)
v_mfma_f32_16x16x32_bf16 v[200:203],v[128:131],v[16:19],v[200:203]
ds_read_b64_tr_b16 v[120:121],v232 offset:8192
v_mfma_f32_16x16x32_bf16 v[204:207],v[128:131],v[20:23],v[204:207]
ds_read_b64_tr_b16 v[122:123],v232 offset:9216
s_waitcnt lgkmcnt(12)
s_waitcnt lgkmcnt(10)
v_mfma_f32_16x16x32_bf16 v[244:247],v[240:243],v[0:3],v[244:247]
v_mfma_f32_16x16x32_bf16 v[248:251],v[0:3],v[0:3],v[248:251]
v_mfma_f32_16x16x32_bf16 v[144:147],v[100:103],v[0:3],v[144:147]
ds_read_b64_tr_b16 v[124:125],v233 offset:8192
v_mfma_f32_16x16x32_bf16 v[148:151],v[100:103],v[4:7],v[148:151]
ds_read_b64_tr_b16 v[126:127],v233 offset:9216
s_waitcnt lgkmcnt(10)
v_mfma_f32_16x16x32_bf16 v[152:155],v[104:107],v[0:3],v[152:155]
ds_read_b64_tr_b16 v[128:129],v234 offset:8192
v_mfma_f32_16x16x32_bf16 v[156:159],v[104:107],v[4:7],v[156:159]
ds_read_b64_tr_b16 v[130:131],v234 offset:9216
s_waitcnt lgkmcnt(10)
v_mfma_f32_16x16x32_bf16 v[160:163],v[108:111],v[0:3],v[160:163]
s_barrier
ds_read_b128 v[8:11],v254 offset:20480
ds_read_b128 v[12:15],v254 offset:22528
v_add_u32 v232,24576,v232
ds_read_b64_tr_b16 v[100:101],v232 offset:0
v_mfma_f32_16x16x32_bf16 v[164:167],v[108:111],v[4:7],v[164:167]
ds_read_b64_tr_b16 v[102:103],v232 offset:1024
s_waitcnt lgkmcnt(12)
v_mfma_f32_16x16x32_bf16 v[168:171],v[112:115],v[0:3],v[168:171]
v_add_u32 v233,24576,v233
ds_read_b64_tr_b16 v[104:105],v233 offset:0
v_mfma_f32_16x16x32_bf16 v[172:175],v[112:115],v[4:7],v[172:175]
ds_read_b64_tr_b16 v[106:107],v233 offset:1024
s_waitcnt lgkmcnt(12)
v_mfma_f32_16x16x32_bf16 v[176:179],v[116:119],v[0:3],v[176:179]
v_add_u32 v234,24576,v234
ds_read_b64_tr_b16 v[108:109],v234 offset:0
v_mfma_f32_16x16x32_bf16 v[180:183],v[116:119],v[4:7],v[180:183]
ds_read_b64_tr_b16 v[110:111],v234 offset:1024
s_waitcnt lgkmcnt(12)
v_mfma_f32_16x16x32_bf16 v[184:187],v[120:123],v[0:3],v[184:187]
v_add_u32 v235,24576,v235
ds_read_b64_tr_b16 v[112:113],v235 offset:0
v_mfma_f32_16x16x32_bf16 v[188:191],v[120:123],v[4:7],v[188:191]
ds_read_b64_tr_b16 v[114:115],v235 offset:1024
s_waitcnt lgkmcnt(12)
v_mfma_f32_16x16x32_bf16 v[192:195],v[124:127],v[0:3],v[192:195]
v_add_u32 v236,24576,v236
ds_read_b64_tr_b16 v[116:117],v236 offset:0
v_mfma_f32_16x16x32_bf16 v[196:199],v[124:127],v[4:7],v[196:199]
ds_read_b64_tr_b16 v[118:119],v236 offset:1024
s_waitcnt lgkmcnt(12)
v_mfma_f32_16x16x32_bf16 v[200:203],v[128:131],v[0:3],v[200:203]
ds_read_b64_tr_b16 v[120:121],v232 offset:8192
v_mfma_f32_16x16x32_bf16 v[204:207],v[128:131],v[4:7],v[204:207]
ds_read_b64_tr_b16 v[122:123],v232 offset:9216
s_waitcnt lgkmcnt(12)
s_waitcnt lgkmcnt(10)
v_mfma_f32_16x16x32_bf16 v[244:247],v[240:243],v[8:11],v[244:247]
v_mfma_f32_16x16x32_bf16 v[248:251],v[8:11],v[8:11],v[248:251]
v_mfma_f32_16x16x32_bf16 v[144:147],v[100:103],v[8:11],v[144:147]
ds_read_b64_tr_b16 v[124:125],v233 offset:8192
v_mfma_f32_16x16x32_bf16 v[148:151],v[100:103],v[12:15],v[148:151]
ds_read_b64_tr_b16 v[126:127],v233 offset:9216
s_waitcnt lgkmcnt(10)
v_mfma_f32_16x16x32_bf16 v[152:155],v[104:107],v[8:11],v[152:155]
ds_read_b64_tr_b16 v[128:129],v234 offset:8192
v_mfma_f32_16x16x32_bf16 v[156:159],v[104:107],v[12:15],v[156:159]
ds_read_b64_tr_b16 v[130:131],v234 offset:9216
s_waitcnt lgkmcnt(10)
v_mfma_f32_16x16x32_bf16 v[160:163],v[108:111],v[8:11],v[160:163]
s_barrier
ds_read_b128 v[16:19],v255 offset:20480
ds_read_b128 v[20:23],v255 offset:22528
v_add_u32 v232,24576,v232
ds_read_b64_tr_b16 v[100:101],v232 offset:0
v_mfma_f32_16x16x32_bf16 v[164:167],v[108:111],v[12:15],v[164:167]
ds_read_b64_tr_b16 v[102:103],v232 offset:1024
s_waitcnt lgkmcnt(12)
v_mfma_f32_16x16x32_bf16 v[168:171],v[112:115],v[8:11],v[168:171]
v_add_u32 v233,24576,v233
ds_read_b64_tr_b16 v[104:105],v233 offset:0
v_mfma_f32_16x16x32_bf16 v[172:175],v[112:115],v[12:15],v[172:175]
ds_read_b64_tr_b16 v[106:107],v233 offset:1024
s_waitcnt lgkmcnt(12)
v_mfma_f32_16x16x32_bf16 v[176:179],v[116:119],v[8:11],v[176:179]
v_add_u32 v234,24576,v234
ds_read_b64_tr_b16 v[108:109],v234 offset:0
v_mfma_f32_16x16x32_bf16 v[180:183],v[116:119],v[12:15],v[180:183]
ds_read_b64_tr_b16 v[110:111],v234 offset:1024
s_waitcnt lgkmcnt(12)
v_mfma_f32_16x16x32_bf16 v[184:187],v[120:123],v[8:11],v[184:187]
v_add_u32 v235,24576,v235
ds_read_b64_tr_b16 v[112:113],v235 offset:0
v_mfma_f32_16x16x32_bf16 v[188:191],v[120:123],v[12:15],v[188:191]
ds_read_b64_tr_b16 v[114:115],v235 offset:1024
s_waitcnt lgkmcnt(12)
v_mfma_f32_16x16x32_bf16 v[192:195],v[124:127],v[8:11],v[192:195]
v_add_u32 v236,24576,v236
ds_read_b64_tr_b16 v[116:117],v236 offset:0
v_mfma_f32_16x16x32_bf16 v[196:199],v[124:127],v[12:15],v[196:199]
ds_read_b64_tr_b16 v[118:119],v236 offset:1024
s_waitcnt lgkmcnt(12)
v_mfma_f32_16x16x32_bf16 v[200:203],v[128:131],v[8:11],v[200:203]
ds_read_b64_tr_b16 v[120:121],v232 offset:8192
v_mfma_f32_16x16x32_bf16 v[204:207],v[128:131],v[12:15],v[204:207]
ds_read_b64_tr_b16 v[122:123],v232 offset:9216
s_waitcnt lgkmcnt(12)
s_waitcnt lgkmcnt(10)
v_mfma_f32_16x16x32_bf16 v[244:247],v[240:243],v[16:19],v[244:247]
v_mfma_f32_16x16x32_bf16 v[248:251],v[16:19],v[16:19],v[248:251]
v_mfma_f32_16x16x32_bf16 v[144:147],v[100:103],v[16:19],v[144:147]
ds_read_b64_tr_b16 v[124:125],v233 offset:8192
v_mfma_f32_16x16x32_bf16 v[148:151],v[100:103],v[20:23],v[148:151]
ds_read_b64_tr_b16 v[126:127],v233 offset:9216
s_waitcnt lgkmcnt(10)
v_mfma_f32_16x16x32_bf16 v[152:155],v[104:107],v[16:19],v[152:155]
ds_read_b64_tr_b16 v[128:129],v234 offset:8192
v_mfma_f32_16x16x32_bf16 v[156:159],v[104:107],v[20:23],v[156:159]
ds_read_b64_tr_b16 v[130:131],v234 offset:9216
s_waitcnt lgkmcnt(10)
v_mfma_f32_16x16x32_bf16 v[160:163],v[108:111],v[16:19],v[160:163]
v_mfma_f32_16x16x32_bf16 v[164:167],v[108:111],v[20:23],v[164:167]
s_waitcnt lgkmcnt(8)
v_mfma_f32_16x16x32_bf16 v[168:171],v[112:115],v[16:19],v[168:171]
v_mfma_f32_16x16x32_bf16 v[172:175],v[112:115],v[20:23],v[172:175]
v_and_b32 v25,3,v59
v_lshrrev_b32 v26,2,v59
v_cmp_eq_u32 s[56:57],1,v25
v_cmp_eq_u32 s[58:59],2,v25
v_cmp_eq_u32 s[60:61],3,v25
v_cmp_eq_u32 s[62:63],v26,v253
s_waitcnt lgkmcnt(6)
v_mfma_f32_16x16x32_bf16 v[176:179],v[116:119],v[16:19],v[176:179]
v_mfma_f32_16x16x32_bf16 v[180:183],v[116:119],v[20:23],v[180:183]
s_nop 0
v_cndmask_b32 v27,v248,v249,s[56:57]
v_cndmask_b32 v27,v27,v250,s[58:59]
v_cndmask_b32 v27,v27,v251,s[60:61]
v_cndmask_b32 v27,0,v27,s[62:63]
v_mov_b32 v28,v27
s_waitcnt lgkmcnt(4)
v_mfma_f32_16x16x32_bf16 v[184:187],v[120:123],v[16:19],v[184:187]
v_mfma_f32_16x16x32_bf16 v[188:191],v[120:123],v[20:23],v[188:191]
s_nop 1
v_permlane16_swap_b32 v27,v28
s_nop 0
v_add_f32 v27,v27,v28
v_mov_b32 v28,v27
s_nop 1
s_waitcnt lgkmcnt(2)
v_mfma_f32_16x16x32_bf16 v[192:195],v[124:127],v[16:19],v[192:195]
v_mfma_f32_16x16x32_bf16 v[196:199],v[124:127],v[20:23],v[196:199]
v_permlane32_swap_b32 v27,v28
s_nop 0
v_add_f32 v27,v27,v28
s_mov_b32 s37,987991609
v_mul_f32 v29,s37,v244
v_mul_f32 v27,s37,v27
s_waitcnt lgkmcnt(0)
v_mfma_f32_16x16x32_bf16 v[200:203],v[128:131],v[16:19],v[200:203]
v_mfma_f32_16x16x32_bf16 v[204:207],v[128:131],v[20:23],v[204:207]
v_fma_f32 v27,-v29,v29,v27
v_max_f32 v27,0,v27
v_add_f32 v27,925353388,v27
v_rsq_f32 v31,v27
v_add_u32 v33,0,v56
v_mul_f32 v30,v29,v31
ds_write_b64 v33,v[30:31]
s_cmp_lg_u32 s35,0
s_cbranch_scc1 attn_kernel_noxm_m0
s_add_u32 s16,s26,4849664
s_addc_u32 s17,s27,0
s_mov_b32 s18,8192
s_mov_b32 s19,0x20000
s_lshl_b32 s38,s36,6
s_add_u32 s39,s43,0
s_lshl_b32 s39,s39,4
s_add_u32 s38,s38,s39
s_sub_u32 s38,s38,16
v_add_u32 v32,s38,v59
v_lshlrev_b32 v32,2,v32
buffer_store_dword v29,v32,s[16:19],0 offen
attn_kernel_noxm_m0:
s_nop 5
s_waitcnt lgkmcnt(0)
s_barrier
ds_read_b64 v[4:5],v56 offset:0
ds_read_b64 v[6:7],v56 offset:128
ds_read_b128 v[64:67],v57 offset:0
ds_read_b128 v[68:71],v57 offset:64
ds_read_b128 v[72:75],v57 offset:128
ds_read_b128 v[76:79],v57 offset:192
ds_read_b128 v[80:83],v57 offset:256
ds_read_b128 v[84:87],v57 offset:320
ds_read_b128 v[88:91],v57 offset:384
ds_read_b128 v[92:95],v57 offset:448
s_waitcnt lgkmcnt(8)
s_waitcnt lgkmcnt(7)
v_pk_mul_f32 v[8:9],v[64:65],v[4:5] op_sel_hi:[1,0]
v_pk_mul_f32 v[10:11],v[66:67],v[4:5] op_sel_hi:[1,0]
v_pk_fma_f32 v[144:145],v[144:145],v[4:5],v[8:9] op_sel:[0,1,0] op_sel_hi:[1,1,1] neg_lo:[0,0,1] neg_hi:[0,0,1]
v_pk_fma_f32 v[146:147],v[146:147],v[4:5],v[10:11] op_sel:[0,1,0] op_sel_hi:[1,1,1] neg_lo:[0,0,1] neg_hi:[0,0,1]
v_cvt_pk_bf16_f32 v16,v144,v145
v_cvt_pk_bf16_f32 v17,v146,v147
ds_write_b64 v40,v[16:17] offset:0
v_pk_mul_f32 v[12:13],v[64:65],v[6:7] op_sel_hi:[1,0]
v_pk_mul_f32 v[14:15],v[66:67],v[6:7] op_sel_hi:[1,0]
v_pk_fma_f32 v[148:149],v[148:149],v[6:7],v[12:13] op_sel:[0,1,0] op_sel_hi:[1,1,1] neg_lo:[0,0,1] neg_hi:[0,0,1]
v_pk_fma_f32 v[150:151],v[150:151],v[6:7],v[14:15] op_sel:[0,1,0] op_sel_hi:[1,1,1] neg_lo:[0,0,1] neg_hi:[0,0,1]
v_cvt_pk_bf16_f32 v18,v148,v149
v_cvt_pk_bf16_f32 v19,v150,v151
ds_write_b64 v40,v[18:19] offset:768
s_waitcnt lgkmcnt(8)
v_pk_mul_f32 v[8:9],v[68:69],v[4:5] op_sel_hi:[1,0]
v_pk_mul_f32 v[10:11],v[70:71],v[4:5] op_sel_hi:[1,0]
v_pk_fma_f32 v[152:153],v[152:153],v[4:5],v[8:9] op_sel:[0,1,0] op_sel_hi:[1,1,1] neg_lo:[0,0,1] neg_hi:[0,0,1]
v_pk_fma_f32 v[154:155],v[154:155],v[4:5],v[10:11] op_sel:[0,1,0] op_sel_hi:[1,1,1] neg_lo:[0,0,1] neg_hi:[0,0,1]
v_cvt_pk_bf16_f32 v16,v152,v153
v_cvt_pk_bf16_f32 v17,v154,v155
ds_write_b64 v41,v[16:17] offset:0
v_pk_mul_f32 v[12:13],v[68:69],v[6:7] op_sel_hi:[1,0]
v_pk_mul_f32 v[14:15],v[70:71],v[6:7] op_sel_hi:[1,0]
v_pk_fma_f32 v[156:157],v[156:157],v[6:7],v[12:13] op_sel:[0,1,0] op_sel_hi:[1,1,1] neg_lo:[0,0,1] neg_hi:[0,0,1]
v_pk_fma_f32 v[158:159],v[158:159],v[6:7],v[14:15] op_sel:[0,1,0] op_sel_hi:[1,1,1] neg_lo:[0,0,1] neg_hi:[0,0,1]
v_cvt_pk_bf16_f32 v18,v156,v157
v_cvt_pk_bf16_f32 v19,v158,v159
ds_write_b64 v41,v[18:19] offset:768
s_waitcnt lgkmcnt(9)
v_pk_mul_f32 v[8:9],v[72:73],v[4:5] op_sel_hi:[1,0]
v_pk_mul_f32 v[10:11],v[74:75],v[4:5] op_sel_hi:[1,0]
v_pk_fma_f32 v[160:161],v[160:161],v[4:5],v[8:9] op_sel:[0,1,0] op_sel_hi:[1,1,1] neg_lo:[0,0,1] neg_hi:[0,0,1]
v_pk_fma_f32 v[162:163],v[162:163],v[4:5],v[10:11] op_sel:[0,1,0] op_sel_hi:[1,1,1] neg_lo:[0,0,1] neg_hi:[0,0,1]
v_cvt_pk_bf16_f32 v16,v160,v161
v_cvt_pk_bf16_f32 v17,v162,v163
ds_write_b64 v42,v[16:17] offset:0
v_pk_mul_f32 v[12:13],v[72:73],v[6:7] op_sel_hi:[1,0]
v_pk_mul_f32 v[14:15],v[74:75],v[6:7] op_sel_hi:[1,0]
v_pk_fma_f32 v[164:165],v[164:165],v[6:7],v[12:13] op_sel:[0,1,0] op_sel_hi:[1,1,1] neg_lo:[0,0,1] neg_hi:[0,0,1]
v_pk_fma_f32 v[166:167],v[166:167],v[6:7],v[14:15] op_sel:[0,1,0] op_sel_hi:[1,1,1] neg_lo:[0,0,1] neg_hi:[0,0,1]
v_cvt_pk_bf16_f32 v18,v164,v165
v_cvt_pk_bf16_f32 v19,v166,v167
ds_write_b64 v42,v[18:19] offset:768
s_waitcnt lgkmcnt(10)
v_pk_mul_f32 v[8:9],v[76:77],v[4:5] op_sel_hi:[1,0]
v_pk_mul_f32 v[10:11],v[78:79],v[4:5] op_sel_hi:[1,0]
v_pk_fma_f32 v[168:169],v[168:169],v[4:5],v[8:9] op_sel:[0,1,0] op_sel_hi:[1,1,1] neg_lo:[0,0,1] neg_hi:[0,0,1]
v_pk_fma_f32 v[170:171],v[170:171],v[4:5],v[10:11] op_sel:[0,1,0] op_sel_hi:[1,1,1] neg_lo:[0,0,1] neg_hi:[0,0,1]
v_cvt_pk_bf16_f32 v16,v168,v169
v_cvt_pk_bf16_f32 v17,v170,v171
ds_write_b64 v43,v[16:17] offset:0
v_pk_mul_f32 v[12:13],v[76:77],v[6:7] op_sel_hi:[1,0]
v_pk_mul_f32 v[14:15],v[78:79],v[6:7] op_sel_hi:[1,0]
v_pk_fma_f32 v[172:173],v[172:173],v[6:7],v[12:13] op_sel:[0,1,0] op_sel_hi:[1,1,1] neg_lo:[0,0,1] neg_hi:[0,0,1]
v_pk_fma_f32 v[174:175],v[174:175],v[6:7],v[14:15] op_sel:[0,1,0] op_sel_hi:[1,1,1] neg_lo:[0,0,1] neg_hi:[0,0,1]
v_cvt_pk_bf16_f32 v18,v172,v173
v_cvt_pk_bf16_f32 v19,v174,v175
ds_write_b64 v43,v[18:19] offset:768
s_waitcnt lgkmcnt(11)
v_pk_mul_f32 v[8:9],v[80:81],v[4:5] op_sel_hi:[1,0]
v_pk_mul_f32 v[10:11],v[82:83],v[4:5] op_sel_hi:[1,0]
v_pk_fma_f32 v[176:177],v[176:177],v[4:5],v[8:9] op_sel:[0,1,0] op_sel_hi:[1,1,1] neg_lo:[0,0,1] neg_hi:[0,0,1]
v_pk_fma_f32 v[178:179],v[178:179],v[4:5],v[10:11] op_sel:[0,1,0] op_sel_hi:[1,1,1] neg_lo:[0,0,1] neg_hi:[0,0,1]
v_cvt_pk_bf16_f32 v16,v176,v177
v_cvt_pk_bf16_f32 v17,v178,v179
ds_write_b64 v44,v[16:17] offset:0
v_pk_mul_f32 v[12:13],v[80:81],v[6:7] op_sel_hi:[1,0]
v_pk_mul_f32 v[14:15],v[82:83],v[6:7] op_sel_hi:[1,0]
v_pk_fma_f32 v[180:181],v[180:181],v[6:7],v[12:13] op_sel:[0,1,0] op_sel_hi:[1,1,1] neg_lo:[0,0,1] neg_hi:[0,0,1]
v_pk_fma_f32 v[182:183],v[182:183],v[6:7],v[14:15] op_sel:[0,1,0] op_sel_hi:[1,1,1] neg_lo:[0,0,1] neg_hi:[0,0,1]
v_cvt_pk_bf16_f32 v18,v180,v181
v_cvt_pk_bf16_f32 v19,v182,v183
ds_write_b64 v44,v[18:19] offset:768
s_waitcnt lgkmcnt(12)
v_pk_mul_f32 v[8:9],v[84:85],v[4:5] op_sel_hi:[1,0]
v_pk_mul_f32 v[10:11],v[86:87],v[4:5] op_sel_hi:[1,0]
v_pk_fma_f32 v[184:185],v[184:185],v[4:5],v[8:9] op_sel:[0,1,0] op_sel_hi:[1,1,1] neg_lo:[0,0,1] neg_hi:[0,0,1]
v_pk_fma_f32 v[186:187],v[186:187],v[4:5],v[10:11] op_sel:[0,1,0] op_sel_hi:[1,1,1] neg_lo:[0,0,1] neg_hi:[0,0,1]
v_cvt_pk_bf16_f32 v16,v184,v185
v_cvt_pk_bf16_f32 v17,v186,v187
ds_write_b64 v40,v[16:17] offset:15360
v_pk_mul_f32 v[12:13],v[84:85],v[6:7] op_sel_hi:[1,0]
v_pk_mul_f32 v[14:15],v[86:87],v[6:7] op_sel_hi:[1,0]
v_pk_fma_f32 v[188:189],v[188:189],v[6:7],v[12:13] op_sel:[0,1,0] op_sel_hi:[1,1,1] neg_lo:[0,0,1] neg_hi:[0,0,1]
v_pk_fma_f32 v[190:191],v[190:191],v[6:7],v[14:15] op_sel:[0,1,0] op_sel_hi:[1,1,1] neg_lo:[0,0,1] neg_hi:[0,0,1]
v_cvt_pk_bf16_f32 v18,v188,v189
v_cvt_pk_bf16_f32 v19,v190,v191
ds_write_b64 v40,v[18:19] offset:16128
s_waitcnt lgkmcnt(13)
v_pk_mul_f32 v[8:9],v[88:89],v[4:5] op_sel_hi:[1,0]
v_pk_mul_f32 v[10:11],v[90:91],v[4:5] op_sel_hi:[1,0]
v_pk_fma_f32 v[192:193],v[192:193],v[4:5],v[8:9] op_sel:[0,1,0] op_sel_hi:[1,1,1] neg_lo:[0,0,1] neg_hi:[0,0,1]
v_pk_fma_f32 v[194:195],v[194:195],v[4:5],v[10:11] op_sel:[0,1,0] op_sel_hi:[1,1,1] neg_lo:[0,0,1] neg_hi:[0,0,1]
v_cvt_pk_bf16_f32 v16,v192,v193
v_cvt_pk_bf16_f32 v17,v194,v195
ds_write_b64 v41,v[16:17] offset:15360
v_pk_mul_f32 v[12:13],v[88:89],v[6:7] op_sel_hi:[1,0]
v_pk_mul_f32 v[14:15],v[90:91],v[6:7] op_sel_hi:[1,0]
v_pk_fma_f32 v[196:197],v[196:197],v[6:7],v[12:13] op_sel:[0,1,0] op_sel_hi:[1,1,1] neg_lo:[0,0,1] neg_hi:[0,0,1]
v_pk_fma_f32 v[198:199],v[198:199],v[6:7],v[14:15] op_sel:[0,1,0] op_sel_hi:[1,1,1] neg_lo:[0,0,1] neg_hi:[0,0,1]
v_cvt_pk_bf16_f32 v18,v196,v197
v_cvt_pk_bf16_f32 v19,v198,v199
ds_write_b64 v41,v[18:19] offset:16128
s_waitcnt lgkmcnt(14)
v_pk_mul_f32 v[8:9],v[92:93],v[4:5] op_sel_hi:[1,0]
v_pk_mul_f32 v[10:11],v[94:95],v[4:5] op_sel_hi:[1,0]
v_pk_fma_f32 v[200:201],v[200:201],v[4:5],v[8:9] op_sel:[0,1,0] op_sel_hi:[1,1,1] neg_lo:[0,0,1] neg_hi:[0,0,1]
v_pk_fma_f32 v[202:203],v[202:203],v[4:5],v[10:11] op_sel:[0,1,0] op_sel_hi:[1,1,1] neg_lo:[0,0,1] neg_hi:[0,0,1]
v_cvt_pk_bf16_f32 v16,v200,v201
v_cvt_pk_bf16_f32 v17,v202,v203
ds_write_b64 v42,v[16:17] offset:15360
v_pk_mul_f32 v[12:13],v[92:93],v[6:7] op_sel_hi:[1,0]
v_pk_mul_f32 v[14:15],v[94:95],v[6:7] op_sel_hi:[1,0]
v_pk_fma_f32 v[204:205],v[204:205],v[6:7],v[12:13] op_sel:[0,1,0] op_sel_hi:[1,1,1] neg_lo:[0,0,1] neg_hi:[0,0,1]
v_pk_fma_f32 v[206:207],v[206:207],v[6:7],v[14:15] op_sel:[0,1,0] op_sel_hi:[1,1,1] neg_lo:[0,0,1] neg_hi:[0,0,1]
v_cvt_pk_bf16_f32 v18,v204,v205
v_cvt_pk_bf16_f32 v19,v206,v207
ds_write_b64 v42,v[18:19] offset:16128
s_waitcnt lgkmcnt(0)
s_barrier
s_mul_i32 s37,s34,3840
v_mul_u32_u24 v180,48,v252
v_add_u32 v180,s37,v180
v_add_u32 v181,96,v180
v_add_u32 v180,768,v180
v_mul_u32_u24 v182,80,v252
s_mul_i32 s37,s34,6400
s_add_u32 s37,s37,160
v_add_u32 v182,s37,v182
ds_read_b128 v[0:3],v180 offset:0
ds_read_b128 v[4:7],v180 offset:16
ds_read_b64 v[8:9],v180 offset:32
ds_read_b128 v[12:15],v181 offset:16032
ds_read_b128 v[16:19],v181 offset:16048
ds_read_b64 v[20:21],v181 offset:16064
ds_read_b128 v[22:25],v181 offset:15936
ds_read_b128 v[26:29],v181 offset:15952
ds_read_b64 v[30:31],v181 offset:15968
ds_read_b128 v[32:35],v181 offset:15840
ds_read_b128 v[36:39],v181 offset:15856
ds_read_b64 v[40:41],v181 offset:15872
ds_read_b128 v[42:45],v181 offset:15744
ds_read_b128 v[46:49],v181 offset:15760
ds_read_b64 v[50:51],v181 offset:15776
s_and_b32 s37,s34,1
s_sub_u32 s38,s37,1
s_not_b32 s39,s38
s_lshl_b32 s37,s36,6
v_add_u32 v183,s37,v252
v_cmp_le_u32 s[66:67],2,v183
v_cmp_le_u32 s[68:69],4,v183
v_cmp_le_u32 s[70:71],6,v183
v_cmp_le_u32 s[72:73],8,v183
v_cmp_le_u32 s[74:75],10,v183
v_cmp_le_u32 s[76:77],12,v183
v_cmp_le_u32 s[78:79],14,v183
s_waitcnt lgkmcnt(12)
v_and_b32 v0,s38,v0
v_and_b32 v9,s39,v9
ds_read_b128 v[52:55],v181 offset:15648
ds_read_b128 v[56:59],v181 offset:15664
ds_read_b64 v[60:61],v181 offset:15680
s_waitcnt lgkmcnt(12)
v_dot2_f32_bf16 v92,v0,v12,0
v_dot2_f32_bf16 v92,v1,v13,v92
v_dot2_f32_bf16 v92,v2,v14,v92
v_dot2_f32_bf16 v92,v3,v15,v92
v_dot2_f32_bf16 v92,v4,v16,v92
v_dot2_f32_bf16 v92,v5,v17,v92
v_dot2_f32_bf16 v92,v6,v18,v92
v_dot2_f32_bf16 v92,v7,v19,v92
v_dot2_f32_bf16 v92,v8,v20,v92
v_dot2_f32_bf16 v92,v9,v21,v92
ds_read_b128 v[62:65],v181 offset:15552
ds_read_b128 v[66:69],v181 offset:15568
ds_read_b64 v[70:71],v181 offset:15584
s_waitcnt lgkmcnt(12)
v_dot2_f32_bf16 v93,v0,v22,0
v_dot2_f32_bf16 v93,v1,v23,v93
v_dot2_f32_bf16 v93,v2,v24,v93
v_dot2_f32_bf16 v93,v3,v25,v93
v_dot2_f32_bf16 v93,v4,v26,v93
v_dot2_f32_bf16 v93,v5,v27,v93
v_dot2_f32_bf16 v93,v6,v28,v93
v_dot2_f32_bf16 v93,v7,v29,v93
v_dot2_f32_bf16 v93,v8,v30,v93
v_dot2_f32_bf16 v93,v9,v31,v93
ds_read_b128 v[72:75],v181 offset:15456
ds_read_b128 v[76:79],v181 offset:15472
ds_read_b64 v[80:81],v181 offset:15488
s_waitcnt lgkmcnt(12)
v_dot2_f32_bf16 v94,v0,v32,0
v_dot2_f32_bf16 v94,v1,v33,v94
v_dot2_f32_bf16 v94,v2,v34,v94
v_dot2_f32_bf16 v94,v3,v35,v94
v_dot2_f32_bf16 v94,v4,v36,v94
v_dot2_f32_bf16 v94,v5,v37,v94
v_dot2_f32_bf16 v94,v6,v38,v94
v_dot2_f32_bf16 v94,v7,v39,v94
v_dot2_f32_bf16 v94,v8,v40,v94
v_dot2_f32_bf16 v94,v9,v41,v94
ds_read_b128 v[82:85],v181 offset:15360
ds_read_b128 v[86:89],v181 offset:15376
ds_read_b64 v[90:91],v181 offset:15392
s_waitcnt lgkmcnt(12)
v_dot2_f32_bf16 v95,v0,v42,0
v_dot2_f32_bf16 v95,v1,v43,v95
v_dot2_f32_bf16 v95,v2,v44,v95
v_dot2_f32_bf16 v95,v3,v45,v95
v_dot2_f32_bf16 v95,v4,v46,v95
v_dot2_f32_bf16 v95,v5,v47,v95
v_dot2_f32_bf16 v95,v6,v48,v95
v_dot2_f32_bf16 v95,v7,v49,v95
v_dot2_f32_bf16 v95,v8,v50,v95
v_dot2_f32_bf16 v95,v9,v51,v95
s_waitcnt lgkmcnt(9)
v_dot2_f32_bf16 v96,v0,v52,0
v_dot2_f32_bf16 v96,v1,v53,v96
v_dot2_f32_bf16 v96,v2,v54,v96
v_dot2_f32_bf16 v96,v3,v55,v96
v_dot2_f32_bf16 v96,v4,v56,v96
v_dot2_f32_bf16 v96,v5,v57,v96
v_dot2_f32_bf16 v96,v6,v58,v96
v_dot2_f32_bf16 v96,v7,v59,v96
v_dot2_f32_bf16 v96,v8,v60,v96
v_dot2_f32_bf16 v96,v9,v61,v96
s_waitcnt lgkmcnt(6)
v_dot2_f32_bf16 v97,v0,v62,0
v_dot2_f32_bf16 v97,v1,v63,v97
v_dot2_f32_bf16 v97,v2,v64,v97
v_dot2_f32_bf16 v97,v3,v65,v97
v_dot2_f32_bf16 v97,v4,v66,v97
v_dot2_f32_bf16 v97,v5,v67,v97
v_dot2_f32_bf16 v97,v6,v68,v97
v_dot2_f32_bf16 v97,v7,v69,v97
v_dot2_f32_bf16 v97,v8,v70,v97
v_dot2_f32_bf16 v97,v9,v71,v97
ds_read_b128 v[100:103],v182 offset:31840
ds_read_b128 v[104:107],v182 offset:31856
ds_read_b128 v[108:111],v182 offset:31872
ds_read_b128 v[112:115],v182 offset:31888
ds_read_b128 v[116:119],v182 offset:31904
s_waitcnt lgkmcnt(8)
v_dot2_f32_bf16 v98,v0,v72,0
v_dot2_f32_bf16 v98,v1,v73,v98
v_dot2_f32_bf16 v98,v2,v74,v98
v_dot2_f32_bf16 v98,v3,v75,v98
v_dot2_f32_bf16 v98,v4,v76,v98
v_dot2_f32_bf16 v98,v5,v77,v98
v_dot2_f32_bf16 v98,v6,v78,v98
v_dot2_f32_bf16 v98,v7,v79,v98
v_dot2_f32_bf16 v98,v8,v80,v98
v_dot2_f32_bf16 v98,v9,v81,v98
ds_read_b128 v[120:123],v182 offset:31680
ds_read_b128 v[124:127],v182 offset:31696
ds_read_b128 v[128:131],v182 offset:31712
ds_read_b128 v[132:135],v182 offset:31728
ds_read_b128 v[136:139],v182 offset:31744
s_waitcnt lgkmcnt(10)
v_dot2_f32_bf16 v99,v0,v82,0
v_dot2_f32_bf16 v99,v1,v83,v99
v_dot2_f32_bf16 v99,v2,v84,v99
v_dot2_f32_bf16 v99,v3,v85,v99
v_dot2_f32_bf16 v99,v4,v86,v99
v_dot2_f32_bf16 v99,v5,v87,v99
v_dot2_f32_bf16 v99,v6,v88,v99
v_dot2_f32_bf16 v99,v7,v89,v99
v_dot2_f32_bf16 v99,v8,v90,v99
v_dot2_f32_bf16 v99,v9,v91,v99
v_mov_b32 v184,4048155338
s_nop 1
v_cndmask_b32 v93,v184,v93,s[66:67]
v_cndmask_b32 v94,v184,v94,s[68:69]
v_cndmask_b32 v95,v184,v95,s[70:71]
v_cndmask_b32 v96,v184,v96,s[72:73]
v_cndmask_b32 v97,v184,v97,s[74:75]
v_cndmask_b32 v98,v184,v98,s[76:77]
v_cndmask_b32 v99,v184,v99,s[78:79]
v_max3_f32 v185,v92,v93,v94
v_max3_f32 v185,v185,v95,v96
v_max3_f32 v185,v185,v97,v98
v_max_f32 v185,v185,v99
s_mov_b32 s37,1051597459
v_mul_f32 v185,s37,v185
v_fma_f32 v92,v92,s37,-v185
v_fma_f32 v93,v93,s37,-v185
v_fma_f32 v94,v94,s37,-v185
v_fma_f32 v95,v95,s37,-v185
v_fma_f32 v96,v96,s37,-v185
v_fma_f32 v97,v97,s37,-v185
v_fma_f32 v98,v98,s37,-v185
v_fma_f32 v99,v99,s37,-v185
v_exp_f32 v92,v92
v_exp_f32 v93,v93
v_exp_f32 v94,v94
v_exp_f32 v95,v95
v_exp_f32 v96,v96
v_exp_f32 v97,v97
v_exp_f32 v98,v98
v_exp_f32 v99,v99
s_nop 0
v_add_f32 v186,v92,v93
v_add_f32 v187,v94,v95
v_add_f32 v188,v96,v97
v_add_f32 v189,v98,v99
v_add_f32 v186,v186,v187
v_add_f32 v188,v188,v189
v_add_f32 v186,v186,v188
v_rcp_f32 v186,v186
s_nop 0
v_mul_f32 v92,v92,v186
v_mul_f32 v93,v93,v186
v_mul_f32 v94,v94,v186
v_mul_f32 v95,v95,v186
v_mul_f32 v96,v96,v186
v_mul_f32 v97,v97,v186
v_mul_f32 v98,v98,v186
v_mul_f32 v99,v99,v186
ds_read_b128 v[140:143],v182 offset:31520
ds_read_b128 v[144:147],v182 offset:31536
ds_read_b128 v[148:151],v182 offset:31552
ds_read_b128 v[152:155],v182 offset:31568
ds_read_b128 v[156:159],v182 offset:31584
s_waitcnt lgkmcnt(10)
v_pk_mul_f32 v[160:161],v[100:101],v[92:93] op_sel_hi:[1,0]
v_pk_mul_f32 v[162:163],v[102:103],v[92:93] op_sel_hi:[1,0]
v_pk_mul_f32 v[164:165],v[104:105],v[92:93] op_sel_hi:[1,0]
v_pk_mul_f32 v[166:167],v[106:107],v[92:93] op_sel_hi:[1,0]
v_pk_mul_f32 v[168:169],v[108:109],v[92:93] op_sel_hi:[1,0]
v_pk_mul_f32 v[170:171],v[110:111],v[92:93] op_sel_hi:[1,0]
v_pk_mul_f32 v[172:173],v[112:113],v[92:93] op_sel_hi:[1,0]
v_pk_mul_f32 v[174:175],v[114:115],v[92:93] op_sel_hi:[1,0]
v_pk_mul_f32 v[176:177],v[116:117],v[92:93] op_sel_hi:[1,0]
v_pk_mul_f32 v[178:179],v[118:119],v[92:93] op_sel_hi:[1,0]
ds_read_b128 v[100:103],v182 offset:31360
ds_read_b128 v[104:107],v182 offset:31376
ds_read_b128 v[108:111],v182 offset:31392
ds_read_b128 v[112:115],v182 offset:31408
ds_read_b128 v[116:119],v182 offset:31424
s_waitcnt lgkmcnt(10)
v_pk_fma_f32 v[160:161],v[120:121],v[92:93],v[160:161] op_sel:[0,1,0] op_sel_hi:[1,1,1]
v_pk_fma_f32 v[162:163],v[122:123],v[92:93],v[162:163] op_sel:[0,1,0] op_sel_hi:[1,1,1]
v_pk_fma_f32 v[164:165],v[124:125],v[92:93],v[164:165] op_sel:[0,1,0] op_sel_hi:[1,1,1]
v_pk_fma_f32 v[166:167],v[126:127],v[92:93],v[166:167] op_sel:[0,1,0] op_sel_hi:[1,1,1]
v_pk_fma_f32 v[168:169],v[128:129],v[92:93],v[168:169] op_sel:[0,1,0] op_sel_hi:[1,1,1]
v_pk_fma_f32 v[170:171],v[130:131],v[92:93],v[170:171] op_sel:[0,1,0] op_sel_hi:[1,1,1]
v_pk_fma_f32 v[172:173],v[132:133],v[92:93],v[172:173] op_sel:[0,1,0] op_sel_hi:[1,1,1]
v_pk_fma_f32 v[174:175],v[134:135],v[92:93],v[174:175] op_sel:[0,1,0] op_sel_hi:[1,1,1]
v_pk_fma_f32 v[176:177],v[136:137],v[92:93],v[176:177] op_sel:[0,1,0] op_sel_hi:[1,1,1]
v_pk_fma_f32 v[178:179],v[138:139],v[92:93],v[178:179] op_sel:[0,1,0] op_sel_hi:[1,1,1]
ds_read_b128 v[120:123],v182 offset:31200
ds_read_b128 v[124:127],v182 offset:31216
ds_read_b128 v[128:131],v182 offset:31232
ds_read_b128 v[132:135],v182 offset:31248
ds_read_b128 v[136:139],v182 offset:31264
s_waitcnt lgkmcnt(10)
v_pk_fma_f32 v[160:161],v[140:141],v[94:95],v[160:161] op_sel_hi:[1,0,1]
v_pk_fma_f32 v[162:163],v[142:143],v[94:95],v[162:163] op_sel_hi:[1,0,1]
v_pk_fma_f32 v[164:165],v[144:145],v[94:95],v[164:165] op_sel_hi:[1,0,1]
v_pk_fma_f32 v[166:167],v[146:147],v[94:95],v[166:167] op_sel_hi:[1,0,1]
v_pk_fma_f32 v[168:169],v[148:149],v[94:95],v[168:169] op_sel_hi:[1,0,1]
v_pk_fma_f32 v[170:171],v[150:151],v[94:95],v[170:171] op_sel_hi:[1,0,1]
v_pk_fma_f32 v[172:173],v[152:153],v[94:95],v[172:173] op_sel_hi:[1,0,1]
v_pk_fma_f32 v[174:175],v[154:155],v[94:95],v[174:175] op_sel_hi:[1,0,1]
v_pk_fma_f32 v[176:177],v[156:157],v[94:95],v[176:177] op_sel_hi:[1,0,1]
v_pk_fma_f32 v[178:179],v[158:159],v[94:95],v[178:179] op_sel_hi:[1,0,1]
ds_read_b128 v[140:143],v182 offset:31040
ds_read_b128 v[144:147],v182 offset:31056
ds_read_b128 v[148:151],v182 offset:31072
ds_read_b128 v[152:155],v182 offset:31088
ds_read_b128 v[156:159],v182 offset:31104
s_waitcnt lgkmcnt(10)
v_pk_fma_f32 v[160:161],v[100:101],v[94:95],v[160:161] op_sel:[0,1,0] op_sel_hi:[1,1,1]
v_pk_fma_f32 v[162:163],v[102:103],v[94:95],v[162:163] op_sel:[0,1,0] op_sel_hi:[1,1,1]
v_pk_fma_f32 v[164:165],v[104:105],v[94:95],v[164:165] op_sel:[0,1,0] op_sel_hi:[1,1,1]
v_pk_fma_f32 v[166:167],v[106:107],v[94:95],v[166:167] op_sel:[0,1,0] op_sel_hi:[1,1,1]
v_pk_fma_f32 v[168:169],v[108:109],v[94:95],v[168:169] op_sel:[0,1,0] op_sel_hi:[1,1,1]
v_pk_fma_f32 v[170:171],v[110:111],v[94:95],v[170:171] op_sel:[0,1,0] op_sel_hi:[1,1,1]
v_pk_fma_f32 v[172:173],v[112:113],v[94:95],v[172:173] op_sel:[0,1,0] op_sel_hi:[1,1,1]
v_pk_fma_f32 v[174:175],v[114:115],v[94:95],v[174:175] op_sel:[0,1,0] op_sel_hi:[1,1,1]
v_pk_fma_f32 v[176:177],v[116:117],v[94:95],v[176:177] op_sel:[0,1,0] op_sel_hi:[1,1,1]
v_pk_fma_f32 v[178:179],v[118:119],v[94:95],v[178:179] op_sel:[0,1,0] op_sel_hi:[1,1,1]
ds_read_b128 v[100:103],v182 offset:30880
ds_read_b128 v[104:107],v182 offset:30896
ds_read_b128 v[108:111],v182 offset:30912
ds_read_b128 v[112:115],v182 offset:30928
ds_read_b128 v[116:119],v182 offset:30944
s_waitcnt lgkmcnt(10)
v_pk_fma_f32 v[160:161],v[120:121],v[96:97],v[160:161] op_sel_hi:[1,0,1]
v_pk_fma_f32 v[162:163],v[122:123],v[96:97],v[162:163] op_sel_hi:[1,0,1]
v_pk_fma_f32 v[164:165],v[124:125],v[96:97],v[164:165] op_sel_hi:[1,0,1]
v_pk_fma_f32 v[166:167],v[126:127],v[96:97],v[166:167] op_sel_hi:[1,0,1]
v_pk_fma_f32 v[168:169],v[128:129],v[96:97],v[168:169] op_sel_hi:[1,0,1]
v_pk_fma_f32 v[170:171],v[130:131],v[96:97],v[170:171] op_sel_hi:[1,0,1]
v_pk_fma_f32 v[172:173],v[132:133],v[96:97],v[172:173] op_sel_hi:[1,0,1]
v_pk_fma_f32 v[174:175],v[134:135],v[96:97],v[174:175] op_sel_hi:[1,0,1]
v_pk_fma_f32 v[176:177],v[136:137],v[96:97],v[176:177] op_sel_hi:[1,0,1]
v_pk_fma_f32 v[178:179],v[138:139],v[96:97],v[178:179] op_sel_hi:[1,0,1]
ds_read_b128 v[120:123],v182 offset:30720
ds_read_b128 v[124:127],v182 offset:30736
ds_read_b128 v[128:131],v182 offset:30752
ds_read_b128 v[132:135],v182 offset:30768
ds_read_b128 v[136:139],v182 offset:30784
s_waitcnt lgkmcnt(10)
v_pk_fma_f32 v[160:161],v[140:141],v[96:97],v[160:161] op_sel:[0,1,0] op_sel_hi:[1,1,1]
v_pk_fma_f32 v[162:163],v[142:143],v[96:97],v[162:163] op_sel:[0,1,0] op_sel_hi:[1,1,1]
v_pk_fma_f32 v[164:165],v[144:145],v[96:97],v[164:165] op_sel:[0,1,0] op_sel_hi:[1,1,1]
v_pk_fma_f32 v[166:167],v[146:147],v[96:97],v[166:167] op_sel:[0,1,0] op_sel_hi:[1,1,1]
v_pk_fma_f32 v[168:169],v[148:149],v[96:97],v[168:169] op_sel:[0,1,0] op_sel_hi:[1,1,1]
v_pk_fma_f32 v[170:171],v[150:151],v[96:97],v[170:171] op_sel:[0,1,0] op_sel_hi:[1,1,1]
v_pk_fma_f32 v[172:173],v[152:153],v[96:97],v[172:173] op_sel:[0,1,0] op_sel_hi:[1,1,1]
v_pk_fma_f32 v[174:175],v[154:155],v[96:97],v[174:175] op_sel:[0,1,0] op_sel_hi:[1,1,1]
v_pk_fma_f32 v[176:177],v[156:157],v[96:97],v[176:177] op_sel:[0,1,0] op_sel_hi:[1,1,1]
v_pk_fma_f32 v[178:179],v[158:159],v[96:97],v[178:179] op_sel:[0,1,0] op_sel_hi:[1,1,1]
s_waitcnt lgkmcnt(5)
v_pk_fma_f32 v[160:161],v[100:101],v[98:99],v[160:161] op_sel_hi:[1,0,1]
v_pk_fma_f32 v[162:163],v[102:103],v[98:99],v[162:163] op_sel_hi:[1,0,1]
v_pk_fma_f32 v[164:165],v[104:105],v[98:99],v[164:165] op_sel_hi:[1,0,1]
v_pk_fma_f32 v[166:167],v[106:107],v[98:99],v[166:167] op_sel_hi:[1,0,1]
v_pk_fma_f32 v[168:169],v[108:109],v[98:99],v[168:169] op_sel_hi:[1,0,1]
v_pk_fma_f32 v[170:171],v[110:111],v[98:99],v[170:171] op_sel_hi:[1,0,1]
v_pk_fma_f32 v[172:173],v[112:113],v[98:99],v[172:173] op_sel_hi:[1,0,1]
v_pk_fma_f32 v[174:175],v[114:115],v[98:99],v[174:175] op_sel_hi:[1,0,1]
v_pk_fma_f32 v[176:177],v[116:117],v[98:99],v[176:177] op_sel_hi:[1,0,1]
v_pk_fma_f32 v[178:179],v[118:119],v[98:99],v[178:179] op_sel_hi:[1,0,1]
s_waitcnt lgkmcnt(0)
v_pk_fma_f32 v[160:161],v[120:121],v[98:99],v[160:161] op_sel:[0,1,0] op_sel_hi:[1,1,1]
v_pk_fma_f32 v[162:163],v[122:123],v[98:99],v[162:163] op_sel:[0,1,0] op_sel_hi:[1,1,1]
v_pk_fma_f32 v[164:165],v[124:125],v[98:99],v[164:165] op_sel:[0,1,0] op_sel_hi:[1,1,1]
v_pk_fma_f32 v[166:167],v[126:127],v[98:99],v[166:167] op_sel:[0,1,0] op_sel_hi:[1,1,1]
v_pk_fma_f32 v[168:169],v[128:129],v[98:99],v[168:169] op_sel:[0,1,0] op_sel_hi:[1,1,1]
v_pk_fma_f32 v[170:171],v[130:131],v[98:99],v[170:171] op_sel:[0,1,0] op_sel_hi:[1,1,1]
v_pk_fma_f32 v[172:173],v[132:133],v[98:99],v[172:173] op_sel:[0,1,0] op_sel_hi:[1,1,1]
v_pk_fma_f32 v[174:175],v[134:135],v[98:99],v[174:175] op_sel:[0,1,0] op_sel_hi:[1,1,1]
v_pk_fma_f32 v[176:177],v[136:137],v[98:99],v[176:177] op_sel:[0,1,0] op_sel_hi:[1,1,1]
v_pk_fma_f32 v[178:179],v[138:139],v[98:99],v[178:179] op_sel:[0,1,0] op_sel_hi:[1,1,1]
v_cvt_pk_bf16_f32 v0,v162,v163
v_cvt_pk_bf16_f32 v1,v164,v165
v_cvt_pk_bf16_f32 v2,v166,v167
v_cvt_pk_bf16_f32 v3,v168,v169
v_cvt_pk_bf16_f32 v4,v170,v171
v_cvt_pk_bf16_f32 v5,v172,v173
v_cvt_pk_bf16_f32 v6,v174,v175
v_cvt_pk_bf16_f32 v7,v176,v177
v_cvt_pk_bf16_f32 v8,v178,v179
v_mul_u32_u24 v184,144,v252
s_mul_i32 s37,s34,36
v_add_u32 v184,s37,v184
ds_write_b32 v184,v0 offset:56320
ds_write_b32 v184,v1 offset:56324
ds_write_b32 v184,v2 offset:56328
ds_write_b32 v184,v3 offset:56332
ds_write_b32 v184,v4 offset:56336
ds_write_b32 v184,v5 offset:56340
ds_write_b32 v184,v6 offset:56344
ds_write_b32 v184,v7 offset:56348
ds_write_b32 v184,v8 offset:56352
s_waitcnt lgkmcnt(0)
s_barrier
s_mov_b32 s12,s26
s_mov_b32 s13,s27
s_mov_b32 s14,2359296
s_mov_b32 s15,0x20000
s_lshl_b32 s37,s34,6
v_add_u32 v200,s37,v252
v_and_b32 v201,15,v200
v_lshrrev_b32 v200,4,v200
v_mul_u32_u24 v202,57,v200
v_lshrrev_b32 v202,9,v202
v_mul_u32_u24 v203,9,v202
v_sub_u32 v200,v200,v203
v_lshl_add_u32 v203,v202,4,v201
v_mul_u32_u24 v203,144,v203
v_lshl_add_u32 v203,v200,4,v203
ds_read_b128 v[204:207],v203 offset:56320
s_mul_i32 s38,s35,9
v_add_u32 v200,s38,v200
s_lshl_b32 s38,s36,2
v_add_u32 v202,s38,v202
v_mul_u32_u24 v202,72,v202
v_add_u32 v202,v202,v200
v_lshl_add_u32 v202,v202,4,v201
v_lshlrev_b32 v202,4,v202
s_waitcnt lgkmcnt(0)
buffer_store_dwordx4 v[204:207],v202,s[12:15],0 offen sc1
s_endpgm
attn_kernel_a0:
s_mov_b32 s43,0
v_and_b32 v59,15,v252
s_lshl_b32 s38,s43,4
v_add_u32 v70,s38,v59
v_lshlrev_b32 v71,7,v70
v_add_u32 v71,122880,v71
v_and_b32 v72,7,v59
v_add_u32 v73,0,v253
v_xor_b32 v73,v73,v72
v_lshl_add_u32 v254,v73,4,v71
v_add_u32 v73,4,v253
v_xor_b32 v73,v73,v72
v_lshl_add_u32 v255,v73,4,v71
v_bfe_u32 v61,v252,2,2
v_lshl_add_u32 v62,v253,3,v61
v_lshlrev_b32 v62,8,v62
v_and_b32 v63,1,v253
v_lshl_or_b32 v63,v63,2,v61
v_lshlrev_b32 v63,1,v63
v_and_b32 v64,3,v252
s_lshl_b32 s37,s35,4
v_add_u32 v65,0,v64
v_mul_u32_u24 v66,52,v65
v_lshrrev_b32 v66,8,v66
v_mul_u32_u24 v67,5,v66
v_sub_u32 v67,v65,v67
v_mul_u32_u24 v68,36,v66
v_and_b32 v66,1,v66
v_lshlrev_b32 v66,2,v66
v_sub_u32 v68,v68,v66
v_lshl_add_u32 v68,v67,3,v68
v_add_u32 v68,s37,v68
v_lshrrev_b32 v67,4,v68
v_xor_b32 v67,v67,v63
v_and_b32 v68,8,v68
v_lshl_add_u32 v67,v67,4,v68
v_add_u32 v232,v67,v62
v_add_u32 v65,4,v64
v_mul_u32_u24 v66,52,v65
v_lshrrev_b32 v66,8,v66
v_mul_u32_u24 v67,5,v66
v_sub_u32 v67,v65,v67
v_mul_u32_u24 v68,36,v66
v_and_b32 v66,1,v66
v_lshlrev_b32 v66,2,v66
v_sub_u32 v68,v68,v66
v_lshl_add_u32 v68,v67,3,v68
v_add_u32 v68,s37,v68
v_lshrrev_b32 v67,4,v68
v_xor_b32 v67,v67,v63
v_and_b32 v68,8,v68
v_lshl_add_u32 v67,v67,4,v68
v_add_u32 v233,v67,v62
v_add_u32 v65,8,v64
v_mul_u32_u24 v66,52,v65
v_lshrrev_b32 v66,8,v66
v_mul_u32_u24 v67,5,v66
v_sub_u32 v67,v65,v67
v_mul_u32_u24 v68,36,v66
v_and_b32 v66,1,v66
v_lshlrev_b32 v66,2,v66
v_sub_u32 v68,v68,v66
v_lshl_add_u32 v68,v67,3,v68
v_add_u32 v68,s37,v68
v_lshrrev_b32 v67,4,v68
v_xor_b32 v67,v67,v63
v_and_b32 v68,8,v68
v_lshl_add_u32 v67,v67,4,v68
v_add_u32 v234,v67,v62
v_add_u32 v65,12,v64
v_mul_u32_u24 v66,52,v65
v_lshrrev_b32 v66,8,v66
v_mul_u32_u24 v67,5,v66
v_sub_u32 v67,v65,v67
v_mul_u32_u24 v68,36,v66
v_and_b32 v66,1,v66
v_lshlrev_b32 v66,2,v66
v_sub_u32 v68,v68,v66
v_lshl_add_u32 v68,v67,3,v68
v_add_u32 v68,s37,v68
v_lshrrev_b32 v67,4,v68
v_xor_b32 v67,v67,v63
v_and_b32 v68,8,v68
v_lshl_add_u32 v67,v67,4,v68
v_add_u32 v235,v67,v62
v_add_u32 v65,16,v64
v_mul_u32_u24 v66,52,v65
v_lshrrev_b32 v66,8,v66
v_mul_u32_u24 v67,5,v66
v_sub_u32 v67,v65,v67
v_mul_u32_u24 v68,36,v66
v_and_b32 v66,1,v66
v_lshlrev_b32 v66,2,v66
v_sub_u32 v68,v68,v66
v_lshl_add_u32 v68,v67,3,v68
v_add_u32 v68,s37,v68
v_lshrrev_b32 v67,4,v68
v_xor_b32 v67,v67,v63
v_and_b32 v68,8,v68
v_lshl_add_u32 v67,v67,4,v68
v_add_u32 v236,v67,v62
v_mov_b32 v240,0x3f803f80
v_mov_b32 v241,0x3f803f80
v_mov_b32 v242,0x3f803f80
v_mov_b32 v243,0x3f803f80
v_mul_u32_u24 v61,48,v70
v_mul_u32_u24 v62,80,v70
v_add_u32 v63,0,v253
v_mul_u32_u24 v64,52,v63
v_lshrrev_b32 v64,8,v64
v_mul_u32_u24 v65,5,v64
v_sub_u32 v65,v63,v65
v_mul_u32_u24 v66,3840,v64
v_lshl_add_u32 v66,v65,3,v66
v_add_u32 v40,v66,v61
v_mul_u32_u24 v66,6400,v64
v_lshl_add_u32 v66,v65,4,v66
v_add_u32 v48,v66,v62
v_add_u32 v63,4,v253
v_mul_u32_u24 v64,52,v63
v_lshrrev_b32 v64,8,v64
v_mul_u32_u24 v65,5,v64
v_sub_u32 v65,v63,v65
v_mul_u32_u24 v66,3840,v64
v_lshl_add_u32 v66,v65,3,v66
v_add_u32 v41,v66,v61
v_mul_u32_u24 v66,6400,v64
v_lshl_add_u32 v66,v65,4,v66
v_add_u32 v49,v66,v62
v_add_u32 v63,8,v253
v_mul_u32_u24 v64,52,v63
v_lshrrev_b32 v64,8,v64
v_mul_u32_u24 v65,5,v64
v_sub_u32 v65,v63,v65
v_mul_u32_u24 v66,3840,v64
v_lshl_add_u32 v66,v65,3,v66
v_add_u32 v42,v66,v61
v_mul_u32_u24 v66,6400,v64
v_lshl_add_u32 v66,v65,4,v66
v_add_u32 v50,v66,v62
v_add_u32 v63,12,v253
v_mul_u32_u24 v64,52,v63
v_lshrrev_b32 v64,8,v64
v_mul_u32_u24 v65,5,v64
v_sub_u32 v65,v63,v65
v_mul_u32_u24 v66,3840,v64
v_lshl_add_u32 v66,v65,3,v66
v_add_u32 v43,v66,v61
v_mul_u32_u24 v66,6400,v64
v_lshl_add_u32 v66,v65,4,v66
v_add_u32 v51,v66,v62
v_add_u32 v63,16,v253
v_mul_u32_u24 v64,52,v63
v_lshrrev_b32 v64,8,v64
v_mul_u32_u24 v65,5,v64
v_sub_u32 v65,v63,v65
v_mul_u32_u24 v66,3840,v64
v_lshl_add_u32 v66,v65,3,v66
v_add_u32 v44,v66,v61
v_mul_u32_u24 v66,6400,v64
v_lshl_add_u32 v66,v65,4,v66
v_add_u32 v52,v66,v62
v_lshlrev_b32 v56,3,v70
v_add_u32 v56,154624,v56
v_lshlrev_b32 v57,4,v253
v_add_u32 v57,153600,v57
v_and_b32 v58,7,v252
v_lshlrev_b32 v58,4,v58
v_add_u32 v58,122880,v58
s_waitcnt lgkmcnt(0)
s_barrier
ds_write_b128 v58,v[240:243] offset:0
ds_read_b128 v[0:3],v254 offset:0
ds_read_b64_tr_b16 v[100:101],v232 offset:0
ds_read_b64_tr_b16 v[102:103],v232 offset:1024
ds_read_b64_tr_b16 v[104:105],v233 offset:0
ds_read_b64_tr_b16 v[106:107],v233 offset:1024
ds_read_b64_tr_b16 v[108:109],v234 offset:0
ds_read_b64_tr_b16 v[110:111],v234 offset:1024
ds_read_b64_tr_b16 v[112:113],v235 offset:0
ds_read_b64_tr_b16 v[114:115],v235 offset:1024
ds_read_b64_tr_b16 v[116:117],v236 offset:0
ds_read_b64_tr_b16 v[118:119],v236 offset:1024
ds_read_b64_tr_b16 v[120:121],v232 offset:8192
ds_read_b64_tr_b16 v[122:123],v232 offset:9216
ds_read_b64_tr_b16 v[124:125],v233 offset:8192
ds_read_b64_tr_b16 v[126:127],v233 offset:9216
s_waitcnt lgkmcnt(14)
s_waitcnt lgkmcnt(12)
v_mfma_f32_16x16x32_bf16 v[244:247],v[240:243],v[0:3],0
v_mfma_f32_16x16x32_bf16 v[248:251],v[0:3],v[0:3],0
v_mfma_f32_16x16x32_bf16 v[144:147],v[100:103],v[0:3],0
ds_read_b64_tr_b16 v[128:129],v234 offset:8192
ds_read_b64_tr_b16 v[130:131],v234 offset:9216
s_waitcnt lgkmcnt(12)
v_mfma_f32_16x16x32_bf16 v[148:151],v[104:107],v[0:3],0
s_barrier
ds_read_b128 v[4:7],v255 offset:0
v_add_u32 v232,24576,v232
ds_read_b64_tr_b16 v[132:133],v232 offset:0
ds_read_b64_tr_b16 v[134:135],v232 offset:1024
s_waitcnt lgkmcnt(13)
v_mfma_f32_16x16x32_bf16 v[152:155],v[108:111],v[0:3],0
v_add_u32 v233,24576,v233
ds_read_b64_tr_b16 v[136:137],v233 offset:0
ds_read_b64_tr_b16 v[138:139],v233 offset:1024
s_waitcnt lgkmcnt(13)
v_mfma_f32_16x16x32_bf16 v[156:159],v[112:115],v[0:3],0
v_add_u32 v234,24576,v234
ds_read_b64_tr_b16 v[100:101],v234 offset:0
ds_read_b64_tr_b16 v[102:103],v234 offset:1024
s_waitcnt lgkmcnt(13)
v_mfma_f32_16x16x32_bf16 v[160:163],v[116:119],v[0:3],0
v_add_u32 v235,24576,v235
ds_read_b64_tr_b16 v[104:105],v235 offset:0
ds_read_b64_tr_b16 v[106:107],v235 offset:1024
s_waitcnt lgkmcnt(13)
v_mfma_f32_16x16x32_bf16 v[164:167],v[120:123],v[0:3],0
v_add_u32 v236,24576,v236
ds_read_b64_tr_b16 v[108:109],v236 offset:0
ds_read_b64_tr_b16 v[110:111],v236 offset:1024
s_waitcnt lgkmcnt(13)
v_mfma_f32_16x16x32_bf16 v[168:171],v[124:127],v[0:3],0
ds_read_b64_tr_b16 v[112:113],v232 offset:8192
ds_read_b64_tr_b16 v[114:115],v232 offset:9216
s_waitcnt lgkmcnt(13)
v_mfma_f32_16x16x32_bf16 v[172:175],v[128:131],v[0:3],0
ds_read_b64_tr_b16 v[116:117],v233 offset:8192
ds_read_b64_tr_b16 v[118:119],v233 offset:9216
s_waitcnt lgkmcnt(14)
s_waitcnt lgkmcnt(12)
v_mfma_f32_16x16x32_bf16 v[244:247],v[240:243],v[4:7],v[244:247]
v_mfma_f32_16x16x32_bf16 v[248:251],v[4:7],v[4:7],v[248:251]
v_mfma_f32_16x16x32_bf16 v[144:147],v[132:135],v[4:7],v[144:147]
ds_read_b64_tr_b16 v[120:121],v234 offset:8192
ds_read_b64_tr_b16 v[122:123],v234 offset:9216
s_waitcnt lgkmcnt(12)
v_mfma_f32_16x16x32_bf16 v[148:151],v[136:139],v[4:7],v[148:151]
s_barrier
ds_write_b128 v58,v[240:243] offset:10240
ds_read_b128 v[8:11],v254 offset:10240
v_add_u32 v232,24576,v232
ds_read_b64_tr_b16 v[124:125],v232 offset:0
ds_read_b64_tr_b16 v[126:127],v232 offset:1024
s_waitcnt lgkmcnt(14)
v_mfma_f32_16x16x32_bf16 v[152:155],v[100:103],v[4:7],v[152:155]
v_add_u32 v233,24576,v233
ds_read_b64_tr_b16 v[128:129],v233 offset:0
ds_read_b64_tr_b16 v[130:131],v233 offset:1024
s_waitcnt lgkmcnt(14)
v_mfma_f32_16x16x32_bf16 v[156:159],v[104:107],v[4:7],v[156:159]
v_add_u32 v234,24576,v234
ds_read_b64_tr_b16 v[132:133],v234 offset:0
ds_read_b64_tr_b16 v[134:135],v234 offset:1024
s_waitcnt lgkmcnt(14)
v_mfma_f32_16x16x32_bf16 v[160:163],v[108:111],v[4:7],v[160:163]
v_add_u32 v235,24576,v235
ds_read_b64_tr_b16 v[136:137],v235 offset:0
ds_read_b64_tr_b16 v[138:139],v235 offset:1024
s_waitcnt lgkmcnt(14)
v_mfma_f32_16x16x32_bf16 v[164:167],v[112:115],v[4:7],v[164:167]
v_add_u32 v236,24576,v236
ds_read_b64_tr_b16 v[100:101],v236 offset:0
ds_read_b64_tr_b16 v[102:103],v236 offset:1024
s_waitcnt lgkmcnt(14)
v_mfma_f32_16x16x32_bf16 v[168:171],v[116:119],v[4:7],v[168:171]
ds_read_b64_tr_b16 v[104:105],v232 offset:8192
ds_read_b64_tr_b16 v[106:107],v232 offset:9216
s_waitcnt lgkmcnt(14)
v_mfma_f32_16x16x32_bf16 v[172:175],v[120:123],v[4:7],v[172:175]
ds_read_b64_tr_b16 v[108:109],v233 offset:8192
ds_read_b64_tr_b16 v[110:111],v233 offset:9216
s_waitcnt lgkmcnt(14)
s_waitcnt lgkmcnt(12)
v_mfma_f32_16x16x32_bf16 v[244:247],v[240:243],v[8:11],v[244:247]
v_mfma_f32_16x16x32_bf16 v[248:251],v[8:11],v[8:11],v[248:251]
v_mfma_f32_16x16x32_bf16 v[144:147],v[124:127],v[8:11],v[144:147]
ds_read_b64_tr_b16 v[112:113],v234 offset:8192
ds_read_b64_tr_b16 v[114:115],v234 offset:9216
s_waitcnt lgkmcnt(12)
v_mfma_f32_16x16x32_bf16 v[148:151],v[128:131],v[8:11],v[148:151]
s_barrier
ds_read_b128 v[0:3],v255 offset:10240
v_add_u32 v232,24576,v232
ds_read_b64_tr_b16 v[116:117],v232 offset:0
ds_read_b64_tr_b16 v[118:119],v232 offset:1024
s_waitcnt lgkmcnt(13)
v_mfma_f32_16x16x32_bf16 v[152:155],v[132:135],v[8:11],v[152:155]
v_add_u32 v233,24576,v233
ds_read_b64_tr_b16 v[120:121],v233 offset:0
ds_read_b64_tr_b16 v[122:123],v233 offset:1024
s_waitcnt lgkmcnt(13)
v_mfma_f32_16x16x32_bf16 v[156:159],v[136:139],v[8:11],v[156:159]
v_add_u32 v234,24576,v234
ds_read_b64_tr_b16 v[124:125],v234 offset:0
ds_read_b64_tr_b16 v[126:127],v234 offset:1024
s_waitcnt lgkmcnt(13)
v_mfma_f32_16x16x32_bf16 v[160:163],v[100:103],v[8:11],v[160:163]
v_add_u32 v235,24576,v235
ds_read_b64_tr_b16 v[128:129],v235 offset:0
ds_read_b64_tr_b16 v[130:131],v235 offset:1024
s_waitcnt lgkmcnt(13)
v_mfma_f32_16x16x32_bf16 v[164:167],v[104:107],v[8:11],v[164:167]
v_add_u32 v236,24576,v236
ds_read_b64_tr_b16 v[132:133],v236 offset:0
ds_read_b64_tr_b16 v[134:135],v236 offset:1024
s_waitcnt lgkmcnt(13)
v_mfma_f32_16x16x32_bf16 v[168:171],v[108:111],v[8:11],v[168:171]
ds_read_b64_tr_b16 v[136:137],v232 offset:8192
ds_read_b64_tr_b16 v[138:139],v232 offset:9216
s_waitcnt lgkmcnt(13)
v_mfma_f32_16x16x32_bf16 v[172:175],v[112:115],v[8:11],v[172:175]
ds_read_b64_tr_b16 v[100:101],v233 offset:8192
ds_read_b64_tr_b16 v[102:103],v233 offset:9216
s_waitcnt lgkmcnt(14)
s_waitcnt lgkmcnt(12)
v_mfma_f32_16x16x32_bf16 v[244:247],v[240:243],v[0:3],v[244:247]
v_mfma_f32_16x16x32_bf16 v[248:251],v[0:3],v[0:3],v[248:251]
v_mfma_f32_16x16x32_bf16 v[144:147],v[116:119],v[0:3],v[144:147]
ds_read_b64_tr_b16 v[104:105],v234 offset:8192
ds_read_b64_tr_b16 v[106:107],v234 offset:9216
s_waitcnt lgkmcnt(12)
v_mfma_f32_16x16x32_bf16 v[148:151],v[120:123],v[0:3],v[148:151]
s_barrier
ds_write_b128 v58,v[240:243] offset:20480
ds_read_b128 v[4:7],v254 offset:20480
v_add_u32 v232,24576,v232
ds_read_b64_tr_b16 v[108:109],v232 offset:0
ds_read_b64_tr_b16 v[110:111],v232 offset:1024
s_waitcnt lgkmcnt(14)
v_mfma_f32_16x16x32_bf16 v[152:155],v[124:127],v[0:3],v[152:155]
v_add_u32 v233,24576,v233
ds_read_b64_tr_b16 v[112:113],v233 offset:0
ds_read_b64_tr_b16 v[114:115],v233 offset:1024
s_waitcnt lgkmcnt(14)
v_mfma_f32_16x16x32_bf16 v[156:159],v[128:131],v[0:3],v[156:159]
v_add_u32 v234,24576,v234
ds_read_b64_tr_b16 v[116:117],v234 offset:0
ds_read_b64_tr_b16 v[118:119],v234 offset:1024
s_waitcnt lgkmcnt(14)
v_mfma_f32_16x16x32_bf16 v[160:163],v[132:135],v[0:3],v[160:163]
v_add_u32 v235,24576,v235
ds_read_b64_tr_b16 v[120:121],v235 offset:0
ds_read_b64_tr_b16 v[122:123],v235 offset:1024
s_waitcnt lgkmcnt(14)
v_mfma_f32_16x16x32_bf16 v[164:167],v[136:139],v[0:3],v[164:167]
v_add_u32 v236,24576,v236
ds_read_b64_tr_b16 v[124:125],v236 offset:0
ds_read_b64_tr_b16 v[126:127],v236 offset:1024
s_waitcnt lgkmcnt(14)
v_mfma_f32_16x16x32_bf16 v[168:171],v[100:103],v[0:3],v[168:171]
ds_read_b64_tr_b16 v[128:129],v232 offset:8192
ds_read_b64_tr_b16 v[130:131],v232 offset:9216
s_waitcnt lgkmcnt(14)
v_mfma_f32_16x16x32_bf16 v[172:175],v[104:107],v[0:3],v[172:175]
ds_read_b64_tr_b16 v[132:133],v233 offset:8192
ds_read_b64_tr_b16 v[134:135],v233 offset:9216
s_waitcnt lgkmcnt(14)
s_waitcnt lgkmcnt(12)
v_mfma_f32_16x16x32_bf16 v[244:247],v[240:243],v[4:7],v[244:247]
v_mfma_f32_16x16x32_bf16 v[248:251],v[4:7],v[4:7],v[248:251]
v_mfma_f32_16x16x32_bf16 v[144:147],v[108:111],v[4:7],v[144:147]
ds_read_b64_tr_b16 v[136:137],v234 offset:8192
ds_read_b64_tr_b16 v[138:139],v234 offset:9216
s_waitcnt lgkmcnt(12)
v_mfma_f32_16x16x32_bf16 v[148:151],v[112:115],v[4:7],v[148:151]
s_barrier
ds_read_b128 v[8:11],v255 offset:20480
v_subrev_u32 v232,98304,v232
ds_read_b64_tr_b16 v[100:101],v232 offset:0
ds_read_b64_tr_b16 v[102:103],v232 offset:1024
s_waitcnt lgkmcnt(13)
v_mfma_f32_16x16x32_bf16 v[152:155],v[116:119],v[4:7],v[152:155]
v_subrev_u32 v233,98304,v233
ds_read_b64_tr_b16 v[104:105],v233 offset:0
ds_read_b64_tr_b16 v[106:107],v233 offset:1024
s_waitcnt lgkmcnt(13)
v_mfma_f32_16x16x32_bf16 v[156:159],v[120:123],v[4:7],v[156:159]
v_subrev_u32 v234,98304,v234
ds_read_b64_tr_b16 v[108:109],v234 offset:0
ds_read_b64_tr_b16 v[110:111],v234 offset:1024
s_waitcnt lgkmcnt(13)
v_mfma_f32_16x16x32_bf16 v[160:163],v[124:127],v[4:7],v[160:163]
v_subrev_u32 v235,98304,v235
ds_read_b64_tr_b16 v[112:113],v235 offset:0
ds_read_b64_tr_b16 v[114:115],v235 offset:1024
s_waitcnt lgkmcnt(13)
v_mfma_f32_16x16x32_bf16 v[164:167],v[128:131],v[4:7],v[164:167]
v_subrev_u32 v236,98304,v236
ds_read_b64_tr_b16 v[116:117],v236 offset:0
ds_read_b64_tr_b16 v[118:119],v236 offset:1024
s_waitcnt lgkmcnt(13)
v_mfma_f32_16x16x32_bf16 v[168:171],v[132:135],v[4:7],v[168:171]
ds_read_b64_tr_b16 v[120:121],v232 offset:8192
ds_read_b64_tr_b16 v[122:123],v232 offset:9216
s_waitcnt lgkmcnt(13)
v_mfma_f32_16x16x32_bf16 v[172:175],v[136:139],v[4:7],v[172:175]
ds_read_b64_tr_b16 v[124:125],v233 offset:8192
ds_read_b64_tr_b16 v[126:127],v233 offset:9216
s_waitcnt lgkmcnt(14)
s_waitcnt lgkmcnt(12)
v_mfma_f32_16x16x32_bf16 v[244:247],v[240:243],v[8:11],v[244:247]
v_mfma_f32_16x16x32_bf16 v[248:251],v[8:11],v[8:11],v[248:251]
v_mfma_f32_16x16x32_bf16 v[144:147],v[100:103],v[8:11],v[144:147]
ds_read_b64_tr_b16 v[128:129],v234 offset:8192
ds_read_b64_tr_b16 v[130:131],v234 offset:9216
s_waitcnt lgkmcnt(12)
v_mfma_f32_16x16x32_bf16 v[148:151],v[104:107],v[8:11],v[148:151]
s_barrier
ds_write_b128 v58,v[240:243] offset:0
ds_read_b128 v[0:3],v254 offset:0
v_add_u32 v232,24576,v232
ds_read_b64_tr_b16 v[132:133],v232 offset:0
ds_read_b64_tr_b16 v[134:135],v232 offset:1024
s_waitcnt lgkmcnt(14)
v_mfma_f32_16x16x32_bf16 v[152:155],v[108:111],v[8:11],v[152:155]
v_add_u32 v233,24576,v233
ds_read_b64_tr_b16 v[136:137],v233 offset:0
ds_read_b64_tr_b16 v[138:139],v233 offset:1024
s_waitcnt lgkmcnt(14)
v_mfma_f32_16x16x32_bf16 v[156:159],v[112:115],v[8:11],v[156:159]
v_add_u32 v234,24576,v234
ds_read_b64_tr_b16 v[100:101],v234 offset:0
ds_read_b64_tr_b16 v[102:103],v234 offset:1024
s_waitcnt lgkmcnt(14)
v_mfma_f32_16x16x32_bf16 v[160:163],v[116:119],v[8:11],v[160:163]
v_add_u32 v235,24576,v235
ds_read_b64_tr_b16 v[104:105],v235 offset:0
ds_read_b64_tr_b16 v[106:107],v235 offset:1024
s_waitcnt lgkmcnt(14)
v_mfma_f32_16x16x32_bf16 v[164:167],v[120:123],v[8:11],v[164:167]
v_add_u32 v236,24576,v236
ds_read_b64_tr_b16 v[108:109],v236 offset:0
ds_read_b64_tr_b16 v[110:111],v236 offset:1024
s_waitcnt lgkmcnt(14)
v_mfma_f32_16x16x32_bf16 v[168:171],v[124:127],v[8:11],v[168:171]
ds_read_b64_tr_b16 v[112:113],v232 offset:8192
ds_read_b64_tr_b16 v[114:115],v232 offset:9216
s_waitcnt lgkmcnt(14)
v_mfma_f32_16x16x32_bf16 v[172:175],v[128:131],v[8:11],v[172:175]
ds_read_b64_tr_b16 v[116:117],v233 offset:8192
ds_read_b64_tr_b16 v[118:119],v233 offset:9216
s_waitcnt lgkmcnt(14)
s_waitcnt lgkmcnt(12)
v_mfma_f32_16x16x32_bf16 v[244:247],v[240:243],v[0:3],v[244:247]
v_mfma_f32_16x16x32_bf16 v[248:251],v[0:3],v[0:3],v[248:251]
v_mfma_f32_16x16x32_bf16 v[144:147],v[132:135],v[0:3],v[144:147]
ds_read_b64_tr_b16 v[120:121],v234 offset:8192
ds_read_b64_tr_b16 v[122:123],v234 offset:9216
s_waitcnt lgkmcnt(12)
v_mfma_f32_16x16x32_bf16 v[148:151],v[136:139],v[0:3],v[148:151]
s_barrier
ds_read_b128 v[4:7],v255 offset:0
v_add_u32 v232,24576,v232
ds_read_b64_tr_b16 v[124:125],v232 offset:0
ds_read_b64_tr_b16 v[126:127],v232 offset:1024
s_waitcnt lgkmcnt(13)
v_mfma_f32_16x16x32_bf16 v[152:155],v[100:103],v[0:3],v[152:155]
v_add_u32 v233,24576,v233
ds_read_b64_tr_b16 v[128:129],v233 offset:0
ds_read_b64_tr_b16 v[130:131],v233 offset:1024
s_waitcnt lgkmcnt(13)
v_mfma_f32_16x16x32_bf16 v[156:159],v[104:107],v[0:3],v[156:159]
v_add_u32 v234,24576,v234
ds_read_b64_tr_b16 v[132:133],v234 offset:0
ds_read_b64_tr_b16 v[134:135],v234 offset:1024
s_waitcnt lgkmcnt(13)
v_mfma_f32_16x16x32_bf16 v[160:163],v[108:111],v[0:3],v[160:163]
v_add_u32 v235,24576,v235
ds_read_b64_tr_b16 v[136:137],v235 offset:0
ds_read_b64_tr_b16 v[138:139],v235 offset:1024
s_waitcnt lgkmcnt(13)
v_mfma_f32_16x16x32_bf16 v[164:167],v[112:115],v[0:3],v[164:167]
v_add_u32 v236,24576,v236
ds_read_b64_tr_b16 v[100:101],v236 offset:0
ds_read_b64_tr_b16 v[102:103],v236 offset:1024
s_waitcnt lgkmcnt(13)
v_mfma_f32_16x16x32_bf16 v[168:171],v[116:119],v[0:3],v[168:171]
ds_read_b64_tr_b16 v[104:105],v232 offset:8192
ds_read_b64_tr_b16 v[106:107],v232 offset:9216
s_waitcnt lgkmcnt(13)
v_mfma_f32_16x16x32_bf16 v[172:175],v[120:123],v[0:3],v[172:175]
ds_read_b64_tr_b16 v[108:109],v233 offset:8192
ds_read_b64_tr_b16 v[110:111],v233 offset:9216
s_waitcnt lgkmcnt(14)
s_waitcnt lgkmcnt(12)
v_mfma_f32_16x16x32_bf16 v[244:247],v[240:243],v[4:7],v[244:247]
v_mfma_f32_16x16x32_bf16 v[248:251],v[4:7],v[4:7],v[248:251]
v_mfma_f32_16x16x32_bf16 v[144:147],v[124:127],v[4:7],v[144:147]
ds_read_b64_tr_b16 v[112:113],v234 offset:8192
ds_read_b64_tr_b16 v[114:115],v234 offset:9216
s_waitcnt lgkmcnt(12)
v_mfma_f32_16x16x32_bf16 v[148:151],v[128:131],v[4:7],v[148:151]
s_barrier
ds_write_b128 v58,v[240:243] offset:10240
ds_read_b128 v[8:11],v254 offset:10240
v_add_u32 v232,24576,v232
ds_read_b64_tr_b16 v[116:117],v232 offset:0
ds_read_b64_tr_b16 v[118:119],v232 offset:1024
s_waitcnt lgkmcnt(14)
v_mfma_f32_16x16x32_bf16 v[152:155],v[132:135],v[4:7],v[152:155]
v_add_u32 v233,24576,v233
ds_read_b64_tr_b16 v[120:121],v233 offset:0
ds_read_b64_tr_b16 v[122:123],v233 offset:1024
s_waitcnt lgkmcnt(14)
v_mfma_f32_16x16x32_bf16 v[156:159],v[136:139],v[4:7],v[156:159]
v_add_u32 v234,24576,v234
ds_read_b64_tr_b16 v[124:125],v234 offset:0
ds_read_b64_tr_b16 v[126:127],v234 offset:1024
s_waitcnt lgkmcnt(14)
v_mfma_f32_16x16x32_bf16 v[160:163],v[100:103],v[4:7],v[160:163]
v_add_u32 v235,24576,v235
ds_read_b64_tr_b16 v[128:129],v235 offset:0
ds_read_b64_tr_b16 v[130:131],v235 offset:1024
s_waitcnt lgkmcnt(14)
v_mfma_f32_16x16x32_bf16 v[164:167],v[104:107],v[4:7],v[164:167]
v_add_u32 v236,24576,v236
ds_read_b64_tr_b16 v[132:133],v236 offset:0
ds_read_b64_tr_b16 v[134:135],v236 offset:1024
s_waitcnt lgkmcnt(14)
v_mfma_f32_16x16x32_bf16 v[168:171],v[108:111],v[4:7],v[168:171]
ds_read_b64_tr_b16 v[136:137],v232 offset:8192
ds_read_b64_tr_b16 v[138:139],v232 offset:9216
s_waitcnt lgkmcnt(14)
v_mfma_f32_16x16x32_bf16 v[172:175],v[112:115],v[4:7],v[172:175]
ds_read_b64_tr_b16 v[100:101],v233 offset:8192
ds_read_b64_tr_b16 v[102:103],v233 offset:9216
s_waitcnt lgkmcnt(14)
s_waitcnt lgkmcnt(12)
v_mfma_f32_16x16x32_bf16 v[244:247],v[240:243],v[8:11],v[244:247]
v_mfma_f32_16x16x32_bf16 v[248:251],v[8:11],v[8:11],v[248:251]
v_mfma_f32_16x16x32_bf16 v[144:147],v[116:119],v[8:11],v[144:147]
ds_read_b64_tr_b16 v[104:105],v234 offset:8192
ds_read_b64_tr_b16 v[106:107],v234 offset:9216
s_waitcnt lgkmcnt(12)
v_mfma_f32_16x16x32_bf16 v[148:151],v[120:123],v[8:11],v[148:151]
s_barrier
ds_read_b128 v[0:3],v255 offset:10240
v_add_u32 v232,24576,v232
ds_read_b64_tr_b16 v[108:109],v232 offset:0
ds_read_b64_tr_b16 v[110:111],v232 offset:1024
s_waitcnt lgkmcnt(13)
v_mfma_f32_16x16x32_bf16 v[152:155],v[124:127],v[8:11],v[152:155]
v_add_u32 v233,24576,v233
ds_read_b64_tr_b16 v[112:113],v233 offset:0
ds_read_b64_tr_b16 v[114:115],v233 offset:1024
s_waitcnt lgkmcnt(13)
v_mfma_f32_16x16x32_bf16 v[156:159],v[128:131],v[8:11],v[156:159]
v_add_u32 v234,24576,v234
ds_read_b64_tr_b16 v[116:117],v234 offset:0
ds_read_b64_tr_b16 v[118:119],v234 offset:1024
s_waitcnt lgkmcnt(13)
v_mfma_f32_16x16x32_bf16 v[160:163],v[132:135],v[8:11],v[160:163]
v_add_u32 v235,24576,v235
ds_read_b64_tr_b16 v[120:121],v235 offset:0
ds_read_b64_tr_b16 v[122:123],v235 offset:1024
s_waitcnt lgkmcnt(13)
v_mfma_f32_16x16x32_bf16 v[164:167],v[136:139],v[8:11],v[164:167]
v_add_u32 v236,24576,v236
ds_read_b64_tr_b16 v[124:125],v236 offset:0
ds_read_b64_tr_b16 v[126:127],v236 offset:1024
s_waitcnt lgkmcnt(13)
v_mfma_f32_16x16x32_bf16 v[168:171],v[100:103],v[8:11],v[168:171]
ds_read_b64_tr_b16 v[128:129],v232 offset:8192
ds_read_b64_tr_b16 v[130:131],v232 offset:9216
s_waitcnt lgkmcnt(13)
v_mfma_f32_16x16x32_bf16 v[172:175],v[104:107],v[8:11],v[172:175]
ds_read_b64_tr_b16 v[132:133],v233 offset:8192
ds_read_b64_tr_b16 v[134:135],v233 offset:9216
s_waitcnt lgkmcnt(14)
s_waitcnt lgkmcnt(12)
v_mfma_f32_16x16x32_bf16 v[244:247],v[240:243],v[0:3],v[244:247]
v_mfma_f32_16x16x32_bf16 v[248:251],v[0:3],v[0:3],v[248:251]
v_mfma_f32_16x16x32_bf16 v[144:147],v[108:111],v[0:3],v[144:147]
ds_read_b64_tr_b16 v[136:137],v234 offset:8192
ds_read_b64_tr_b16 v[138:139],v234 offset:9216
s_waitcnt lgkmcnt(12)
v_mfma_f32_16x16x32_bf16 v[148:151],v[112:115],v[0:3],v[148:151]
s_barrier
ds_write_b128 v58,v[240:243] offset:20480
ds_read_b128 v[4:7],v254 offset:20480
v_subrev_u32 v232,98304,v232
ds_read_b64_tr_b16 v[100:101],v232 offset:0
ds_read_b64_tr_b16 v[102:103],v232 offset:1024
s_waitcnt lgkmcnt(14)
v_mfma_f32_16x16x32_bf16 v[152:155],v[116:119],v[0:3],v[152:155]
v_subrev_u32 v233,98304,v233
ds_read_b64_tr_b16 v[104:105],v233 offset:0
ds_read_b64_tr_b16 v[106:107],v233 offset:1024
s_waitcnt lgkmcnt(14)
v_mfma_f32_16x16x32_bf16 v[156:159],v[120:123],v[0:3],v[156:159]
v_subrev_u32 v234,98304,v234
ds_read_b64_tr_b16 v[108:109],v234 offset:0
ds_read_b64_tr_b16 v[110:111],v234 offset:1024
s_waitcnt lgkmcnt(14)
v_mfma_f32_16x16x32_bf16 v[160:163],v[124:127],v[0:3],v[160:163]
v_subrev_u32 v235,98304,v235
ds_read_b64_tr_b16 v[112:113],v235 offset:0
ds_read_b64_tr_b16 v[114:115],v235 offset:1024
s_waitcnt lgkmcnt(14)
v_mfma_f32_16x16x32_bf16 v[164:167],v[128:131],v[0:3],v[164:167]
v_subrev_u32 v236,98304,v236
ds_read_b64_tr_b16 v[116:117],v236 offset:0
ds_read_b64_tr_b16 v[118:119],v236 offset:1024
s_waitcnt lgkmcnt(14)
v_mfma_f32_16x16x32_bf16 v[168:171],v[132:135],v[0:3],v[168:171]
ds_read_b64_tr_b16 v[120:121],v232 offset:8192
ds_read_b64_tr_b16 v[122:123],v232 offset:9216
s_waitcnt lgkmcnt(14)
v_mfma_f32_16x16x32_bf16 v[172:175],v[136:139],v[0:3],v[172:175]
ds_read_b64_tr_b16 v[124:125],v233 offset:8192
ds_read_b64_tr_b16 v[126:127],v233 offset:9216
s_waitcnt lgkmcnt(14)
s_waitcnt lgkmcnt(12)
v_mfma_f32_16x16x32_bf16 v[244:247],v[240:243],v[4:7],v[244:247]
v_mfma_f32_16x16x32_bf16 v[248:251],v[4:7],v[4:7],v[248:251]
v_mfma_f32_16x16x32_bf16 v[144:147],v[100:103],v[4:7],v[144:147]
ds_read_b64_tr_b16 v[128:129],v234 offset:8192
ds_read_b64_tr_b16 v[130:131],v234 offset:9216
s_waitcnt lgkmcnt(12)
v_mfma_f32_16x16x32_bf16 v[148:151],v[104:107],v[4:7],v[148:151]
s_barrier
ds_read_b128 v[8:11],v255 offset:20480
v_add_u32 v232,24576,v232
ds_read_b64_tr_b16 v[132:133],v232 offset:0
ds_read_b64_tr_b16 v[134:135],v232 offset:1024
s_waitcnt lgkmcnt(13)
v_mfma_f32_16x16x32_bf16 v[152:155],v[108:111],v[4:7],v[152:155]
v_add_u32 v233,24576,v233
ds_read_b64_tr_b16 v[136:137],v233 offset:0
ds_read_b64_tr_b16 v[138:139],v233 offset:1024
s_waitcnt lgkmcnt(13)
v_mfma_f32_16x16x32_bf16 v[156:159],v[112:115],v[4:7],v[156:159]
v_add_u32 v234,24576,v234
ds_read_b64_tr_b16 v[100:101],v234 offset:0
ds_read_b64_tr_b16 v[102:103],v234 offset:1024
s_waitcnt lgkmcnt(13)
v_mfma_f32_16x16x32_bf16 v[160:163],v[116:119],v[4:7],v[160:163]
v_add_u32 v235,24576,v235
ds_read_b64_tr_b16 v[104:105],v235 offset:0
ds_read_b64_tr_b16 v[106:107],v235 offset:1024
s_waitcnt lgkmcnt(13)
v_mfma_f32_16x16x32_bf16 v[164:167],v[120:123],v[4:7],v[164:167]
v_add_u32 v236,24576,v236
ds_read_b64_tr_b16 v[108:109],v236 offset:0
ds_read_b64_tr_b16 v[110:111],v236 offset:1024
s_waitcnt lgkmcnt(13)
v_mfma_f32_16x16x32_bf16 v[168:171],v[124:127],v[4:7],v[168:171]
ds_read_b64_tr_b16 v[112:113],v232 offset:8192
ds_read_b64_tr_b16 v[114:115],v232 offset:9216
s_waitcnt lgkmcnt(13)
v_mfma_f32_16x16x32_bf16 v[172:175],v[128:131],v[4:7],v[172:175]
ds_read_b64_tr_b16 v[116:117],v233 offset:8192
ds_read_b64_tr_b16 v[118:119],v233 offset:9216
s_waitcnt lgkmcnt(14)
s_waitcnt lgkmcnt(12)
v_mfma_f32_16x16x32_bf16 v[244:247],v[240:243],v[8:11],v[244:247]
v_mfma_f32_16x16x32_bf16 v[248:251],v[8:11],v[8:11],v[248:251]
v_mfma_f32_16x16x32_bf16 v[144:147],v[132:135],v[8:11],v[144:147]
ds_read_b64_tr_b16 v[120:121],v234 offset:8192
ds_read_b64_tr_b16 v[122:123],v234 offset:9216
s_waitcnt lgkmcnt(12)
v_mfma_f32_16x16x32_bf16 v[148:151],v[136:139],v[8:11],v[148:151]
s_barrier
ds_write_b128 v58,v[240:243] offset:0
ds_read_b128 v[0:3],v254 offset:0
v_add_u32 v232,24576,v232
ds_read_b64_tr_b16 v[124:125],v232 offset:0
ds_read_b64_tr_b16 v[126:127],v232 offset:1024
s_waitcnt lgkmcnt(14)
v_mfma_f32_16x16x32_bf16 v[152:155],v[100:103],v[8:11],v[152:155]
v_add_u32 v233,24576,v233
ds_read_b64_tr_b16 v[128:129],v233 offset:0
ds_read_b64_tr_b16 v[130:131],v233 offset:1024
s_waitcnt lgkmcnt(14)
v_mfma_f32_16x16x32_bf16 v[156:159],v[104:107],v[8:11],v[156:159]
v_add_u32 v234,24576,v234
ds_read_b64_tr_b16 v[132:133],v234 offset:0
ds_read_b64_tr_b16 v[134:135],v234 offset:1024
s_waitcnt lgkmcnt(14)
v_mfma_f32_16x16x32_bf16 v[160:163],v[108:111],v[8:11],v[160:163]
v_add_u32 v235,24576,v235
ds_read_b64_tr_b16 v[136:137],v235 offset:0
ds_read_b64_tr_b16 v[138:139],v235 offset:1024
s_waitcnt lgkmcnt(14)
v_mfma_f32_16x16x32_bf16 v[164:167],v[112:115],v[8:11],v[164:167]
v_add_u32 v236,24576,v236
ds_read_b64_tr_b16 v[100:101],v236 offset:0
ds_read_b64_tr_b16 v[102:103],v236 offset:1024
s_waitcnt lgkmcnt(14)
v_mfma_f32_16x16x32_bf16 v[168:171],v[116:119],v[8:11],v[168:171]
ds_read_b64_tr_b16 v[104:105],v232 offset:8192
ds_read_b64_tr_b16 v[106:107],v232 offset:9216
s_waitcnt lgkmcnt(14)
v_mfma_f32_16x16x32_bf16 v[172:175],v[120:123],v[8:11],v[172:175]
ds_read_b64_tr_b16 v[108:109],v233 offset:8192
ds_read_b64_tr_b16 v[110:111],v233 offset:9216
s_waitcnt lgkmcnt(14)
s_waitcnt lgkmcnt(12)
v_mfma_f32_16x16x32_bf16 v[244:247],v[240:243],v[0:3],v[244:247]
v_mfma_f32_16x16x32_bf16 v[248:251],v[0:3],v[0:3],v[248:251]
v_mfma_f32_16x16x32_bf16 v[144:147],v[124:127],v[0:3],v[144:147]
ds_read_b64_tr_b16 v[112:113],v234 offset:8192
ds_read_b64_tr_b16 v[114:115],v234 offset:9216
s_waitcnt lgkmcnt(12)
v_mfma_f32_16x16x32_bf16 v[148:151],v[128:131],v[0:3],v[148:151]
s_barrier
ds_read_b128 v[4:7],v255 offset:0
v_add_u32 v232,24576,v232
ds_read_b64_tr_b16 v[116:117],v232 offset:0
ds_read_b64_tr_b16 v[118:119],v232 offset:1024
s_waitcnt lgkmcnt(13)
v_mfma_f32_16x16x32_bf16 v[152:155],v[132:135],v[0:3],v[152:155]
v_add_u32 v233,24576,v233
ds_read_b64_tr_b16 v[120:121],v233 offset:0
ds_read_b64_tr_b16 v[122:123],v233 offset:1024
s_waitcnt lgkmcnt(13)
v_mfma_f32_16x16x32_bf16 v[156:159],v[136:139],v[0:3],v[156:159]
v_add_u32 v234,24576,v234
ds_read_b64_tr_b16 v[124:125],v234 offset:0
ds_read_b64_tr_b16 v[126:127],v234 offset:1024
s_waitcnt lgkmcnt(13)
v_mfma_f32_16x16x32_bf16 v[160:163],v[100:103],v[0:3],v[160:163]
v_add_u32 v235,24576,v235
ds_read_b64_tr_b16 v[128:129],v235 offset:0
ds_read_b64_tr_b16 v[130:131],v235 offset:1024
s_waitcnt lgkmcnt(13)
v_mfma_f32_16x16x32_bf16 v[164:167],v[104:107],v[0:3],v[164:167]
v_add_u32 v236,24576,v236
ds_read_b64_tr_b16 v[132:133],v236 offset:0
ds_read_b64_tr_b16 v[134:135],v236 offset:1024
s_waitcnt lgkmcnt(13)
v_mfma_f32_16x16x32_bf16 v[168:171],v[108:111],v[0:3],v[168:171]
ds_read_b64_tr_b16 v[136:137],v232 offset:8192
ds_read_b64_tr_b16 v[138:139],v232 offset:9216
s_waitcnt lgkmcnt(13)
v_mfma_f32_16x16x32_bf16 v[172:175],v[112:115],v[0:3],v[172:175]
ds_read_b64_tr_b16 v[100:101],v233 offset:8192
ds_read_b64_tr_b16 v[102:103],v233 offset:9216
s_waitcnt lgkmcnt(14)
s_waitcnt lgkmcnt(12)
v_mfma_f32_16x16x32_bf16 v[244:247],v[240:243],v[4:7],v[244:247]
v_mfma_f32_16x16x32_bf16 v[248:251],v[4:7],v[4:7],v[248:251]
v_mfma_f32_16x16x32_bf16 v[144:147],v[116:119],v[4:7],v[144:147]
ds_read_b64_tr_b16 v[104:105],v234 offset:8192
ds_read_b64_tr_b16 v[106:107],v234 offset:9216
s_waitcnt lgkmcnt(12)
v_mfma_f32_16x16x32_bf16 v[148:151],v[120:123],v[4:7],v[148:151]
s_barrier
ds_write_b128 v58,v[240:243] offset:10240
ds_read_b128 v[8:11],v254 offset:10240
v_add_u32 v232,24576,v232
ds_read_b64_tr_b16 v[108:109],v232 offset:0
ds_read_b64_tr_b16 v[110:111],v232 offset:1024
s_waitcnt lgkmcnt(14)
v_mfma_f32_16x16x32_bf16 v[152:155],v[124:127],v[4:7],v[152:155]
v_add_u32 v233,24576,v233
ds_read_b64_tr_b16 v[112:113],v233 offset:0
ds_read_b64_tr_b16 v[114:115],v233 offset:1024
s_waitcnt lgkmcnt(14)
v_mfma_f32_16x16x32_bf16 v[156:159],v[128:131],v[4:7],v[156:159]
v_add_u32 v234,24576,v234
ds_read_b64_tr_b16 v[116:117],v234 offset:0
ds_read_b64_tr_b16 v[118:119],v234 offset:1024
s_waitcnt lgkmcnt(14)
v_mfma_f32_16x16x32_bf16 v[160:163],v[132:135],v[4:7],v[160:163]
v_add_u32 v235,24576,v235
ds_read_b64_tr_b16 v[120:121],v235 offset:0
ds_read_b64_tr_b16 v[122:123],v235 offset:1024
s_waitcnt lgkmcnt(14)
v_mfma_f32_16x16x32_bf16 v[164:167],v[136:139],v[4:7],v[164:167]
v_add_u32 v236,24576,v236
ds_read_b64_tr_b16 v[124:125],v236 offset:0
ds_read_b64_tr_b16 v[126:127],v236 offset:1024
s_waitcnt lgkmcnt(14)
v_mfma_f32_16x16x32_bf16 v[168:171],v[100:103],v[4:7],v[168:171]
ds_read_b64_tr_b16 v[128:129],v232 offset:8192
ds_read_b64_tr_b16 v[130:131],v232 offset:9216
s_waitcnt lgkmcnt(14)
v_mfma_f32_16x16x32_bf16 v[172:175],v[104:107],v[4:7],v[172:175]
ds_read_b64_tr_b16 v[132:133],v233 offset:8192
ds_read_b64_tr_b16 v[134:135],v233 offset:9216
s_waitcnt lgkmcnt(14)
s_waitcnt lgkmcnt(12)
v_mfma_f32_16x16x32_bf16 v[244:247],v[240:243],v[8:11],v[244:247]
v_mfma_f32_16x16x32_bf16 v[248:251],v[8:11],v[8:11],v[248:251]
v_mfma_f32_16x16x32_bf16 v[144:147],v[108:111],v[8:11],v[144:147]
ds_read_b64_tr_b16 v[136:137],v234 offset:8192
ds_read_b64_tr_b16 v[138:139],v234 offset:9216
s_waitcnt lgkmcnt(12)
v_mfma_f32_16x16x32_bf16 v[148:151],v[112:115],v[8:11],v[148:151]
s_barrier
ds_read_b128 v[0:3],v255 offset:10240
v_subrev_u32 v232,98304,v232
ds_read_b64_tr_b16 v[100:101],v232 offset:0
ds_read_b64_tr_b16 v[102:103],v232 offset:1024
s_waitcnt lgkmcnt(13)
v_mfma_f32_16x16x32_bf16 v[152:155],v[116:119],v[8:11],v[152:155]
v_subrev_u32 v233,98304,v233
ds_read_b64_tr_b16 v[104:105],v233 offset:0
ds_read_b64_tr_b16 v[106:107],v233 offset:1024
s_waitcnt lgkmcnt(13)
v_mfma_f32_16x16x32_bf16 v[156:159],v[120:123],v[8:11],v[156:159]
v_subrev_u32 v234,98304,v234
ds_read_b64_tr_b16 v[108:109],v234 offset:0
ds_read_b64_tr_b16 v[110:111],v234 offset:1024
s_waitcnt lgkmcnt(13)
v_mfma_f32_16x16x32_bf16 v[160:163],v[124:127],v[8:11],v[160:163]
v_subrev_u32 v235,98304,v235
ds_read_b64_tr_b16 v[112:113],v235 offset:0
ds_read_b64_tr_b16 v[114:115],v235 offset:1024
s_waitcnt lgkmcnt(13)
v_mfma_f32_16x16x32_bf16 v[164:167],v[128:131],v[8:11],v[164:167]
v_subrev_u32 v236,98304,v236
ds_read_b64_tr_b16 v[116:117],v236 offset:0
ds_read_b64_tr_b16 v[118:119],v236 offset:1024
s_waitcnt lgkmcnt(13)
v_mfma_f32_16x16x32_bf16 v[168:171],v[132:135],v[8:11],v[168:171]
ds_read_b64_tr_b16 v[120:121],v232 offset:8192
ds_read_b64_tr_b16 v[122:123],v232 offset:9216
s_waitcnt lgkmcnt(13)
v_mfma_f32_16x16x32_bf16 v[172:175],v[136:139],v[8:11],v[172:175]
ds_read_b64_tr_b16 v[124:125],v233 offset:8192
ds_read_b64_tr_b16 v[126:127],v233 offset:9216
s_waitcnt lgkmcnt(14)
s_waitcnt lgkmcnt(12)
v_mfma_f32_16x16x32_bf16 v[244:247],v[240:243],v[0:3],v[244:247]
v_mfma_f32_16x16x32_bf16 v[248:251],v[0:3],v[0:3],v[248:251]
v_mfma_f32_16x16x32_bf16 v[144:147],v[100:103],v[0:3],v[144:147]
ds_read_b64_tr_b16 v[128:129],v234 offset:8192
ds_read_b64_tr_b16 v[130:131],v234 offset:9216
s_waitcnt lgkmcnt(12)
v_mfma_f32_16x16x32_bf16 v[148:151],v[104:107],v[0:3],v[148:151]
s_barrier
ds_write_b128 v58,v[240:243] offset:20480
ds_read_b128 v[4:7],v254 offset:20480
v_add_u32 v232,24576,v232
ds_read_b64_tr_b16 v[132:133],v232 offset:0
ds_read_b64_tr_b16 v[134:135],v232 offset:1024
s_waitcnt lgkmcnt(14)
v_mfma_f32_16x16x32_bf16 v[152:155],v[108:111],v[0:3],v[152:155]
v_add_u32 v233,24576,v233
ds_read_b64_tr_b16 v[136:137],v233 offset:0
ds_read_b64_tr_b16 v[138:139],v233 offset:1024
s_waitcnt lgkmcnt(14)
v_mfma_f32_16x16x32_bf16 v[156:159],v[112:115],v[0:3],v[156:159]
v_add_u32 v234,24576,v234
ds_read_b64_tr_b16 v[100:101],v234 offset:0
ds_read_b64_tr_b16 v[102:103],v234 offset:1024
s_waitcnt lgkmcnt(14)
v_mfma_f32_16x16x32_bf16 v[160:163],v[116:119],v[0:3],v[160:163]
v_add_u32 v235,24576,v235
ds_read_b64_tr_b16 v[104:105],v235 offset:0
ds_read_b64_tr_b16 v[106:107],v235 offset:1024
s_waitcnt lgkmcnt(14)
v_mfma_f32_16x16x32_bf16 v[164:167],v[120:123],v[0:3],v[164:167]
v_add_u32 v236,24576,v236
ds_read_b64_tr_b16 v[108:109],v236 offset:0
ds_read_b64_tr_b16 v[110:111],v236 offset:1024
s_waitcnt lgkmcnt(14)
v_mfma_f32_16x16x32_bf16 v[168:171],v[124:127],v[0:3],v[168:171]
ds_read_b64_tr_b16 v[112:113],v232 offset:8192
ds_read_b64_tr_b16 v[114:115],v232 offset:9216
s_waitcnt lgkmcnt(14)
v_mfma_f32_16x16x32_bf16 v[172:175],v[128:131],v[0:3],v[172:175]
ds_read_b64_tr_b16 v[116:117],v233 offset:8192
ds_read_b64_tr_b16 v[118:119],v233 offset:9216
s_waitcnt lgkmcnt(14)
s_waitcnt lgkmcnt(12)
v_mfma_f32_16x16x32_bf16 v[244:247],v[240:243],v[4:7],v[244:247]
v_mfma_f32_16x16x32_bf16 v[248:251],v[4:7],v[4:7],v[248:251]
v_mfma_f32_16x16x32_bf16 v[144:147],v[132:135],v[4:7],v[144:147]
ds_read_b64_tr_b16 v[120:121],v234 offset:8192
ds_read_b64_tr_b16 v[122:123],v234 offset:9216
s_waitcnt lgkmcnt(12)
v_mfma_f32_16x16x32_bf16 v[148:151],v[136:139],v[4:7],v[148:151]
s_barrier
ds_read_b128 v[8:11],v255 offset:20480
v_add_u32 v232,24576,v232
ds_read_b64_tr_b16 v[124:125],v232 offset:0
ds_read_b64_tr_b16 v[126:127],v232 offset:1024
s_waitcnt lgkmcnt(13)
v_mfma_f32_16x16x32_bf16 v[152:155],v[100:103],v[4:7],v[152:155]
v_add_u32 v233,24576,v233
ds_read_b64_tr_b16 v[128:129],v233 offset:0
ds_read_b64_tr_b16 v[130:131],v233 offset:1024
s_waitcnt lgkmcnt(13)
v_mfma_f32_16x16x32_bf16 v[156:159],v[104:107],v[4:7],v[156:159]
v_add_u32 v234,24576,v234
ds_read_b64_tr_b16 v[132:133],v234 offset:0
ds_read_b64_tr_b16 v[134:135],v234 offset:1024
s_waitcnt lgkmcnt(13)
v_mfma_f32_16x16x32_bf16 v[160:163],v[108:111],v[4:7],v[160:163]
v_add_u32 v235,24576,v235
ds_read_b64_tr_b16 v[136:137],v235 offset:0
ds_read_b64_tr_b16 v[138:139],v235 offset:1024
s_waitcnt lgkmcnt(13)
v_mfma_f32_16x16x32_bf16 v[164:167],v[112:115],v[4:7],v[164:167]
v_add_u32 v236,24576,v236
ds_read_b64_tr_b16 v[100:101],v236 offset:0
ds_read_b64_tr_b16 v[102:103],v236 offset:1024
s_waitcnt lgkmcnt(13)
v_mfma_f32_16x16x32_bf16 v[168:171],v[116:119],v[4:7],v[168:171]
ds_read_b64_tr_b16 v[104:105],v232 offset:8192
ds_read_b64_tr_b16 v[106:107],v232 offset:9216
s_waitcnt lgkmcnt(13)
v_mfma_f32_16x16x32_bf16 v[172:175],v[120:123],v[4:7],v[172:175]
ds_read_b64_tr_b16 v[108:109],v233 offset:8192
ds_read_b64_tr_b16 v[110:111],v233 offset:9216
s_waitcnt lgkmcnt(14)
s_waitcnt lgkmcnt(12)
v_mfma_f32_16x16x32_bf16 v[244:247],v[240:243],v[8:11],v[244:247]
v_mfma_f32_16x16x32_bf16 v[248:251],v[8:11],v[8:11],v[248:251]
v_mfma_f32_16x16x32_bf16 v[144:147],v[124:127],v[8:11],v[144:147]
ds_read_b64_tr_b16 v[112:113],v234 offset:8192
ds_read_b64_tr_b16 v[114:115],v234 offset:9216
s_waitcnt lgkmcnt(12)
v_mfma_f32_16x16x32_bf16 v[148:151],v[128:131],v[8:11],v[148:151]
s_waitcnt lgkmcnt(10)
v_mfma_f32_16x16x32_bf16 v[152:155],v[132:135],v[8:11],v[152:155]
s_waitcnt lgkmcnt(8)
v_mfma_f32_16x16x32_bf16 v[156:159],v[136:139],v[8:11],v[156:159]
v_and_b32 v25,3,v59
v_lshrrev_b32 v26,2,v59
v_cmp_eq_u32 s[56:57],1,v25
v_cmp_eq_u32 s[58:59],2,v25
v_cmp_eq_u32 s[60:61],3,v25
v_cmp_eq_u32 s[62:63],v26,v253
s_waitcnt lgkmcnt(6)
v_mfma_f32_16x16x32_bf16 v[160:163],v[100:103],v[8:11],v[160:163]
s_nop 0
v_cndmask_b32 v27,v248,v249,s[56:57]
v_cndmask_b32 v27,v27,v250,s[58:59]
v_cndmask_b32 v27,v27,v251,s[60:61]
v_cndmask_b32 v27,0,v27,s[62:63]
v_mov_b32 v28,v27
s_waitcnt lgkmcnt(4)
v_mfma_f32_16x16x32_bf16 v[164:167],v[104:107],v[8:11],v[164:167]
s_nop 1
v_permlane16_swap_b32 v27,v28
s_nop 0
v_add_f32 v27,v27,v28
v_mov_b32 v28,v27
s_nop 1
s_waitcnt lgkmcnt(2)
v_mfma_f32_16x16x32_bf16 v[168:171],v[108:111],v[8:11],v[168:171]
v_permlane32_swap_b32 v27,v28
s_nop 0
v_add_f32 v27,v27,v28
s_mov_b32 s37,987991609
v_mul_f32 v29,s37,v244
v_mul_f32 v27,s37,v27
s_waitcnt lgkmcnt(0)
v_mfma_f32_16x16x32_bf16 v[172:175],v[112:115],v[8:11],v[172:175]
v_fma_f32 v27,-v29,v29,v27
v_max_f32 v27,0,v27
v_add_f32 v27,925353388,v27
v_rsq_f32 v31,v27
v_add_u32 v33,0,v56
v_mul_f32 v30,v29,v31
ds_write_b64 v33,v[30:31]
s_nop 5
s_mov_b32 exec_lo,0x00010001
s_mov_b32 exec_hi,0x00010001
ds_write_b128 v57,v[144:147] offset:0
ds_write_b128 v57,v[148:151] offset:64
ds_write_b128 v57,v[152:155] offset:128
ds_write_b128 v57,v[156:159] offset:192
ds_write_b128 v57,v[160:163] offset:256
ds_write_b128 v57,v[164:167] offset:320
ds_write_b128 v57,v[168:171] offset:384
ds_write_b128 v57,v[172:175] offset:448
s_mov_b64 exec,-1
s_waitcnt lgkmcnt(0)
s_barrier
ds_read_b64 v[4:5],v56 offset:0
ds_read_b128 v[84:87],v57 offset:320
ds_read_b128 v[88:91],v57 offset:384
ds_read_b128 v[92:95],v57 offset:448
s_waitcnt lgkmcnt(3)
s_waitcnt lgkmcnt(2)
v_pk_mul_f32 v[12:13],v[84:85],v[4:5] op_sel_hi:[1,0]
v_pk_mul_f32 v[14:15],v[86:87],v[4:5] op_sel_hi:[1,0]
v_pk_fma_f32 v[164:165],v[164:165],v[4:5],v[12:13] op_sel:[0,1,0] op_sel_hi:[1,1,1] neg_lo:[0,0,1] neg_hi:[0,0,1]
v_pk_fma_f32 v[166:167],v[166:167],v[4:5],v[14:15] op_sel:[0,1,0] op_sel_hi:[1,1,1] neg_lo:[0,0,1] neg_hi:[0,0,1]
v_cvt_pk_bf16_f32 v18,v164,v165
v_cvt_pk_bf16_f32 v19,v166,v167
ds_write_b64 v40,v[18:19] offset:15360
s_waitcnt lgkmcnt(2)
v_pk_mul_f32 v[8:9],v[88:89],v[4:5] op_sel_hi:[1,0]
v_pk_mul_f32 v[10:11],v[90:91],v[4:5] op_sel_hi:[1,0]
v_pk_fma_f32 v[168:169],v[168:169],v[4:5],v[8:9] op_sel:[0,1,0] op_sel_hi:[1,1,1] neg_lo:[0,0,1] neg_hi:[0,0,1]
v_pk_fma_f32 v[170:171],v[170:171],v[4:5],v[10:11] op_sel:[0,1,0] op_sel_hi:[1,1,1] neg_lo:[0,0,1] neg_hi:[0,0,1]
v_cvt_pk_bf16_f32 v16,v168,v169
v_cvt_pk_bf16_f32 v17,v170,v171
ds_write_b64 v41,v[16:17] offset:15360
s_waitcnt lgkmcnt(2)
v_pk_mul_f32 v[12:13],v[92:93],v[4:5] op_sel_hi:[1,0]
v_pk_mul_f32 v[14:15],v[94:95],v[4:5] op_sel_hi:[1,0]
v_pk_fma_f32 v[172:173],v[172:173],v[4:5],v[12:13] op_sel:[0,1,0] op_sel_hi:[1,1,1] neg_lo:[0,0,1] neg_hi:[0,0,1]
v_pk_fma_f32 v[174:175],v[174:175],v[4:5],v[14:15] op_sel:[0,1,0] op_sel_hi:[1,1,1] neg_lo:[0,0,1] neg_hi:[0,0,1]
v_cvt_pk_bf16_f32 v18,v172,v173
v_cvt_pk_bf16_f32 v19,v174,v175
ds_write_b64 v42,v[18:19] offset:15360
s_waitcnt lgkmcnt(0)
s_barrier
s_waitcnt lgkmcnt(0)
s_barrier
s_mov_b32 s12,s26
s_mov_b32 s13,s27
s_mov_b32 s14,2359296
s_mov_b32 s15,0x20000
s_lshl_b32 s37,s34,6
v_add_u32 v200,s37,v252
v_and_b32 v201,15,v200
v_lshrrev_b32 v200,4,v200
v_mul_u32_u24 v202,57,v200
v_lshrrev_b32 v202,9,v202
v_mul_u32_u24 v203,9,v202
v_sub_u32 v200,v200,v203
v_lshl_add_u32 v203,v202,4,v201
v_mul_u32_u24 v203,144,v203
v_lshl_add_u32 v203,v200,4,v203
ds_read_b128 v[204:207],v203 offset:56320
s_mul_i32 s38,s35,9
v_add_u32 v200,s38,v200
s_lshl_b32 s38,s36,2
v_add_u32 v202,s38,v202
v_mul_u32_u24 v202,72,v202
v_add_u32 v202,v202,v200
v_lshl_add_u32 v202,v202,4,v201
v_lshlrev_b32 v202,4,v202
s_waitcnt lgkmcnt(0)
buffer_store_dwordx4 v[204:207],v202,s[12:15],0 offen sc1
s_endpgm
attn_kernel_a1:
s_mov_b32 s43,0
v_and_b32 v59,15,v252
s_lshl_b32 s38,s43,4
v_add_u32 v70,s38,v59
v_lshlrev_b32 v71,7,v70
v_add_u32 v71,122880,v71
v_and_b32 v72,7,v59
v_add_u32 v73,0,v253
v_xor_b32 v73,v73,v72
v_lshl_add_u32 v254,v73,4,v71
v_add_u32 v73,4,v253
v_xor_b32 v73,v73,v72
v_lshl_add_u32 v255,v73,4,v71
v_bfe_u32 v61,v252,2,2
v_lshl_add_u32 v62,v253,3,v61
v_lshlrev_b32 v62,8,v62
v_and_b32 v63,1,v253
v_lshl_or_b32 v63,v63,2,v61
v_lshlrev_b32 v63,1,v63
v_and_b32 v64,3,v252
s_lshl_b32 s37,s35,4
v_add_u32 v65,0,v64
v_mul_u32_u24 v66,52,v65
v_lshrrev_b32 v66,8,v66
v_mul_u32_u24 v67,5,v66
v_sub_u32 v67,v65,v67
v_mul_u32_u24 v68,36,v66
v_and_b32 v66,1,v66
v_lshlrev_b32 v66,2,v66
v_sub_u32 v68,v68,v66
v_lshl_add_u32 v68,v67,3,v68
v_add_u32 v68,s37,v68
v_lshrrev_b32 v67,4,v68
v_xor_b32 v67,v67,v63
v_and_b32 v68,8,v68
v_lshl_add_u32 v67,v67,4,v68
v_add_u32 v232,v67,v62
v_add_u32 v65,4,v64
v_mul_u32_u24 v66,52,v65
v_lshrrev_b32 v66,8,v66
v_mul_u32_u24 v67,5,v66
v_sub_u32 v67,v65,v67
v_mul_u32_u24 v68,36,v66
v_and_b32 v66,1,v66
v_lshlrev_b32 v66,2,v66
v_sub_u32 v68,v68,v66
v_lshl_add_u32 v68,v67,3,v68
v_add_u32 v68,s37,v68
v_lshrrev_b32 v67,4,v68
v_xor_b32 v67,v67,v63
v_and_b32 v68,8,v68
v_lshl_add_u32 v67,v67,4,v68
v_add_u32 v233,v67,v62
v_add_u32 v65,8,v64
v_mul_u32_u24 v66,52,v65
v_lshrrev_b32 v66,8,v66
v_mul_u32_u24 v67,5,v66
v_sub_u32 v67,v65,v67
v_mul_u32_u24 v68,36,v66
v_and_b32 v66,1,v66
v_lshlrev_b32 v66,2,v66
v_sub_u32 v68,v68,v66
v_lshl_add_u32 v68,v67,3,v68
v_add_u32 v68,s37,v68
v_lshrrev_b32 v67,4,v68
v_xor_b32 v67,v67,v63
v_and_b32 v68,8,v68
v_lshl_add_u32 v67,v67,4,v68
v_add_u32 v234,v67,v62
v_add_u32 v65,12,v64
v_mul_u32_u24 v66,52,v65
v_lshrrev_b32 v66,8,v66
v_mul_u32_u24 v67,5,v66
v_sub_u32 v67,v65,v67
v_mul_u32_u24 v68,36,v66
v_and_b32 v66,1,v66
v_lshlrev_b32 v66,2,v66
v_sub_u32 v68,v68,v66
v_lshl_add_u32 v68,v67,3,v68
v_add_u32 v68,s37,v68
v_lshrrev_b32 v67,4,v68
v_xor_b32 v67,v67,v63
v_and_b32 v68,8,v68
v_lshl_add_u32 v67,v67,4,v68
v_add_u32 v235,v67,v62
v_add_u32 v65,16,v64
v_mul_u32_u24 v66,52,v65
v_lshrrev_b32 v66,8,v66
v_mul_u32_u24 v67,5,v66
v_sub_u32 v67,v65,v67
v_mul_u32_u24 v68,36,v66
v_and_b32 v66,1,v66
v_lshlrev_b32 v66,2,v66
v_sub_u32 v68,v68,v66
v_lshl_add_u32 v68,v67,3,v68
v_add_u32 v68,s37,v68
v_lshrrev_b32 v67,4,v68
v_xor_b32 v67,v67,v63
v_and_b32 v68,8,v68
v_lshl_add_u32 v67,v67,4,v68
v_add_u32 v236,v67,v62
v_mov_b32 v240,0x3f803f80
v_mov_b32 v241,0x3f803f80
v_mov_b32 v242,0x3f803f80
v_mov_b32 v243,0x3f803f80
v_mul_u32_u24 v61,48,v70
v_mul_u32_u24 v62,80,v70
v_add_u32 v63,0,v253
v_mul_u32_u24 v64,52,v63
v_lshrrev_b32 v64,8,v64
v_mul_u32_u24 v65,5,v64
v_sub_u32 v65,v63,v65
v_mul_u32_u24 v66,3840,v64
v_lshl_add_u32 v66,v65,3,v66
v_add_u32 v40,v66,v61
v_mul_u32_u24 v66,6400,v64
v_lshl_add_u32 v66,v65,4,v66
v_add_u32 v48,v66,v62
v_add_u32 v63,4,v253
v_mul_u32_u24 v64,52,v63
v_lshrrev_b32 v64,8,v64
v_mul_u32_u24 v65,5,v64
v_sub_u32 v65,v63,v65
v_mul_u32_u24 v66,3840,v64
v_lshl_add_u32 v66,v65,3,v66
v_add_u32 v41,v66,v61
v_mul_u32_u24 v66,6400,v64
v_lshl_add_u32 v66,v65,4,v66
v_add_u32 v49,v66,v62
v_add_u32 v63,8,v253
v_mul_u32_u24 v64,52,v63
v_lshrrev_b32 v64,8,v64
v_mul_u32_u24 v65,5,v64
v_sub_u32 v65,v63,v65
v_mul_u32_u24 v66,3840,v64
v_lshl_add_u32 v66,v65,3,v66
v_add_u32 v42,v66,v61
v_mul_u32_u24 v66,6400,v64
v_lshl_add_u32 v66,v65,4,v66
v_add_u32 v50,v66,v62
v_add_u32 v63,12,v253
v_mul_u32_u24 v64,52,v63
v_lshrrev_b32 v64,8,v64
v_mul_u32_u24 v65,5,v64
v_sub_u32 v65,v63,v65
v_mul_u32_u24 v66,3840,v64
v_lshl_add_u32 v66,v65,3,v66
v_add_u32 v43,v66,v61
v_mul_u32_u24 v66,6400,v64
v_lshl_add_u32 v66,v65,4,v66
v_add_u32 v51,v66,v62
v_add_u32 v63,16,v253
v_mul_u32_u24 v64,52,v63
v_lshrrev_b32 v64,8,v64
v_mul_u32_u24 v65,5,v64
v_sub_u32 v65,v63,v65
v_mul_u32_u24 v66,3840,v64
v_lshl_add_u32 v66,v65,3,v66
v_add_u32 v44,v66,v61
v_mul_u32_u24 v66,6400,v64
v_lshl_add_u32 v66,v65,4,v66
v_add_u32 v52,v66,v62
v_lshlrev_b32 v56,3,v70
v_add_u32 v56,154624,v56
v_lshlrev_b32 v57,4,v253
v_add_u32 v57,153600,v57
v_and_b32 v58,7,v252
v_lshlrev_b32 v58,4,v58
v_add_u32 v58,122880,v58
s_waitcnt lgkmcnt(0)
s_barrier
ds_write_b128 v58,v[240:243] offset:0
ds_read_b128 v[0:3],v254 offset:0
ds_read_b64_tr_b16 v[100:101],v235 offset:8192
ds_read_b64_tr_b16 v[102:103],v235 offset:9216
ds_read_b64_tr_b16 v[104:105],v236 offset:8192
ds_read_b64_tr_b16 v[106:107],v236 offset:9216
ds_read_b64_tr_b16 v[108:109],v232 offset:16384
ds_read_b64_tr_b16 v[110:111],v232 offset:17408
ds_read_b64_tr_b16 v[112:113],v233 offset:16384
ds_read_b64_tr_b16 v[114:115],v233 offset:17408
ds_read_b64_tr_b16 v[116:117],v234 offset:16384
ds_read_b64_tr_b16 v[118:119],v234 offset:17408
ds_read_b64_tr_b16 v[120:121],v235 offset:16384
ds_read_b64_tr_b16 v[122:123],v235 offset:17408
ds_read_b64_tr_b16 v[124:125],v236 offset:16384
ds_read_b64_tr_b16 v[126:127],v236 offset:17408
s_waitcnt lgkmcnt(14)
s_waitcnt lgkmcnt(12)
v_mfma_f32_16x16x32_bf16 v[144:147],v[100:103],v[0:3],0
s_barrier
ds_read_b128 v[4:7],v255 offset:0
v_add_u32 v235,24576,v235
ds_read_b64_tr_b16 v[128:129],v235 offset:8192
ds_read_b64_tr_b16 v[130:131],v235 offset:9216
s_waitcnt lgkmcnt(13)
v_mfma_f32_16x16x32_bf16 v[148:151],v[104:107],v[0:3],0
v_add_u32 v236,24576,v236
ds_read_b64_tr_b16 v[132:133],v236 offset:8192
ds_read_b64_tr_b16 v[134:135],v236 offset:9216
s_waitcnt lgkmcnt(13)
v_mfma_f32_16x16x32_bf16 v[152:155],v[108:111],v[0:3],0
v_add_u32 v232,24576,v232
ds_read_b64_tr_b16 v[136:137],v232 offset:16384
ds_read_b64_tr_b16 v[138:139],v232 offset:17408
s_waitcnt lgkmcnt(13)
v_mfma_f32_16x16x32_bf16 v[156:159],v[112:115],v[0:3],0
v_add_u32 v233,24576,v233
ds_read_b64_tr_b16 v[100:101],v233 offset:16384
ds_read_b64_tr_b16 v[102:103],v233 offset:17408
s_waitcnt lgkmcnt(13)
v_mfma_f32_16x16x32_bf16 v[160:163],v[116:119],v[0:3],0
v_add_u32 v234,24576,v234
ds_read_b64_tr_b16 v[104:105],v234 offset:16384
ds_read_b64_tr_b16 v[106:107],v234 offset:17408
s_waitcnt lgkmcnt(13)
v_mfma_f32_16x16x32_bf16 v[164:167],v[120:123],v[0:3],0
ds_read_b64_tr_b16 v[108:109],v235 offset:16384
ds_read_b64_tr_b16 v[110:111],v235 offset:17408
s_waitcnt lgkmcnt(13)
v_mfma_f32_16x16x32_bf16 v[168:171],v[124:127],v[0:3],0
ds_read_b64_tr_b16 v[112:113],v236 offset:16384
ds_read_b64_tr_b16 v[114:115],v236 offset:17408
s_waitcnt lgkmcnt(14)
s_waitcnt lgkmcnt(12)
v_mfma_f32_16x16x32_bf16 v[144:147],v[128:131],v[4:7],v[144:147]
s_barrier
ds_write_b128 v58,v[240:243] offset:10240
ds_read_b128 v[8:11],v254 offset:10240
v_add_u32 v235,24576,v235
ds_read_b64_tr_b16 v[116:117],v235 offset:8192
ds_read_b64_tr_b16 v[118:119],v235 offset:9216
s_waitcnt lgkmcnt(14)
v_mfma_f32_16x16x32_bf16 v[148:151],v[132:135],v[4:7],v[148:151]
v_add_u32 v236,24576,v236
ds_read_b64_tr_b16 v[120:121],v236 offset:8192
ds_read_b64_tr_b16 v[122:123],v236 offset:9216
s_waitcnt lgkmcnt(14)
v_mfma_f32_16x16x32_bf16 v[152:155],v[136:139],v[4:7],v[152:155]
v_add_u32 v232,24576,v232
ds_read_b64_tr_b16 v[124:125],v232 offset:16384
ds_read_b64_tr_b16 v[126:127],v232 offset:17408
s_waitcnt lgkmcnt(14)
v_mfma_f32_16x16x32_bf16 v[156:159],v[100:103],v[4:7],v[156:159]
v_add_u32 v233,24576,v233
ds_read_b64_tr_b16 v[128:129],v233 offset:16384
ds_read_b64_tr_b16 v[130:131],v233 offset:17408
s_waitcnt lgkmcnt(14)
v_mfma_f32_16x16x32_bf16 v[160:163],v[104:107],v[4:7],v[160:163]
v_add_u32 v234,24576,v234
ds_read_b64_tr_b16 v[132:133],v234 offset:16384
ds_read_b64_tr_b16 v[134:135],v234 offset:17408
s_waitcnt lgkmcnt(14)
v_mfma_f32_16x16x32_bf16 v[164:167],v[108:111],v[4:7],v[164:167]
ds_read_b64_tr_b16 v[136:137],v235 offset:16384
ds_read_b64_tr_b16 v[138:139],v235 offset:17408
s_waitcnt lgkmcnt(14)
v_mfma_f32_16x16x32_bf16 v[168:171],v[112:115],v[4:7],v[168:171]
ds_read_b64_tr_b16 v[100:101],v236 offset:16384
ds_read_b64_tr_b16 v[102:103],v236 offset:17408
s_waitcnt lgkmcnt(14)
s_waitcnt lgkmcnt(12)
v_mfma_f32_16x16x32_bf16 v[144:147],v[116:119],v[8:11],v[144:147]
s_barrier
ds_read_b128 v[0:3],v255 offset:10240
v_add_u32 v235,24576,v235
ds_read_b64_tr_b16 v[104:105],v235 offset:8192
ds_read_b64_tr_b16 v[106:107],v235 offset:9216
s_waitcnt lgkmcnt(13)
v_mfma_f32_16x16x32_bf16 v[148:151],v[120:123],v[8:11],v[148:151]
v_add_u32 v236,24576,v236
ds_read_b64_tr_b16 v[108:109],v236 offset:8192
ds_read_b64_tr_b16 v[110:111],v236 offset:9216
s_waitcnt lgkmcnt(13)
v_mfma_f32_16x16x32_bf16 v[152:155],v[124:127],v[8:11],v[152:155]
v_add_u32 v232,24576,v232
ds_read_b64_tr_b16 v[112:113],v232 offset:16384
ds_read_b64_tr_b16 v[114:115],v232 offset:17408
s_waitcnt lgkmcnt(13)
v_mfma_f32_16x16x32_bf16 v[156:159],v[128:131],v[8:11],v[156:159]
v_add_u32 v233,24576,v233
ds_read_b64_tr_b16 v[116:117],v233 offset:16384
ds_read_b64_tr_b16 v[118:119],v233 offset:17408
s_waitcnt lgkmcnt(13)
v_mfma_f32_16x16x32_bf16 v[160:163],v[132:135],v[8:11],v[160:163]
v_add_u32 v234,24576,v234
ds_read_b64_tr_b16 v[120:121],v234 offset:16384
ds_read_b64_tr_b16 v[122:123],v234 offset:17408
s_waitcnt lgkmcnt(13)
v_mfma_f32_16x16x32_bf16 v[164:167],v[136:139],v[8:11],v[164:167]
ds_read_b64_tr_b16 v[124:125],v235 offset:16384
ds_read_b64_tr_b16 v[126:127],v235 offset:17408
s_waitcnt lgkmcnt(13)
v_mfma_f32_16x16x32_bf16 v[168:171],v[100:103],v[8:11],v[168:171]
ds_read_b64_tr_b16 v[128:129],v236 offset:16384
ds_read_b64_tr_b16 v[130:131],v236 offset:17408
s_waitcnt lgkmcnt(14)
s_waitcnt lgkmcnt(12)
v_mfma_f32_16x16x32_bf16 v[144:147],v[104:107],v[0:3],v[144:147]
s_barrier
ds_write_b128 v58,v[240:243] offset:20480
ds_read_b128 v[4:7],v254 offset:20480
v_add_u32 v235,24576,v235
ds_read_b64_tr_b16 v[132:133],v235 offset:8192
ds_read_b64_tr_b16 v[134:135],v235 offset:9216
s_waitcnt lgkmcnt(14)
v_mfma_f32_16x16x32_bf16 v[148:151],v[108:111],v[0:3],v[148:151]
v_add_u32 v236,24576,v236
ds_read_b64_tr_b16 v[136:137],v236 offset:8192
ds_read_b64_tr_b16 v[138:139],v236 offset:9216
s_waitcnt lgkmcnt(14)
v_mfma_f32_16x16x32_bf16 v[152:155],v[112:115],v[0:3],v[152:155]
v_add_u32 v232,24576,v232
ds_read_b64_tr_b16 v[100:101],v232 offset:16384
ds_read_b64_tr_b16 v[102:103],v232 offset:17408
s_waitcnt lgkmcnt(14)
v_mfma_f32_16x16x32_bf16 v[156:159],v[116:119],v[0:3],v[156:159]
v_add_u32 v233,24576,v233
ds_read_b64_tr_b16 v[104:105],v233 offset:16384
ds_read_b64_tr_b16 v[106:107],v233 offset:17408
s_waitcnt lgkmcnt(14)
v_mfma_f32_16x16x32_bf16 v[160:163],v[120:123],v[0:3],v[160:163]
v_add_u32 v234,24576,v234
ds_read_b64_tr_b16 v[108:109],v234 offset:16384
ds_read_b64_tr_b16 v[110:111],v234 offset:17408
s_waitcnt lgkmcnt(14)
v_mfma_f32_16x16x32_bf16 v[164:167],v[124:127],v[0:3],v[164:167]
ds_read_b64_tr_b16 v[112:113],v235 offset:16384
ds_read_b64_tr_b16 v[114:115],v235 offset:17408
s_waitcnt lgkmcnt(14)
v_mfma_f32_16x16x32_bf16 v[168:171],v[128:131],v[0:3],v[168:171]
ds_read_b64_tr_b16 v[116:117],v236 offset:16384
ds_read_b64_tr_b16 v[118:119],v236 offset:17408
s_waitcnt lgkmcnt(14)
s_waitcnt lgkmcnt(12)
v_mfma_f32_16x16x32_bf16 v[144:147],v[132:135],v[4:7],v[144:147]
s_barrier
ds_read_b128 v[8:11],v255 offset:20480
v_subrev_u32 v235,98304,v235
ds_read_b64_tr_b16 v[120:121],v235 offset:8192
ds_read_b64_tr_b16 v[122:123],v235 offset:9216
s_waitcnt lgkmcnt(13)
v_mfma_f32_16x16x32_bf16 v[148:151],v[136:139],v[4:7],v[148:151]
v_subrev_u32 v236,98304,v236
ds_read_b64_tr_b16 v[124:125],v236 offset:8192
ds_read_b64_tr_b16 v[126:127],v236 offset:9216
s_waitcnt lgkmcnt(13)
v_mfma_f32_16x16x32_bf16 v[152:155],v[100:103],v[4:7],v[152:155]
v_subrev_u32 v232,98304,v232
ds_read_b64_tr_b16 v[128:129],v232 offset:16384
ds_read_b64_tr_b16 v[130:131],v232 offset:17408
s_waitcnt lgkmcnt(13)
v_mfma_f32_16x16x32_bf16 v[156:159],v[104:107],v[4:7],v[156:159]
v_subrev_u32 v233,98304,v233
ds_read_b64_tr_b16 v[132:133],v233 offset:16384
ds_read_b64_tr_b16 v[134:135],v233 offset:17408
s_waitcnt lgkmcnt(13)
v_mfma_f32_16x16x32_bf16 v[160:163],v[108:111],v[4:7],v[160:163]
v_subrev_u32 v234,98304,v234
ds_read_b64_tr_b16 v[136:137],v234 offset:16384
ds_read_b64_tr_b16 v[138:139],v234 offset:17408
s_waitcnt lgkmcnt(13)
v_mfma_f32_16x16x32_bf16 v[164:167],v[112:115],v[4:7],v[164:167]
ds_read_b64_tr_b16 v[100:101],v235 offset:16384
ds_read_b64_tr_b16 v[102:103],v235 offset:17408
s_waitcnt lgkmcnt(13)
v_mfma_f32_16x16x32_bf16 v[168:171],v[116:119],v[4:7],v[168:171]
ds_read_b64_tr_b16 v[104:105],v236 offset:16384
ds_read_b64_tr_b16 v[106:107],v236 offset:17408
s_waitcnt lgkmcnt(14)
s_waitcnt lgkmcnt(12)
v_mfma_f32_16x16x32_bf16 v[144:147],v[120:123],v[8:11],v[144:147]
s_barrier
ds_write_b128 v58,v[240:243] offset:0
ds_read_b128 v[0:3],v254 offset:0
v_add_u32 v235,24576,v235
ds_read_b64_tr_b16 v[108:109],v235 offset:8192
ds_read_b64_tr_b16 v[110:111],v235 offset:9216
s_waitcnt lgkmcnt(14)
v_mfma_f32_16x16x32_bf16 v[148:151],v[124:127],v[8:11],v[148:151]
v_add_u32 v236,24576,v236
ds_read_b64_tr_b16 v[112:113],v236 offset:8192
ds_read_b64_tr_b16 v[114:115],v236 offset:9216
s_waitcnt lgkmcnt(14)
v_mfma_f32_16x16x32_bf16 v[152:155],v[128:131],v[8:11],v[152:155]
v_add_u32 v232,24576,v232
ds_read_b64_tr_b16 v[116:117],v232 offset:16384
ds_read_b64_tr_b16 v[118:119],v232 offset:17408
s_waitcnt lgkmcnt(14)
v_mfma_f32_16x16x32_bf16 v[156:159],v[132:135],v[8:11],v[156:159]
v_add_u32 v233,24576,v233
ds_read_b64_tr_b16 v[120:121],v233 offset:16384
ds_read_b64_tr_b16 v[122:123],v233 offset:17408
s_waitcnt lgkmcnt(14)
v_mfma_f32_16x16x32_bf16 v[160:163],v[136:139],v[8:11],v[160:163]
v_add_u32 v234,24576,v234
ds_read_b64_tr_b16 v[124:125],v234 offset:16384
ds_read_b64_tr_b16 v[126:127],v234 offset:17408
s_waitcnt lgkmcnt(14)
v_mfma_f32_16x16x32_bf16 v[164:167],v[100:103],v[8:11],v[164:167]
ds_read_b64_tr_b16 v[128:129],v235 offset:16384
ds_read_b64_tr_b16 v[130:131],v235 offset:17408
s_waitcnt lgkmcnt(14)
v_mfma_f32_16x16x32_bf16 v[168:171],v[104:107],v[8:11],v[168:171]
ds_read_b64_tr_b16 v[132:133],v236 offset:16384
ds_read_b64_tr_b16 v[134:135],v236 offset:17408
s_waitcnt lgkmcnt(14)
s_waitcnt lgkmcnt(12)
v_mfma_f32_16x16x32_bf16 v[144:147],v[108:111],v[0:3],v[144:147]
s_barrier
ds_read_b128 v[4:7],v255 offset:0
v_add_u32 v235,24576,v235
ds_read_b64_tr_b16 v[136:137],v235 offset:8192
ds_read_b64_tr_b16 v[138:139],v235 offset:9216
s_waitcnt lgkmcnt(13)
v_mfma_f32_16x16x32_bf16 v[148:151],v[112:115],v[0:3],v[148:151]
v_add_u32 v236,24576,v236
ds_read_b64_tr_b16 v[100:101],v236 offset:8192
ds_read_b64_tr_b16 v[102:103],v236 offset:9216
s_waitcnt lgkmcnt(13)
v_mfma_f32_16x16x32_bf16 v[152:155],v[116:119],v[0:3],v[152:155]
v_add_u32 v232,24576,v232
ds_read_b64_tr_b16 v[104:105],v232 offset:16384
ds_read_b64_tr_b16 v[106:107],v232 offset:17408
s_waitcnt lgkmcnt(13)
v_mfma_f32_16x16x32_bf16 v[156:159],v[120:123],v[0:3],v[156:159]
v_add_u32 v233,24576,v233
ds_read_b64_tr_b16 v[108:109],v233 offset:16384
ds_read_b64_tr_b16 v[110:111],v233 offset:17408
s_waitcnt lgkmcnt(13)
v_mfma_f32_16x16x32_bf16 v[160:163],v[124:127],v[0:3],v[160:163]
v_add_u32 v234,24576,v234
ds_read_b64_tr_b16 v[112:113],v234 offset:16384
ds_read_b64_tr_b16 v[114:115],v234 offset:17408
s_waitcnt lgkmcnt(13)
v_mfma_f32_16x16x32_bf16 v[164:167],v[128:131],v[0:3],v[164:167]
ds_read_b64_tr_b16 v[116:117],v235 offset:16384
ds_read_b64_tr_b16 v[118:119],v235 offset:17408
s_waitcnt lgkmcnt(13)
v_mfma_f32_16x16x32_bf16 v[168:171],v[132:135],v[0:3],v[168:171]
ds_read_b64_tr_b16 v[120:121],v236 offset:16384
ds_read_b64_tr_b16 v[122:123],v236 offset:17408
s_waitcnt lgkmcnt(14)
s_waitcnt lgkmcnt(12)
v_mfma_f32_16x16x32_bf16 v[144:147],v[136:139],v[4:7],v[144:147]
s_barrier
ds_write_b128 v58,v[240:243] offset:10240
ds_read_b128 v[8:11],v254 offset:10240
v_add_u32 v235,24576,v235
ds_read_b64_tr_b16 v[124:125],v235 offset:8192
ds_read_b64_tr_b16 v[126:127],v235 offset:9216
s_waitcnt lgkmcnt(14)
v_mfma_f32_16x16x32_bf16 v[148:151],v[100:103],v[4:7],v[148:151]
v_add_u32 v236,24576,v236
ds_read_b64_tr_b16 v[128:129],v236 offset:8192
ds_read_b64_tr_b16 v[130:131],v236 offset:9216
s_waitcnt lgkmcnt(14)
v_mfma_f32_16x16x32_bf16 v[152:155],v[104:107],v[4:7],v[152:155]
v_add_u32 v232,24576,v232
ds_read_b64_tr_b16 v[132:133],v232 offset:16384
ds_read_b64_tr_b16 v[134:135],v232 offset:17408
s_waitcnt lgkmcnt(14)
v_mfma_f32_16x16x32_bf16 v[156:159],v[108:111],v[4:7],v[156:159]
v_add_u32 v233,24576,v233
ds_read_b64_tr_b16 v[136:137],v233 offset:16384
ds_read_b64_tr_b16 v[138:139],v233 offset:17408
s_waitcnt lgkmcnt(14)
v_mfma_f32_16x16x32_bf16 v[160:163],v[112:115],v[4:7],v[160:163]
v_add_u32 v234,24576,v234
ds_read_b64_tr_b16 v[100:101],v234 offset:16384
ds_read_b64_tr_b16 v[102:103],v234 offset:17408
s_waitcnt lgkmcnt(14)
v_mfma_f32_16x16x32_bf16 v[164:167],v[116:119],v[4:7],v[164:167]
ds_read_b64_tr_b16 v[104:105],v235 offset:16384
ds_read_b64_tr_b16 v[106:107],v235 offset:17408
s_waitcnt lgkmcnt(14)
v_mfma_f32_16x16x32_bf16 v[168:171],v[120:123],v[4:7],v[168:171]
ds_read_b64_tr_b16 v[108:109],v236 offset:16384
ds_read_b64_tr_b16 v[110:111],v236 offset:17408
s_waitcnt lgkmcnt(14)
s_waitcnt lgkmcnt(12)
v_mfma_f32_16x16x32_bf16 v[144:147],v[124:127],v[8:11],v[144:147]
s_barrier
ds_read_b128 v[0:3],v255 offset:10240
v_add_u32 v235,24576,v235
ds_read_b64_tr_b16 v[112:113],v235 offset:8192
ds_read_b64_tr_b16 v[114:115],v235 offset:9216
s_waitcnt lgkmcnt(13)
v_mfma_f32_16x16x32_bf16 v[148:151],v[128:131],v[8:11],v[148:151]
v_add_u32 v236,24576,v236
ds_read_b64_tr_b16 v[116:117],v236 offset:8192
ds_read_b64_tr_b16 v[118:119],v236 offset:9216
s_waitcnt lgkmcnt(13)
v_mfma_f32_16x16x32_bf16 v[152:155],v[132:135],v[8:11],v[152:155]
v_add_u32 v232,24576,v232
ds_read_b64_tr_b16 v[120:121],v232 offset:16384
ds_read_b64_tr_b16 v[122:123],v232 offset:17408
s_waitcnt lgkmcnt(13)
v_mfma_f32_16x16x32_bf16 v[156:159],v[136:139],v[8:11],v[156:159]
v_add_u32 v233,24576,v233
ds_read_b64_tr_b16 v[124:125],v233 offset:16384
ds_read_b64_tr_b16 v[126:127],v233 offset:17408
s_waitcnt lgkmcnt(13)
v_mfma_f32_16x16x32_bf16 v[160:163],v[100:103],v[8:11],v[160:163]
v_add_u32 v234,24576,v234
ds_read_b64_tr_b16 v[128:129],v234 offset:16384
ds_read_b64_tr_b16 v[130:131],v234 offset:17408
s_waitcnt lgkmcnt(13)
v_mfma_f32_16x16x32_bf16 v[164:167],v[104:107],v[8:11],v[164:167]
ds_read_b64_tr_b16 v[132:133],v235 offset:16384
ds_read_b64_tr_b16 v[134:135],v235 offset:17408
s_waitcnt lgkmcnt(13)
v_mfma_f32_16x16x32_bf16 v[168:171],v[108:111],v[8:11],v[168:171]
ds_read_b64_tr_b16 v[136:137],v236 offset:16384
ds_read_b64_tr_b16 v[138:139],v236 offset:17408
s_waitcnt lgkmcnt(14)
s_waitcnt lgkmcnt(12)
v_mfma_f32_16x16x32_bf16 v[144:147],v[112:115],v[0:3],v[144:147]
s_barrier
ds_write_b128 v58,v[240:243] offset:20480
ds_read_b128 v[4:7],v254 offset:20480
v_subrev_u32 v235,98304,v235
ds_read_b64_tr_b16 v[100:101],v235 offset:8192
ds_read_b64_tr_b16 v[102:103],v235 offset:9216
s_waitcnt lgkmcnt(14)
v_mfma_f32_16x16x32_bf16 v[148:151],v[116:119],v[0:3],v[148:151]
v_subrev_u32 v236,98304,v236
ds_read_b64_tr_b16 v[104:105],v236 offset:8192
ds_read_b64_tr_b16 v[106:107],v236 offset:9216
s_waitcnt lgkmcnt(14)
v_mfma_f32_16x16x32_bf16 v[152:155],v[120:123],v[0:3],v[152:155]
v_subrev_u32 v232,98304,v232
ds_read_b64_tr_b16 v[108:109],v232 offset:16384
ds_read_b64_tr_b16 v[110:111],v232 offset:17408
s_waitcnt lgkmcnt(14)
v_mfma_f32_16x16x32_bf16 v[156:159],v[124:127],v[0:3],v[156:159]
v_subrev_u32 v233,98304,v233
ds_read_b64_tr_b16 v[112:113],v233 offset:16384
ds_read_b64_tr_b16 v[114:115],v233 offset:17408
s_waitcnt lgkmcnt(14)
v_mfma_f32_16x16x32_bf16 v[160:163],v[128:131],v[0:3],v[160:163]
v_subrev_u32 v234,98304,v234
ds_read_b64_tr_b16 v[116:117],v234 offset:16384
ds_read_b64_tr_b16 v[118:119],v234 offset:17408
s_waitcnt lgkmcnt(14)
v_mfma_f32_16x16x32_bf16 v[164:167],v[132:135],v[0:3],v[164:167]
ds_read_b64_tr_b16 v[120:121],v235 offset:16384
ds_read_b64_tr_b16 v[122:123],v235 offset:17408
s_waitcnt lgkmcnt(14)
v_mfma_f32_16x16x32_bf16 v[168:171],v[136:139],v[0:3],v[168:171]
ds_read_b64_tr_b16 v[124:125],v236 offset:16384
ds_read_b64_tr_b16 v[126:127],v236 offset:17408
s_waitcnt lgkmcnt(14)
s_waitcnt lgkmcnt(12)
v_mfma_f32_16x16x32_bf16 v[144:147],v[100:103],v[4:7],v[144:147]
s_barrier
ds_read_b128 v[8:11],v255 offset:20480
v_add_u32 v235,24576,v235
ds_read_b64_tr_b16 v[128:129],v235 offset:8192
ds_read_b64_tr_b16 v[130:131],v235 offset:9216
s_waitcnt lgkmcnt(13)
v_mfma_f32_16x16x32_bf16 v[148:151],v[104:107],v[4:7],v[148:151]
v_add_u32 v236,24576,v236
ds_read_b64_tr_b16 v[132:133],v236 offset:8192
ds_read_b64_tr_b16 v[134:135],v236 offset:9216
s_waitcnt lgkmcnt(13)
v_mfma_f32_16x16x32_bf16 v[152:155],v[108:111],v[4:7],v[152:155]
v_add_u32 v232,24576,v232
ds_read_b64_tr_b16 v[136:137],v232 offset:16384
ds_read_b64_tr_b16 v[138:139],v232 offset:17408
s_waitcnt lgkmcnt(13)
v_mfma_f32_16x16x32_bf16 v[156:159],v[112:115],v[4:7],v[156:159]
v_add_u32 v233,24576,v233
ds_read_b64_tr_b16 v[100:101],v233 offset:16384
ds_read_b64_tr_b16 v[102:103],v233 offset:17408
s_waitcnt lgkmcnt(13)
v_mfma_f32_16x16x32_bf16 v[160:163],v[116:119],v[4:7],v[160:163]
v_add_u32 v234,24576,v234
ds_read_b64_tr_b16 v[104:105],v234 offset:16384
ds_read_b64_tr_b16 v[106:107],v234 offset:17408
s_waitcnt lgkmcnt(13)
v_mfma_f32_16x16x32_bf16 v[164:167],v[120:123],v[4:7],v[164:167]
ds_read_b64_tr_b16 v[108:109],v235 offset:16384
ds_read_b64_tr_b16 v[110:111],v235 offset:17408
s_waitcnt lgkmcnt(13)
v_mfma_f32_16x16x32_bf16 v[168:171],v[124:127],v[4:7],v[168:171]
ds_read_b64_tr_b16 v[112:113],v236 offset:16384
ds_read_b64_tr_b16 v[114:115],v236 offset:17408
s_waitcnt lgkmcnt(14)
s_waitcnt lgkmcnt(12)
v_mfma_f32_16x16x32_bf16 v[144:147],v[128:131],v[8:11],v[144:147]
s_barrier
ds_write_b128 v58,v[240:243] offset:0
ds_read_b128 v[0:3],v254 offset:0
v_add_u32 v235,24576,v235
ds_read_b64_tr_b16 v[116:117],v235 offset:8192
ds_read_b64_tr_b16 v[118:119],v235 offset:9216
s_waitcnt lgkmcnt(14)
v_mfma_f32_16x16x32_bf16 v[148:151],v[132:135],v[8:11],v[148:151]
v_add_u32 v236,24576,v236
ds_read_b64_tr_b16 v[120:121],v236 offset:8192
ds_read_b64_tr_b16 v[122:123],v236 offset:9216
s_waitcnt lgkmcnt(14)
v_mfma_f32_16x16x32_bf16 v[152:155],v[136:139],v[8:11],v[152:155]
v_add_u32 v232,24576,v232
ds_read_b64_tr_b16 v[124:125],v232 offset:16384
ds_read_b64_tr_b16 v[126:127],v232 offset:17408
s_waitcnt lgkmcnt(14)
v_mfma_f32_16x16x32_bf16 v[156:159],v[100:103],v[8:11],v[156:159]
v_add_u32 v233,24576,v233
ds_read_b64_tr_b16 v[128:129],v233 offset:16384
ds_read_b64_tr_b16 v[130:131],v233 offset:17408
s_waitcnt lgkmcnt(14)
v_mfma_f32_16x16x32_bf16 v[160:163],v[104:107],v[8:11],v[160:163]
v_add_u32 v234,24576,v234
ds_read_b64_tr_b16 v[132:133],v234 offset:16384
ds_read_b64_tr_b16 v[134:135],v234 offset:17408
s_waitcnt lgkmcnt(14)
v_mfma_f32_16x16x32_bf16 v[164:167],v[108:111],v[8:11],v[164:167]
ds_read_b64_tr_b16 v[136:137],v235 offset:16384
ds_read_b64_tr_b16 v[138:139],v235 offset:17408
s_waitcnt lgkmcnt(14)
v_mfma_f32_16x16x32_bf16 v[168:171],v[112:115],v[8:11],v[168:171]
ds_read_b64_tr_b16 v[100:101],v236 offset:16384
ds_read_b64_tr_b16 v[102:103],v236 offset:17408
s_waitcnt lgkmcnt(14)
s_waitcnt lgkmcnt(12)
v_mfma_f32_16x16x32_bf16 v[144:147],v[116:119],v[0:3],v[144:147]
s_barrier
ds_read_b128 v[4:7],v255 offset:0
v_add_u32 v235,24576,v235
ds_read_b64_tr_b16 v[104:105],v235 offset:8192
ds_read_b64_tr_b16 v[106:107],v235 offset:9216
s_waitcnt lgkmcnt(13)
v_mfma_f32_16x16x32_bf16 v[148:151],v[120:123],v[0:3],v[148:151]
v_add_u32 v236,24576,v236
ds_read_b64_tr_b16 v[108:109],v236 offset:8192
ds_read_b64_tr_b16 v[110:111],v236 offset:9216
s_waitcnt lgkmcnt(13)
v_mfma_f32_16x16x32_bf16 v[152:155],v[124:127],v[0:3],v[152:155]
v_add_u32 v232,24576,v232
ds_read_b64_tr_b16 v[112:113],v232 offset:16384
ds_read_b64_tr_b16 v[114:115],v232 offset:17408
s_waitcnt lgkmcnt(13)
v_mfma_f32_16x16x32_bf16 v[156:159],v[128:131],v[0:3],v[156:159]
v_add_u32 v233,24576,v233
ds_read_b64_tr_b16 v[116:117],v233 offset:16384
ds_read_b64_tr_b16 v[118:119],v233 offset:17408
s_waitcnt lgkmcnt(13)
v_mfma_f32_16x16x32_bf16 v[160:163],v[132:135],v[0:3],v[160:163]
v_add_u32 v234,24576,v234
ds_read_b64_tr_b16 v[120:121],v234 offset:16384
ds_read_b64_tr_b16 v[122:123],v234 offset:17408
s_waitcnt lgkmcnt(13)
v_mfma_f32_16x16x32_bf16 v[164:167],v[136:139],v[0:3],v[164:167]
ds_read_b64_tr_b16 v[124:125],v235 offset:16384
ds_read_b64_tr_b16 v[126:127],v235 offset:17408
s_waitcnt lgkmcnt(13)
v_mfma_f32_16x16x32_bf16 v[168:171],v[100:103],v[0:3],v[168:171]
ds_read_b64_tr_b16 v[128:129],v236 offset:16384
ds_read_b64_tr_b16 v[130:131],v236 offset:17408
s_waitcnt lgkmcnt(14)
s_waitcnt lgkmcnt(12)
v_mfma_f32_16x16x32_bf16 v[144:147],v[104:107],v[4:7],v[144:147]
s_barrier
ds_write_b128 v58,v[240:243] offset:10240
ds_read_b128 v[8:11],v254 offset:10240
v_add_u32 v235,24576,v235
ds_read_b64_tr_b16 v[132:133],v235 offset:8192
ds_read_b64_tr_b16 v[134:135],v235 offset:9216
s_waitcnt lgkmcnt(14)
v_mfma_f32_16x16x32_bf16 v[148:151],v[108:111],v[4:7],v[148:151]
v_add_u32 v236,24576,v236
ds_read_b64_tr_b16 v[136:137],v236 offset:8192
ds_read_b64_tr_b16 v[138:139],v236 offset:9216
s_waitcnt lgkmcnt(14)
v_mfma_f32_16x16x32_bf16 v[152:155],v[112:115],v[4:7],v[152:155]
v_add_u32 v232,24576,v232
ds_read_b64_tr_b16 v[100:101],v232 offset:16384
ds_read_b64_tr_b16 v[102:103],v232 offset:17408
s_waitcnt lgkmcnt(14)
v_mfma_f32_16x16x32_bf16 v[156:159],v[116:119],v[4:7],v[156:159]
v_add_u32 v233,24576,v233
ds_read_b64_tr_b16 v[104:105],v233 offset:16384
ds_read_b64_tr_b16 v[106:107],v233 offset:17408
s_waitcnt lgkmcnt(14)
v_mfma_f32_16x16x32_bf16 v[160:163],v[120:123],v[4:7],v[160:163]
v_add_u32 v234,24576,v234
ds_read_b64_tr_b16 v[108:109],v234 offset:16384
ds_read_b64_tr_b16 v[110:111],v234 offset:17408
s_waitcnt lgkmcnt(14)
v_mfma_f32_16x16x32_bf16 v[164:167],v[124:127],v[4:7],v[164:167]
ds_read_b64_tr_b16 v[112:113],v235 offset:16384
ds_read_b64_tr_b16 v[114:115],v235 offset:17408
s_waitcnt lgkmcnt(14)
v_mfma_f32_16x16x32_bf16 v[168:171],v[128:131],v[4:7],v[168:171]
ds_read_b64_tr_b16 v[116:117],v236 offset:16384
ds_read_b64_tr_b16 v[118:119],v236 offset:17408
s_waitcnt lgkmcnt(14)
s_waitcnt lgkmcnt(12)
v_mfma_f32_16x16x32_bf16 v[144:147],v[132:135],v[8:11],v[144:147]
s_barrier
ds_read_b128 v[0:3],v255 offset:10240
v_subrev_u32 v235,98304,v235
ds_read_b64_tr_b16 v[120:121],v235 offset:8192
ds_read_b64_tr_b16 v[122:123],v235 offset:9216
s_waitcnt lgkmcnt(13)
v_mfma_f32_16x16x32_bf16 v[148:151],v[136:139],v[8:11],v[148:151]
v_subrev_u32 v236,98304,v236
ds_read_b64_tr_b16 v[124:125],v236 offset:8192
ds_read_b64_tr_b16 v[126:127],v236 offset:9216
s_waitcnt lgkmcnt(13)
v_mfma_f32_16x16x32_bf16 v[152:155],v[100:103],v[8:11],v[152:155]
v_subrev_u32 v232,98304,v232
ds_read_b64_tr_b16 v[128:129],v232 offset:16384
ds_read_b64_tr_b16 v[130:131],v232 offset:17408
s_waitcnt lgkmcnt(13)
v_mfma_f32_16x16x32_bf16 v[156:159],v[104:107],v[8:11],v[156:159]
v_subrev_u32 v233,98304,v233
ds_read_b64_tr_b16 v[132:133],v233 offset:16384
ds_read_b64_tr_b16 v[134:135],v233 offset:17408
s_waitcnt lgkmcnt(13)
v_mfma_f32_16x16x32_bf16 v[160:163],v[108:111],v[8:11],v[160:163]
v_subrev_u32 v234,98304,v234
ds_read_b64_tr_b16 v[136:137],v234 offset:16384
ds_read_b64_tr_b16 v[138:139],v234 offset:17408
s_waitcnt lgkmcnt(13)
v_mfma_f32_16x16x32_bf16 v[164:167],v[112:115],v[8:11],v[164:167]
ds_read_b64_tr_b16 v[100:101],v235 offset:16384
ds_read_b64_tr_b16 v[102:103],v235 offset:17408
s_waitcnt lgkmcnt(13)
v_mfma_f32_16x16x32_bf16 v[168:171],v[116:119],v[8:11],v[168:171]
ds_read_b64_tr_b16 v[104:105],v236 offset:16384
ds_read_b64_tr_b16 v[106:107],v236 offset:17408
s_waitcnt lgkmcnt(14)
s_waitcnt lgkmcnt(12)
v_mfma_f32_16x16x32_bf16 v[144:147],v[120:123],v[0:3],v[144:147]
s_barrier
ds_write_b128 v58,v[240:243] offset:20480
ds_read_b128 v[4:7],v254 offset:20480
v_add_u32 v235,24576,v235
ds_read_b64_tr_b16 v[108:109],v235 offset:8192
ds_read_b64_tr_b16 v[110:111],v235 offset:9216
s_waitcnt lgkmcnt(14)
v_mfma_f32_16x16x32_bf16 v[148:151],v[124:127],v[0:3],v[148:151]
v_add_u32 v236,24576,v236
ds_read_b64_tr_b16 v[112:113],v236 offset:8192
ds_read_b64_tr_b16 v[114:115],v236 offset:9216
s_waitcnt lgkmcnt(14)
v_mfma_f32_16x16x32_bf16 v[152:155],v[128:131],v[0:3],v[152:155]
v_add_u32 v232,24576,v232
ds_read_b64_tr_b16 v[116:117],v232 offset:16384
ds_read_b64_tr_b16 v[118:119],v232 offset:17408
s_waitcnt lgkmcnt(14)
v_mfma_f32_16x16x32_bf16 v[156:159],v[132:135],v[0:3],v[156:159]
v_add_u32 v233,24576,v233
ds_read_b64_tr_b16 v[120:121],v233 offset:16384
ds_read_b64_tr_b16 v[122:123],v233 offset:17408
s_waitcnt lgkmcnt(14)
v_mfma_f32_16x16x32_bf16 v[160:163],v[136:139],v[0:3],v[160:163]
v_add_u32 v234,24576,v234
ds_read_b64_tr_b16 v[124:125],v234 offset:16384
ds_read_b64_tr_b16 v[126:127],v234 offset:17408
s_waitcnt lgkmcnt(14)
v_mfma_f32_16x16x32_bf16 v[164:167],v[100:103],v[0:3],v[164:167]
ds_read_b64_tr_b16 v[128:129],v235 offset:16384
ds_read_b64_tr_b16 v[130:131],v235 offset:17408
s_waitcnt lgkmcnt(14)
v_mfma_f32_16x16x32_bf16 v[168:171],v[104:107],v[0:3],v[168:171]
ds_read_b64_tr_b16 v[132:133],v236 offset:16384
ds_read_b64_tr_b16 v[134:135],v236 offset:17408
s_waitcnt lgkmcnt(14)
s_waitcnt lgkmcnt(12)
v_mfma_f32_16x16x32_bf16 v[144:147],v[108:111],v[4:7],v[144:147]
s_barrier
ds_read_b128 v[8:11],v255 offset:20480
v_add_u32 v235,24576,v235
ds_read_b64_tr_b16 v[136:137],v235 offset:8192
ds_read_b64_tr_b16 v[138:139],v235 offset:9216
s_waitcnt lgkmcnt(13)
v_mfma_f32_16x16x32_bf16 v[148:151],v[112:115],v[4:7],v[148:151]
v_add_u32 v236,24576,v236
ds_read_b64_tr_b16 v[100:101],v236 offset:8192
ds_read_b64_tr_b16 v[102:103],v236 offset:9216
s_waitcnt lgkmcnt(13)
v_mfma_f32_16x16x32_bf16 v[152:155],v[116:119],v[4:7],v[152:155]
v_add_u32 v232,24576,v232
ds_read_b64_tr_b16 v[104:105],v232 offset:16384
ds_read_b64_tr_b16 v[106:107],v232 offset:17408
s_waitcnt lgkmcnt(13)
v_mfma_f32_16x16x32_bf16 v[156:159],v[120:123],v[4:7],v[156:159]
v_add_u32 v233,24576,v233
ds_read_b64_tr_b16 v[108:109],v233 offset:16384
ds_read_b64_tr_b16 v[110:111],v233 offset:17408
s_waitcnt lgkmcnt(13)
v_mfma_f32_16x16x32_bf16 v[160:163],v[124:127],v[4:7],v[160:163]
v_add_u32 v234,24576,v234
ds_read_b64_tr_b16 v[112:113],v234 offset:16384
ds_read_b64_tr_b16 v[114:115],v234 offset:17408
s_waitcnt lgkmcnt(13)
v_mfma_f32_16x16x32_bf16 v[164:167],v[128:131],v[4:7],v[164:167]
ds_read_b64_tr_b16 v[116:117],v235 offset:16384
ds_read_b64_tr_b16 v[118:119],v235 offset:17408
s_waitcnt lgkmcnt(13)
v_mfma_f32_16x16x32_bf16 v[168:171],v[132:135],v[4:7],v[168:171]
ds_read_b64_tr_b16 v[120:121],v236 offset:16384
ds_read_b64_tr_b16 v[122:123],v236 offset:17408
s_waitcnt lgkmcnt(14)
s_waitcnt lgkmcnt(12)
v_mfma_f32_16x16x32_bf16 v[144:147],v[136:139],v[8:11],v[144:147]
s_waitcnt lgkmcnt(10)
v_mfma_f32_16x16x32_bf16 v[148:151],v[100:103],v[8:11],v[148:151]
s_waitcnt lgkmcnt(8)
v_mfma_f32_16x16x32_bf16 v[152:155],v[104:107],v[8:11],v[152:155]
s_waitcnt lgkmcnt(6)
v_mfma_f32_16x16x32_bf16 v[156:159],v[108:111],v[8:11],v[156:159]
s_waitcnt lgkmcnt(4)
v_mfma_f32_16x16x32_bf16 v[160:163],v[112:115],v[8:11],v[160:163]
s_waitcnt lgkmcnt(2)
v_mfma_f32_16x16x32_bf16 v[164:167],v[116:119],v[8:11],v[164:167]
s_waitcnt lgkmcnt(0)
v_mfma_f32_16x16x32_bf16 v[168:171],v[120:123],v[8:11],v[168:171]
s_nop 5
s_mov_b32 exec_lo,0x00010001
s_mov_b32 exec_hi,0x00010001
ds_write_b128 v57,v[144:147] offset:512
ds_write_b128 v57,v[148:151] offset:576
ds_write_b128 v57,v[152:155] offset:640
ds_write_b128 v57,v[156:159] offset:704
ds_write_b128 v57,v[160:163] offset:768
ds_write_b128 v57,v[164:167] offset:832
ds_write_b128 v57,v[168:171] offset:896
s_mov_b64 exec,-1
s_waitcnt lgkmcnt(0)
s_barrier
ds_read_b64 v[4:5],v56 offset:0
ds_read_b128 v[64:67],v57 offset:512
ds_read_b128 v[68:71],v57 offset:576
ds_read_b128 v[72:75],v57 offset:640
ds_read_b128 v[76:79],v57 offset:704
ds_read_b128 v[80:83],v57 offset:768
ds_read_b128 v[84:87],v57 offset:832
ds_read_b128 v[88:91],v57 offset:896
s_waitcnt lgkmcnt(7)
s_waitcnt lgkmcnt(6)
v_pk_mul_f32 v[8:9],v[64:65],v[4:5] op_sel_hi:[1,0]
v_pk_mul_f32 v[10:11],v[66:67],v[4:5] op_sel_hi:[1,0]
v_pk_fma_f32 v[144:145],v[144:145],v[4:5],v[8:9] op_sel:[0,1,0] op_sel_hi:[1,1,1] neg_lo:[0,0,1] neg_hi:[0,0,1]
v_pk_fma_f32 v[146:147],v[146:147],v[4:5],v[10:11] op_sel:[0,1,0] op_sel_hi:[1,1,1] neg_lo:[0,0,1] neg_hi:[0,0,1]
v_cvt_pk_bf16_f32 v16,v144,v145
v_cvt_pk_bf16_f32 v17,v146,v147
ds_write_b64 v43,v[16:17] offset:15360
s_waitcnt lgkmcnt(6)
v_pk_mul_f32 v[12:13],v[68:69],v[4:5] op_sel_hi:[1,0]
v_pk_mul_f32 v[14:15],v[70:71],v[4:5] op_sel_hi:[1,0]
v_pk_fma_f32 v[148:149],v[148:149],v[4:5],v[12:13] op_sel:[0,1,0] op_sel_hi:[1,1,1] neg_lo:[0,0,1] neg_hi:[0,0,1]
v_pk_fma_f32 v[150:151],v[150:151],v[4:5],v[14:15] op_sel:[0,1,0] op_sel_hi:[1,1,1] neg_lo:[0,0,1] neg_hi:[0,0,1]
v_cvt_pk_bf16_f32 v18,v148,v149
v_cvt_pk_bf16_f32 v19,v150,v151
ds_write_b64 v44,v[18:19] offset:15360
s_waitcnt lgkmcnt(6)
v_pk_mul_f32 v[8:9],v[72:73],v[4:5] op_sel_hi:[1,0]
v_pk_mul_f32 v[10:11],v[74:75],v[4:5] op_sel_hi:[1,0]
v_pk_fma_f32 v[152:153],v[152:153],v[4:5],v[8:9] op_sel:[0,1,0] op_sel_hi:[1,1,1] neg_lo:[0,0,1] neg_hi:[0,0,1]
v_pk_fma_f32 v[154:155],v[154:155],v[4:5],v[10:11] op_sel:[0,1,0] op_sel_hi:[1,1,1] neg_lo:[0,0,1] neg_hi:[0,0,1]
ds_write_b128 v48,v[152:155] offset:30720
s_waitcnt lgkmcnt(6)
v_pk_mul_f32 v[12:13],v[76:77],v[4:5] op_sel_hi:[1,0]
v_pk_mul_f32 v[14:15],v[78:79],v[4:5] op_sel_hi:[1,0]
v_pk_fma_f32 v[156:157],v[156:157],v[4:5],v[12:13] op_sel:[0,1,0] op_sel_hi:[1,1,1] neg_lo:[0,0,1] neg_hi:[0,0,1]
v_pk_fma_f32 v[158:159],v[158:159],v[4:5],v[14:15] op_sel:[0,1,0] op_sel_hi:[1,1,1] neg_lo:[0,0,1] neg_hi:[0,0,1]
ds_write_b128 v49,v[156:159] offset:30720
s_waitcnt lgkmcnt(6)
v_pk_mul_f32 v[8:9],v[80:81],v[4:5] op_sel_hi:[1,0]
v_pk_mul_f32 v[10:11],v[82:83],v[4:5] op_sel_hi:[1,0]
v_pk_fma_f32 v[160:161],v[160:161],v[4:5],v[8:9] op_sel:[0,1,0] op_sel_hi:[1,1,1] neg_lo:[0,0,1] neg_hi:[0,0,1]
v_pk_fma_f32 v[162:163],v[162:163],v[4:5],v[10:11] op_sel:[0,1,0] op_sel_hi:[1,1,1] neg_lo:[0,0,1] neg_hi:[0,0,1]
ds_write_b128 v50,v[160:163] offset:30720
s_waitcnt lgkmcnt(6)
v_pk_mul_f32 v[12:13],v[84:85],v[4:5] op_sel_hi:[1,0]
v_pk_mul_f32 v[14:15],v[86:87],v[4:5] op_sel_hi:[1,0]
v_pk_fma_f32 v[164:165],v[164:165],v[4:5],v[12:13] op_sel:[0,1,0] op_sel_hi:[1,1,1] neg_lo:[0,0,1] neg_hi:[0,0,1]
v_pk_fma_f32 v[166:167],v[166:167],v[4:5],v[14:15] op_sel:[0,1,0] op_sel_hi:[1,1,1] neg_lo:[0,0,1] neg_hi:[0,0,1]
ds_write_b128 v51,v[164:167] offset:30720
s_waitcnt lgkmcnt(6)
v_pk_mul_f32 v[8:9],v[88:89],v[4:5] op_sel_hi:[1,0]
v_pk_mul_f32 v[10:11],v[90:91],v[4:5] op_sel_hi:[1,0]
v_pk_fma_f32 v[168:169],v[168:169],v[4:5],v[8:9] op_sel:[0,1,0] op_sel_hi:[1,1,1] neg_lo:[0,0,1] neg_hi:[0,0,1]
v_pk_fma_f32 v[170:171],v[170:171],v[4:5],v[10:11] op_sel:[0,1,0] op_sel_hi:[1,1,1] neg_lo:[0,0,1] neg_hi:[0,0,1]
ds_write_b128 v52,v[168:171] offset:30720
s_waitcnt lgkmcnt(0)
s_barrier
s_waitcnt lgkmcnt(0)
s_barrier
s_mov_b32 s12,s26
s_mov_b32 s13,s27
s_mov_b32 s14,2359296
s_mov_b32 s15,0x20000
s_lshl_b32 s37,s34,6
v_add_u32 v200,s37,v252
v_and_b32 v201,15,v200
v_lshrrev_b32 v200,4,v200
v_mul_u32_u24 v202,57,v200
v_lshrrev_b32 v202,9,v202
v_mul_u32_u24 v203,9,v202
v_sub_u32 v200,v200,v203
v_lshl_add_u32 v203,v202,4,v201
v_mul_u32_u24 v203,144,v203
v_lshl_add_u32 v203,v200,4,v203
ds_read_b128 v[204:207],v203 offset:56320
s_mul_i32 s38,s35,9
v_add_u32 v200,s38,v200
s_lshl_b32 s38,s36,2
v_add_u32 v202,s38,v202
v_mul_u32_u24 v202,72,v202
v_add_u32 v202,v202,v200
v_lshl_add_u32 v202,v202,4,v201
v_lshlrev_b32 v202,4,v202
s_waitcnt lgkmcnt(0)
buffer_store_dwordx4 v[204:207],v202,s[12:15],0 offen sc1
s_endpgm
attn_kernel_ld0:
s_setprio 3
v_lshrrev_b32 v2,4,v252
v_and_b32 v3,15,v252
v_mul_u32_u24 v5,3456,v2
s_lshl_b32 s39,s35,7
v_add_u32 v5,s39,v5
v_or_b32 v4,0,v2
v_lshlrev_b32 v4,1,v4
v_xor_b32 v4,v4,v3
v_lshl_add_u32 v6,v4,4,v5
v_or_b32 v4,4,v2
v_lshlrev_b32 v4,1,v4
v_xor_b32 v4,v4,v3
v_lshl_add_u32 v7,v4,4,v5
v_add_u32 v100,0,v6
v_add_u32 v101,12800,v6
v_add_u32 v102,25600,v7
v_add_u32 v103,38400,v7
v_add_u32 v104,55296,v6
v_add_u32 v105,68096,v6
v_add_u32 v106,80896,v7
v_add_u32 v107,93696,v7
v_add_u32 v108,1152,v6
v_add_u32 v109,13952,v6
v_add_u32 v110,26752,v7
v_add_u32 v111,39552,v7
v_add_u32 v112,56448,v6
v_add_u32 v113,69248,v6
v_add_u32 v114,82048,v7
v_add_u32 v115,94848,v7
v_add_u32 v116,2304,v6
v_add_u32 v117,15104,v6
v_add_u32 v118,27904,v7
v_add_u32 v119,40704,v7
v_add_u32 v120,57600,v6
v_add_u32 v121,70400,v6
v_add_u32 v122,83200,v7
v_add_u32 v123,96000,v7
s_mul_i32 s45,s44,221184
v_lshrrev_b32 v2,3,v252
v_and_b32 v3,7,v252
v_xor_b32 v3,v3,v2
s_lshl_b32 s37,s36,6
s_sub_u32 s37,s37,16
v_add_u32 v2,s37,v2
v_add_u32 v4,0,v2
v_max_i32 v4,0,v4
v_mul_u32_u24 v4,72,v4
v_add_lshl_u32 v60,v4,v3,4
v_add_u32 v4,8,v2
v_max_i32 v4,0,v4
v_mul_u32_u24 v4,72,v4
v_add_lshl_u32 v61,v4,v3,4
v_add_u32 v4,16,v2
v_max_i32 v4,0,v4
v_mul_u32_u24 v4,72,v4
v_add_lshl_u32 v62,v4,v3,4
v_add_u32 v4,24,v2
v_max_i32 v4,0,v4
v_mul_u32_u24 v4,72,v4
v_add_lshl_u32 v63,v4,v3,4
v_add_u32 v4,32,v2
v_max_i32 v4,0,v4
v_mul_u32_u24 v4,72,v4
v_add_lshl_u32 v64,v4,v3,4
v_add_u32 v4,40,v2
v_max_i32 v4,0,v4
v_mul_u32_u24 v4,72,v4
v_add_lshl_u32 v65,v4,v3,4
v_add_u32 v4,48,v2
v_max_i32 v4,0,v4
v_mul_u32_u24 v4,72,v4
v_add_lshl_u32 v66,v4,v3,4
v_add_u32 v4,56,v2
v_max_i32 v4,0,v4
v_mul_u32_u24 v4,72,v4
v_add_lshl_u32 v67,v4,v3,4
v_add_u32 v4,64,v2
v_max_i32 v4,0,v4
v_mul_u32_u24 v4,72,v4
v_add_lshl_u32 v68,v4,v3,4
v_add_u32 v4,72,v2
v_max_i32 v4,0,v4
v_mul_u32_u24 v4,72,v4
v_add_lshl_u32 v69,v4,v3,4
s_waitcnt lgkmcnt(0)
s_mov_b32 s4,s20
s_mov_b32 s5,s21
s_mov_b32 s6,2359296
s_mov_b32 s7,0x20000
s_mov_b32 s8,s22
s_mov_b32 s9,s23
s_mov_b32 s10,1990656
s_mov_b32 s11,0x20000
s_add_u32 s46,s44,0
s_cmp_ge_u32 s46,9
s_cselect_b32 s37,9,0
s_sub_u32 s46,s46,s37
s_lshl_b32 s46,s46,7
s_mov_b32 m0,122880
s_nop 0
buffer_load_dwordx4 v60,s[4:7],s46 offen lds
s_mov_b32 m0,123904
s_nop 0
buffer_load_dwordx4 v61,s[4:7],s46 offen lds
s_mov_b32 m0,124928
s_nop 0
buffer_load_dwordx4 v62,s[4:7],s46 offen lds
s_mov_b32 m0,125952
s_nop 0
buffer_load_dwordx4 v63,s[4:7],s46 offen lds
s_mov_b32 m0,126976
s_nop 0
buffer_load_dwordx4 v64,s[4:7],s46 offen lds
s_mov_b32 m0,0
s_nop 0
buffer_load_dwordx4 v100,s[8:11],s45 offen offset:0 lds
buffer_load_dwordx4 v101,s[8:11],s45 offen offset:1024 lds
buffer_load_dwordx4 v102,s[8:11],s45 offen offset:2048 lds
buffer_load_dwordx4 v103,s[8:11],s45 offen offset:3072 lds
s_mov_b32 m0,4096
s_nop 0
buffer_load_dwordx4 v104,s[8:11],s45 offen offset:0 lds
buffer_load_dwordx4 v105,s[8:11],s45 offen offset:1024 lds
buffer_load_dwordx4 v106,s[8:11],s45 offen offset:2048 lds
buffer_load_dwordx4 v107,s[8:11],s45 offen offset:3072 lds
s_mov_b32 m0,8192
s_nop 0
buffer_load_dwordx4 v108,s[8:11],s45 offen offset:0 lds
buffer_load_dwordx4 v109,s[8:11],s45 offen offset:1024 lds
buffer_load_dwordx4 v110,s[8:11],s45 offen offset:2048 lds
buffer_load_dwordx4 v111,s[8:11],s45 offen offset:3072 lds
s_add_u32 s45,s45,110592
s_cmp_ge_u32 s45,1990656
s_cselect_b32 s40,1990656,0
s_sub_u32 s45,s45,s40
s_mov_b32 m0,24576
s_nop 0
buffer_load_dwordx4 v100,s[8:11],s45 offen offset:0 lds
buffer_load_dwordx4 v101,s[8:11],s45 offen offset:1024 lds
buffer_load_dwordx4 v102,s[8:11],s45 offen offset:2048 lds
buffer_load_dwordx4 v103,s[8:11],s45 offen offset:3072 lds
s_mov_b32 m0,28672
s_nop 0
buffer_load_dwordx4 v104,s[8:11],s45 offen offset:0 lds
buffer_load_dwordx4 v105,s[8:11],s45 offen offset:1024 lds
buffer_load_dwordx4 v106,s[8:11],s45 offen offset:2048 lds
buffer_load_dwordx4 v107,s[8:11],s45 offen offset:3072 lds
s_mov_b32 m0,32768
s_nop 0
buffer_load_dwordx4 v108,s[8:11],s45 offen offset:0 lds
buffer_load_dwordx4 v109,s[8:11],s45 offen offset:1024 lds
buffer_load_dwordx4 v110,s[8:11],s45 offen offset:2048 lds
buffer_load_dwordx4 v111,s[8:11],s45 offen offset:3072 lds
s_add_u32 s45,s45,110592
s_cmp_ge_u32 s45,1990656
s_cselect_b32 s40,1990656,0
s_sub_u32 s45,s45,s40
s_mov_b32 m0,49152
s_nop 0
buffer_load_dwordx4 v100,s[8:11],s45 offen offset:0 lds
buffer_load_dwordx4 v101,s[8:11],s45 offen offset:1024 lds
buffer_load_dwordx4 v102,s[8:11],s45 offen offset:2048 lds
buffer_load_dwordx4 v103,s[8:11],s45 offen offset:3072 lds
s_mov_b32 m0,53248
s_nop 0
buffer_load_dwordx4 v104,s[8:11],s45 offen offset:0 lds
buffer_load_dwordx4 v105,s[8:11],s45 offen offset:1024 lds
buffer_load_dwordx4 v106,s[8:11],s45 offen offset:2048 lds
buffer_load_dwordx4 v107,s[8:11],s45 offen offset:3072 lds
s_mov_b32 m0,57344
s_nop 0
buffer_load_dwordx4 v108,s[8:11],s45 offen offset:0 lds
buffer_load_dwordx4 v109,s[8:11],s45 offen offset:1024 lds
buffer_load_dwordx4 v110,s[8:11],s45 offen offset:2048 lds
buffer_load_dwordx4 v111,s[8:11],s45 offen offset:3072 lds
s_add_u32 s16,s26,5898240
s_addc_u32 s17,s27,0
s_mov_b32 s18,131072
s_mov_b32 s19,0x20000
v_lshlrev_b32 v8,3,v252
v_mov_b32 v12,0
v_mov_b32 v13,0
s_lshl_b32 s37,s2,9
buffer_store_dwordx2 v[12:13],v8,s[16:19],s37 offen sc1
s_add_u32 s16,s26,6029312
s_addc_u32 s17,s27,0
s_mov_b32 s18,32768
s_mov_b32 s19,0x20000
v_lshlrev_b32 v8,1,v252
s_lshl_b32 s37,s2,7
buffer_store_short v12,v8,s[16:19],s37 offen sc1
s_waitcnt vmcnt(26)
s_barrier
s_add_u32 s46,s44,1
s_cmp_ge_u32 s46,9
s_cselect_b32 s37,9,0
s_sub_u32 s46,s46,s37
s_lshl_b32 s46,s46,7
s_mov_b32 m0,133120
s_nop 0
buffer_load_dwordx4 v60,s[4:7],s46 offen lds
s_mov_b32 m0,134144
s_nop 0
buffer_load_dwordx4 v61,s[4:7],s46 offen lds
s_mov_b32 m0,135168
s_nop 0
buffer_load_dwordx4 v62,s[4:7],s46 offen lds
s_mov_b32 m0,136192
s_nop 0
buffer_load_dwordx4 v63,s[4:7],s46 offen lds
s_mov_b32 m0,137216
s_nop 0
buffer_load_dwordx4 v64,s[4:7],s46 offen lds
s_add_u32 s45,s45,110592
s_cmp_ge_u32 s45,1990656
s_cselect_b32 s40,1990656,0
s_sub_u32 s45,s45,s40
s_mov_b32 m0,73728
s_nop 0
buffer_load_dwordx4 v100,s[8:11],s45 offen offset:0 lds
buffer_load_dwordx4 v101,s[8:11],s45 offen offset:1024 lds
buffer_load_dwordx4 v102,s[8:11],s45 offen offset:2048 lds
buffer_load_dwordx4 v103,s[8:11],s45 offen offset:3072 lds
s_mov_b32 m0,77824
s_nop 0
buffer_load_dwordx4 v104,s[8:11],s45 offen offset:0 lds
buffer_load_dwordx4 v105,s[8:11],s45 offen offset:1024 lds
buffer_load_dwordx4 v106,s[8:11],s45 offen offset:2048 lds
buffer_load_dwordx4 v107,s[8:11],s45 offen offset:3072 lds
s_mov_b32 m0,81920
s_nop 0
buffer_load_dwordx4 v108,s[8:11],s45 offen offset:0 lds
buffer_load_dwordx4 v109,s[8:11],s45 offen offset:1024 lds
buffer_load_dwordx4 v110,s[8:11],s45 offen offset:2048 lds
buffer_load_dwordx4 v111,s[8:11],s45 offen offset:3072 lds
s_waitcnt vmcnt(31)
s_barrier
s_add_u32 s45,s45,110592
s_cmp_ge_u32 s45,1990656
s_cselect_b32 s40,1990656,0
s_sub_u32 s45,s45,s40
s_mov_b32 m0,98304
s_nop 0
buffer_load_dwordx4 v100,s[8:11],s45 offen offset:0 lds
buffer_load_dwordx4 v101,s[8:11],s45 offen offset:1024 lds
buffer_load_dwordx4 v102,s[8:11],s45 offen offset:2048 lds
buffer_load_dwordx4 v103,s[8:11],s45 offen offset:3072 lds
s_mov_b32 m0,102400
s_nop 0
buffer_load_dwordx4 v104,s[8:11],s45 offen offset:0 lds
buffer_load_dwordx4 v105,s[8:11],s45 offen offset:1024 lds
buffer_load_dwordx4 v106,s[8:11],s45 offen offset:2048 lds
buffer_load_dwordx4 v107,s[8:11],s45 offen offset:3072 lds
s_mov_b32 m0,106496
s_nop 0
buffer_load_dwordx4 v108,s[8:11],s45 offen offset:0 lds
buffer_load_dwordx4 v109,s[8:11],s45 offen offset:1024 lds
buffer_load_dwordx4 v110,s[8:11],s45 offen offset:2048 lds
buffer_load_dwordx4 v111,s[8:11],s45 offen offset:3072 lds
s_waitcnt vmcnt(24)
s_barrier
s_add_u32 s46,s44,2
s_cmp_ge_u32 s46,9
s_cselect_b32 s37,9,0
s_sub_u32 s46,s46,s37
s_lshl_b32 s46,s46,7
s_mov_b32 m0,143360
s_nop 0
buffer_load_dwordx4 v60,s[4:7],s46 offen lds
s_mov_b32 m0,144384
s_nop 0
buffer_load_dwordx4 v61,s[4:7],s46 offen lds
s_mov_b32 m0,145408
s_nop 0
buffer_load_dwordx4 v62,s[4:7],s46 offen lds
s_mov_b32 m0,146432
s_nop 0
buffer_load_dwordx4 v63,s[4:7],s46 offen lds
s_mov_b32 m0,147456
s_nop 0
buffer_load_dwordx4 v64,s[4:7],s46 offen lds
s_add_u32 s45,s45,110592
s_cmp_ge_u32 s45,1990656
s_cselect_b32 s40,1990656,0
s_sub_u32 s45,s45,s40
s_mov_b32 m0,0
s_nop 0
buffer_load_dwordx4 v100,s[8:11],s45 offen offset:0 lds
buffer_load_dwordx4 v101,s[8:11],s45 offen offset:1024 lds
buffer_load_dwordx4 v102,s[8:11],s45 offen offset:2048 lds
buffer_load_dwordx4 v103,s[8:11],s45 offen offset:3072 lds
s_mov_b32 m0,4096
s_nop 0
buffer_load_dwordx4 v104,s[8:11],s45 offen offset:0 lds
buffer_load_dwordx4 v105,s[8:11],s45 offen offset:1024 lds
buffer_load_dwordx4 v106,s[8:11],s45 offen offset:2048 lds
buffer_load_dwordx4 v107,s[8:11],s45 offen offset:3072 lds
s_mov_b32 m0,8192
s_nop 0
buffer_load_dwordx4 v108,s[8:11],s45 offen offset:0 lds
buffer_load_dwordx4 v109,s[8:11],s45 offen offset:1024 lds
buffer_load_dwordx4 v110,s[8:11],s45 offen offset:2048 lds
buffer_load_dwordx4 v111,s[8:11],s45 offen offset:3072 lds
s_waitcnt vmcnt(29)
s_barrier
s_add_u32 s45,s45,110592
s_cmp_ge_u32 s45,1990656
s_cselect_b32 s40,1990656,0
s_sub_u32 s45,s45,s40
s_mov_b32 m0,24576
s_nop 0
buffer_load_dwordx4 v100,s[8:11],s45 offen offset:0 lds
buffer_load_dwordx4 v101,s[8:11],s45 offen offset:1024 lds
buffer_load_dwordx4 v102,s[8:11],s45 offen offset:2048 lds
buffer_load_dwordx4 v103,s[8:11],s45 offen offset:3072 lds
s_mov_b32 m0,28672
s_nop 0
buffer_load_dwordx4 v104,s[8:11],s45 offen offset:0 lds
buffer_load_dwordx4 v105,s[8:11],s45 offen offset:1024 lds
buffer_load_dwordx4 v106,s[8:11],s45 offen offset:2048 lds
buffer_load_dwordx4 v107,s[8:11],s45 offen offset:3072 lds
s_mov_b32 m0,32768
s_nop 0
buffer_load_dwordx4 v108,s[8:11],s45 offen offset:0 lds
buffer_load_dwordx4 v109,s[8:11],s45 offen offset:1024 lds
buffer_load_dwordx4 v110,s[8:11],s45 offen offset:2048 lds
buffer_load_dwordx4 v111,s[8:11],s45 offen offset:3072 lds
s_waitcnt vmcnt(24)
s_barrier
s_add_u32 s46,s44,3
s_cmp_ge_u32 s46,9
s_cselect_b32 s37,9,0
s_sub_u32 s46,s46,s37
s_lshl_b32 s46,s46,7
s_mov_b32 m0,122880
s_nop 0
buffer_load_dwordx4 v60,s[4:7],s46 offen lds
s_mov_b32 m0,123904
s_nop 0
buffer_load_dwordx4 v61,s[4:7],s46 offen lds
s_mov_b32 m0,124928
s_nop 0
buffer_load_dwordx4 v62,s[4:7],s46 offen lds
s_mov_b32 m0,125952
s_nop 0
buffer_load_dwordx4 v63,s[4:7],s46 offen lds
s_mov_b32 m0,126976
s_nop 0
buffer_load_dwordx4 v64,s[4:7],s46 offen lds
s_add_u32 s45,s45,110592
s_cmp_ge_u32 s45,1990656
s_cselect_b32 s40,1990656,0
s_sub_u32 s45,s45,s40
s_mov_b32 m0,49152
s_nop 0
buffer_load_dwordx4 v100,s[8:11],s45 offen offset:0 lds
buffer_load_dwordx4 v101,s[8:11],s45 offen offset:1024 lds
buffer_load_dwordx4 v102,s[8:11],s45 offen offset:2048 lds
buffer_load_dwordx4 v103,s[8:11],s45 offen offset:3072 lds
s_mov_b32 m0,53248
s_nop 0
buffer_load_dwordx4 v104,s[8:11],s45 offen offset:0 lds
buffer_load_dwordx4 v105,s[8:11],s45 offen offset:1024 lds
buffer_load_dwordx4 v106,s[8:11],s45 offen offset:2048 lds
buffer_load_dwordx4 v107,s[8:11],s45 offen offset:3072 lds
s_mov_b32 m0,57344
s_nop 0
buffer_load_dwordx4 v108,s[8:11],s45 offen offset:0 lds
buffer_load_dwordx4 v109,s[8:11],s45 offen offset:1024 lds
buffer_load_dwordx4 v110,s[8:11],s45 offen offset:2048 lds
buffer_load_dwordx4 v111,s[8:11],s45 offen offset:3072 lds
s_waitcnt vmcnt(29)
s_barrier
s_add_u32 s45,s45,110592
s_cmp_ge_u32 s45,1990656
s_cselect_b32 s40,1990656,0
s_sub_u32 s45,s45,s40
s_mov_b32 m0,73728
s_nop 0
buffer_load_dwordx4 v100,s[8:11],s45 offen offset:0 lds
buffer_load_dwordx4 v101,s[8:11],s45 offen offset:1024 lds
buffer_load_dwordx4 v102,s[8:11],s45 offen offset:2048 lds
buffer_load_dwordx4 v103,s[8:11],s45 offen offset:3072 lds
s_mov_b32 m0,77824
s_nop 0
buffer_load_dwordx4 v104,s[8:11],s45 offen offset:0 lds
buffer_load_dwordx4 v105,s[8:11],s45 offen offset:1024 lds
buffer_load_dwordx4 v106,s[8:11],s45 offen offset:2048 lds
buffer_load_dwordx4 v107,s[8:11],s45 offen offset:3072 lds
s_mov_b32 m0,81920
s_nop 0
buffer_load_dwordx4 v108,s[8:11],s45 offen offset:0 lds
buffer_load_dwordx4 v109,s[8:11],s45 offen offset:1024 lds
buffer_load_dwordx4 v110,s[8:11],s45 offen offset:2048 lds
buffer_load_dwordx4 v111,s[8:11],s45 offen offset:3072 lds
s_waitcnt vmcnt(24)
s_barrier
s_add_u32 s46,s44,4
s_cmp_ge_u32 s46,9
s_cselect_b32 s37,9,0
s_sub_u32 s46,s46,s37
s_lshl_b32 s46,s46,7
s_mov_b32 m0,133120
s_nop 0
buffer_load_dwordx4 v60,s[4:7],s46 offen lds
s_mov_b32 m0,134144
s_nop 0
buffer_load_dwordx4 v61,s[4:7],s46 offen lds
s_mov_b32 m0,135168
s_nop 0
buffer_load_dwordx4 v62,s[4:7],s46 offen lds
s_mov_b32 m0,136192
s_nop 0
buffer_load_dwordx4 v63,s[4:7],s46 offen lds
s_mov_b32 m0,137216
s_nop 0
buffer_load_dwordx4 v64,s[4:7],s46 offen lds
s_add_u32 s45,s45,110592
s_cmp_ge_u32 s45,1990656
s_cselect_b32 s40,1990656,0
s_sub_u32 s45,s45,s40
s_mov_b32 m0,98304
s_nop 0
buffer_load_dwordx4 v100,s[8:11],s45 offen offset:0 lds
buffer_load_dwordx4 v101,s[8:11],s45 offen offset:1024 lds
buffer_load_dwordx4 v102,s[8:11],s45 offen offset:2048 lds
buffer_load_dwordx4 v103,s[8:11],s45 offen offset:3072 lds
s_mov_b32 m0,102400
s_nop 0
buffer_load_dwordx4 v104,s[8:11],s45 offen offset:0 lds
buffer_load_dwordx4 v105,s[8:11],s45 offen offset:1024 lds
buffer_load_dwordx4 v106,s[8:11],s45 offen offset:2048 lds
buffer_load_dwordx4 v107,s[8:11],s45 offen offset:3072 lds
s_mov_b32 m0,106496
s_nop 0
buffer_load_dwordx4 v108,s[8:11],s45 offen offset:0 lds
buffer_load_dwordx4 v109,s[8:11],s45 offen offset:1024 lds
buffer_load_dwordx4 v110,s[8:11],s45 offen offset:2048 lds
buffer_load_dwordx4 v111,s[8:11],s45 offen offset:3072 lds
s_waitcnt vmcnt(29)
s_barrier
s_add_u32 s45,s45,110592
s_cmp_ge_u32 s45,1990656
s_cselect_b32 s40,1990656,0
s_sub_u32 s45,s45,s40
s_mov_b32 m0,0
s_nop 0
buffer_load_dwordx4 v100,s[8:11],s45 offen offset:0 lds
buffer_load_dwordx4 v101,s[8:11],s45 offen offset:1024 lds
buffer_load_dwordx4 v102,s[8:11],s45 offen offset:2048 lds
buffer_load_dwordx4 v103,s[8:11],s45 offen offset:3072 lds
s_mov_b32 m0,4096
s_nop 0
buffer_load_dwordx4 v104,s[8:11],s45 offen offset:0 lds
buffer_load_dwordx4 v105,s[8:11],s45 offen offset:1024 lds
buffer_load_dwordx4 v106,s[8:11],s45 offen offset:2048 lds
buffer_load_dwordx4 v107,s[8:11],s45 offen offset:3072 lds
s_mov_b32 m0,8192
s_nop 0
buffer_load_dwordx4 v108,s[8:11],s45 offen offset:0 lds
buffer_load_dwordx4 v109,s[8:11],s45 offen offset:1024 lds
buffer_load_dwordx4 v110,s[8:11],s45 offen offset:2048 lds
buffer_load_dwordx4 v111,s[8:11],s45 offen offset:3072 lds
s_waitcnt vmcnt(24)
s_barrier
s_add_u32 s46,s44,5
s_cmp_ge_u32 s46,9
s_cselect_b32 s37,9,0
s_sub_u32 s46,s46,s37
s_lshl_b32 s46,s46,7
s_mov_b32 m0,143360
s_nop 0
buffer_load_dwordx4 v60,s[4:7],s46 offen lds
s_mov_b32 m0,144384
s_nop 0
buffer_load_dwordx4 v61,s[4:7],s46 offen lds
s_mov_b32 m0,145408
s_nop 0
buffer_load_dwordx4 v62,s[4:7],s46 offen lds
s_mov_b32 m0,146432
s_nop 0
buffer_load_dwordx4 v63,s[4:7],s46 offen lds
s_mov_b32 m0,147456
s_nop 0
buffer_load_dwordx4 v64,s[4:7],s46 offen lds
s_add_u32 s45,s45,110592
s_cmp_ge_u32 s45,1990656
s_cselect_b32 s40,1990656,0
s_sub_u32 s45,s45,s40
s_mov_b32 m0,24576
s_nop 0
buffer_load_dwordx4 v100,s[8:11],s45 offen offset:0 lds
buffer_load_dwordx4 v101,s[8:11],s45 offen offset:1024 lds
buffer_load_dwordx4 v102,s[8:11],s45 offen offset:2048 lds
buffer_load_dwordx4 v103,s[8:11],s45 offen offset:3072 lds
s_mov_b32 m0,28672
s_nop 0
buffer_load_dwordx4 v104,s[8:11],s45 offen offset:0 lds
buffer_load_dwordx4 v105,s[8:11],s45 offen offset:1024 lds
buffer_load_dwordx4 v106,s[8:11],s45 offen offset:2048 lds
buffer_load_dwordx4 v107,s[8:11],s45 offen offset:3072 lds
s_mov_b32 m0,32768
s_nop 0
buffer_load_dwordx4 v108,s[8:11],s45 offen offset:0 lds
buffer_load_dwordx4 v109,s[8:11],s45 offen offset:1024 lds
buffer_load_dwordx4 v110,s[8:11],s45 offen offset:2048 lds
buffer_load_dwordx4 v111,s[8:11],s45 offen offset:3072 lds
s_waitcnt vmcnt(29)
s_barrier
s_add_u32 s45,s45,110592
s_cmp_ge_u32 s45,1990656
s_cselect_b32 s40,1990656,0
s_sub_u32 s45,s45,s40
s_mov_b32 m0,49152
s_nop 0
buffer_load_dwordx4 v100,s[8:11],s45 offen offset:0 lds
buffer_load_dwordx4 v101,s[8:11],s45 offen offset:1024 lds
buffer_load_dwordx4 v102,s[8:11],s45 offen offset:2048 lds
buffer_load_dwordx4 v103,s[8:11],s45 offen offset:3072 lds
s_mov_b32 m0,53248
s_nop 0
buffer_load_dwordx4 v104,s[8:11],s45 offen offset:0 lds
buffer_load_dwordx4 v105,s[8:11],s45 offen offset:1024 lds
buffer_load_dwordx4 v106,s[8:11],s45 offen offset:2048 lds
buffer_load_dwordx4 v107,s[8:11],s45 offen offset:3072 lds
s_mov_b32 m0,57344
s_nop 0
buffer_load_dwordx4 v108,s[8:11],s45 offen offset:0 lds
buffer_load_dwordx4 v109,s[8:11],s45 offen offset:1024 lds
buffer_load_dwordx4 v110,s[8:11],s45 offen offset:2048 lds
buffer_load_dwordx4 v111,s[8:11],s45 offen offset:3072 lds
s_waitcnt vmcnt(24)
s_barrier
s_add_u32 s46,s44,6
s_cmp_ge_u32 s46,9
s_cselect_b32 s37,9,0
s_sub_u32 s46,s46,s37
s_lshl_b32 s46,s46,7
s_mov_b32 m0,122880
s_nop 0
buffer_load_dwordx4 v60,s[4:7],s46 offen lds
s_mov_b32 m0,123904
s_nop 0
buffer_load_dwordx4 v61,s[4:7],s46 offen lds
s_mov_b32 m0,124928
s_nop 0
buffer_load_dwordx4 v62,s[4:7],s46 offen lds
s_mov_b32 m0,125952
s_nop 0
buffer_load_dwordx4 v63,s[4:7],s46 offen lds
s_mov_b32 m0,126976
s_nop 0
buffer_load_dwordx4 v64,s[4:7],s46 offen lds
s_add_u32 s45,s45,110592
s_cmp_ge_u32 s45,1990656
s_cselect_b32 s40,1990656,0
s_sub_u32 s45,s45,s40
s_mov_b32 m0,73728
s_nop 0
buffer_load_dwordx4 v100,s[8:11],s45 offen offset:0 lds
buffer_load_dwordx4 v101,s[8:11],s45 offen offset:1024 lds
buffer_load_dwordx4 v102,s[8:11],s45 offen offset:2048 lds
buffer_load_dwordx4 v103,s[8:11],s45 offen offset:3072 lds
s_mov_b32 m0,77824
s_nop 0
buffer_load_dwordx4 v104,s[8:11],s45 offen offset:0 lds
buffer_load_dwordx4 v105,s[8:11],s45 offen offset:1024 lds
buffer_load_dwordx4 v106,s[8:11],s45 offen offset:2048 lds
buffer_load_dwordx4 v107,s[8:11],s45 offen offset:3072 lds
s_mov_b32 m0,81920
s_nop 0
buffer_load_dwordx4 v108,s[8:11],s45 offen offset:0 lds
buffer_load_dwordx4 v109,s[8:11],s45 offen offset:1024 lds
buffer_load_dwordx4 v110,s[8:11],s45 offen offset:2048 lds
buffer_load_dwordx4 v111,s[8:11],s45 offen offset:3072 lds
s_waitcnt vmcnt(29)
s_barrier
s_add_u32 s45,s45,110592
s_cmp_ge_u32 s45,1990656
s_cselect_b32 s40,1990656,0
s_sub_u32 s45,s45,s40
s_mov_b32 m0,98304
s_nop 0
buffer_load_dwordx4 v100,s[8:11],s45 offen offset:0 lds
buffer_load_dwordx4 v101,s[8:11],s45 offen offset:1024 lds
buffer_load_dwordx4 v102,s[8:11],s45 offen offset:2048 lds
buffer_load_dwordx4 v103,s[8:11],s45 offen offset:3072 lds
s_mov_b32 m0,102400
s_nop 0
buffer_load_dwordx4 v104,s[8:11],s45 offen offset:0 lds
buffer_load_dwordx4 v105,s[8:11],s45 offen offset:1024 lds
buffer_load_dwordx4 v106,s[8:11],s45 offen offset:2048 lds
buffer_load_dwordx4 v107,s[8:11],s45 offen offset:3072 lds
s_mov_b32 m0,106496
s_nop 0
buffer_load_dwordx4 v108,s[8:11],s45 offen offset:0 lds
buffer_load_dwordx4 v109,s[8:11],s45 offen offset:1024 lds
buffer_load_dwordx4 v110,s[8:11],s45 offen offset:2048 lds
buffer_load_dwordx4 v111,s[8:11],s45 offen offset:3072 lds
s_waitcnt vmcnt(24)
s_barrier
s_add_u32 s46,s44,7
s_cmp_ge_u32 s46,9
s_cselect_b32 s37,9,0
s_sub_u32 s46,s46,s37
s_lshl_b32 s46,s46,7
s_mov_b32 m0,133120
s_nop 0
buffer_load_dwordx4 v60,s[4:7],s46 offen lds
s_mov_b32 m0,134144
s_nop 0
buffer_load_dwordx4 v61,s[4:7],s46 offen lds
s_mov_b32 m0,135168
s_nop 0
buffer_load_dwordx4 v62,s[4:7],s46 offen lds
s_mov_b32 m0,136192
s_nop 0
buffer_load_dwordx4 v63,s[4:7],s46 offen lds
s_mov_b32 m0,137216
s_nop 0
buffer_load_dwordx4 v64,s[4:7],s46 offen lds
s_add_u32 s45,s45,110592
s_cmp_ge_u32 s45,1990656
s_cselect_b32 s40,1990656,0
s_sub_u32 s45,s45,s40
s_mov_b32 m0,0
s_nop 0
buffer_load_dwordx4 v100,s[8:11],s45 offen offset:0 lds
buffer_load_dwordx4 v101,s[8:11],s45 offen offset:1024 lds
buffer_load_dwordx4 v102,s[8:11],s45 offen offset:2048 lds
buffer_load_dwordx4 v103,s[8:11],s45 offen offset:3072 lds
s_mov_b32 m0,4096
s_nop 0
buffer_load_dwordx4 v104,s[8:11],s45 offen offset:0 lds
buffer_load_dwordx4 v105,s[8:11],s45 offen offset:1024 lds
buffer_load_dwordx4 v106,s[8:11],s45 offen offset:2048 lds
buffer_load_dwordx4 v107,s[8:11],s45 offen offset:3072 lds
s_mov_b32 m0,8192
s_nop 0
buffer_load_dwordx4 v108,s[8:11],s45 offen offset:0 lds
buffer_load_dwordx4 v109,s[8:11],s45 offen offset:1024 lds
buffer_load_dwordx4 v110,s[8:11],s45 offen offset:2048 lds
buffer_load_dwordx4 v111,s[8:11],s45 offen offset:3072 lds
s_waitcnt vmcnt(29)
s_barrier
s_add_u32 s45,s45,110592
s_cmp_ge_u32 s45,1990656
s_cselect_b32 s40,1990656,0
s_sub_u32 s45,s45,s40
s_mov_b32 m0,24576
s_nop 0
buffer_load_dwordx4 v100,s[8:11],s45 offen offset:0 lds
buffer_load_dwordx4 v101,s[8:11],s45 offen offset:1024 lds
buffer_load_dwordx4 v102,s[8:11],s45 offen offset:2048 lds
buffer_load_dwordx4 v103,s[8:11],s45 offen offset:3072 lds
s_mov_b32 m0,28672
s_nop 0
buffer_load_dwordx4 v104,s[8:11],s45 offen offset:0 lds
buffer_load_dwordx4 v105,s[8:11],s45 offen offset:1024 lds
buffer_load_dwordx4 v106,s[8:11],s45 offen offset:2048 lds
buffer_load_dwordx4 v107,s[8:11],s45 offen offset:3072 lds
s_mov_b32 m0,32768
s_nop 0
buffer_load_dwordx4 v108,s[8:11],s45 offen offset:0 lds
buffer_load_dwordx4 v109,s[8:11],s45 offen offset:1024 lds
buffer_load_dwordx4 v110,s[8:11],s45 offen offset:2048 lds
buffer_load_dwordx4 v111,s[8:11],s45 offen offset:3072 lds
s_waitcnt vmcnt(24)
s_barrier
s_add_u32 s46,s44,8
s_cmp_ge_u32 s46,9
s_cselect_b32 s37,9,0
s_sub_u32 s46,s46,s37
s_lshl_b32 s46,s46,7
s_mov_b32 m0,143360
s_nop 0
buffer_load_dwordx4 v60,s[4:7],s46 offen lds
s_mov_b32 m0,144384
s_nop 0
buffer_load_dwordx4 v61,s[4:7],s46 offen lds
s_mov_b32 m0,145408
s_nop 0
buffer_load_dwordx4 v62,s[4:7],s46 offen lds
s_mov_b32 m0,146432
s_nop 0
buffer_load_dwordx4 v63,s[4:7],s46 offen lds
s_mov_b32 m0,147456
s_nop 0
buffer_load_dwordx4 v64,s[4:7],s46 offen lds
s_add_u32 s45,s45,110592
s_cmp_ge_u32 s45,1990656
s_cselect_b32 s40,1990656,0
s_sub_u32 s45,s45,s40
s_mov_b32 m0,49152
s_nop 0
buffer_load_dwordx4 v100,s[8:11],s45 offen offset:0 lds
buffer_load_dwordx4 v101,s[8:11],s45 offen offset:1024 lds
buffer_load_dwordx4 v102,s[8:11],s45 offen offset:2048 lds
buffer_load_dwordx4 v103,s[8:11],s45 offen offset:3072 lds
s_mov_b32 m0,53248
s_nop 0
buffer_load_dwordx4 v104,s[8:11],s45 offen offset:0 lds
buffer_load_dwordx4 v105,s[8:11],s45 offen offset:1024 lds
buffer_load_dwordx4 v106,s[8:11],s45 offen offset:2048 lds
buffer_load_dwordx4 v107,s[8:11],s45 offen offset:3072 lds
s_mov_b32 m0,57344
s_nop 0
buffer_load_dwordx4 v108,s[8:11],s45 offen offset:0 lds
buffer_load_dwordx4 v109,s[8:11],s45 offen offset:1024 lds
buffer_load_dwordx4 v110,s[8:11],s45 offen offset:2048 lds
buffer_load_dwordx4 v111,s[8:11],s45 offen offset:3072 lds
s_waitcnt vmcnt(29)
s_barrier
s_waitcnt vmcnt(12)
s_barrier
s_waitcnt vmcnt(0)
s_barrier
s_barrier
s_barrier
s_barrier
s_mov_b32 s12,s26
s_mov_b32 s13,s27
s_mov_b32 s14,2359296
s_mov_b32 s15,0x20000
s_lshl_b32 s37,s34,6
v_add_u32 v200,s37,v252
v_and_b32 v201,15,v200
v_lshrrev_b32 v200,4,v200
v_mul_u32_u24 v202,57,v200
v_lshrrev_b32 v202,9,v202
v_mul_u32_u24 v203,9,v202
v_sub_u32 v200,v200,v203
v_lshl_add_u32 v203,v202,4,v201
v_mul_u32_u24 v203,144,v203
v_lshl_add_u32 v203,v200,4,v203
ds_read_b128 v[204:207],v203 offset:56320
s_mul_i32 s38,s35,9
v_add_u32 v200,s38,v200
s_lshl_b32 s38,s36,2
v_add_u32 v202,s38,v202
v_mul_u32_u24 v202,72,v202
v_add_u32 v202,v202,v200
v_lshl_add_u32 v202,v202,4,v201
v_lshlrev_b32 v202,4,v202
s_waitcnt lgkmcnt(0)
buffer_store_dwordx4 v[204:207],v202,s[12:15],0 offen sc1
s_endpgm
attn_kernel_ld1:
s_setprio 3
v_lshrrev_b32 v2,4,v252
v_and_b32 v3,15,v252
v_mul_u32_u24 v5,3456,v2
s_lshl_b32 s39,s35,7
v_add_u32 v5,s39,v5
v_or_b32 v4,0,v2
v_lshlrev_b32 v4,1,v4
v_xor_b32 v4,v4,v3
v_lshl_add_u32 v6,v4,4,v5
v_or_b32 v4,4,v2
v_lshlrev_b32 v4,1,v4
v_xor_b32 v4,v4,v3
v_lshl_add_u32 v7,v4,4,v5
v_add_u32 v100,0,v6
v_add_u32 v101,12800,v6
v_add_u32 v102,25600,v7
v_add_u32 v103,38400,v7
v_add_u32 v104,55296,v6
v_add_u32 v105,68096,v6
v_add_u32 v106,80896,v7
v_add_u32 v107,93696,v7
v_add_u32 v108,1152,v6
v_add_u32 v109,13952,v6
v_add_u32 v110,26752,v7
v_add_u32 v111,39552,v7
v_add_u32 v112,56448,v6
v_add_u32 v113,69248,v6
v_add_u32 v114,82048,v7
v_add_u32 v115,94848,v7
v_add_u32 v116,2304,v6
v_add_u32 v117,15104,v6
v_add_u32 v118,27904,v7
v_add_u32 v119,40704,v7
v_add_u32 v120,57600,v6
v_add_u32 v121,70400,v6
v_add_u32 v122,83200,v7
v_add_u32 v123,96000,v7
s_mul_i32 s45,s44,221184
v_lshrrev_b32 v2,3,v252
v_and_b32 v3,7,v252
v_xor_b32 v3,v3,v2
s_lshl_b32 s37,s36,6
s_sub_u32 s37,s37,16
v_add_u32 v2,s37,v2
v_add_u32 v4,0,v2
v_max_i32 v4,0,v4
v_mul_u32_u24 v4,72,v4
v_add_lshl_u32 v60,v4,v3,4
v_add_u32 v4,8,v2
v_max_i32 v4,0,v4
v_mul_u32_u24 v4,72,v4
v_add_lshl_u32 v61,v4,v3,4
v_add_u32 v4,16,v2
v_max_i32 v4,0,v4
v_mul_u32_u24 v4,72,v4
v_add_lshl_u32 v62,v4,v3,4
v_add_u32 v4,24,v2
v_max_i32 v4,0,v4
v_mul_u32_u24 v4,72,v4
v_add_lshl_u32 v63,v4,v3,4
v_add_u32 v4,32,v2
v_max_i32 v4,0,v4
v_mul_u32_u24 v4,72,v4
v_add_lshl_u32 v64,v4,v3,4
v_add_u32 v4,40,v2
v_max_i32 v4,0,v4
v_mul_u32_u24 v4,72,v4
v_add_lshl_u32 v65,v4,v3,4
v_add_u32 v4,48,v2
v_max_i32 v4,0,v4
v_mul_u32_u24 v4,72,v4
v_add_lshl_u32 v66,v4,v3,4
v_add_u32 v4,56,v2
v_max_i32 v4,0,v4
v_mul_u32_u24 v4,72,v4
v_add_lshl_u32 v67,v4,v3,4
v_add_u32 v4,64,v2
v_max_i32 v4,0,v4
v_mul_u32_u24 v4,72,v4
v_add_lshl_u32 v68,v4,v3,4
v_add_u32 v4,72,v2
v_max_i32 v4,0,v4
v_mul_u32_u24 v4,72,v4
v_add_lshl_u32 v69,v4,v3,4
s_waitcnt lgkmcnt(0)
s_mov_b32 s4,s20
s_mov_b32 s5,s21
s_mov_b32 s6,2359296
s_mov_b32 s7,0x20000
s_mov_b32 s8,s22
s_mov_b32 s9,s23
s_mov_b32 s10,1990656
s_mov_b32 s11,0x20000
s_add_u32 s46,s44,0
s_cmp_ge_u32 s46,9
s_cselect_b32 s37,9,0
s_sub_u32 s46,s46,s37
s_lshl_b32 s46,s46,7
s_mov_b32 m0,128000
s_nop 0
buffer_load_dwordx4 v65,s[4:7],s46 offen lds
s_mov_b32 m0,129024
s_nop 0
buffer_load_dwordx4 v66,s[4:7],s46 offen lds
s_mov_b32 m0,130048
s_nop 0
buffer_load_dwordx4 v67,s[4:7],s46 offen lds
s_mov_b32 m0,131072
s_nop 0
buffer_load_dwordx4 v68,s[4:7],s46 offen lds
s_mov_b32 m0,132096
s_nop 0
buffer_load_dwordx4 v69,s[4:7],s46 offen lds
s_mov_b32 m0,12288
s_nop 0
buffer_load_dwordx4 v112,s[8:11],s45 offen offset:0 lds
buffer_load_dwordx4 v113,s[8:11],s45 offen offset:1024 lds
buffer_load_dwordx4 v114,s[8:11],s45 offen offset:2048 lds
buffer_load_dwordx4 v115,s[8:11],s45 offen offset:3072 lds
s_mov_b32 m0,16384
s_nop 0
buffer_load_dwordx4 v116,s[8:11],s45 offen offset:0 lds
buffer_load_dwordx4 v117,s[8:11],s45 offen offset:1024 lds
buffer_load_dwordx4 v118,s[8:11],s45 offen offset:2048 lds
buffer_load_dwordx4 v119,s[8:11],s45 offen offset:3072 lds
s_mov_b32 m0,20480
s_nop 0
buffer_load_dwordx4 v120,s[8:11],s45 offen offset:0 lds
buffer_load_dwordx4 v121,s[8:11],s45 offen offset:1024 lds
buffer_load_dwordx4 v122,s[8:11],s45 offen offset:2048 lds
buffer_load_dwordx4 v123,s[8:11],s45 offen offset:3072 lds
s_add_u32 s45,s45,110592
s_cmp_ge_u32 s45,1990656
s_cselect_b32 s40,1990656,0
s_sub_u32 s45,s45,s40
s_mov_b32 m0,36864
s_nop 0
buffer_load_dwordx4 v112,s[8:11],s45 offen offset:0 lds
buffer_load_dwordx4 v113,s[8:11],s45 offen offset:1024 lds
buffer_load_dwordx4 v114,s[8:11],s45 offen offset:2048 lds
buffer_load_dwordx4 v115,s[8:11],s45 offen offset:3072 lds
s_mov_b32 m0,40960
s_nop 0
buffer_load_dwordx4 v116,s[8:11],s45 offen offset:0 lds
buffer_load_dwordx4 v117,s[8:11],s45 offen offset:1024 lds
buffer_load_dwordx4 v118,s[8:11],s45 offen offset:2048 lds
buffer_load_dwordx4 v119,s[8:11],s45 offen offset:3072 lds
s_mov_b32 m0,45056
s_nop 0
buffer_load_dwordx4 v120,s[8:11],s45 offen offset:0 lds
buffer_load_dwordx4 v121,s[8:11],s45 offen offset:1024 lds
buffer_load_dwordx4 v122,s[8:11],s45 offen offset:2048 lds
buffer_load_dwordx4 v123,s[8:11],s45 offen offset:3072 lds
s_add_u32 s45,s45,110592
s_cmp_ge_u32 s45,1990656
s_cselect_b32 s40,1990656,0
s_sub_u32 s45,s45,s40
s_mov_b32 m0,61440
s_nop 0
buffer_load_dwordx4 v112,s[8:11],s45 offen offset:0 lds
buffer_load_dwordx4 v113,s[8:11],s45 offen offset:1024 lds
buffer_load_dwordx4 v114,s[8:11],s45 offen offset:2048 lds
buffer_load_dwordx4 v115,s[8:11],s45 offen offset:3072 lds
s_mov_b32 m0,65536
s_nop 0
buffer_load_dwordx4 v116,s[8:11],s45 offen offset:0 lds
buffer_load_dwordx4 v117,s[8:11],s45 offen offset:1024 lds
buffer_load_dwordx4 v118,s[8:11],s45 offen offset:2048 lds
buffer_load_dwordx4 v119,s[8:11],s45 offen offset:3072 lds
s_mov_b32 m0,69632
s_nop 0
buffer_load_dwordx4 v120,s[8:11],s45 offen offset:0 lds
buffer_load_dwordx4 v121,s[8:11],s45 offen offset:1024 lds
buffer_load_dwordx4 v122,s[8:11],s45 offen offset:2048 lds
buffer_load_dwordx4 v123,s[8:11],s45 offen offset:3072 lds
s_waitcnt vmcnt(24)
s_barrier
s_add_u32 s46,s44,1
s_cmp_ge_u32 s46,9
s_cselect_b32 s37,9,0
s_sub_u32 s46,s46,s37
s_lshl_b32 s46,s46,7
s_mov_b32 m0,138240
s_nop 0
buffer_load_dwordx4 v65,s[4:7],s46 offen lds
s_mov_b32 m0,139264
s_nop 0
buffer_load_dwordx4 v66,s[4:7],s46 offen lds
s_mov_b32 m0,140288
s_nop 0
buffer_load_dwordx4 v67,s[4:7],s46 offen lds
s_mov_b32 m0,141312
s_nop 0
buffer_load_dwordx4 v68,s[4:7],s46 offen lds
s_mov_b32 m0,142336
s_nop 0
buffer_load_dwordx4 v69,s[4:7],s46 offen lds
s_add_u32 s45,s45,110592
s_cmp_ge_u32 s45,1990656
s_cselect_b32 s40,1990656,0
s_sub_u32 s45,s45,s40
s_mov_b32 m0,86016
s_nop 0
buffer_load_dwordx4 v112,s[8:11],s45 offen offset:0 lds
buffer_load_dwordx4 v113,s[8:11],s45 offen offset:1024 lds
buffer_load_dwordx4 v114,s[8:11],s45 offen offset:2048 lds
buffer_load_dwordx4 v115,s[8:11],s45 offen offset:3072 lds
s_mov_b32 m0,90112
s_nop 0
buffer_load_dwordx4 v116,s[8:11],s45 offen offset:0 lds
buffer_load_dwordx4 v117,s[8:11],s45 offen offset:1024 lds
buffer_load_dwordx4 v118,s[8:11],s45 offen offset:2048 lds
buffer_load_dwordx4 v119,s[8:11],s45 offen offset:3072 lds
s_mov_b32 m0,94208
s_nop 0
buffer_load_dwordx4 v120,s[8:11],s45 offen offset:0 lds
buffer_load_dwordx4 v121,s[8:11],s45 offen offset:1024 lds
buffer_load_dwordx4 v122,s[8:11],s45 offen offset:2048 lds
buffer_load_dwordx4 v123,s[8:11],s45 offen offset:3072 lds
s_waitcnt vmcnt(29)
s_barrier
s_add_u32 s45,s45,110592
s_cmp_ge_u32 s45,1990656
s_cselect_b32 s40,1990656,0
s_sub_u32 s45,s45,s40
s_mov_b32 m0,110592
s_nop 0
buffer_load_dwordx4 v112,s[8:11],s45 offen offset:0 lds
buffer_load_dwordx4 v113,s[8:11],s45 offen offset:1024 lds
buffer_load_dwordx4 v114,s[8:11],s45 offen offset:2048 lds
buffer_load_dwordx4 v115,s[8:11],s45 offen offset:3072 lds
s_mov_b32 m0,114688
s_nop 0
buffer_load_dwordx4 v116,s[8:11],s45 offen offset:0 lds
buffer_load_dwordx4 v117,s[8:11],s45 offen offset:1024 lds
buffer_load_dwordx4 v118,s[8:11],s45 offen offset:2048 lds
buffer_load_dwordx4 v119,s[8:11],s45 offen offset:3072 lds
s_mov_b32 m0,118784
s_nop 0
buffer_load_dwordx4 v120,s[8:11],s45 offen offset:0 lds
buffer_load_dwordx4 v121,s[8:11],s45 offen offset:1024 lds
buffer_load_dwordx4 v122,s[8:11],s45 offen offset:2048 lds
buffer_load_dwordx4 v123,s[8:11],s45 offen offset:3072 lds
s_waitcnt vmcnt(24)
s_barrier
s_add_u32 s46,s44,2
s_cmp_ge_u32 s46,9
s_cselect_b32 s37,9,0
s_sub_u32 s46,s46,s37
s_lshl_b32 s46,s46,7
s_mov_b32 m0,148480
s_nop 0
buffer_load_dwordx4 v65,s[4:7],s46 offen lds
s_mov_b32 m0,149504
s_nop 0
buffer_load_dwordx4 v66,s[4:7],s46 offen lds
s_mov_b32 m0,150528
s_nop 0
buffer_load_dwordx4 v67,s[4:7],s46 offen lds
s_mov_b32 m0,151552
s_nop 0
buffer_load_dwordx4 v68,s[4:7],s46 offen lds
s_mov_b32 m0,152576
s_nop 0
buffer_load_dwordx4 v69,s[4:7],s46 offen lds
s_add_u32 s45,s45,110592
s_cmp_ge_u32 s45,1990656
s_cselect_b32 s40,1990656,0
s_sub_u32 s45,s45,s40
s_mov_b32 m0,12288
s_nop 0
buffer_load_dwordx4 v112,s[8:11],s45 offen offset:0 lds
buffer_load_dwordx4 v113,s[8:11],s45 offen offset:1024 lds
buffer_load_dwordx4 v114,s[8:11],s45 offen offset:2048 lds
buffer_load_dwordx4 v115,s[8:11],s45 offen offset:3072 lds
s_mov_b32 m0,16384
s_nop 0
buffer_load_dwordx4 v116,s[8:11],s45 offen offset:0 lds
buffer_load_dwordx4 v117,s[8:11],s45 offen offset:1024 lds
buffer_load_dwordx4 v118,s[8:11],s45 offen offset:2048 lds
buffer_load_dwordx4 v119,s[8:11],s45 offen offset:3072 lds
s_mov_b32 m0,20480
s_nop 0
buffer_load_dwordx4 v120,s[8:11],s45 offen offset:0 lds
buffer_load_dwordx4 v121,s[8:11],s45 offen offset:1024 lds
buffer_load_dwordx4 v122,s[8:11],s45 offen offset:2048 lds
buffer_load_dwordx4 v123,s[8:11],s45 offen offset:3072 lds
s_waitcnt vmcnt(29)
s_barrier
s_add_u32 s45,s45,110592
s_cmp_ge_u32 s45,1990656
s_cselect_b32 s40,1990656,0
s_sub_u32 s45,s45,s40
s_mov_b32 m0,36864
s_nop 0
buffer_load_dwordx4 v112,s[8:11],s45 offen offset:0 lds
buffer_load_dwordx4 v113,s[8:11],s45 offen offset:1024 lds
buffer_load_dwordx4 v114,s[8:11],s45 offen offset:2048 lds
buffer_load_dwordx4 v115,s[8:11],s45 offen offset:3072 lds
s_mov_b32 m0,40960
s_nop 0
buffer_load_dwordx4 v116,s[8:11],s45 offen offset:0 lds
buffer_load_dwordx4 v117,s[8:11],s45 offen offset:1024 lds
buffer_load_dwordx4 v118,s[8:11],s45 offen offset:2048 lds
buffer_load_dwordx4 v119,s[8:11],s45 offen offset:3072 lds
s_mov_b32 m0,45056
s_nop 0
buffer_load_dwordx4 v120,s[8:11],s45 offen offset:0 lds
buffer_load_dwordx4 v121,s[8:11],s45 offen offset:1024 lds
buffer_load_dwordx4 v122,s[8:11],s45 offen offset:2048 lds
buffer_load_dwordx4 v123,s[8:11],s45 offen offset:3072 lds
s_waitcnt vmcnt(24)
s_barrier
s_add_u32 s46,s44,3
s_cmp_ge_u32 s46,9
s_cselect_b32 s37,9,0
s_sub_u32 s46,s46,s37
s_lshl_b32 s46,s46,7
s_mov_b32 m0,128000
s_nop 0
buffer_load_dwordx4 v65,s[4:7],s46 offen lds
s_mov_b32 m0,129024
s_nop 0
buffer_load_dwordx4 v66,s[4:7],s46 offen lds
s_mov_b32 m0,130048
s_nop 0
buffer_load_dwordx4 v67,s[4:7],s46 offen lds
s_mov_b32 m0,131072
s_nop 0
buffer_load_dwordx4 v68,s[4:7],s46 offen lds
s_mov_b32 m0,132096
s_nop 0
buffer_load_dwordx4 v69,s[4:7],s46 offen lds
s_add_u32 s45,s45,110592
s_cmp_ge_u32 s45,1990656
s_cselect_b32 s40,1990656,0
s_sub_u32 s45,s45,s40
s_mov_b32 m0,61440
s_nop 0
buffer_load_dwordx4 v112,s[8:11],s45 offen offset:0 lds
buffer_load_dwordx4 v113,s[8:11],s45 offen offset:1024 lds
buffer_load_dwordx4 v114,s[8:11],s45 offen offset:2048 lds
buffer_load_dwordx4 v115,s[8:11],s45 offen offset:3072 lds
s_mov_b32 m0,65536
s_nop 0
buffer_load_dwordx4 v116,s[8:11],s45 offen offset:0 lds
buffer_load_dwordx4 v117,s[8:11],s45 offen offset:1024 lds
buffer_load_dwordx4 v118,s[8:11],s45 offen offset:2048 lds
buffer_load_dwordx4 v119,s[8:11],s45 offen offset:3072 lds
s_mov_b32 m0,69632
s_nop 0
buffer_load_dwordx4 v120,s[8:11],s45 offen offset:0 lds
buffer_load_dwordx4 v121,s[8:11],s45 offen offset:1024 lds
buffer_load_dwordx4 v122,s[8:11],s45 offen offset:2048 lds
buffer_load_dwordx4 v123,s[8:11],s45 offen offset:3072 lds
s_waitcnt vmcnt(29)
s_barrier
s_add_u32 s45,s45,110592
s_cmp_ge_u32 s45,1990656
s_cselect_b32 s40,1990656,0
s_sub_u32 s45,s45,s40
s_mov_b32 m0,86016
s_nop 0
buffer_load_dwordx4 v112,s[8:11],s45 offen offset:0 lds
buffer_load_dwordx4 v113,s[8:11],s45 offen offset:1024 lds
buffer_load_dwordx4 v114,s[8:11],s45 offen offset:2048 lds
buffer_load_dwordx4 v115,s[8:11],s45 offen offset:3072 lds
s_mov_b32 m0,90112
s_nop 0
buffer_load_dwordx4 v116,s[8:11],s45 offen offset:0 lds
buffer_load_dwordx4 v117,s[8:11],s45 offen offset:1024 lds
buffer_load_dwordx4 v118,s[8:11],s45 offen offset:2048 lds
buffer_load_dwordx4 v119,s[8:11],s45 offen offset:3072 lds
s_mov_b32 m0,94208
s_nop 0
buffer_load_dwordx4 v120,s[8:11],s45 offen offset:0 lds
buffer_load_dwordx4 v121,s[8:11],s45 offen offset:1024 lds
buffer_load_dwordx4 v122,s[8:11],s45 offen offset:2048 lds
buffer_load_dwordx4 v123,s[8:11],s45 offen offset:3072 lds
s_waitcnt vmcnt(24)
s_barrier
s_add_u32 s46,s44,4
s_cmp_ge_u32 s46,9
s_cselect_b32 s37,9,0
s_sub_u32 s46,s46,s37
s_lshl_b32 s46,s46,7
s_mov_b32 m0,138240
s_nop 0
buffer_load_dwordx4 v65,s[4:7],s46 offen lds
s_mov_b32 m0,139264
s_nop 0
buffer_load_dwordx4 v66,s[4:7],s46 offen lds
s_mov_b32 m0,140288
s_nop 0
buffer_load_dwordx4 v67,s[4:7],s46 offen lds
s_mov_b32 m0,141312
s_nop 0
buffer_load_dwordx4 v68,s[4:7],s46 offen lds
s_mov_b32 m0,142336
s_nop 0
buffer_load_dwordx4 v69,s[4:7],s46 offen lds
s_add_u32 s45,s45,110592
s_cmp_ge_u32 s45,1990656
s_cselect_b32 s40,1990656,0
s_sub_u32 s45,s45,s40
s_mov_b32 m0,110592
s_nop 0
buffer_load_dwordx4 v112,s[8:11],s45 offen offset:0 lds
buffer_load_dwordx4 v113,s[8:11],s45 offen offset:1024 lds
buffer_load_dwordx4 v114,s[8:11],s45 offen offset:2048 lds
buffer_load_dwordx4 v115,s[8:11],s45 offen offset:3072 lds
s_mov_b32 m0,114688
s_nop 0
buffer_load_dwordx4 v116,s[8:11],s45 offen offset:0 lds
buffer_load_dwordx4 v117,s[8:11],s45 offen offset:1024 lds
buffer_load_dwordx4 v118,s[8:11],s45 offen offset:2048 lds
buffer_load_dwordx4 v119,s[8:11],s45 offen offset:3072 lds
s_mov_b32 m0,118784
s_nop 0
buffer_load_dwordx4 v120,s[8:11],s45 offen offset:0 lds
buffer_load_dwordx4 v121,s[8:11],s45 offen offset:1024 lds
buffer_load_dwordx4 v122,s[8:11],s45 offen offset:2048 lds
buffer_load_dwordx4 v123,s[8:11],s45 offen offset:3072 lds
s_waitcnt vmcnt(29)
s_barrier
s_add_u32 s45,s45,110592
s_cmp_ge_u32 s45,1990656
s_cselect_b32 s40,1990656,0
s_sub_u32 s45,s45,s40
s_mov_b32 m0,12288
s_nop 0
buffer_load_dwordx4 v112,s[8:11],s45 offen offset:0 lds
buffer_load_dwordx4 v113,s[8:11],s45 offen offset:1024 lds
buffer_load_dwordx4 v114,s[8:11],s45 offen offset:2048 lds
buffer_load_dwordx4 v115,s[8:11],s45 offen offset:3072 lds
s_mov_b32 m0,16384
s_nop 0
buffer_load_dwordx4 v116,s[8:11],s45 offen offset:0 lds
buffer_load_dwordx4 v117,s[8:11],s45 offen offset:1024 lds
buffer_load_dwordx4 v118,s[8:11],s45 offen offset:2048 lds
buffer_load_dwordx4 v119,s[8:11],s45 offen offset:3072 lds
s_mov_b32 m0,20480
s_nop 0
buffer_load_dwordx4 v120,s[8:11],s45 offen offset:0 lds
buffer_load_dwordx4 v121,s[8:11],s45 offen offset:1024 lds
buffer_load_dwordx4 v122,s[8:11],s45 offen offset:2048 lds
buffer_load_dwordx4 v123,s[8:11],s45 offen offset:3072 lds
s_waitcnt vmcnt(24)
s_barrier
s_add_u32 s46,s44,5
s_cmp_ge_u32 s46,9
s_cselect_b32 s37,9,0
s_sub_u32 s46,s46,s37
s_lshl_b32 s46,s46,7
s_mov_b32 m0,148480
s_nop 0
buffer_load_dwordx4 v65,s[4:7],s46 offen lds
s_mov_b32 m0,149504
s_nop 0
buffer_load_dwordx4 v66,s[4:7],s46 offen lds
s_mov_b32 m0,150528
s_nop 0
buffer_load_dwordx4 v67,s[4:7],s46 offen lds
s_mov_b32 m0,151552
s_nop 0
buffer_load_dwordx4 v68,s[4:7],s46 offen lds
s_mov_b32 m0,152576
s_nop 0
buffer_load_dwordx4 v69,s[4:7],s46 offen lds
s_add_u32 s45,s45,110592
s_cmp_ge_u32 s45,1990656
s_cselect_b32 s40,1990656,0
s_sub_u32 s45,s45,s40
s_mov_b32 m0,36864
s_nop 0
buffer_load_dwordx4 v112,s[8:11],s45 offen offset:0 lds
buffer_load_dwordx4 v113,s[8:11],s45 offen offset:1024 lds
buffer_load_dwordx4 v114,s[8:11],s45 offen offset:2048 lds
buffer_load_dwordx4 v115,s[8:11],s45 offen offset:3072 lds
s_mov_b32 m0,40960
s_nop 0
buffer_load_dwordx4 v116,s[8:11],s45 offen offset:0 lds
buffer_load_dwordx4 v117,s[8:11],s45 offen offset:1024 lds
buffer_load_dwordx4 v118,s[8:11],s45 offen offset:2048 lds
buffer_load_dwordx4 v119,s[8:11],s45 offen offset:3072 lds
s_mov_b32 m0,45056
s_nop 0
buffer_load_dwordx4 v120,s[8:11],s45 offen offset:0 lds
buffer_load_dwordx4 v121,s[8:11],s45 offen offset:1024 lds
buffer_load_dwordx4 v122,s[8:11],s45 offen offset:2048 lds
buffer_load_dwordx4 v123,s[8:11],s45 offen offset:3072 lds
s_waitcnt vmcnt(29)
s_barrier
s_add_u32 s45,s45,110592
s_cmp_ge_u32 s45,1990656
s_cselect_b32 s40,1990656,0
s_sub_u32 s45,s45,s40
s_mov_b32 m0,61440
s_nop 0
buffer_load_dwordx4 v112,s[8:11],s45 offen offset:0 lds
buffer_load_dwordx4 v113,s[8:11],s45 offen offset:1024 lds
buffer_load_dwordx4 v114,s[8:11],s45 offen offset:2048 lds
buffer_load_dwordx4 v115,s[8:11],s45 offen offset:3072 lds
s_mov_b32 m0,65536
s_nop 0
buffer_load_dwordx4 v116,s[8:11],s45 offen offset:0 lds
buffer_load_dwordx4 v117,s[8:11],s45 offen offset:1024 lds
buffer_load_dwordx4 v118,s[8:11],s45 offen offset:2048 lds
buffer_load_dwordx4 v119,s[8:11],s45 offen offset:3072 lds
s_mov_b32 m0,69632
s_nop 0
buffer_load_dwordx4 v120,s[8:11],s45 offen offset:0 lds
buffer_load_dwordx4 v121,s[8:11],s45 offen offset:1024 lds
buffer_load_dwordx4 v122,s[8:11],s45 offen offset:2048 lds
buffer_load_dwordx4 v123,s[8:11],s45 offen offset:3072 lds
s_waitcnt vmcnt(24)
s_barrier
s_add_u32 s46,s44,6
s_cmp_ge_u32 s46,9
s_cselect_b32 s37,9,0
s_sub_u32 s46,s46,s37
s_lshl_b32 s46,s46,7
s_mov_b32 m0,128000
s_nop 0
buffer_load_dwordx4 v65,s[4:7],s46 offen lds
s_mov_b32 m0,129024
s_nop 0
buffer_load_dwordx4 v66,s[4:7],s46 offen lds
s_mov_b32 m0,130048
s_nop 0
buffer_load_dwordx4 v67,s[4:7],s46 offen lds
s_mov_b32 m0,131072
s_nop 0
buffer_load_dwordx4 v68,s[4:7],s46 offen lds
s_mov_b32 m0,132096
s_nop 0
buffer_load_dwordx4 v69,s[4:7],s46 offen lds
s_add_u32 s45,s45,110592
s_cmp_ge_u32 s45,1990656
s_cselect_b32 s40,1990656,0
s_sub_u32 s45,s45,s40
s_mov_b32 m0,86016
s_nop 0
buffer_load_dwordx4 v112,s[8:11],s45 offen offset:0 lds
buffer_load_dwordx4 v113,s[8:11],s45 offen offset:1024 lds
buffer_load_dwordx4 v114,s[8:11],s45 offen offset:2048 lds
buffer_load_dwordx4 v115,s[8:11],s45 offen offset:3072 lds
s_mov_b32 m0,90112
s_nop 0
buffer_load_dwordx4 v116,s[8:11],s45 offen offset:0 lds
buffer_load_dwordx4 v117,s[8:11],s45 offen offset:1024 lds
buffer_load_dwordx4 v118,s[8:11],s45 offen offset:2048 lds
buffer_load_dwordx4 v119,s[8:11],s45 offen offset:3072 lds
s_mov_b32 m0,94208
s_nop 0
buffer_load_dwordx4 v120,s[8:11],s45 offen offset:0 lds
buffer_load_dwordx4 v121,s[8:11],s45 offen offset:1024 lds
buffer_load_dwordx4 v122,s[8:11],s45 offen offset:2048 lds
buffer_load_dwordx4 v123,s[8:11],s45 offen offset:3072 lds
s_waitcnt vmcnt(29)
s_barrier
s_add_u32 s45,s45,110592
s_cmp_ge_u32 s45,1990656
s_cselect_b32 s40,1990656,0
s_sub_u32 s45,s45,s40
s_mov_b32 m0,110592
s_nop 0
buffer_load_dwordx4 v112,s[8:11],s45 offen offset:0 lds
buffer_load_dwordx4 v113,s[8:11],s45 offen offset:1024 lds
buffer_load_dwordx4 v114,s[8:11],s45 offen offset:2048 lds
buffer_load_dwordx4 v115,s[8:11],s45 offen offset:3072 lds
s_mov_b32 m0,114688
s_nop 0
buffer_load_dwordx4 v116,s[8:11],s45 offen offset:0 lds
buffer_load_dwordx4 v117,s[8:11],s45 offen offset:1024 lds
buffer_load_dwordx4 v118,s[8:11],s45 offen offset:2048 lds
buffer_load_dwordx4 v119,s[8:11],s45 offen offset:3072 lds
s_mov_b32 m0,118784
s_nop 0
buffer_load_dwordx4 v120,s[8:11],s45 offen offset:0 lds
buffer_load_dwordx4 v121,s[8:11],s45 offen offset:1024 lds
buffer_load_dwordx4 v122,s[8:11],s45 offen offset:2048 lds
buffer_load_dwordx4 v123,s[8:11],s45 offen offset:3072 lds
s_waitcnt vmcnt(24)
s_barrier
s_add_u32 s46,s44,7
s_cmp_ge_u32 s46,9
s_cselect_b32 s37,9,0
s_sub_u32 s46,s46,s37
s_lshl_b32 s46,s46,7
s_mov_b32 m0,138240
s_nop 0
buffer_load_dwordx4 v65,s[4:7],s46 offen lds
s_mov_b32 m0,139264
s_nop 0
buffer_load_dwordx4 v66,s[4:7],s46 offen lds
s_mov_b32 m0,140288
s_nop 0
buffer_load_dwordx4 v67,s[4:7],s46 offen lds
s_mov_b32 m0,141312
s_nop 0
buffer_load_dwordx4 v68,s[4:7],s46 offen lds
s_mov_b32 m0,142336
s_nop 0
buffer_load_dwordx4 v69,s[4:7],s46 offen lds
s_add_u32 s45,s45,110592
s_cmp_ge_u32 s45,1990656
s_cselect_b32 s40,1990656,0
s_sub_u32 s45,s45,s40
s_mov_b32 m0,12288
s_nop 0
buffer_load_dwordx4 v112,s[8:11],s45 offen offset:0 lds
buffer_load_dwordx4 v113,s[8:11],s45 offen offset:1024 lds
buffer_load_dwordx4 v114,s[8:11],s45 offen offset:2048 lds
buffer_load_dwordx4 v115,s[8:11],s45 offen offset:3072 lds
s_mov_b32 m0,16384
s_nop 0
buffer_load_dwordx4 v116,s[8:11],s45 offen offset:0 lds
buffer_load_dwordx4 v117,s[8:11],s45 offen offset:1024 lds
buffer_load_dwordx4 v118,s[8:11],s45 offen offset:2048 lds
buffer_load_dwordx4 v119,s[8:11],s45 offen offset:3072 lds
s_mov_b32 m0,20480
s_nop 0
buffer_load_dwordx4 v120,s[8:11],s45 offen offset:0 lds
buffer_load_dwordx4 v121,s[8:11],s45 offen offset:1024 lds
buffer_load_dwordx4 v122,s[8:11],s45 offen offset:2048 lds
buffer_load_dwordx4 v123,s[8:11],s45 offen offset:3072 lds
s_waitcnt vmcnt(29)
s_barrier
s_add_u32 s45,s45,110592
s_cmp_ge_u32 s45,1990656
s_cselect_b32 s40,1990656,0
s_sub_u32 s45,s45,s40
s_mov_b32 m0,36864
s_nop 0
buffer_load_dwordx4 v112,s[8:11],s45 offen offset:0 lds
buffer_load_dwordx4 v113,s[8:11],s45 offen offset:1024 lds
buffer_load_dwordx4 v114,s[8:11],s45 offen offset:2048 lds
buffer_load_dwordx4 v115,s[8:11],s45 offen offset:3072 lds
s_mov_b32 m0,40960
s_nop 0
buffer_load_dwordx4 v116,s[8:11],s45 offen offset:0 lds
buffer_load_dwordx4 v117,s[8:11],s45 offen offset:1024 lds
buffer_load_dwordx4 v118,s[8:11],s45 offen offset:2048 lds
buffer_load_dwordx4 v119,s[8:11],s45 offen offset:3072 lds
s_mov_b32 m0,45056
s_nop 0
buffer_load_dwordx4 v120,s[8:11],s45 offen offset:0 lds
buffer_load_dwordx4 v121,s[8:11],s45 offen offset:1024 lds
buffer_load_dwordx4 v122,s[8:11],s45 offen offset:2048 lds
buffer_load_dwordx4 v123,s[8:11],s45 offen offset:3072 lds
s_waitcnt vmcnt(24)
s_barrier
s_add_u32 s46,s44,8
s_cmp_ge_u32 s46,9
s_cselect_b32 s37,9,0
s_sub_u32 s46,s46,s37
s_lshl_b32 s46,s46,7
s_mov_b32 m0,148480
s_nop 0
buffer_load_dwordx4 v65,s[4:7],s46 offen lds
s_mov_b32 m0,149504
s_nop 0
buffer_load_dwordx4 v66,s[4:7],s46 offen lds
s_mov_b32 m0,150528
s_nop 0
buffer_load_dwordx4 v67,s[4:7],s46 offen lds
s_mov_b32 m0,151552
s_nop 0
buffer_load_dwordx4 v68,s[4:7],s46 offen lds
s_mov_b32 m0,152576
s_nop 0
buffer_load_dwordx4 v69,s[4:7],s46 offen lds
s_add_u32 s45,s45,110592
s_cmp_ge_u32 s45,1990656
s_cselect_b32 s40,1990656,0
s_sub_u32 s45,s45,s40
s_mov_b32 m0,61440
s_nop 0
buffer_load_dwordx4 v112,s[8:11],s45 offen offset:0 lds
buffer_load_dwordx4 v113,s[8:11],s45 offen offset:1024 lds
buffer_load_dwordx4 v114,s[8:11],s45 offen offset:2048 lds
buffer_load_dwordx4 v115,s[8:11],s45 offen offset:3072 lds
s_mov_b32 m0,65536
s_nop 0
buffer_load_dwordx4 v116,s[8:11],s45 offen offset:0 lds
buffer_load_dwordx4 v117,s[8:11],s45 offen offset:1024 lds
buffer_load_dwordx4 v118,s[8:11],s45 offen offset:2048 lds
buffer_load_dwordx4 v119,s[8:11],s45 offen offset:3072 lds
s_mov_b32 m0,69632
s_nop 0
buffer_load_dwordx4 v120,s[8:11],s45 offen offset:0 lds
buffer_load_dwordx4 v121,s[8:11],s45 offen offset:1024 lds
buffer_load_dwordx4 v122,s[8:11],s45 offen offset:2048 lds
buffer_load_dwordx4 v123,s[8:11],s45 offen offset:3072 lds
s_mov_b32 s16,s24
s_mov_b32 s17,s25
s_mov_b32 s18,663552
s_mov_b32 s19,0x20000
v_lshrrev_b32 v10,4,v252
s_lshl_b32 s37,s2,2
v_add_u32 v10,s37,v10
v_mul_u32_u24 v11,1152,v10
v_and_b32 v12,15,v252
v_mul_u32_u24 v12,72,v12
v_add_u32 v11,v11,v12
buffer_load_dwordx2 v[14:15],v11,s[16:19],0 offen offset:0
buffer_load_dwordx2 v[16:17],v11,s[16:19],0 offen offset:8
buffer_load_dwordx2 v[18:19],v11,s[16:19],0 offen offset:16
buffer_load_dwordx2 v[20:21],v11,s[16:19],0 offen offset:24
buffer_load_dwordx2 v[22:23],v11,s[16:19],0 offen offset:32
buffer_load_dwordx2 v[24:25],v11,s[16:19],0 offen offset:40
buffer_load_dwordx2 v[26:27],v11,s[16:19],0 offen offset:48
buffer_load_dwordx2 v[28:29],v11,s[16:19],0 offen offset:56
buffer_load_dwordx2 v[30:31],v11,s[16:19],0 offen offset:64
s_waitcnt vmcnt(38)
s_barrier
s_waitcnt vmcnt(21)
s_barrier
s_waitcnt vmcnt(9)
s_barrier
s_barrier
s_waitcnt vmcnt(0)
s_mov_b32 s42,0x3f803f80
v_mov_b32 v6,0
v_dot2_f32_bf16 v6,v14,s42,v6
v_dot2_f32_bf16 v6,v15,s42,v6
v_dot2_f32_bf16 v6,v16,s42,v6
v_dot2_f32_bf16 v6,v17,s42,v6
v_dot2_f32_bf16 v6,v18,s42,v6
v_dot2_f32_bf16 v6,v19,s42,v6
v_dot2_f32_bf16 v6,v20,s42,v6
v_dot2_f32_bf16 v6,v21,s42,v6
v_dot2_f32_bf16 v6,v22,s42,v6
v_dot2_f32_bf16 v6,v23,s42,v6
v_dot2_f32_bf16 v6,v24,s42,v6
v_dot2_f32_bf16 v6,v25,s42,v6
v_dot2_f32_bf16 v6,v26,s42,v6
v_dot2_f32_bf16 v6,v27,s42,v6
v_dot2_f32_bf16 v6,v28,s42,v6
v_dot2_f32_bf16 v6,v29,s42,v6
v_dot2_f32_bf16 v6,v30,s42,v6
v_dot2_f32_bf16 v6,v31,s42,v6
s_nop 2
v_add_f32_dpp v6,v6,v6 row_ror:8 row_mask:0xf bank_mask:0xf
s_nop 2
v_add_f32_dpp v6,v6,v6 row_ror:4 row_mask:0xf bank_mask:0xf
s_nop 2
v_add_f32_dpp v6,v6,v6 row_ror:2 row_mask:0xf bank_mask:0xf
s_nop 2
v_add_f32_dpp v6,v6,v6 row_ror:1 row_mask:0xf bank_mask:0xf
s_mov_b32 s37,987991609
v_mul_f32 v6,s37,v6
v_cvt_pk_bf16_f32 v6,v6,v6
s_add_u32 s16,s26,4866048
s_addc_u32 s17,s27,0
s_mov_b32 s18,1152
s_mov_b32 s19,0x20000
v_lshlrev_b32 v7,1,v10
s_mov_b32 exec_lo,0x00010001
s_mov_b32 exec_hi,0x00010001
buffer_store_short v6,v7,s[16:19],0 offen
s_mov_b64 exec,-1
s_barrier
s_barrier
s_mov_b32 s12,s26
s_mov_b32 s13,s27
s_mov_b32 s14,2359296
s_mov_b32 s15,0x20000
s_lshl_b32 s37,s34,6
v_add_u32 v200,s37,v252
v_and_b32 v201,15,v200
v_lshrrev_b32 v200,4,v200
v_mul_u32_u24 v202,57,v200
v_lshrrev_b32 v202,9,v202
v_mul_u32_u24 v203,9,v202
v_sub_u32 v200,v200,v203
v_lshl_add_u32 v203,v202,4,v201
v_mul_u32_u24 v203,144,v203
v_lshl_add_u32 v203,v200,4,v203
ds_read_b128 v[204:207],v203 offset:56320
s_mul_i32 s38,s35,9
v_add_u32 v200,s38,v200
s_lshl_b32 s38,s36,2
v_add_u32 v202,s38,v202
v_mul_u32_u24 v202,72,v202
v_add_u32 v202,v202,v200
v_lshl_add_u32 v202,v202,4,v201
v_lshlrev_b32 v202,4,v202
s_waitcnt lgkmcnt(0)
buffer_store_dwordx4 v[204:207],v202,s[12:15],0 offen sc1
s_endpgm
attn_kernel_done:
s_endpgm
.section .rodata,"a"
.p2align 6
.amdhsa_kernel attn_kernel
.amdhsa_next_free_vgpr 256
.amdhsa_next_free_sgpr 96
.amdhsa_accum_offset 256
.amdhsa_group_segment_fixed_size 0
.amdhsa_kernarg_size 80
.amdhsa_user_sgpr_count 2
.amdhsa_user_sgpr_kernarg_segment_ptr 1
.amdhsa_system_sgpr_workgroup_id_x 1
.amdhsa_float_denorm_mode_32 3
.end_amdhsa_kernel
.text
attn_kernel_end:
.globl ffn_kernel
.p2align 8
.type ffn_kernel,@function
ffn_kernel:
s_cmp_ge_u32 s2,256
s_cbranch_scc1 ffn_kernel_done
v_mov_b32 v200,v0
s_getpc_b64 s[60:61]
ffn_kernel_pc:
v_lshrrev_b32 v202,4,v0
s_lshr_b32 s3,s2,3
s_lshl_b32 s3,s3,5
v_add_lshl_u32 v202,s3,v202,7
v_min_u32 v202,ffn_kernel_end-ffn_kernel-4,v202
s_sub_u32 s60,s60,ffn_kernel_pc-ffn_kernel
s_subb_u32 s61,s61,0
v_mov_b32 v203,s61
v_add_co_u32 v202,vcc,s60,v202
s_nop 1
v_addc_co_u32 v203,vcc,0,v203,vcc
global_load_dword v204,v[202:203],off
oproj_part:
s_cmp_ge_u32 s2,216
s_cbranch_scc1 ffn_kernel_main
s_load_dwordx2 s[20:21],s[0:1],0
s_load_dwordx2 s[22:23],s[0:1],16
s_load_dwordx2 s[24:25],s[0:1],72
v_lshrrev_b32 v1,6,v0
v_and_b32 v94,63,v0
v_readfirstlane_b32 s26,v1
s_lshr_b32 s30,s2,3
s_mul_i32 s31,s30,57
s_lshr_b32 s31,s31,9
s_mul_i32 s28,s31,9
s_sub_u32 s28,s30,s28
s_mul_i32 s31,s31,6
s_min_u32 s31,s31,10
s_and_b32 s27,s2,7
s_lshl_b32 s27,s27,4
s_add_u32 s27,s27,s31
v_lshlrev_b32 v95,4,v94
s_cmp_eq_u32 s26,6
s_cbranch_scc1 oproj_part_ld0
s_cmp_eq_u32 s26,7
s_cbranch_scc1 oproj_part_ld1
s_and_b32 s33,s26,1
s_and_b32 s29,s26,6
s_mul_i32 s31,s29,3072
s_add_u32 s31,s31,88064
v_add_u32 v101,s31,v95
v_lshrrev_b32 v97,4,v94
v_and_b32 v102,15,v94
s_add_u32 s30,s27,s29
s_lshl_b32 s30,s30,4
v_add_u32 v96,s30,v102
v_lshlrev_b32 v110,2,v96
s_waitcnt lgkmcnt(0)
s_add_u32 s16,s24,4849664
s_addc_u32 s17,s25,0
s_mov_b32 s18,8192
s_mov_b32 s19,0x20000
buffer_load_dword v88,v110,s[16:19],0 offen offset:0
buffer_load_dword v89,v110,s[16:19],0 offen offset:64
v_bfe_u32 v112,v94,2,2
v_lshl_add_u32 v113,v97,3,v112
v_lshlrev_b32 v113,7,v113
v_and_b32 v114,3,v94
v_lshl_add_u32 v113,v114,3,v113
v_lshrrev_b32 v112,1,v112
v_and_b32 v114,1,v97
v_lshl_or_b32 v112,v114,1,v112
s_lshl_b32 s30,s33,1
v_xor_b32 v112,s30,v112
v_lshl_add_u32 v90,v112,5,v113
v_xor_b32 v91,32,v90
v_add_u32 v92,0x10000,v90
v_add_u32 v93,0x10000,v91
v_lshlrev_b32 v98,4,v97
v_add_u32 v98,73728,v98
s_lshl_b32 s30,s29,4
v_add_u32 v112,s30,v102
v_lshlrev_b32 v112,7,v112
v_lshrrev_b32 v113,1,v97
s_lshl_b32 s30,s33,2
v_or_b32 v113,s30,v113
v_and_b32 v114,7,v102
v_xor_b32 v113,v113,v114
v_lshl_add_u32 v112,v113,4,v112
v_and_b32 v114,1,v97
v_lshl_add_u32 v112,v114,3,v112
v_add_u32 v100,75776,v112
s_add_u32 s36,s24,2359296
s_addc_u32 s37,s25,0
s_mov_b32 s38,2359296
s_mov_b32 s39,0x20000
s_add_u32 s40,s24,5636096
s_addc_u32 s41,s25,0
s_mov_b32 s42,147456
s_mov_b32 s43,0x20000
s_barrier
ds_read_b64_tr_b16 v[24:25],v90 offset:0
ds_read_b64_tr_b16 v[26:27],v90 offset:512
ds_read_b64_tr_b16 v[28:29],v91 offset:0
ds_read_b64_tr_b16 v[30:31],v91 offset:512
ds_read_b128 v[0:3],v101 offset:0
ds_read_b128 v[4:7],v101 offset:3072
ds_read_b128 v[32:35],v98 offset:0
ds_read_b64_tr_b16 v[36:37],v90 offset:4096
ds_read_b64_tr_b16 v[38:39],v90 offset:4608
ds_read_b64_tr_b16 v[40:41],v91 offset:4096
ds_read_b64_tr_b16 v[42:43],v91 offset:4608
ds_read_b128 v[8:11],v101 offset:1024
ds_read_b128 v[12:15],v101 offset:4096
ds_read_b128 v[44:47],v98 offset:64
s_cmp_eq_u32 s33,1
s_cbranch_scc1 oproj_part_ch1
s_waitcnt lgkmcnt(7)
v_mfma_f32_16x16x32_bf16 v[60:63],v[24:27],v[0:3],0
v_mfma_f32_16x16x32_bf16 v[64:67],v[28:31],v[0:3],0
v_mfma_f32_16x16x32_bf16 v[68:71],v[24:27],v[4:7],0
v_mfma_f32_16x16x32_bf16 v[72:75],v[28:31],v[4:7],0
v_mfma_f32_16x16x32_bf16 v[76:79],v[32:35],v[0:3],0
ds_read_b64_tr_b16 v[48:49],v90 offset:8192
ds_read_b64_tr_b16 v[50:51],v90 offset:8704
ds_read_b64_tr_b16 v[52:53],v91 offset:8192
ds_read_b64_tr_b16 v[54:55],v91 offset:8704
ds_read_b128 v[16:19],v101 offset:2048
ds_read_b128 v[20:23],v101 offset:5120
ds_read_b128 v[56:59],v98 offset:128
s_waitcnt lgkmcnt(7)
v_mfma_f32_16x16x32_bf16 v[60:63],v[36:39],v[8:11],v[60:63]
v_mfma_f32_16x16x32_bf16 v[64:67],v[40:43],v[8:11],v[64:67]
v_mfma_f32_16x16x32_bf16 v[68:71],v[36:39],v[12:15],v[68:71]
v_mfma_f32_16x16x32_bf16 v[72:75],v[40:43],v[12:15],v[72:75]
v_mfma_f32_16x16x32_bf16 v[76:79],v[44:47],v[8:11],v[76:79]
s_barrier
ds_read_b64_tr_b16 v[24:25],v90 offset:12288
ds_read_b64_tr_b16 v[26:27],v90 offset:12800
ds_read_b64_tr_b16 v[28:29],v91 offset:12288
ds_read_b64_tr_b16 v[30:31],v91 offset:12800
ds_read_b128 v[0:3],v101 offset:18432
ds_read_b128 v[4:7],v101 offset:21504
ds_read_b128 v[32:35],v98 offset:192
s_waitcnt lgkmcnt(7)
v_mfma_f32_16x16x32_bf16 v[60:63],v[48:51],v[16:19],v[60:63]
v_mfma_f32_16x16x32_bf16 v[64:67],v[52:55],v[16:19],v[64:67]
v_mfma_f32_16x16x32_bf16 v[68:71],v[48:51],v[20:23],v[68:71]
v_mfma_f32_16x16x32_bf16 v[72:75],v[52:55],v[20:23],v[72:75]
v_mfma_f32_16x16x32_bf16 v[76:79],v[56:59],v[16:19],v[76:79]
ds_read_b64_tr_b16 v[36:37],v90 offset:16384
ds_read_b64_tr_b16 v[38:39],v90 offset:16896
ds_read_b64_tr_b16 v[40:41],v91 offset:16384
ds_read_b64_tr_b16 v[42:43],v91 offset:16896
ds_read_b128 v[8:11],v101 offset:19456
ds_read_b128 v[12:15],v101 offset:22528
ds_read_b128 v[44:47],v98 offset:256
s_waitcnt lgkmcnt(7)
v_mfma_f32_16x16x32_bf16 v[60:63],v[24:27],v[0:3],v[60:63]
v_mfma_f32_16x16x32_bf16 v[64:67],v[28:31],v[0:3],v[64:67]
v_mfma_f32_16x16x32_bf16 v[68:71],v[24:27],v[4:7],v[68:71]
v_mfma_f32_16x16x32_bf16 v[72:75],v[28:31],v[4:7],v[72:75]
v_mfma_f32_16x16x32_bf16 v[76:79],v[32:35],v[0:3],v[76:79]
ds_read_b64_tr_b16 v[48:49],v90 offset:20480
ds_read_b64_tr_b16 v[50:51],v90 offset:20992
ds_read_b64_tr_b16 v[52:53],v91 offset:20480
ds_read_b64_tr_b16 v[54:55],v91 offset:20992
ds_read_b128 v[16:19],v101 offset:20480
ds_read_b128 v[20:23],v101 offset:23552
ds_read_b128 v[56:59],v98 offset:320
s_waitcnt lgkmcnt(7)
v_mfma_f32_16x16x32_bf16 v[60:63],v[36:39],v[8:11],v[60:63]
v_mfma_f32_16x16x32_bf16 v[64:67],v[40:43],v[8:11],v[64:67]
v_mfma_f32_16x16x32_bf16 v[68:71],v[36:39],v[12:15],v[68:71]
v_mfma_f32_16x16x32_bf16 v[72:75],v[40:43],v[12:15],v[72:75]
v_mfma_f32_16x16x32_bf16 v[76:79],v[44:47],v[8:11],v[76:79]
s_barrier
ds_read_b64_tr_b16 v[24:25],v90 offset:24576
ds_read_b64_tr_b16 v[26:27],v90 offset:25088
ds_read_b64_tr_b16 v[28:29],v91 offset:24576
ds_read_b64_tr_b16 v[30:31],v91 offset:25088
ds_read_b128 v[0:3],v101 offset:36864
ds_read_b128 v[4:7],v101 offset:39936
ds_read_b128 v[32:35],v98 offset:384
s_waitcnt lgkmcnt(7)
v_mfma_f32_16x16x32_bf16 v[60:63],v[48:51],v[16:19],v[60:63]
v_mfma_f32_16x16x32_bf16 v[64:67],v[52:55],v[16:19],v[64:67]
v_mfma_f32_16x16x32_bf16 v[68:71],v[48:51],v[20:23],v[68:71]
v_mfma_f32_16x16x32_bf16 v[72:75],v[52:55],v[20:23],v[72:75]
v_mfma_f32_16x16x32_bf16 v[76:79],v[56:59],v[16:19],v[76:79]
ds_read_b64_tr_b16 v[36:37],v90 offset:28672
ds_read_b64_tr_b16 v[38:39],v90 offset:29184
ds_read_b64_tr_b16 v[40:41],v91 offset:28672
ds_read_b64_tr_b16 v[42:43],v91 offset:29184
ds_read_b128 v[8:11],v101 offset:37888
ds_read_b128 v[12:15],v101 offset:40960
ds_read_b128 v[44:47],v98 offset:448
s_waitcnt lgkmcnt(7)
v_mfma_f32_16x16x32_bf16 v[60:63],v[24:27],v[0:3],v[60:63]
v_mfma_f32_16x16x32_bf16 v[64:67],v[28:31],v[0:3],v[64:67]
v_mfma_f32_16x16x32_bf16 v[68:71],v[24:27],v[4:7],v[68:71]
v_mfma_f32_16x16x32_bf16 v[72:75],v[28:31],v[4:7],v[72:75]
v_mfma_f32_16x16x32_bf16 v[76:79],v[32:35],v[0:3],v[76:79]
ds_read_b64_tr_b16 v[48:49],v90 offset:32768
ds_read_b64_tr_b16 v[50:51],v90 offset:33280
ds_read_b64_tr_b16 v[52:53],v91 offset:32768
ds_read_b64_tr_b16 v[54:55],v91 offset:33280
ds_read_b128 v[16:19],v101 offset:38912
ds_read_b128 v[20:23],v101 offset:41984
ds_read_b128 v[56:59],v98 offset:512
s_waitcnt lgkmcnt(7)
v_mfma_f32_16x16x32_bf16 v[60:63],v[36:39],v[8:11],v[60:63]
v_mfma_f32_16x16x32_bf16 v[64:67],v[40:43],v[8:11],v[64:67]
v_mfma_f32_16x16x32_bf16 v[68:71],v[36:39],v[12:15],v[68:71]
v_mfma_f32_16x16x32_bf16 v[72:75],v[40:43],v[12:15],v[72:75]
v_mfma_f32_16x16x32_bf16 v[76:79],v[44:47],v[8:11],v[76:79]
s_barrier
ds_read_b64_tr_b16 v[24:25],v90 offset:36864
ds_read_b64_tr_b16 v[26:27],v90 offset:37376
ds_read_b64_tr_b16 v[28:29],v91 offset:36864
ds_read_b64_tr_b16 v[30:31],v91 offset:37376
ds_read_b128 v[0:3],v101 offset:55296
ds_read_b128 v[4:7],v101 offset:58368
ds_read_b128 v[32:35],v98 offset:576
s_waitcnt lgkmcnt(7)
v_mfma_f32_16x16x32_bf16 v[60:63],v[48:51],v[16:19],v[60:63]
v_mfma_f32_16x16x32_bf16 v[64:67],v[52:55],v[16:19],v[64:67]
v_mfma_f32_16x16x32_bf16 v[68:71],v[48:51],v[20:23],v[68:71]
v_mfma_f32_16x16x32_bf16 v[72:75],v[52:55],v[20:23],v[72:75]
v_mfma_f32_16x16x32_bf16 v[76:79],v[56:59],v[16:19],v[76:79]
ds_read_b64_tr_b16 v[36:37],v90 offset:40960
ds_read_b64_tr_b16 v[38:39],v90 offset:41472
ds_read_b64_tr_b16 v[40:41],v91 offset:40960
ds_read_b64_tr_b16 v[42:43],v91 offset:41472
ds_read_b128 v[8:11],v101 offset:56320
ds_read_b128 v[12:15],v101 offset:59392
ds_read_b128 v[44:47],v98 offset:640
s_waitcnt lgkmcnt(7)
v_mfma_f32_16x16x32_bf16 v[60:63],v[24:27],v[0:3],v[60:63]
v_mfma_f32_16x16x32_bf16 v[64:67],v[28:31],v[0:3],v[64:67]
v_mfma_f32_16x16x32_bf16 v[68:71],v[24:27],v[4:7],v[68:71]
v_mfma_f32_16x16x32_bf16 v[72:75],v[28:31],v[4:7],v[72:75]
v_mfma_f32_16x16x32_bf16 v[76:79],v[32:35],v[0:3],v[76:79]
ds_read_b64_tr_b16 v[48:49],v90 offset:45056
ds_read_b64_tr_b16 v[50:51],v90 offset:45568
ds_read_b64_tr_b16 v[52:53],v91 offset:45056
ds_read_b64_tr_b16 v[54:55],v91 offset:45568
ds_read_b128 v[16:19],v101 offset:57344
ds_read_b128 v[20:23],v101 offset:60416
ds_read_b128 v[56:59],v98 offset:704
s_waitcnt lgkmcnt(7)
v_mfma_f32_16x16x32_bf16 v[60:63],v[36:39],v[8:11],v[60:63]
v_mfma_f32_16x16x32_bf16 v[64:67],v[40:43],v[8:11],v[64:67]
v_mfma_f32_16x16x32_bf16 v[68:71],v[36:39],v[12:15],v[68:71]
v_mfma_f32_16x16x32_bf16 v[72:75],v[40:43],v[12:15],v[72:75]
v_mfma_f32_16x16x32_bf16 v[76:79],v[44:47],v[8:11],v[76:79]
s_barrier
ds_read_b64_tr_b16 v[24:25],v90 offset:49152
ds_read_b64_tr_b16 v[26:27],v90 offset:49664
ds_read_b64_tr_b16 v[28:29],v91 offset:49152
ds_read_b64_tr_b16 v[30:31],v91 offset:49664
ds_read_b128 v[0:3],v101 offset:0
ds_read_b128 v[4:7],v101 offset:3072
ds_read_b128 v[32:35],v98 offset:768
s_waitcnt lgkmcnt(7)
v_mfma_f32_16x16x32_bf16 v[60:63],v[48:51],v[16:19],v[60:63]
v_mfma_f32_16x16x32_bf16 v[64:67],v[52:55],v[16:19],v[64:67]
v_mfma_f32_16x16x32_bf16 v[68:71],v[48:51],v[20:23],v[68:71]
v_mfma_f32_16x16x32_bf16 v[72:75],v[52:55],v[20:23],v[72:75]
v_mfma_f32_16x16x32_bf16 v[76:79],v[56:59],v[16:19],v[76:79]
ds_read_b64_tr_b16 v[36:37],v90 offset:53248
ds_read_b64_tr_b16 v[38:39],v90 offset:53760
ds_read_b64_tr_b16 v[40:41],v91 offset:53248
ds_read_b64_tr_b16 v[42:43],v91 offset:53760
ds_read_b128 v[8:11],v101 offset:1024
ds_read_b128 v[12:15],v101 offset:4096
ds_read_b128 v[44:47],v98 offset:832
s_waitcnt lgkmcnt(7)
v_mfma_f32_16x16x32_bf16 v[60:63],v[24:27],v[0:3],v[60:63]
v_mfma_f32_16x16x32_bf16 v[64:67],v[28:31],v[0:3],v[64:67]
v_mfma_f32_16x16x32_bf16 v[68:71],v[24:27],v[4:7],v[68:71]
v_mfma_f32_16x16x32_bf16 v[72:75],v[28:31],v[4:7],v[72:75]
v_mfma_f32_16x16x32_bf16 v[76:79],v[32:35],v[0:3],v[76:79]
ds_read_b64_tr_b16 v[48:49],v90 offset:57344
ds_read_b64_tr_b16 v[50:51],v90 offset:57856
ds_read_b64_tr_b16 v[52:53],v91 offset:57344
ds_read_b64_tr_b16 v[54:55],v91 offset:57856
ds_read_b128 v[16:19],v101 offset:2048
ds_read_b128 v[20:23],v101 offset:5120
ds_read_b128 v[56:59],v98 offset:896
s_waitcnt lgkmcnt(7)
v_mfma_f32_16x16x32_bf16 v[60:63],v[36:39],v[8:11],v[60:63]
v_mfma_f32_16x16x32_bf16 v[64:67],v[40:43],v[8:11],v[64:67]
v_mfma_f32_16x16x32_bf16 v[68:71],v[36:39],v[12:15],v[68:71]
v_mfma_f32_16x16x32_bf16 v[72:75],v[40:43],v[12:15],v[72:75]
v_mfma_f32_16x16x32_bf16 v[76:79],v[44:47],v[8:11],v[76:79]
s_barrier
ds_read_b64_tr_b16 v[24:25],v90 offset:61440
ds_read_b64_tr_b16 v[26:27],v90 offset:61952
ds_read_b64_tr_b16 v[28:29],v91 offset:61440
ds_read_b64_tr_b16 v[30:31],v91 offset:61952
ds_read_b128 v[0:3],v101 offset:18432
ds_read_b128 v[4:7],v101 offset:21504
ds_read_b128 v[32:35],v98 offset:960
s_waitcnt lgkmcnt(7)
v_mfma_f32_16x16x32_bf16 v[60:63],v[48:51],v[16:19],v[60:63]
v_mfma_f32_16x16x32_bf16 v[64:67],v[52:55],v[16:19],v[64:67]
v_mfma_f32_16x16x32_bf16 v[68:71],v[48:51],v[20:23],v[68:71]
v_mfma_f32_16x16x32_bf16 v[72:75],v[52:55],v[20:23],v[72:75]
v_mfma_f32_16x16x32_bf16 v[76:79],v[56:59],v[16:19],v[76:79]
ds_read_b64_tr_b16 v[36:37],v92 offset:0
ds_read_b64_tr_b16 v[38:39],v92 offset:512
ds_read_b64_tr_b16 v[40:41],v93 offset:0
ds_read_b64_tr_b16 v[42:43],v93 offset:512
ds_read_b128 v[8:11],v101 offset:19456
ds_read_b128 v[12:15],v101 offset:22528
ds_read_b128 v[44:47],v98 offset:1024
s_waitcnt lgkmcnt(7)
v_mfma_f32_16x16x32_bf16 v[60:63],v[24:27],v[0:3],v[60:63]
v_mfma_f32_16x16x32_bf16 v[64:67],v[28:31],v[0:3],v[64:67]
v_mfma_f32_16x16x32_bf16 v[68:71],v[24:27],v[4:7],v[68:71]
v_mfma_f32_16x16x32_bf16 v[72:75],v[28:31],v[4:7],v[72:75]
v_mfma_f32_16x16x32_bf16 v[76:79],v[32:35],v[0:3],v[76:79]
ds_read_b64_tr_b16 v[48:49],v92 offset:4096
ds_read_b64_tr_b16 v[50:51],v92 offset:4608
ds_read_b64_tr_b16 v[52:53],v93 offset:4096
ds_read_b64_tr_b16 v[54:55],v93 offset:4608
ds_read_b128 v[16:19],v101 offset:20480
ds_read_b128 v[20:23],v101 offset:23552
ds_read_b128 v[56:59],v98 offset:1088
s_waitcnt lgkmcnt(7)
v_mfma_f32_16x16x32_bf16 v[60:63],v[36:39],v[8:11],v[60:63]
v_mfma_f32_16x16x32_bf16 v[64:67],v[40:43],v[8:11],v[64:67]
v_mfma_f32_16x16x32_bf16 v[68:71],v[36:39],v[12:15],v[68:71]
v_mfma_f32_16x16x32_bf16 v[72:75],v[40:43],v[12:15],v[72:75]
v_mfma_f32_16x16x32_bf16 v[76:79],v[44:47],v[8:11],v[76:79]
v_xor_b32 v99,0,v100
ds_read_b64 v[80:81],v99 offset:0
v_xor_b32 v99,32,v100
ds_read_b64 v[82:83],v99 offset:0
v_xor_b32 v99,0,v100
ds_read_b64 v[84:85],v99 offset:2048
v_xor_b32 v99,32,v100
ds_read_b64 v[86:87],v99 offset:2048
s_waitcnt lgkmcnt(4)
v_mfma_f32_16x16x32_bf16 v[60:63],v[48:51],v[16:19],v[60:63]
v_mfma_f32_16x16x32_bf16 v[64:67],v[52:55],v[16:19],v[64:67]
v_mfma_f32_16x16x32_bf16 v[68:71],v[48:51],v[20:23],v[68:71]
v_mfma_f32_16x16x32_bf16 v[72:75],v[52:55],v[20:23],v[72:75]
v_mfma_f32_16x16x32_bf16 v[76:79],v[56:59],v[16:19],v[76:79]
s_waitcnt vmcnt(0) lgkmcnt(0)
s_nop 7
v_add_f32 v110,v88,v76
s_add_u32 s30,s29,0
s_lshl_b32 s30,s30,6
s_add_u32 s30,s30,75008
v_lshl_add_u32 v111,v102,2,s30
ds_write_b32 v111,v110
s_waitcnt lgkmcnt(0)
s_barrier
ds_read_b32 v89,v111 offset:64
v_mov_b32 v88,v110
v_mov_b32 v0,0xffff0000
s_waitcnt lgkmcnt(0)
v_lshlrev_b32 v1,16,v80
v_and_b32 v2,v0,v80
v_lshlrev_b32 v3,16,v81
v_and_b32 v4,v0,v81
v_sub_f32 v1,v1,v88
v_sub_f32 v2,v2,v88
v_sub_f32 v3,v3,v88
v_sub_f32 v4,v4,v88
v_add_f32 v60,v60,v1
v_add_f32 v61,v61,v2
v_add_f32 v62,v62,v3
v_add_f32 v63,v63,v4
v_lshlrev_b32 v1,16,v82
v_and_b32 v2,v0,v82
v_lshlrev_b32 v3,16,v83
v_and_b32 v4,v0,v83
v_sub_f32 v1,v1,v88
v_sub_f32 v2,v2,v88
v_sub_f32 v3,v3,v88
v_sub_f32 v4,v4,v88
v_add_f32 v64,v64,v1
v_add_f32 v65,v65,v2
v_add_f32 v66,v66,v3
v_add_f32 v67,v67,v4
v_lshlrev_b32 v1,16,v84
v_and_b32 v2,v0,v84
v_lshlrev_b32 v3,16,v85
v_and_b32 v4,v0,v85
v_sub_f32 v1,v1,v89
v_sub_f32 v2,v2,v89
v_sub_f32 v3,v3,v89
v_sub_f32 v4,v4,v89
v_add_f32 v68,v68,v1
v_add_f32 v69,v69,v2
v_add_f32 v70,v70,v3
v_add_f32 v71,v71,v4
v_lshlrev_b32 v1,16,v86
v_and_b32 v2,v0,v86
v_lshlrev_b32 v3,16,v87
v_and_b32 v4,v0,v87
v_sub_f32 v1,v1,v89
v_sub_f32 v2,v2,v89
v_sub_f32 v3,v3,v89
v_sub_f32 v4,v4,v89
v_add_f32 v72,v72,v1
v_add_f32 v73,v73,v2
v_add_f32 v74,v74,v3
v_add_f32 v75,v75,v4
v_cvt_pk_bf16_f32 v8,v60,v61
v_cvt_pk_bf16_f32 v9,v62,v63
v_cvt_pk_bf16_f32 v10,v64,v65
v_cvt_pk_bf16_f32 v11,v66,v67
v_cvt_pk_bf16_f32 v12,v68,v69
v_cvt_pk_bf16_f32 v13,v70,v71
v_cvt_pk_bf16_f32 v14,v72,v73
v_cvt_pk_bf16_f32 v15,v74,v75
s_add_u32 s30,s27,s29
s_mul_i32 s30,s30,18
s_lshl_b32 s31,s28,1
s_add_u32 s30,s30,s31
s_add_u32 s30,s30,0
s_lshl_b32 s30,s30,10
buffer_store_dwordx4 v[8:11],v95,s[36:39],s30 offen sc1
s_add_u32 s30,s30,18432
buffer_store_dwordx4 v[12:15],v95,s[36:39],s30 offen sc1
v_mul_f32 v16,v60,v60
v_mul_f32 v17,v61,v61
v_fma_f32 v16,v62,v62,v16
v_fma_f32 v17,v63,v63,v17
v_fma_f32 v16,v64,v64,v16
v_fma_f32 v17,v65,v65,v17
v_fma_f32 v16,v66,v66,v16
v_fma_f32 v17,v67,v67,v17
v_add_f32 v16,v16,v17
v_mul_f32 v18,v68,v68
v_mul_f32 v19,v69,v69
v_fma_f32 v18,v70,v70,v18
v_fma_f32 v19,v71,v71,v19
v_fma_f32 v18,v72,v72,v18
v_fma_f32 v19,v73,v73,v19
v_fma_f32 v18,v74,v74,v18
v_fma_f32 v19,v75,v75,v19
v_add_f32 v18,v18,v19
v_mov_b32 v17,v16
v_mov_b32 v19,v18
s_nop 1
v_permlane16_swap_b32 v16,v17
v_permlane16_swap_b32 v18,v19
s_nop 0
v_add_f32 v16,v16,v17
v_add_f32 v18,v18,v19
v_mov_b32 v17,v16
v_mov_b32 v19,v18
s_nop 1
v_permlane32_swap_b32 v16,v17
v_permlane32_swap_b32 v18,v19
s_nop 0
v_add_f32 v16,v16,v17
v_add_f32 v18,v18,v19
v_cmp_eq_u32 vcc,1,v97
v_and_b32 v4,31,v94
s_add_u32 s30,s27,s29
s_lshl_b32 s30,s30,4
v_add_lshl_u32 v4,s30,v4,2
v_cndmask_b32 v16,v16,v18,vcc
v_cndmask_b32 v17,v88,v89,vcc
s_lshl_b32 s30,s28,1
s_add_u32 s30,s30,0
s_lshl_b32 s30,s30,13
s_add_u32 s16,s24,4857856
s_addc_u32 s17,s25,0
s_mov_b32 s18,8192
s_mov_b32 s19,0x20000
s_mov_b64 exec,0xffffffff
buffer_store_dword v16,v4,s[40:43],s30 offen sc1
s_cmp_lg_u32 s28,0
s_cbranch_scc1 oproj_part_nohm
buffer_store_dword v17,v4,s[16:19],0 offen sc1
oproj_part_nohm:
s_mov_b64 exec,-1
s_waitcnt vmcnt(0) lgkmcnt(0)
s_barrier
s_cmp_lg_u32 s26,0
s_cbranch_scc1 ffn_kernel_main
s_add_u32 s16,s24,6029312
s_addc_u32 s17,s25,0
s_mov_b32 s18,32768
s_mov_b32 s19,0x20000
s_lshl_b32 s30,s2,7
v_mov_b32 v1,1
buffer_store_dword v1,off,s[16:19],s30 sc1
s_branch ffn_kernel_main
oproj_part_ch1:
s_waitcnt lgkmcnt(7)
v_mfma_f32_16x16x32_bf16 v[60:63],v[24:27],v[0:3],0
v_mfma_f32_16x16x32_bf16 v[64:67],v[28:31],v[0:3],0
v_mfma_f32_16x16x32_bf16 v[68:71],v[24:27],v[4:7],0
v_mfma_f32_16x16x32_bf16 v[72:75],v[28:31],v[4:7],0
v_mfma_f32_16x16x32_bf16 v[76:79],v[32:35],v[4:7],0
ds_read_b64_tr_b16 v[48:49],v90 offset:8192
ds_read_b64_tr_b16 v[50:51],v90 offset:8704
ds_read_b64_tr_b16 v[52:53],v91 offset:8192
ds_read_b64_tr_b16 v[54:55],v91 offset:8704
ds_read_b128 v[16:19],v101 offset:2048
ds_read_b128 v[20:23],v101 offset:5120
ds_read_b128 v[56:59],v98 offset:128
s_waitcnt lgkmcnt(7)
v_mfma_f32_16x16x32_bf16 v[60:63],v[36:39],v[8:11],v[60:63]
v_mfma_f32_16x16x32_bf16 v[64:67],v[40:43],v[8:11],v[64:67]
v_mfma_f32_16x16x32_bf16 v[68:71],v[36:39],v[12:15],v[68:71]
v_mfma_f32_16x16x32_bf16 v[72:75],v[40:43],v[12:15],v[72:75]
v_mfma_f32_16x16x32_bf16 v[76:79],v[44:47],v[12:15],v[76:79]
s_barrier
ds_read_b64_tr_b16 v[24:25],v90 offset:12288
ds_read_b64_tr_b16 v[26:27],v90 offset:12800
ds_read_b64_tr_b16 v[28:29],v91 offset:12288
ds_read_b64_tr_b16 v[30:31],v91 offset:12800
ds_read_b128 v[0:3],v101 offset:18432
ds_read_b128 v[4:7],v101 offset:21504
ds_read_b128 v[32:35],v98 offset:192
s_waitcnt lgkmcnt(7)
v_mfma_f32_16x16x32_bf16 v[60:63],v[48:51],v[16:19],v[60:63]
v_mfma_f32_16x16x32_bf16 v[64:67],v[52:55],v[16:19],v[64:67]
v_mfma_f32_16x16x32_bf16 v[68:71],v[48:51],v[20:23],v[68:71]
v_mfma_f32_16x16x32_bf16 v[72:75],v[52:55],v[20:23],v[72:75]
v_mfma_f32_16x16x32_bf16 v[76:79],v[56:59],v[20:23],v[76:79]
ds_read_b64_tr_b16 v[36:37],v90 offset:16384
ds_read_b64_tr_b16 v[38:39],v90 offset:16896
ds_read_b64_tr_b16 v[40:41],v91 offset:16384
ds_read_b64_tr_b16 v[42:43],v91 offset:16896
ds_read_b128 v[8:11],v101 offset:19456
ds_read_b128 v[12:15],v101 offset:22528
ds_read_b128 v[44:47],v98 offset:256
s_waitcnt lgkmcnt(7)
v_mfma_f32_16x16x32_bf16 v[60:63],v[24:27],v[0:3],v[60:63]
v_mfma_f32_16x16x32_bf16 v[64:67],v[28:31],v[0:3],v[64:67]
v_mfma_f32_16x16x32_bf16 v[68:71],v[24:27],v[4:7],v[68:71]
v_mfma_f32_16x16x32_bf16 v[72:75],v[28:31],v[4:7],v[72:75]
v_mfma_f32_16x16x32_bf16 v[76:79],v[32:35],v[4:7],v[76:79]
ds_read_b64_tr_b16 v[48:49],v90 offset:20480
ds_read_b64_tr_b16 v[50:51],v90 offset:20992
ds_read_b64_tr_b16 v[52:53],v91 offset:20480
ds_read_b64_tr_b16 v[54:55],v91 offset:20992
ds_read_b128 v[16:19],v101 offset:20480
ds_read_b128 v[20:23],v101 offset:23552
ds_read_b128 v[56:59],v98 offset:320
s_waitcnt lgkmcnt(7)
v_mfma_f32_16x16x32_bf16 v[60:63],v[36:39],v[8:11],v[60:63]
v_mfma_f32_16x16x32_bf16 v[64:67],v[40:43],v[8:11],v[64:67]
v_mfma_f32_16x16x32_bf16 v[68:71],v[36:39],v[12:15],v[68:71]
v_mfma_f32_16x16x32_bf16 v[72:75],v[40:43],v[12:15],v[72:75]
v_mfma_f32_16x16x32_bf16 v[76:79],v[44:47],v[12:15],v[76:79]
s_barrier
ds_read_b64_tr_b16 v[24:25],v90 offset:24576
ds_read_b64_tr_b16 v[26:27],v90 offset:25088
ds_read_b64_tr_b16 v[28:29],v91 offset:24576
ds_read_b64_tr_b16 v[30:31],v91 offset:25088
ds_read_b128 v[0:3],v101 offset:36864
ds_read_b128 v[4:7],v101 offset:39936
ds_read_b128 v[32:35],v98 offset:384
s_waitcnt lgkmcnt(7)
v_mfma_f32_16x16x32_bf16 v[60:63],v[48:51],v[16:19],v[60:63]
v_mfma_f32_16x16x32_bf16 v[64:67],v[52:55],v[16:19],v[64:67]
v_mfma_f32_16x16x32_bf16 v[68:71],v[48:51],v[20:23],v[68:71]
v_mfma_f32_16x16x32_bf16 v[72:75],v[52:55],v[20:23],v[72:75]
v_mfma_f32_16x16x32_bf16 v[76:79],v[56:59],v[20:23],v[76:79]
ds_read_b64_tr_b16 v[36:37],v90 offset:28672
ds_read_b64_tr_b16 v[38:39],v90 offset:29184
ds_read_b64_tr_b16 v[40:41],v91 offset:28672
ds_read_b64_tr_b16 v[42:43],v91 offset:29184
ds_read_b128 v[8:11],v101 offset:37888
ds_read_b128 v[12:15],v101 offset:40960
ds_read_b128 v[44:47],v98 offset:448
s_waitcnt lgkmcnt(7)
v_mfma_f32_16x16x32_bf16 v[60:63],v[24:27],v[0:3],v[60:63]
v_mfma_f32_16x16x32_bf16 v[64:67],v[28:31],v[0:3],v[64:67]
v_mfma_f32_16x16x32_bf16 v[68:71],v[24:27],v[4:7],v[68:71]
v_mfma_f32_16x16x32_bf16 v[72:75],v[28:31],v[4:7],v[72:75]
v_mfma_f32_16x16x32_bf16 v[76:79],v[32:35],v[4:7],v[76:79]
ds_read_b64_tr_b16 v[48:49],v90 offset:32768
ds_read_b64_tr_b16 v[50:51],v90 offset:33280
ds_read_b64_tr_b16 v[52:53],v91 offset:32768
ds_read_b64_tr_b16 v[54:55],v91 offset:33280
ds_read_b128 v[16:19],v101 offset:38912
ds_read_b128 v[20:23],v101 offset:41984
ds_read_b128 v[56:59],v98 offset:512
s_waitcnt lgkmcnt(7)
v_mfma_f32_16x16x32_bf16 v[60:63],v[36:39],v[8:11],v[60:63]
v_mfma_f32_16x16x32_bf16 v[64:67],v[40:43],v[8:11],v[64:67]
v_mfma_f32_16x16x32_bf16 v[68:71],v[36:39],v[12:15],v[68:71]
v_mfma_f32_16x16x32_bf16 v[72:75],v[40:43],v[12:15],v[72:75]
v_mfma_f32_16x16x32_bf16 v[76:79],v[44:47],v[12:15],v[76:79]
s_barrier
ds_read_b64_tr_b16 v[24:25],v90 offset:36864
ds_read_b64_tr_b16 v[26:27],v90 offset:37376
ds_read_b64_tr_b16 v[28:29],v91 offset:36864
ds_read_b64_tr_b16 v[30:31],v91 offset:37376
ds_read_b128 v[0:3],v101 offset:55296
ds_read_b128 v[4:7],v101 offset:58368
ds_read_b128 v[32:35],v98 offset:576
s_waitcnt lgkmcnt(7)
v_mfma_f32_16x16x32_bf16 v[60:63],v[48:51],v[16:19],v[60:63]
v_mfma_f32_16x16x32_bf16 v[64:67],v[52:55],v[16:19],v[64:67]
v_mfma_f32_16x16x32_bf16 v[68:71],v[48:51],v[20:23],v[68:71]
v_mfma_f32_16x16x32_bf16 v[72:75],v[52:55],v[20:23],v[72:75]
v_mfma_f32_16x16x32_bf16 v[76:79],v[56:59],v[20:23],v[76:79]
ds_read_b64_tr_b16 v[36:37],v90 offset:40960
ds_read_b64_tr_b16 v[38:39],v90 offset:41472
ds_read_b64_tr_b16 v[40:41],v91 offset:40960
ds_read_b64_tr_b16 v[42:43],v91 offset:41472
ds_read_b128 v[8:11],v101 offset:56320
ds_read_b128 v[12:15],v101 offset:59392
ds_read_b128 v[44:47],v98 offset:640
s_waitcnt lgkmcnt(7)
v_mfma_f32_16x16x32_bf16 v[60:63],v[24:27],v[0:3],v[60:63]
v_mfma_f32_16x16x32_bf16 v[64:67],v[28:31],v[0:3],v[64:67]
v_mfma_f32_16x16x32_bf16 v[68:71],v[24:27],v[4:7],v[68:71]
v_mfma_f32_16x16x32_bf16 v[72:75],v[28:31],v[4:7],v[72:75]
v_mfma_f32_16x16x32_bf16 v[76:79],v[32:35],v[4:7],v[76:79]
ds_read_b64_tr_b16 v[48:49],v90 offset:45056
ds_read_b64_tr_b16 v[50:51],v90 offset:45568
ds_read_b64_tr_b16 v[52:53],v91 offset:45056
ds_read_b64_tr_b16 v[54:55],v91 offset:45568
ds_read_b128 v[16:19],v101 offset:57344
ds_read_b128 v[20:23],v101 offset:60416
ds_read_b128 v[56:59],v98 offset:704
s_waitcnt lgkmcnt(7)
v_mfma_f32_16x16x32_bf16 v[60:63],v[36:39],v[8:11],v[60:63]
v_mfma_f32_16x16x32_bf16 v[64:67],v[40:43],v[8:11],v[64:67]
v_mfma_f32_16x16x32_bf16 v[68:71],v[36:39],v[12:15],v[68:71]
v_mfma_f32_16x16x32_bf16 v[72:75],v[40:43],v[12:15],v[72:75]
v_mfma_f32_16x16x32_bf16 v[76:79],v[44:47],v[12:15],v[76:79]
s_barrier
ds_read_b64_tr_b16 v[24:25],v90 offset:49152
ds_read_b64_tr_b16 v[26:27],v90 offset:49664
ds_read_b64_tr_b16 v[28:29],v91 offset:49152
ds_read_b64_tr_b16 v[30:31],v91 offset:49664
ds_read_b128 v[0:3],v101 offset:0
ds_read_b128 v[4:7],v101 offset:3072
ds_read_b128 v[32:35],v98 offset:768
s_waitcnt lgkmcnt(7)
v_mfma_f32_16x16x32_bf16 v[60:63],v[48:51],v[16:19],v[60:63]
v_mfma_f32_16x16x32_bf16 v[64:67],v[52:55],v[16:19],v[64:67]
v_mfma_f32_16x16x32_bf16 v[68:71],v[48:51],v[20:23],v[68:71]
v_mfma_f32_16x16x32_bf16 v[72:75],v[52:55],v[20:23],v[72:75]
v_mfma_f32_16x16x32_bf16 v[76:79],v[56:59],v[20:23],v[76:79]
ds_read_b64_tr_b16 v[36:37],v90 offset:53248
ds_read_b64_tr_b16 v[38:39],v90 offset:53760
ds_read_b64_tr_b16 v[40:41],v91 offset:53248
ds_read_b64_tr_b16 v[42:43],v91 offset:53760
ds_read_b128 v[8:11],v101 offset:1024
ds_read_b128 v[12:15],v101 offset:4096
ds_read_b128 v[44:47],v98 offset:832
s_waitcnt lgkmcnt(7)
v_mfma_f32_16x16x32_bf16 v[60:63],v[24:27],v[0:3],v[60:63]
v_mfma_f32_16x16x32_bf16 v[64:67],v[28:31],v[0:3],v[64:67]
v_mfma_f32_16x16x32_bf16 v[68:71],v[24:27],v[4:7],v[68:71]
v_mfma_f32_16x16x32_bf16 v[72:75],v[28:31],v[4:7],v[72:75]
v_mfma_f32_16x16x32_bf16 v[76:79],v[32:35],v[4:7],v[76:79]
ds_read_b64_tr_b16 v[48:49],v90 offset:57344
ds_read_b64_tr_b16 v[50:51],v90 offset:57856
ds_read_b64_tr_b16 v[52:53],v91 offset:57344
ds_read_b64_tr_b16 v[54:55],v91 offset:57856
ds_read_b128 v[16:19],v101 offset:2048
ds_read_b128 v[20:23],v101 offset:5120
ds_read_b128 v[56:59],v98 offset:896
s_waitcnt lgkmcnt(7)
v_mfma_f32_16x16x32_bf16 v[60:63],v[36:39],v[8:11],v[60:63]
v_mfma_f32_16x16x32_bf16 v[64:67],v[40:43],v[8:11],v[64:67]
v_mfma_f32_16x16x32_bf16 v[68:71],v[36:39],v[12:15],v[68:71]
v_mfma_f32_16x16x32_bf16 v[72:75],v[40:43],v[12:15],v[72:75]
v_mfma_f32_16x16x32_bf16 v[76:79],v[44:47],v[12:15],v[76:79]
s_barrier
ds_read_b64_tr_b16 v[24:25],v90 offset:61440
ds_read_b64_tr_b16 v[26:27],v90 offset:61952
ds_read_b64_tr_b16 v[28:29],v91 offset:61440
ds_read_b64_tr_b16 v[30:31],v91 offset:61952
ds_read_b128 v[0:3],v101 offset:18432
ds_read_b128 v[4:7],v101 offset:21504
ds_read_b128 v[32:35],v98 offset:960
s_waitcnt lgkmcnt(7)
v_mfma_f32_16x16x32_bf16 v[60:63],v[48:51],v[16:19],v[60:63]
v_mfma_f32_16x16x32_bf16 v[64:67],v[52:55],v[16:19],v[64:67]
v_mfma_f32_16x16x32_bf16 v[68:71],v[48:51],v[20:23],v[68:71]
v_mfma_f32_16x16x32_bf16 v[72:75],v[52:55],v[20:23],v[72:75]
v_mfma_f32_16x16x32_bf16 v[76:79],v[56:59],v[20:23],v[76:79]
ds_read_b64_tr_b16 v[36:37],v92 offset:0
ds_read_b64_tr_b16 v[38:39],v92 offset:512
ds_read_b64_tr_b16 v[40:41],v93 offset:0
ds_read_b64_tr_b16 v[42:43],v93 offset:512
ds_read_b128 v[8:11],v101 offset:19456
ds_read_b128 v[12:15],v101 offset:22528
ds_read_b128 v[44:47],v98 offset:1024
s_waitcnt lgkmcnt(7)
v_mfma_f32_16x16x32_bf16 v[60:63],v[24:27],v[0:3],v[60:63]
v_mfma_f32_16x16x32_bf16 v[64:67],v[28:31],v[0:3],v[64:67]
v_mfma_f32_16x16x32_bf16 v[68:71],v[24:27],v[4:7],v[68:71]
v_mfma_f32_16x16x32_bf16 v[72:75],v[28:31],v[4:7],v[72:75]
v_mfma_f32_16x16x32_bf16 v[76:79],v[32:35],v[4:7],v[76:79]
ds_read_b64_tr_b16 v[48:49],v92 offset:4096
ds_read_b64_tr_b16 v[50:51],v92 offset:4608
ds_read_b64_tr_b16 v[52:53],v93 offset:4096
ds_read_b64_tr_b16 v[54:55],v93 offset:4608
ds_read_b128 v[16:19],v101 offset:20480
ds_read_b128 v[20:23],v101 offset:23552
ds_read_b128 v[56:59],v98 offset:1088
s_waitcnt lgkmcnt(7)
v_mfma_f32_16x16x32_bf16 v[60:63],v[36:39],v[8:11],v[60:63]
v_mfma_f32_16x16x32_bf16 v[64:67],v[40:43],v[8:11],v[64:67]
v_mfma_f32_16x16x32_bf16 v[68:71],v[36:39],v[12:15],v[68:71]
v_mfma_f32_16x16x32_bf16 v[72:75],v[40:43],v[12:15],v[72:75]
v_mfma_f32_16x16x32_bf16 v[76:79],v[44:47],v[12:15],v[76:79]
v_xor_b32 v99,0,v100
ds_read_b64 v[80:81],v99 offset:0
v_xor_b32 v99,32,v100
ds_read_b64 v[82:83],v99 offset:0
v_xor_b32 v99,0,v100
ds_read_b64 v[84:85],v99 offset:2048
v_xor_b32 v99,32,v100
ds_read_b64 v[86:87],v99 offset:2048
s_waitcnt lgkmcnt(4)
v_mfma_f32_16x16x32_bf16 v[60:63],v[48:51],v[16:19],v[60:63]
v_mfma_f32_16x16x32_bf16 v[64:67],v[52:55],v[16:19],v[64:67]
v_mfma_f32_16x16x32_bf16 v[68:71],v[48:51],v[20:23],v[68:71]
v_mfma_f32_16x16x32_bf16 v[72:75],v[52:55],v[20:23],v[72:75]
v_mfma_f32_16x16x32_bf16 v[76:79],v[56:59],v[20:23],v[76:79]
s_waitcnt vmcnt(0) lgkmcnt(0)
s_nop 7
v_add_f32 v110,v89,v76
s_add_u32 s30,s29,1
s_lshl_b32 s30,s30,6
s_add_u32 s30,s30,75008
v_lshl_add_u32 v111,v102,2,s30
ds_write_b32 v111,v110
s_waitcnt lgkmcnt(0)
s_barrier
v_subrev_u32 v111,64,v111
ds_read_b32 v88,v111
v_mov_b32 v89,v110
v_mov_b32 v0,0xffff0000
s_waitcnt lgkmcnt(0)
v_lshlrev_b32 v1,16,v80
v_and_b32 v2,v0,v80
v_lshlrev_b32 v3,16,v81
v_and_b32 v4,v0,v81
v_sub_f32 v1,v1,v88
v_sub_f32 v2,v2,v88
v_sub_f32 v3,v3,v88
v_sub_f32 v4,v4,v88
v_add_f32 v60,v60,v1
v_add_f32 v61,v61,v2
v_add_f32 v62,v62,v3
v_add_f32 v63,v63,v4
v_lshlrev_b32 v1,16,v82
v_and_b32 v2,v0,v82
v_lshlrev_b32 v3,16,v83
v_and_b32 v4,v0,v83
v_sub_f32 v1,v1,v88
v_sub_f32 v2,v2,v88
v_sub_f32 v3,v3,v88
v_sub_f32 v4,v4,v88
v_add_f32 v64,v64,v1
v_add_f32 v65,v65,v2
v_add_f32 v66,v66,v3
v_add_f32 v67,v67,v4
v_lshlrev_b32 v1,16,v84
v_and_b32 v2,v0,v84
v_lshlrev_b32 v3,16,v85
v_and_b32 v4,v0,v85
v_sub_f32 v1,v1,v89
v_sub_f32 v2,v2,v89
v_sub_f32 v3,v3,v89
v_sub_f32 v4,v4,v89
v_add_f32 v68,v68,v1
v_add_f32 v69,v69,v2
v_add_f32 v70,v70,v3
v_add_f32 v71,v71,v4
v_lshlrev_b32 v1,16,v86
v_and_b32 v2,v0,v86
v_lshlrev_b32 v3,16,v87
v_and_b32 v4,v0,v87
v_sub_f32 v1,v1,v89
v_sub_f32 v2,v2,v89
v_sub_f32 v3,v3,v89
v_sub_f32 v4,v4,v89
v_add_f32 v72,v72,v1
v_add_f32 v73,v73,v2
v_add_f32 v74,v74,v3
v_add_f32 v75,v75,v4
v_cvt_pk_bf16_f32 v8,v60,v61
v_cvt_pk_bf16_f32 v9,v62,v63
v_cvt_pk_bf16_f32 v10,v64,v65
v_cvt_pk_bf16_f32 v11,v66,v67
v_cvt_pk_bf16_f32 v12,v68,v69
v_cvt_pk_bf16_f32 v13,v70,v71
v_cvt_pk_bf16_f32 v14,v72,v73
v_cvt_pk_bf16_f32 v15,v74,v75
s_add_u32 s30,s27,s29
s_mul_i32 s30,s30,18
s_lshl_b32 s31,s28,1
s_add_u32 s30,s30,s31
s_add_u32 s30,s30,1
s_lshl_b32 s30,s30,10
buffer_store_dwordx4 v[8:11],v95,s[36:39],s30 offen sc1
s_add_u32 s30,s30,18432
buffer_store_dwordx4 v[12:15],v95,s[36:39],s30 offen sc1
v_mul_f32 v16,v60,v60
v_mul_f32 v17,v61,v61
v_fma_f32 v16,v62,v62,v16
v_fma_f32 v17,v63,v63,v17
v_fma_f32 v16,v64,v64,v16
v_fma_f32 v17,v65,v65,v17
v_fma_f32 v16,v66,v66,v16
v_fma_f32 v17,v67,v67,v17
v_add_f32 v16,v16,v17
v_mul_f32 v18,v68,v68
v_mul_f32 v19,v69,v69
v_fma_f32 v18,v70,v70,v18
v_fma_f32 v19,v71,v71,v19
v_fma_f32 v18,v72,v72,v18
v_fma_f32 v19,v73,v73,v19
v_fma_f32 v18,v74,v74,v18
v_fma_f32 v19,v75,v75,v19
v_add_f32 v18,v18,v19
v_mov_b32 v17,v16
v_mov_b32 v19,v18
s_nop 1
v_permlane16_swap_b32 v16,v17
v_permlane16_swap_b32 v18,v19
s_nop 0
v_add_f32 v16,v16,v17
v_add_f32 v18,v18,v19
v_mov_b32 v17,v16
v_mov_b32 v19,v18
s_nop 1
v_permlane32_swap_b32 v16,v17
v_permlane32_swap_b32 v18,v19
s_nop 0
v_add_f32 v16,v16,v17
v_add_f32 v18,v18,v19
v_cmp_eq_u32 vcc,1,v97
v_and_b32 v4,31,v94
s_add_u32 s30,s27,s29
s_lshl_b32 s30,s30,4
v_add_lshl_u32 v4,s30,v4,2
v_cndmask_b32 v16,v16,v18,vcc
v_cndmask_b32 v17,v88,v89,vcc
s_lshl_b32 s30,s28,1
s_add_u32 s30,s30,1
s_lshl_b32 s30,s30,13
s_add_u32 s16,s24,4857856
s_addc_u32 s17,s25,0
s_mov_b32 s18,8192
s_mov_b32 s19,0x20000
s_mov_b64 exec,0xffffffff
buffer_store_dword v16,v4,s[40:43],s30 offen sc1
s_mov_b64 exec,-1
s_waitcnt vmcnt(0) lgkmcnt(0)
s_barrier
s_cmp_lg_u32 s26,0
s_cbranch_scc1 ffn_kernel_main
s_add_u32 s16,s24,6029312
s_addc_u32 s17,s25,0
s_mov_b32 s18,32768
s_mov_b32 s19,0x20000
s_lshl_b32 s30,s2,7
v_mov_b32 v1,1
buffer_store_dword v1,off,s[16:19],s30 sc1
s_branch ffn_kernel_main
oproj_part_ld0:
v_lshrrev_b32 v6,3,v94
v_and_b32 v8,7,v94
v_bfe_u32 v7,v94,4,1
v_mul_u32_u24 v9,1152,v6
s_lshl_b32 s30,s28,7
v_add_u32 v9,s30,v9
v_or_b32 v20,0,v7
v_lshlrev_b32 v20,1,v20
v_xor_b32 v20,v20,v8
v_lshl_add_u32 v20,v20,4,v9
v_add_u32 v10,0,v20
v_or_b32 v20,2,v7
v_lshlrev_b32 v20,1,v20
v_xor_b32 v20,v20,v8
v_lshl_add_u32 v20,v20,4,v9
v_add_u32 v11,8192,v20
v_or_b32 v20,0,v7
v_lshlrev_b32 v20,1,v20
v_xor_b32 v20,v20,v8
v_lshl_add_u32 v20,v20,4,v9
v_add_u32 v12,16384,v20
v_or_b32 v20,2,v7
v_lshlrev_b32 v20,1,v20
v_xor_b32 v20,v20,v8
v_lshl_add_u32 v20,v20,4,v9
v_add_u32 v13,24576,v20
s_waitcnt lgkmcnt(0)
s_mov_b32 s4,s22
s_mov_b32 s5,s23
s_mov_b32 s6,663552
s_mov_b32 s7,0x20000
s_add_u32 s16,s24,4866048
s_addc_u32 s17,s25,0
s_mov_b32 s18,1152
s_mov_b32 s19,0x20000
s_mov_b32 m0,73728
s_nop 0
buffer_load_dwordx4 v95,s[16:19],0 offen lds
s_mov_b64 exec,0xff
buffer_load_dwordx4 v95,s[16:19],0 offen offset:1024 lds
s_mov_b64 exec,-1
s_mov_b32 m0,0
s_mov_b32 s32,0
buffer_load_dwordx4 v10,s[4:7],s32 offen offset:0 lds
buffer_load_dwordx4 v11,s[4:7],s32 offen offset:1024 lds
buffer_load_dwordx4 v12,s[4:7],s32 offen offset:2048 lds
buffer_load_dwordx4 v13,s[4:7],s32 offen offset:3072 lds
s_mov_b32 m0,4096
s_mov_b32 s32,36864
buffer_load_dwordx4 v10,s[4:7],s32 offen offset:0 lds
buffer_load_dwordx4 v11,s[4:7],s32 offen offset:1024 lds
buffer_load_dwordx4 v12,s[4:7],s32 offen offset:2048 lds
buffer_load_dwordx4 v13,s[4:7],s32 offen offset:3072 lds
s_mov_b32 m0,8192
s_mov_b32 s32,73728
buffer_load_dwordx4 v10,s[4:7],s32 offen offset:0 lds
buffer_load_dwordx4 v11,s[4:7],s32 offen offset:1024 lds
buffer_load_dwordx4 v12,s[4:7],s32 offen offset:2048 lds
buffer_load_dwordx4 v13,s[4:7],s32 offen offset:3072 lds
s_mov_b32 m0,12288
s_mov_b32 s32,110592
buffer_load_dwordx4 v10,s[4:7],s32 offen offset:0 lds
buffer_load_dwordx4 v11,s[4:7],s32 offen offset:1024 lds
buffer_load_dwordx4 v12,s[4:7],s32 offen offset:2048 lds
buffer_load_dwordx4 v13,s[4:7],s32 offen offset:3072 lds
s_mov_b32 m0,16384
s_mov_b32 s32,147456
buffer_load_dwordx4 v10,s[4:7],s32 offen offset:0 lds
buffer_load_dwordx4 v11,s[4:7],s32 offen offset:1024 lds
buffer_load_dwordx4 v12,s[4:7],s32 offen offset:2048 lds
buffer_load_dwordx4 v13,s[4:7],s32 offen offset:3072 lds
s_mov_b32 m0,20480
s_mov_b32 s32,184320
buffer_load_dwordx4 v10,s[4:7],s32 offen offset:0 lds
buffer_load_dwordx4 v11,s[4:7],s32 offen offset:1024 lds
buffer_load_dwordx4 v12,s[4:7],s32 offen offset:2048 lds
buffer_load_dwordx4 v13,s[4:7],s32 offen offset:3072 lds
s_mov_b32 m0,24576
s_mov_b32 s32,221184
buffer_load_dwordx4 v10,s[4:7],s32 offen offset:0 lds
buffer_load_dwordx4 v11,s[4:7],s32 offen offset:1024 lds
buffer_load_dwordx4 v12,s[4:7],s32 offen offset:2048 lds
buffer_load_dwordx4 v13,s[4:7],s32 offen offset:3072 lds
s_mov_b32 m0,28672
s_mov_b32 s32,258048
buffer_load_dwordx4 v10,s[4:7],s32 offen offset:0 lds
buffer_load_dwordx4 v11,s[4:7],s32 offen offset:1024 lds
buffer_load_dwordx4 v12,s[4:7],s32 offen offset:2048 lds
buffer_load_dwordx4 v13,s[4:7],s32 offen offset:3072 lds
s_mov_b32 m0,32768
s_mov_b32 s32,294912
buffer_load_dwordx4 v10,s[4:7],s32 offen offset:0 lds
buffer_load_dwordx4 v11,s[4:7],s32 offen offset:1024 lds
buffer_load_dwordx4 v12,s[4:7],s32 offen offset:2048 lds
buffer_load_dwordx4 v13,s[4:7],s32 offen offset:3072 lds
s_waitcnt vmcnt(24)
s_barrier
s_mov_b32 m0,36864
s_mov_b32 s32,331776
buffer_load_dwordx4 v10,s[4:7],s32 offen offset:0 lds
buffer_load_dwordx4 v11,s[4:7],s32 offen offset:1024 lds
buffer_load_dwordx4 v12,s[4:7],s32 offen offset:2048 lds
buffer_load_dwordx4 v13,s[4:7],s32 offen offset:3072 lds
s_mov_b32 m0,40960
s_mov_b32 s32,368640
buffer_load_dwordx4 v10,s[4:7],s32 offen offset:0 lds
buffer_load_dwordx4 v11,s[4:7],s32 offen offset:1024 lds
buffer_load_dwordx4 v12,s[4:7],s32 offen offset:2048 lds
buffer_load_dwordx4 v13,s[4:7],s32 offen offset:3072 lds
s_mov_b32 m0,45056
s_mov_b32 s32,405504
buffer_load_dwordx4 v10,s[4:7],s32 offen offset:0 lds
buffer_load_dwordx4 v11,s[4:7],s32 offen offset:1024 lds
buffer_load_dwordx4 v12,s[4:7],s32 offen offset:2048 lds
buffer_load_dwordx4 v13,s[4:7],s32 offen offset:3072 lds
s_mov_b32 m0,49152
s_mov_b32 s32,442368
buffer_load_dwordx4 v10,s[4:7],s32 offen offset:0 lds
buffer_load_dwordx4 v11,s[4:7],s32 offen offset:1024 lds
buffer_load_dwordx4 v12,s[4:7],s32 offen offset:2048 lds
buffer_load_dwordx4 v13,s[4:7],s32 offen offset:3072 lds
s_mov_b32 m0,53248
s_mov_b32 s32,479232
buffer_load_dwordx4 v10,s[4:7],s32 offen offset:0 lds
buffer_load_dwordx4 v11,s[4:7],s32 offen offset:1024 lds
buffer_load_dwordx4 v12,s[4:7],s32 offen offset:2048 lds
buffer_load_dwordx4 v13,s[4:7],s32 offen offset:3072 lds
s_mov_b32 m0,57344
s_mov_b32 s32,516096
buffer_load_dwordx4 v10,s[4:7],s32 offen offset:0 lds
buffer_load_dwordx4 v11,s[4:7],s32 offen offset:1024 lds
buffer_load_dwordx4 v12,s[4:7],s32 offen offset:2048 lds
buffer_load_dwordx4 v13,s[4:7],s32 offen offset:3072 lds
s_waitcnt vmcnt(36)
s_barrier
s_mov_b32 m0,61440
s_mov_b32 s32,552960
buffer_load_dwordx4 v10,s[4:7],s32 offen offset:0 lds
buffer_load_dwordx4 v11,s[4:7],s32 offen offset:1024 lds
buffer_load_dwordx4 v12,s[4:7],s32 offen offset:2048 lds
buffer_load_dwordx4 v13,s[4:7],s32 offen offset:3072 lds
s_mov_b32 m0,65536
s_mov_b32 s32,589824
buffer_load_dwordx4 v10,s[4:7],s32 offen offset:0 lds
buffer_load_dwordx4 v11,s[4:7],s32 offen offset:1024 lds
buffer_load_dwordx4 v12,s[4:7],s32 offen offset:2048 lds
buffer_load_dwordx4 v13,s[4:7],s32 offen offset:3072 lds
s_mov_b32 m0,69632
s_mov_b32 s32,626688
buffer_load_dwordx4 v10,s[4:7],s32 offen offset:0 lds
buffer_load_dwordx4 v11,s[4:7],s32 offen offset:1024 lds
buffer_load_dwordx4 v12,s[4:7],s32 offen offset:2048 lds
buffer_load_dwordx4 v13,s[4:7],s32 offen offset:3072 lds
s_waitcnt vmcnt(36)
s_barrier
s_waitcnt vmcnt(24)
s_barrier
s_waitcnt vmcnt(12)
s_barrier
s_waitcnt vmcnt(0)
s_barrier
s_barrier
s_mov_b64 exec,-1
s_waitcnt vmcnt(0) lgkmcnt(0)
s_barrier
s_cmp_lg_u32 s26,0
s_cbranch_scc1 ffn_kernel_main
s_add_u32 s16,s24,6029312
s_addc_u32 s17,s25,0
s_mov_b32 s18,32768
s_mov_b32 s19,0x20000
s_lshl_b32 s30,s2,7
v_mov_b32 v1,1
buffer_store_dword v1,off,s[16:19],s30 sc1
s_branch ffn_kernel_main
oproj_part_ld1:
v_lshrrev_b32 v6,3,v94
v_and_b32 v8,7,v94
v_xor_b32 v20,v6,v8
v_and_b32 v20,7,v20
s_mul_i32 s31,s27,18432
s_lshl_b32 s30,s28,7
s_add_u32 s31,s31,s30
v_mul_u32_u24 v21,1152,v6
v_lshl_add_u32 v21,v20,4,v21
v_add_u32 v21,s31,v21
s_mul_i32 s29,s27,18432
s_waitcnt lgkmcnt(0)
s_mov_b32 s12,s20
s_mov_b32 s13,s21
s_mov_b32 s14,2359296
s_mov_b32 s15,0x20000
s_mov_b32 s8,s24
s_mov_b32 s9,s25
s_mov_b32 s10,2359296
s_mov_b32 s11,0x20000
s_mov_b32 m0,88064
s_add_u32 s32,s29,0
buffer_load_dwordx4 v95,s[8:11],s32 offen offset:0 lds
buffer_load_dwordx4 v95,s[8:11],s32 offen offset:1024 lds
buffer_load_dwordx4 v95,s[8:11],s32 offen offset:2048 lds
s_mov_b32 m0,91136
s_add_u32 s32,s29,18432
buffer_load_dwordx4 v95,s[8:11],s32 offen offset:0 lds
buffer_load_dwordx4 v95,s[8:11],s32 offen offset:1024 lds
buffer_load_dwordx4 v95,s[8:11],s32 offen offset:2048 lds
s_mov_b32 m0,94208
s_add_u32 s32,s29,36864
buffer_load_dwordx4 v95,s[8:11],s32 offen offset:0 lds
buffer_load_dwordx4 v95,s[8:11],s32 offen offset:1024 lds
buffer_load_dwordx4 v95,s[8:11],s32 offen offset:2048 lds
s_mov_b32 m0,97280
s_add_u32 s32,s29,55296
buffer_load_dwordx4 v95,s[8:11],s32 offen offset:0 lds
buffer_load_dwordx4 v95,s[8:11],s32 offen offset:1024 lds
buffer_load_dwordx4 v95,s[8:11],s32 offen offset:2048 lds
s_mov_b32 m0,100352
s_add_u32 s32,s29,73728
buffer_load_dwordx4 v95,s[8:11],s32 offen offset:0 lds
buffer_load_dwordx4 v95,s[8:11],s32 offen offset:1024 lds
buffer_load_dwordx4 v95,s[8:11],s32 offen offset:2048 lds
s_mov_b32 m0,103424
s_add_u32 s32,s29,92160
buffer_load_dwordx4 v95,s[8:11],s32 offen offset:0 lds
buffer_load_dwordx4 v95,s[8:11],s32 offen offset:1024 lds
buffer_load_dwordx4 v95,s[8:11],s32 offen offset:2048 lds
s_mov_b32 m0,106496
s_add_u32 s32,s29,3072
buffer_load_dwordx4 v95,s[8:11],s32 offen offset:0 lds
buffer_load_dwordx4 v95,s[8:11],s32 offen offset:1024 lds
buffer_load_dwordx4 v95,s[8:11],s32 offen offset:2048 lds
s_mov_b32 m0,109568
s_add_u32 s32,s29,21504
buffer_load_dwordx4 v95,s[8:11],s32 offen offset:0 lds
buffer_load_dwordx4 v95,s[8:11],s32 offen offset:1024 lds
buffer_load_dwordx4 v95,s[8:11],s32 offen offset:2048 lds
s_mov_b32 m0,112640
s_add_u32 s32,s29,39936
buffer_load_dwordx4 v95,s[8:11],s32 offen offset:0 lds
buffer_load_dwordx4 v95,s[8:11],s32 offen offset:1024 lds
buffer_load_dwordx4 v95,s[8:11],s32 offen offset:2048 lds
s_mov_b32 m0,115712
s_add_u32 s32,s29,58368
buffer_load_dwordx4 v95,s[8:11],s32 offen offset:0 lds
buffer_load_dwordx4 v95,s[8:11],s32 offen offset:1024 lds
buffer_load_dwordx4 v95,s[8:11],s32 offen offset:2048 lds
s_mov_b32 m0,118784
s_add_u32 s32,s29,76800
buffer_load_dwordx4 v95,s[8:11],s32 offen offset:0 lds
buffer_load_dwordx4 v95,s[8:11],s32 offen offset:1024 lds
buffer_load_dwordx4 v95,s[8:11],s32 offen offset:2048 lds
s_mov_b32 m0,121856
s_add_u32 s32,s29,95232
buffer_load_dwordx4 v95,s[8:11],s32 offen offset:0 lds
buffer_load_dwordx4 v95,s[8:11],s32 offen offset:1024 lds
buffer_load_dwordx4 v95,s[8:11],s32 offen offset:2048 lds
s_mov_b32 m0,124928
s_add_u32 s32,s29,6144
buffer_load_dwordx4 v95,s[8:11],s32 offen offset:0 lds
buffer_load_dwordx4 v95,s[8:11],s32 offen offset:1024 lds
buffer_load_dwordx4 v95,s[8:11],s32 offen offset:2048 lds
s_mov_b32 m0,128000
s_add_u32 s32,s29,24576
buffer_load_dwordx4 v95,s[8:11],s32 offen offset:0 lds
buffer_load_dwordx4 v95,s[8:11],s32 offen offset:1024 lds
buffer_load_dwordx4 v95,s[8:11],s32 offen offset:2048 lds
s_mov_b32 m0,131072
s_add_u32 s32,s29,43008
buffer_load_dwordx4 v95,s[8:11],s32 offen offset:0 lds
buffer_load_dwordx4 v95,s[8:11],s32 offen offset:1024 lds
buffer_load_dwordx4 v95,s[8:11],s32 offen offset:2048 lds
s_mov_b32 m0,134144
s_add_u32 s32,s29,61440
buffer_load_dwordx4 v95,s[8:11],s32 offen offset:0 lds
buffer_load_dwordx4 v95,s[8:11],s32 offen offset:1024 lds
buffer_load_dwordx4 v95,s[8:11],s32 offen offset:2048 lds
s_mov_b32 m0,137216
s_add_u32 s32,s29,79872
buffer_load_dwordx4 v95,s[8:11],s32 offen offset:0 lds
buffer_load_dwordx4 v95,s[8:11],s32 offen offset:1024 lds
buffer_load_dwordx4 v95,s[8:11],s32 offen offset:2048 lds
s_mov_b32 m0,140288
s_add_u32 s32,s29,98304
buffer_load_dwordx4 v95,s[8:11],s32 offen offset:0 lds
buffer_load_dwordx4 v95,s[8:11],s32 offen offset:1024 lds
buffer_load_dwordx4 v95,s[8:11],s32 offen offset:2048 lds
s_waitcnt vmcnt(36)
s_barrier
s_mov_b32 m0,143360
s_add_u32 s32,s29,9216
buffer_load_dwordx4 v95,s[8:11],s32 offen offset:0 lds
buffer_load_dwordx4 v95,s[8:11],s32 offen offset:1024 lds
buffer_load_dwordx4 v95,s[8:11],s32 offen offset:2048 lds
s_mov_b32 m0,146432
s_add_u32 s32,s29,27648
buffer_load_dwordx4 v95,s[8:11],s32 offen offset:0 lds
buffer_load_dwordx4 v95,s[8:11],s32 offen offset:1024 lds
buffer_load_dwordx4 v95,s[8:11],s32 offen offset:2048 lds
s_mov_b32 m0,149504
s_add_u32 s32,s29,46080
buffer_load_dwordx4 v95,s[8:11],s32 offen offset:0 lds
buffer_load_dwordx4 v95,s[8:11],s32 offen offset:1024 lds
buffer_load_dwordx4 v95,s[8:11],s32 offen offset:2048 lds
s_mov_b32 m0,152576
s_add_u32 s32,s29,64512
buffer_load_dwordx4 v95,s[8:11],s32 offen offset:0 lds
buffer_load_dwordx4 v95,s[8:11],s32 offen offset:1024 lds
buffer_load_dwordx4 v95,s[8:11],s32 offen offset:2048 lds
s_mov_b32 m0,155648
s_add_u32 s32,s29,82944
buffer_load_dwordx4 v95,s[8:11],s32 offen offset:0 lds
buffer_load_dwordx4 v95,s[8:11],s32 offen offset:1024 lds
buffer_load_dwordx4 v95,s[8:11],s32 offen offset:2048 lds
s_mov_b32 m0,158720
s_add_u32 s32,s29,101376
buffer_load_dwordx4 v95,s[8:11],s32 offen offset:0 lds
buffer_load_dwordx4 v95,s[8:11],s32 offen offset:1024 lds
buffer_load_dwordx4 v95,s[8:11],s32 offen offset:2048 lds
s_waitcnt vmcnt(36)
s_barrier
s_mov_b32 m0,75776
s_mov_b32 s32,0
buffer_load_dwordx4 v21,s[12:15],s32 offen lds
s_mov_b32 m0,76800
s_mov_b32 s32,9216
buffer_load_dwordx4 v21,s[12:15],s32 offen lds
s_mov_b32 m0,77824
s_mov_b32 s32,18432
buffer_load_dwordx4 v21,s[12:15],s32 offen lds
s_mov_b32 m0,78848
s_mov_b32 s32,27648
buffer_load_dwordx4 v21,s[12:15],s32 offen lds
s_mov_b32 m0,79872
s_mov_b32 s32,36864
buffer_load_dwordx4 v21,s[12:15],s32 offen lds
s_mov_b32 m0,80896
s_mov_b32 s32,46080
buffer_load_dwordx4 v21,s[12:15],s32 offen lds
s_mov_b32 m0,81920
s_mov_b32 s32,55296
buffer_load_dwordx4 v21,s[12:15],s32 offen lds
s_mov_b32 m0,82944
s_mov_b32 s32,64512
buffer_load_dwordx4 v21,s[12:15],s32 offen lds
s_mov_b32 m0,83968
s_mov_b32 s32,73728
buffer_load_dwordx4 v21,s[12:15],s32 offen lds
s_mov_b32 m0,84992
s_mov_b32 s32,82944
buffer_load_dwordx4 v21,s[12:15],s32 offen lds
s_mov_b32 m0,86016
s_mov_b32 s32,92160
buffer_load_dwordx4 v21,s[12:15],s32 offen lds
s_mov_b32 m0,87040
s_mov_b32 s32,101376
buffer_load_dwordx4 v21,s[12:15],s32 offen lds
s_waitcnt vmcnt(30)
s_barrier
s_mov_b32 m0,88064
s_add_u32 s32,s29,12288
buffer_load_dwordx4 v95,s[8:11],s32 offen offset:0 lds
buffer_load_dwordx4 v95,s[8:11],s32 offen offset:1024 lds
buffer_load_dwordx4 v95,s[8:11],s32 offen offset:2048 lds
s_mov_b32 m0,91136
s_add_u32 s32,s29,30720
buffer_load_dwordx4 v95,s[8:11],s32 offen offset:0 lds
buffer_load_dwordx4 v95,s[8:11],s32 offen offset:1024 lds
buffer_load_dwordx4 v95,s[8:11],s32 offen offset:2048 lds
s_mov_b32 m0,94208
s_add_u32 s32,s29,49152
buffer_load_dwordx4 v95,s[8:11],s32 offen offset:0 lds
buffer_load_dwordx4 v95,s[8:11],s32 offen offset:1024 lds
buffer_load_dwordx4 v95,s[8:11],s32 offen offset:2048 lds
s_mov_b32 m0,97280
s_add_u32 s32,s29,67584
buffer_load_dwordx4 v95,s[8:11],s32 offen offset:0 lds
buffer_load_dwordx4 v95,s[8:11],s32 offen offset:1024 lds
buffer_load_dwordx4 v95,s[8:11],s32 offen offset:2048 lds
s_mov_b32 m0,100352
s_add_u32 s32,s29,86016
buffer_load_dwordx4 v95,s[8:11],s32 offen offset:0 lds
buffer_load_dwordx4 v95,s[8:11],s32 offen offset:1024 lds
buffer_load_dwordx4 v95,s[8:11],s32 offen offset:2048 lds
s_mov_b32 m0,103424
s_add_u32 s32,s29,104448
buffer_load_dwordx4 v95,s[8:11],s32 offen offset:0 lds
buffer_load_dwordx4 v95,s[8:11],s32 offen offset:1024 lds
buffer_load_dwordx4 v95,s[8:11],s32 offen offset:2048 lds
s_waitcnt vmcnt(30)
s_barrier
s_mov_b32 m0,106496
s_add_u32 s32,s29,15360
buffer_load_dwordx4 v95,s[8:11],s32 offen offset:0 lds
buffer_load_dwordx4 v95,s[8:11],s32 offen offset:1024 lds
buffer_load_dwordx4 v95,s[8:11],s32 offen offset:2048 lds
s_mov_b32 m0,109568
s_add_u32 s32,s29,33792
buffer_load_dwordx4 v95,s[8:11],s32 offen offset:0 lds
buffer_load_dwordx4 v95,s[8:11],s32 offen offset:1024 lds
buffer_load_dwordx4 v95,s[8:11],s32 offen offset:2048 lds
s_mov_b32 m0,112640
s_add_u32 s32,s29,52224
buffer_load_dwordx4 v95,s[8:11],s32 offen offset:0 lds
buffer_load_dwordx4 v95,s[8:11],s32 offen offset:1024 lds
buffer_load_dwordx4 v95,s[8:11],s32 offen offset:2048 lds
s_mov_b32 m0,115712
s_add_u32 s32,s29,70656
buffer_load_dwordx4 v95,s[8:11],s32 offen offset:0 lds
buffer_load_dwordx4 v95,s[8:11],s32 offen offset:1024 lds
buffer_load_dwordx4 v95,s[8:11],s32 offen offset:2048 lds
s_mov_b32 m0,118784
s_add_u32 s32,s29,89088
buffer_load_dwordx4 v95,s[8:11],s32 offen offset:0 lds
buffer_load_dwordx4 v95,s[8:11],s32 offen offset:1024 lds
buffer_load_dwordx4 v95,s[8:11],s32 offen offset:2048 lds
s_mov_b32 m0,121856
s_add_u32 s32,s29,107520
buffer_load_dwordx4 v95,s[8:11],s32 offen offset:0 lds
buffer_load_dwordx4 v95,s[8:11],s32 offen offset:1024 lds
buffer_load_dwordx4 v95,s[8:11],s32 offen offset:2048 lds
s_waitcnt vmcnt(18)
s_barrier
s_waitcnt vmcnt(0)
s_barrier
s_barrier
s_mov_b64 exec,-1
s_waitcnt vmcnt(0) lgkmcnt(0)
s_barrier
s_cmp_lg_u32 s26,0
s_cbranch_scc1 ffn_kernel_main
s_add_u32 s16,s24,6029312
s_addc_u32 s17,s25,0
s_mov_b32 s18,32768
s_mov_b32 s19,0x20000
s_lshl_b32 s30,s2,7
v_mov_b32 v1,1
buffer_store_dword v1,off,s[16:19],s30 sc1
s_branch ffn_kernel_main
ffn_kernel_main:
v_mov_b32 v0,v200
s_load_dwordx4 s[20:23],s[0:1],32
s_load_dwordx2 s[24:25],s[0:1],48
s_load_dwordx2 s[26:27],s[0:1],72
v_lshrrev_b32 v1,6,v0
v_and_b32 v255,63,v0
v_readfirstlane_b32 s28,v1
s_and_b32 s31,s2,7
s_lshl_b32 s31,s31,1
s_lshr_b32 s37,s2,3
s_and_b32 s37,s37,1
s_add_u32 s31,s31,s37
s_lshr_b32 s30,s2,4
s_and_b32 s32,s30,3
s_mul_i32 s43,s31,288
s_and_b32 s37,s31,1
s_lshl_b32 s44,s37,5
s_add_u32 s33,s43,s44
s_xor_b32 s37,s37,1
s_lshl_b32 s44,s37,8
s_add_u32 s34,s43,s44
s_and_b32 s41,s28,3
s_lshl_b32 s29,s41,10
s_lshr_b32 s42,s28,2
v_lshlrev_b32 v254,4,v255
v_lshrrev_b32 v2,4,v255
v_lshrrev_b32 v6,3,v255
v_bfe_u32 v7,v255,4,2
v_lshlrev_b32 v7,1,v7
v_and_b32 v8,7,v255
v_xor_b32 v8,v7,v8
s_lshl_b32 s37,s41,3
v_add_u32 v9,s37,v6
s_mov_b32 s43,9216
v_mul_lo_u32 v9,v9,s43
v_lshl_add_u32 v245,v8,4,v9
v_and_b32 v6,31,v255
s_lshl_b32 s37,s30,7
s_lshl_b32 s43,s41,5
s_add_u32 s37,s37,s43
v_add_lshl_u32 v6,s37,v6,2
v_lshrrev_b32 v7,5,v255
v_lshl_add_u32 v6,v7,13,v6
s_waitcnt lgkmcnt(0)
s_mov_b32 s4,s20
s_mov_b32 s5,s21
s_mov_b32 s6,5308416
s_mov_b32 s7,0x20000
s_mov_b32 s52,s22
s_mov_b32 s53,s23
s_mov_b32 s54,5308416
s_mov_b32 s55,0x20000
s_add_u32 s12,s26,2359296
s_addc_u32 s13,s27,0
s_mov_b32 s14,2359296
s_mov_b32 s15,0x20000
s_add_u32 s16,s26,5636096
s_addc_u32 s17,s27,0
s_mov_b32 s18,147456
s_mov_b32 s19,0x20000
s_cmp_ge_u32 s28,4
s_cbranch_scc1 ffn_kernel_grpB
s_add_u32 m0,s29,0
s_add_u32 s37,s32,0
s_and_b32 s37,s37,3
s_lshl_b32 s37,s37,7
s_lshl_b32 s43,s33,1
s_add_u32 s35,s43,s37
buffer_load_dwordx4 v245,s[4:7],s35 offen lds
s_add_u32 m0,s29,4096
s_nop 0
buffer_load_dwordx4 v245,s[52:55],s35 offen lds
s_add_u32 m0,s29,8192
s_add_u32 s35,s35,294912
buffer_load_dwordx4 v245,s[4:7],s35 offen lds
s_add_u32 m0,s29,12288
s_nop 0
buffer_load_dwordx4 v245,s[52:55],s35 offen lds
s_add_u32 m0,s29,16384
s_add_u32 s35,s35,294912
buffer_load_dwordx4 v245,s[4:7],s35 offen lds
s_add_u32 m0,s29,20480
s_nop 0
buffer_load_dwordx4 v245,s[52:55],s35 offen lds
s_add_u32 m0,s29,24576
s_add_u32 s35,s35,294912
buffer_load_dwordx4 v245,s[4:7],s35 offen lds
s_add_u32 m0,s29,28672
s_nop 0
buffer_load_dwordx4 v245,s[52:55],s35 offen lds
s_add_u32 m0,s29,32768
s_add_u32 s35,s35,294912
buffer_load_dwordx4 v245,s[4:7],s35 offen lds
s_add_u32 m0,s29,36864
s_nop 0
buffer_load_dwordx4 v245,s[52:55],s35 offen lds
s_add_u32 m0,s29,40960
s_add_u32 s35,s35,294912
buffer_load_dwordx4 v245,s[4:7],s35 offen lds
s_add_u32 m0,s29,45056
s_nop 0
buffer_load_dwordx4 v245,s[52:55],s35 offen lds
s_barrier
s_mov_b32 s37,0
buffer_load_dword v16,v6,s[16:19],s37 offen sc1
s_mov_b32 s37,16384
buffer_load_dword v17,v6,s[16:19],s37 offen sc1
s_mov_b32 s37,32768
buffer_load_dword v18,v6,s[16:19],s37 offen sc1
s_mov_b32 s37,49152
buffer_load_dword v19,v6,s[16:19],s37 offen sc1
s_mov_b32 s37,65536
buffer_load_dword v20,v6,s[16:19],s37 offen sc1
s_mov_b32 s37,81920
buffer_load_dword v21,v6,s[16:19],s37 offen sc1
s_mov_b32 s37,98304
buffer_load_dword v22,v6,s[16:19],s37 offen sc1
s_mov_b32 s37,114688
buffer_load_dword v23,v6,s[16:19],s37 offen sc1
s_mov_b32 s37,131072
buffer_load_dword v24,v6,s[16:19],s37 offen sc1
s_add_u32 m0,s29,65536
s_lshl_b32 s36,s30,3
s_add_u32 s36,s36,s41
s_mul_i32 s36,s36,18432
buffer_load_dwordx4 v254,s[12:15],s36 offen sc1 lds
s_add_u32 m0,s29,69632
s_add_u32 s45,s36,73728
buffer_load_dwordx4 v254,s[12:15],s45 offen sc1 lds
s_add_u32 m0,s29,73728
s_add_u32 s36,s36,1024
buffer_load_dwordx4 v254,s[12:15],s36 offen sc1 lds
s_add_u32 m0,s29,77824
s_add_u32 s45,s36,73728
buffer_load_dwordx4 v254,s[12:15],s45 offen sc1 lds
s_add_u32 m0,s29,81920
s_add_u32 s36,s36,1024
buffer_load_dwordx4 v254,s[12:15],s36 offen sc1 lds
s_add_u32 m0,s29,86016
s_add_u32 s45,s36,73728
buffer_load_dwordx4 v254,s[12:15],s45 offen sc1 lds
s_add_u32 m0,s29,90112
s_add_u32 s36,s36,1024
buffer_load_dwordx4 v254,s[12:15],s36 offen sc1 lds
s_add_u32 m0,s29,94208
s_add_u32 s45,s36,73728
buffer_load_dwordx4 v254,s[12:15],s45 offen sc1 lds
s_add_u32 m0,s29,98304
s_add_u32 s36,s36,1024
buffer_load_dwordx4 v254,s[12:15],s36 offen sc1 lds
s_add_u32 m0,s29,102400
s_add_u32 s45,s36,73728
buffer_load_dwordx4 v254,s[12:15],s45 offen sc1 lds
s_add_u32 m0,s29,106496
s_add_u32 s36,s36,1024
buffer_load_dwordx4 v254,s[12:15],s36 offen sc1 lds
s_add_u32 m0,s29,110592
s_add_u32 s45,s36,73728
buffer_load_dwordx4 v254,s[12:15],s45 offen sc1 lds
s_add_u32 s37,s32,0
s_and_b32 s37,s37,3
s_lshl_b32 s37,s37,6
s_add_u32 s37,s37,s33
s_mul_i32 s46,s37,1152
s_add_u32 s37,s32,1
s_and_b32 s37,s37,3
s_lshl_b32 s37,s37,6
s_add_u32 s37,s37,s33
s_mul_i32 s47,s37,1152
s_add_u32 s37,s32,2
s_and_b32 s37,s37,3
s_lshl_b32 s37,s37,6
s_add_u32 s37,s37,s33
s_mul_i32 s48,s37,1152
s_add_u32 s37,s32,3
s_and_b32 s37,s37,3
s_lshl_b32 s37,s37,6
s_add_u32 s37,s37,s33
s_mul_i32 s49,s37,1152
s_mul_i32 s88,s34,1152
s_xor_b32 s43,s31,1
s_mul_i32 s44,s43,288
s_and_b32 s43,s43,1
s_lshl_b32 s40,s43,5
s_add_u32 s40,s40,s44
s_xor_b32 s43,s43,1
s_lshl_b32 s43,s43,8
s_add_u32 s43,s43,s44
s_mul_i32 s89,s43,1152
s_add_u32 s37,s32,0
s_and_b32 s37,s37,3
s_lshl_b32 s37,s37,6
s_add_u32 s37,s37,s40
s_mul_i32 s84,s37,1152
s_add_u32 s37,s32,1
s_and_b32 s37,s37,3
s_lshl_b32 s37,s37,6
s_add_u32 s37,s37,s40
s_mul_i32 s85,s37,1152
s_add_u32 s37,s32,2
s_and_b32 s37,s37,3
s_lshl_b32 s37,s37,6
s_add_u32 s37,s37,s40
s_mul_i32 s86,s37,1152
s_add_u32 s37,s32,3
s_and_b32 s37,s37,3
s_lshl_b32 s37,s37,6
s_add_u32 s37,s37,s40
s_mul_i32 s87,s37,1152
s_and_b32 s43,s31,1
s_mul_i32 s44,s43,640
s_and_b32 s37,s30,1
s_lshl_b32 s37,s37,8
s_add_u32 s90,s44,s37
s_xor_b32 s37,s37,256
s_add_u32 s91,s44,s37
s_lshl_b32 s43,s43,6
s_add_u32 s92,s43,512
s_mul_i32 s93,s2,73728
s_xor_b32 s37,s2,8
s_mul_i32 s94,s37,73728
s_mul_i32 s37,s41,18432
s_add_u32 s93,s93,s37
s_add_u32 s94,s94,s37
v_bfe_u32 v3,v255,2,2
v_and_b32 v4,3,v255
v_lshl_add_u32 v5,v2,2,v3
v_bfe_u32 v6,v5,1,2
s_lshl_b32 s37,s42,1
v_xor_b32 v6,s37,v6
v_lshlrev_b32 v7,7,v5
v_lshl_add_u32 v7,v4,3,v7
v_lshl_add_u32 v242,v6,5,v7
v_xor_b32 v243,32,v242
v_and_b32 v6,1,v2
v_xor_b32 v6,s42,v6
v_lshlrev_b32 v7,6,v5
v_lshl_add_u32 v7,v4,3,v7
v_lshl_add_u32 v244,v6,5,v7
s_mov_b32 s43,9216
v_lshrrev_b32 v6,2,v255
v_bfe_u32 v7,v255,4,1
v_lshlrev_b32 v7,1,v7
v_and_b32 v8,3,v255
v_xor_b32 v8,v7,v8
s_lshl_b32 s37,s41,4
v_add_u32 v9,s37,v6
v_mul_lo_u32 v9,v9,s43
v_lshl_add_u32 v246,v8,4,v9
s_mul_i32 s37,s41,18432
s_add_u32 s37,s37,65536
v_add_u32 v247,s37,v254
s_lshl_b32 s37,s42,11
v_add_u32 v253,s37,v247
s_lshl_b32 s37,s41,11
s_add_u32 s37,s37,65536
v_add_u32 v252,s37,v254
s_mov_b32 s8,s24
s_mov_b32 s9,s25
s_mov_b32 s10,5308416
s_mov_b32 s11,0x20000
s_add_u32 s64,s26,5898240
s_addc_u32 s65,s27,0
s_mov_b32 s66,131072
s_mov_b32 s67,0x20000
s_add_u32 s68,s26,25165824
s_addc_u32 s69,s27,0
s_mov_b32 s70,18874368
s_mov_b32 s71,0x20000
s_waitcnt vmcnt(12)
v_add_f32 v16,v16,v17
v_add_f32 v18,v18,v19
v_add_f32 v20,v20,v21
v_add_f32 v22,v22,v23
v_add_f32 v16,v16,v18
v_add_f32 v20,v20,v22
v_add_f32 v16,v16,v20
v_add_f32 v16,v16,v24
v_mov_b32 v17,v16
s_nop 1
v_permlane32_swap_b32 v16,v17
s_nop 0
v_add_f32 v16,v16,v17
v_mov_b32 v20,v16
s_nop 1
v_permlane16_swap_b32 v16,v20
s_nop 0
v_mov_b32 v17,925353388
s_mov_b32 s95,987991609
v_fma_f32 v238,v16,s95,v17
v_rsq_f32 v16,v238
s_nop 0
s_mov_b32 s95,3222493025
v_mul_f32 v236,s95,v16
v_mul_f32 v17,v16,v16
v_mul_f32 v17,v17,v16
s_mov_b32 s95,3184710632
v_mul_f32 v237,s95,v17
v_mov_b32 v21,925353388
s_mov_b32 s95,987991609
v_fma_f32 v241,v20,s95,v21
v_rsq_f32 v20,v241
s_nop 0
s_mov_b32 s95,3222493025
v_mul_f32 v239,s95,v20
v_mul_f32 v21,v20,v20
v_mul_f32 v21,v21,v20
s_mov_b32 s95,3184710632
v_mul_f32 v240,s95,v21
s_lshr_b32 s37,s31,1
s_mul_i32 s37,s37,2359296
s_add_u32 s37,s37,6291456
s_add_u32 s16,s26,s37
s_addc_u32 s17,s27,0
s_mov_b32 s18,2359296
s_mov_b32 s19,0x20000
s_lshl_b32 s37,s30,3
s_lshl_b32 s43,s41,1
s_add_u32 s37,s37,s43
s_mul_i32 s39,s37,18432
s_waitcnt vmcnt(6)
s_barrier
ds_read_b128 v[0:3],v252 offset:0
ds_read_b128 v[4:7],v252 offset:1024
ds_read_b64_tr_b16 v[208:209],v242 offset:0
ds_read_b64_tr_b16 v[210:211],v242 offset:2048
ds_read_b64_tr_b16 v[212:213],v243 offset:0
ds_read_b64_tr_b16 v[214:215],v243 offset:2048
ds_read_b64_tr_b16 v[216:217],v242 offset:4096
ds_read_b64_tr_b16 v[218:219],v242 offset:6144
s_waitcnt lgkmcnt(4)
v_mfma_f32_16x16x32_bf16 v[144:147],v[208:211],v[0:3],0
ds_read_b64_tr_b16 v[220:221],v243 offset:4096
v_mfma_f32_16x16x32_bf16 v[148:151],v[208:211],v[4:7],0
ds_read_b64_tr_b16 v[222:223],v243 offset:6144
s_waitcnt lgkmcnt(4)
v_mfma_f32_16x16x32_bf16 v[152:155],v[212:215],v[0:3],0
ds_read_b64_tr_b16 v[208:209],v242 offset:8192
s_add_u32 m0,s29,49152
s_add_u32 s35,s35,294912
buffer_load_dwordx4 v245,s[4:7],s35 offen lds
s_add_u32 m0,s29,53248
s_nop 0
buffer_load_dwordx4 v245,s[52:55],s35 offen lds
s_add_u32 m0,s29,114688
s_add_u32 s36,s36,1024
buffer_load_dwordx4 v254,s[12:15],s36 offen sc1 lds
s_add_u32 m0,s29,118784
s_add_u32 s45,s36,73728
buffer_load_dwordx4 v254,s[12:15],s45 offen sc1 lds
v_mfma_f32_16x16x32_bf16 v[156:159],v[212:215],v[4:7],0
ds_read_b64_tr_b16 v[210:211],v242 offset:10240
s_waitcnt lgkmcnt(4)
v_mfma_f32_16x16x32_bf16 v[160:163],v[216:219],v[0:3],0
ds_read_b64_tr_b16 v[212:213],v243 offset:8192
v_mfma_f32_16x16x32_bf16 v[164:167],v[216:219],v[4:7],0
ds_read_b64_tr_b16 v[214:215],v243 offset:10240
s_waitcnt lgkmcnt(4)
v_mfma_f32_16x16x32_bf16 v[168:171],v[220:223],v[0:3],0
ds_read_b64_tr_b16 v[216:217],v242 offset:12288
v_mfma_f32_16x16x32_bf16 v[172:175],v[220:223],v[4:7],0
ds_read_b64_tr_b16 v[218:219],v242 offset:14336
ds_read_b128 v[8:11],v252 offset:8192
ds_read_b128 v[12:15],v252 offset:9216
s_waitcnt lgkmcnt(0)
v_mfma_f32_16x16x32_bf16 v[144:147],v[208:211],v[8:11],v[144:147]
ds_read_b64_tr_b16 v[220:221],v243 offset:12288
v_mfma_f32_16x16x32_bf16 v[148:151],v[208:211],v[12:15],v[148:151]
ds_read_b64_tr_b16 v[222:223],v243 offset:14336
v_mfma_f32_16x16x32_bf16 v[152:155],v[212:215],v[8:11],v[152:155]
ds_read_b64_tr_b16 v[208:209],v242 offset:16384
s_add_u32 m0,s29,57344
s_add_u32 s35,s35,294912
buffer_load_dwordx4 v245,s[4:7],s35 offen lds
s_add_u32 m0,s29,61440
s_nop 0
buffer_load_dwordx4 v245,s[52:55],s35 offen lds
s_add_u32 m0,s29,122880
s_add_u32 s36,s36,1024
buffer_load_dwordx4 v254,s[12:15],s36 offen sc1 lds
s_add_u32 m0,s29,126976
s_add_u32 s45,s36,73728
buffer_load_dwordx4 v254,s[12:15],s45 offen sc1 lds
v_mfma_f32_16x16x32_bf16 v[156:159],v[212:215],v[12:15],v[156:159]
ds_read_b64_tr_b16 v[210:211],v242 offset:18432
v_mfma_f32_16x16x32_bf16 v[160:163],v[216:219],v[8:11],v[160:163]
ds_read_b64_tr_b16 v[212:213],v243 offset:16384
v_mfma_f32_16x16x32_bf16 v[164:167],v[216:219],v[12:15],v[164:167]
ds_read_b64_tr_b16 v[214:215],v243 offset:18432
s_waitcnt lgkmcnt(4)
v_mfma_f32_16x16x32_bf16 v[168:171],v[220:223],v[8:11],v[168:171]
ds_read_b64_tr_b16 v[216:217],v242 offset:20480
v_mfma_f32_16x16x32_bf16 v[172:175],v[220:223],v[12:15],v[172:175]
ds_read_b64_tr_b16 v[218:219],v242 offset:22528
ds_read_b128 v[16:19],v252 offset:16384
ds_read_b128 v[20:23],v252 offset:17408
s_waitcnt vmcnt(10)
s_barrier
s_waitcnt lgkmcnt(0)
v_mfma_f32_16x16x32_bf16 v[144:147],v[208:211],v[16:19],v[144:147]
ds_read_b64_tr_b16 v[220:221],v243 offset:20480
v_mfma_f32_16x16x32_bf16 v[148:151],v[208:211],v[20:23],v[148:151]
ds_read_b64_tr_b16 v[222:223],v243 offset:22528
v_mfma_f32_16x16x32_bf16 v[152:155],v[212:215],v[16:19],v[152:155]
ds_read_b64_tr_b16 v[208:209],v242 offset:24576
s_add_u32 m0,s29,0
s_add_u32 s35,s35,294912
buffer_load_dwordx4 v245,s[4:7],s35 offen lds
s_add_u32 m0,s29,4096
s_nop 0
buffer_load_dwordx4 v245,s[52:55],s35 offen lds
s_add_u32 m0,s29,65536
s_add_u32 s36,s36,1024
buffer_load_dwordx4 v254,s[12:15],s36 offen sc1 lds
s_add_u32 m0,s29,69632
s_add_u32 s45,s36,73728
buffer_load_dwordx4 v254,s[12:15],s45 offen sc1 lds
v_mfma_f32_16x16x32_bf16 v[156:159],v[212:215],v[20:23],v[156:159]
ds_read_b64_tr_b16 v[210:211],v242 offset:26624
v_mfma_f32_16x16x32_bf16 v[160:163],v[216:219],v[16:19],v[160:163]
ds_read_b64_tr_b16 v[212:213],v243 offset:24576
v_mfma_f32_16x16x32_bf16 v[164:167],v[216:219],v[20:23],v[164:167]
ds_read_b64_tr_b16 v[214:215],v243 offset:26624
s_waitcnt lgkmcnt(4)
v_mfma_f32_16x16x32_bf16 v[168:171],v[220:223],v[16:19],v[168:171]
ds_read_b64_tr_b16 v[216:217],v242 offset:28672
v_mfma_f32_16x16x32_bf16 v[172:175],v[220:223],v[20:23],v[172:175]
ds_read_b64_tr_b16 v[218:219],v242 offset:30720
ds_read_b128 v[24:27],v252 offset:24576
ds_read_b128 v[28:31],v252 offset:25600
s_waitcnt lgkmcnt(0)
v_mfma_f32_16x16x32_bf16 v[144:147],v[208:211],v[24:27],v[144:147]
ds_read_b64_tr_b16 v[220:221],v243 offset:28672
v_mfma_f32_16x16x32_bf16 v[148:151],v[208:211],v[28:31],v[148:151]
ds_read_b64_tr_b16 v[222:223],v243 offset:30720
v_mfma_f32_16x16x32_bf16 v[152:155],v[212:215],v[24:27],v[152:155]
ds_read_b64_tr_b16 v[208:209],v242 offset:32768
s_add_u32 m0,s29,8192
s_add_u32 s35,s35,294912
buffer_load_dwordx4 v245,s[4:7],s35 offen lds
s_add_u32 m0,s29,12288
s_nop 0
buffer_load_dwordx4 v245,s[52:55],s35 offen lds
s_add_u32 m0,s29,73728
s_add_u32 s36,s36,1024
buffer_load_dwordx4 v254,s[12:15],s36 offen sc1 lds
s_add_u32 m0,s29,77824
s_add_u32 s45,s36,73728
buffer_load_dwordx4 v254,s[12:15],s45 offen sc1 lds
v_mfma_f32_16x16x32_bf16 v[156:159],v[212:215],v[28:31],v[156:159]
ds_read_b64_tr_b16 v[210:211],v242 offset:34816
v_mfma_f32_16x16x32_bf16 v[160:163],v[216:219],v[24:27],v[160:163]
ds_read_b64_tr_b16 v[212:213],v243 offset:32768
v_mfma_f32_16x16x32_bf16 v[164:167],v[216:219],v[28:31],v[164:167]
ds_read_b64_tr_b16 v[214:215],v243 offset:34816
s_waitcnt lgkmcnt(4)
v_mfma_f32_16x16x32_bf16 v[168:171],v[220:223],v[24:27],v[168:171]
ds_read_b64_tr_b16 v[216:217],v242 offset:36864
v_mfma_f32_16x16x32_bf16 v[172:175],v[220:223],v[28:31],v[172:175]
ds_read_b64_tr_b16 v[218:219],v242 offset:38912
ds_read_b128 v[32:35],v252 offset:32768
ds_read_b128 v[36:39],v252 offset:33792
s_waitcnt vmcnt(12)
s_barrier
s_waitcnt lgkmcnt(0)
v_mfma_f32_16x16x32_bf16 v[144:147],v[208:211],v[32:35],v[144:147]
ds_read_b64_tr_b16 v[220:221],v243 offset:36864
v_mfma_f32_16x16x32_bf16 v[148:151],v[208:211],v[36:39],v[148:151]
ds_read_b64_tr_b16 v[222:223],v243 offset:38912
v_mfma_f32_16x16x32_bf16 v[152:155],v[212:215],v[32:35],v[152:155]
ds_read_b64_tr_b16 v[208:209],v242 offset:40960
s_add_u32 m0,s29,16384
s_add_u32 s35,s35,294912
buffer_load_dwordx4 v245,s[4:7],s35 offen lds
s_add_u32 m0,s29,20480
s_nop 0
buffer_load_dwordx4 v245,s[52:55],s35 offen lds
s_add_u32 m0,s29,81920
s_add_u32 s36,s36,1024
buffer_load_dwordx4 v254,s[12:15],s36 offen sc1 lds
s_add_u32 m0,s29,86016
s_add_u32 s45,s36,73728
buffer_load_dwordx4 v254,s[12:15],s45 offen sc1 lds
v_mfma_f32_16x16x32_bf16 v[156:159],v[212:215],v[36:39],v[156:159]
ds_read_b64_tr_b16 v[210:211],v242 offset:43008
v_mfma_f32_16x16x32_bf16 v[160:163],v[216:219],v[32:35],v[160:163]
ds_read_b64_tr_b16 v[212:213],v243 offset:40960
v_mfma_f32_16x16x32_bf16 v[164:167],v[216:219],v[36:39],v[164:167]
ds_read_b64_tr_b16 v[214:215],v243 offset:43008
s_waitcnt lgkmcnt(4)
v_mfma_f32_16x16x32_bf16 v[168:171],v[220:223],v[32:35],v[168:171]
ds_read_b64_tr_b16 v[216:217],v242 offset:45056
v_mfma_f32_16x16x32_bf16 v[172:175],v[220:223],v[36:39],v[172:175]
ds_read_b64_tr_b16 v[218:219],v242 offset:47104
ds_read_b128 v[40:43],v252 offset:40960
ds_read_b128 v[44:47],v252 offset:41984
s_waitcnt lgkmcnt(0)
v_mfma_f32_16x16x32_bf16 v[144:147],v[208:211],v[40:43],v[144:147]
ds_read_b64_tr_b16 v[220:221],v243 offset:45056
v_mfma_f32_16x16x32_bf16 v[148:151],v[208:211],v[44:47],v[148:151]
ds_read_b64_tr_b16 v[222:223],v243 offset:47104
v_mfma_f32_16x16x32_bf16 v[152:155],v[212:215],v[40:43],v[152:155]
ds_read_b64_tr_b16 v[208:209],v242 offset:49152
s_add_u32 m0,s29,24576
s_add_u32 s35,s35,294912
buffer_load_dwordx4 v245,s[4:7],s35 offen lds
s_add_u32 m0,s29,28672
s_nop 0
buffer_load_dwordx4 v245,s[52:55],s35 offen lds
s_add_u32 m0,s29,90112
s_add_u32 s36,s36,1024
buffer_load_dwordx4 v254,s[12:15],s36 offen sc1 lds
s_add_u32 m0,s29,94208
s_add_u32 s45,s36,73728
buffer_load_dwordx4 v254,s[12:15],s45 offen sc1 lds
v_mfma_f32_16x16x32_bf16 v[156:159],v[212:215],v[44:47],v[156:159]
ds_read_b64_tr_b16 v[210:211],v242 offset:51200
v_mfma_f32_16x16x32_bf16 v[160:163],v[216:219],v[40:43],v[160:163]
ds_read_b64_tr_b16 v[212:213],v243 offset:49152
v_mfma_f32_16x16x32_bf16 v[164:167],v[216:219],v[44:47],v[164:167]
ds_read_b64_tr_b16 v[214:215],v243 offset:51200
s_waitcnt lgkmcnt(4)
v_mfma_f32_16x16x32_bf16 v[168:171],v[220:223],v[40:43],v[168:171]
ds_read_b64_tr_b16 v[216:217],v242 offset:53248
v_mfma_f32_16x16x32_bf16 v[172:175],v[220:223],v[44:47],v[172:175]
ds_read_b64_tr_b16 v[218:219],v242 offset:55296
ds_read_b128 v[48:51],v252 offset:49152
ds_read_b128 v[52:55],v252 offset:50176
s_waitcnt vmcnt(12)
s_barrier
s_waitcnt lgkmcnt(0)
v_mfma_f32_16x16x32_bf16 v[144:147],v[208:211],v[48:51],v[144:147]
ds_read_b64_tr_b16 v[220:221],v243 offset:53248
v_mfma_f32_16x16x32_bf16 v[148:151],v[208:211],v[52:55],v[148:151]
ds_read_b64_tr_b16 v[222:223],v243 offset:55296
v_mfma_f32_16x16x32_bf16 v[152:155],v[212:215],v[48:51],v[152:155]
ds_read_b64_tr_b16 v[208:209],v242 offset:57344
s_add_u32 m0,s29,32768
s_add_u32 s35,s35,294912
buffer_load_dwordx4 v245,s[4:7],s35 offen lds
s_add_u32 m0,s29,36864
s_nop 0
buffer_load_dwordx4 v245,s[52:55],s35 offen lds
s_add_u32 m0,s29,98304
s_add_u32 s36,s36,1024
buffer_load_dwordx4 v254,s[12:15],s36 offen sc1 lds
s_add_u32 m0,s29,102400
s_add_u32 s45,s36,73728
buffer_load_dwordx4 v254,s[12:15],s45 offen sc1 lds
v_mfma_f32_16x16x32_bf16 v[156:159],v[212:215],v[52:55],v[156:159]
ds_read_b64_tr_b16 v[210:211],v242 offset:59392
v_mfma_f32_16x16x32_bf16 v[160:163],v[216:219],v[48:51],v[160:163]
ds_read_b64_tr_b16 v[212:213],v243 offset:57344
v_mfma_f32_16x16x32_bf16 v[164:167],v[216:219],v[52:55],v[164:167]
ds_read_b64_tr_b16 v[214:215],v243 offset:59392
s_waitcnt lgkmcnt(4)
v_mfma_f32_16x16x32_bf16 v[168:171],v[220:223],v[48:51],v[168:171]
ds_read_b64_tr_b16 v[216:217],v242 offset:61440
v_mfma_f32_16x16x32_bf16 v[172:175],v[220:223],v[52:55],v[172:175]
ds_read_b64_tr_b16 v[218:219],v242 offset:63488
ds_read_b128 v[56:59],v252 offset:57344
ds_read_b128 v[60:63],v252 offset:58368
s_waitcnt lgkmcnt(0)
v_mfma_f32_16x16x32_bf16 v[144:147],v[208:211],v[56:59],v[144:147]
ds_read_b64_tr_b16 v[220:221],v243 offset:61440
v_mfma_f32_16x16x32_bf16 v[148:151],v[208:211],v[60:63],v[148:151]
ds_read_b64_tr_b16 v[222:223],v243 offset:63488
v_mfma_f32_16x16x32_bf16 v[152:155],v[212:215],v[56:59],v[152:155]
ds_read_b64_tr_b16 v[208:209],v242 offset:0
s_add_u32 m0,s29,40960
s_add_u32 s35,s35,294912
buffer_load_dwordx4 v245,s[4:7],s35 offen lds
s_add_u32 m0,s29,45056
s_nop 0
buffer_load_dwordx4 v245,s[52:55],s35 offen lds
s_add_u32 m0,s29,106496
s_add_u32 s36,s36,1024
buffer_load_dwordx4 v254,s[12:15],s36 offen sc1 lds
s_add_u32 m0,s29,110592
s_add_u32 s45,s36,73728
buffer_load_dwordx4 v254,s[12:15],s45 offen sc1 lds
v_mfma_f32_16x16x32_bf16 v[156:159],v[212:215],v[60:63],v[156:159]
ds_read_b64_tr_b16 v[210:211],v242 offset:2048
v_mfma_f32_16x16x32_bf16 v[160:163],v[216:219],v[56:59],v[160:163]
ds_read_b64_tr_b16 v[212:213],v243 offset:0
v_mfma_f32_16x16x32_bf16 v[164:167],v[216:219],v[60:63],v[164:167]
ds_read_b64_tr_b16 v[214:215],v243 offset:2048
s_waitcnt lgkmcnt(4)
v_mfma_f32_16x16x32_bf16 v[168:171],v[220:223],v[56:59],v[168:171]
ds_read_b64_tr_b16 v[216:217],v242 offset:4096
v_mfma_f32_16x16x32_bf16 v[172:175],v[220:223],v[60:63],v[172:175]
ds_read_b64_tr_b16 v[218:219],v242 offset:6144
ds_read_b128 v[64:67],v252 offset:0
ds_read_b128 v[68:71],v252 offset:1024
s_waitcnt vmcnt(12)
s_barrier
s_waitcnt lgkmcnt(0)
v_mfma_f32_16x16x32_bf16 v[144:147],v[208:211],v[64:67],v[144:147]
ds_read_b64_tr_b16 v[220:221],v243 offset:4096
v_mfma_f32_16x16x32_bf16 v[148:151],v[208:211],v[68:71],v[148:151]
ds_read_b64_tr_b16 v[222:223],v243 offset:6144
v_mfma_f32_16x16x32_bf16 v[152:155],v[212:215],v[64:67],v[152:155]
ds_read_b64_tr_b16 v[208:209],v242 offset:8192
s_add_u32 m0,s29,49152
s_add_u32 s35,s35,294912
buffer_load_dwordx4 v245,s[4:7],s35 offen lds
s_add_u32 m0,s29,53248
s_nop 0
buffer_load_dwordx4 v245,s[52:55],s35 offen lds
s_add_u32 m0,s29,114688
s_add_u32 s36,s36,1024
buffer_load_dwordx4 v254,s[12:15],s36 offen sc1 lds
s_add_u32 m0,s29,118784
s_add_u32 s45,s36,73728
buffer_load_dwordx4 v254,s[12:15],s45 offen sc1 lds
v_mfma_f32_16x16x32_bf16 v[156:159],v[212:215],v[68:71],v[156:159]
ds_read_b64_tr_b16 v[210:211],v242 offset:10240
v_mfma_f32_16x16x32_bf16 v[160:163],v[216:219],v[64:67],v[160:163]
ds_read_b64_tr_b16 v[212:213],v243 offset:8192
v_mfma_f32_16x16x32_bf16 v[164:167],v[216:219],v[68:71],v[164:167]
ds_read_b64_tr_b16 v[214:215],v243 offset:10240
s_waitcnt lgkmcnt(4)
v_mfma_f32_16x16x32_bf16 v[168:171],v[220:223],v[64:67],v[168:171]
ds_read_b64_tr_b16 v[216:217],v242 offset:12288
v_mfma_f32_16x16x32_bf16 v[172:175],v[220:223],v[68:71],v[172:175]
ds_read_b64_tr_b16 v[218:219],v242 offset:14336
ds_read_b128 v[72:75],v252 offset:8192
ds_read_b128 v[76:79],v252 offset:9216
s_waitcnt lgkmcnt(0)
v_mfma_f32_16x16x32_bf16 v[144:147],v[208:211],v[72:75],v[144:147]
ds_read_b64_tr_b16 v[220:221],v243 offset:12288
v_mfma_f32_16x16x32_bf16 v[148:151],v[208:211],v[76:79],v[148:151]
ds_read_b64_tr_b16 v[222:223],v243 offset:14336
v_mfma_f32_16x16x32_bf16 v[152:155],v[212:215],v[72:75],v[152:155]
ds_read_b64_tr_b16 v[208:209],v242 offset:16384
s_add_u32 m0,s29,57344
s_add_u32 s35,s35,294912
buffer_load_dwordx4 v245,s[4:7],s35 offen lds
s_add_u32 m0,s29,61440
s_nop 0
buffer_load_dwordx4 v245,s[52:55],s35 offen lds
s_add_u32 m0,s29,122880
s_add_u32 s36,s36,1024
buffer_load_dwordx4 v254,s[12:15],s36 offen sc1 lds
s_add_u32 m0,s29,126976
s_add_u32 s45,s36,73728
buffer_load_dwordx4 v254,s[12:15],s45 offen sc1 lds
v_mfma_f32_16x16x32_bf16 v[156:159],v[212:215],v[76:79],v[156:159]
ds_read_b64_tr_b16 v[210:211],v242 offset:18432
v_mfma_f32_16x16x32_bf16 v[160:163],v[216:219],v[72:75],v[160:163]
ds_read_b64_tr_b16 v[212:213],v243 offset:16384
v_mfma_f32_16x16x32_bf16 v[164:167],v[216:219],v[76:79],v[164:167]
ds_read_b64_tr_b16 v[214:215],v243 offset:18432
s_waitcnt lgkmcnt(4)
v_mfma_f32_16x16x32_bf16 v[168:171],v[220:223],v[72:75],v[168:171]
ds_read_b64_tr_b16 v[216:217],v242 offset:20480
v_mfma_f32_16x16x32_bf16 v[172:175],v[220:223],v[76:79],v[172:175]
ds_read_b64_tr_b16 v[218:219],v242 offset:22528
ds_read_b128 v[80:83],v252 offset:16384
ds_read_b128 v[84:87],v252 offset:17408
s_waitcnt vmcnt(12)
s_barrier
s_waitcnt lgkmcnt(0)
v_mfma_f32_16x16x32_bf16 v[144:147],v[208:211],v[80:83],v[144:147]
ds_read_b64_tr_b16 v[220:221],v243 offset:20480
v_mfma_f32_16x16x32_bf16 v[148:151],v[208:211],v[84:87],v[148:151]
ds_read_b64_tr_b16 v[222:223],v243 offset:22528
v_mfma_f32_16x16x32_bf16 v[152:155],v[212:215],v[80:83],v[152:155]
ds_read_b64_tr_b16 v[208:209],v242 offset:24576
s_add_u32 m0,s29,0
s_add_u32 s35,s35,294912
buffer_load_dwordx4 v245,s[4:7],s35 offen lds
s_add_u32 m0,s29,4096
s_nop 0
buffer_load_dwordx4 v245,s[52:55],s35 offen lds
s_add_u32 m0,s29,65536
s_add_u32 s36,s36,1024
buffer_load_dwordx4 v254,s[12:15],s36 offen sc1 lds
s_add_u32 m0,s29,69632
s_add_u32 s45,s36,73728
buffer_load_dwordx4 v254,s[12:15],s45 offen sc1 lds
v_mfma_f32_16x16x32_bf16 v[156:159],v[212:215],v[84:87],v[156:159]
ds_read_b64_tr_b16 v[210:211],v242 offset:26624
v_mfma_f32_16x16x32_bf16 v[160:163],v[216:219],v[80:83],v[160:163]
ds_read_b64_tr_b16 v[212:213],v243 offset:24576
v_mfma_f32_16x16x32_bf16 v[164:167],v[216:219],v[84:87],v[164:167]
ds_read_b64_tr_b16 v[214:215],v243 offset:26624
s_waitcnt lgkmcnt(4)
v_mfma_f32_16x16x32_bf16 v[168:171],v[220:223],v[80:83],v[168:171]
ds_read_b64_tr_b16 v[216:217],v242 offset:28672
v_mfma_f32_16x16x32_bf16 v[172:175],v[220:223],v[84:87],v[172:175]
ds_read_b64_tr_b16 v[218:219],v242 offset:30720
ds_read_b128 v[88:91],v252 offset:24576
ds_read_b128 v[92:95],v252 offset:25600
s_waitcnt lgkmcnt(0)
v_mfma_f32_16x16x32_bf16 v[144:147],v[208:211],v[88:91],v[144:147]
ds_read_b64_tr_b16 v[220:221],v243 offset:28672
v_mfma_f32_16x16x32_bf16 v[148:151],v[208:211],v[92:95],v[148:151]
ds_read_b64_tr_b16 v[222:223],v243 offset:30720
v_mfma_f32_16x16x32_bf16 v[152:155],v[212:215],v[88:91],v[152:155]
ds_read_b64_tr_b16 v[208:209],v242 offset:32768
s_add_u32 m0,s29,8192
s_add_u32 s35,s35,294912
buffer_load_dwordx4 v245,s[4:7],s35 offen lds
s_add_u32 m0,s29,12288
s_nop 0
buffer_load_dwordx4 v245,s[52:55],s35 offen lds
s_add_u32 m0,s29,73728
s_add_u32 s36,s36,1024
buffer_load_dwordx4 v254,s[12:15],s36 offen sc1 lds
s_add_u32 m0,s29,77824
s_add_u32 s45,s36,73728
buffer_load_dwordx4 v254,s[12:15],s45 offen sc1 lds
v_mfma_f32_16x16x32_bf16 v[156:159],v[212:215],v[92:95],v[156:159]
ds_read_b64_tr_b16 v[210:211],v242 offset:34816
v_mfma_f32_16x16x32_bf16 v[160:163],v[216:219],v[88:91],v[160:163]
ds_read_b64_tr_b16 v[212:213],v243 offset:32768
v_mfma_f32_16x16x32_bf16 v[164:167],v[216:219],v[92:95],v[164:167]
ds_read_b64_tr_b16 v[214:215],v243 offset:34816
s_waitcnt lgkmcnt(4)
v_mfma_f32_16x16x32_bf16 v[168:171],v[220:223],v[88:91],v[168:171]
ds_read_b64_tr_b16 v[216:217],v242 offset:36864
v_mfma_f32_16x16x32_bf16 v[172:175],v[220:223],v[92:95],v[172:175]
ds_read_b64_tr_b16 v[218:219],v242 offset:38912
ds_read_b128 v[96:99],v252 offset:32768
ds_read_b128 v[100:103],v252 offset:33792
s_waitcnt vmcnt(12)
s_barrier
s_waitcnt lgkmcnt(0)
v_mfma_f32_16x16x32_bf16 v[144:147],v[208:211],v[96:99],v[144:147]
ds_read_b64_tr_b16 v[220:221],v243 offset:36864
v_mfma_f32_16x16x32_bf16 v[148:151],v[208:211],v[100:103],v[148:151]
ds_read_b64_tr_b16 v[222:223],v243 offset:38912
v_mfma_f32_16x16x32_bf16 v[152:155],v[212:215],v[96:99],v[152:155]
ds_read_b64_tr_b16 v[208:209],v242 offset:40960
s_add_u32 m0,s29,16384
s_add_u32 s37,s32,1
s_and_b32 s37,s37,3
s_lshl_b32 s37,s37,7
s_lshl_b32 s43,s33,1
s_add_u32 s35,s43,s37
buffer_load_dwordx4 v245,s[4:7],s35 offen lds
s_add_u32 m0,s29,20480
s_nop 0
buffer_load_dwordx4 v245,s[52:55],s35 offen lds
v_mfma_f32_16x16x32_bf16 v[156:159],v[212:215],v[100:103],v[156:159]
ds_read_b64_tr_b16 v[210:211],v242 offset:43008
v_mfma_f32_16x16x32_bf16 v[160:163],v[216:219],v[96:99],v[160:163]
ds_read_b64_tr_b16 v[212:213],v243 offset:40960
v_mfma_f32_16x16x32_bf16 v[164:167],v[216:219],v[100:103],v[164:167]
ds_read_b64_tr_b16 v[214:215],v243 offset:43008
s_waitcnt lgkmcnt(4)
v_mfma_f32_16x16x32_bf16 v[168:171],v[220:223],v[96:99],v[168:171]
ds_read_b64_tr_b16 v[216:217],v242 offset:45056
v_mfma_f32_16x16x32_bf16 v[172:175],v[220:223],v[100:103],v[172:175]
ds_read_b64_tr_b16 v[218:219],v242 offset:47104
ds_read_b128 v[104:107],v252 offset:40960
ds_read_b128 v[108:111],v252 offset:41984
s_waitcnt lgkmcnt(0)
v_mfma_f32_16x16x32_bf16 v[144:147],v[208:211],v[104:107],v[144:147]
ds_read_b64_tr_b16 v[220:221],v243 offset:45056
v_mfma_f32_16x16x32_bf16 v[148:151],v[208:211],v[108:111],v[148:151]
ds_read_b64_tr_b16 v[222:223],v243 offset:47104
v_mfma_f32_16x16x32_bf16 v[152:155],v[212:215],v[104:107],v[152:155]
ds_read_b64_tr_b16 v[208:209],v242 offset:49152
s_add_u32 m0,s29,24576
s_add_u32 s35,s35,294912
buffer_load_dwordx4 v245,s[4:7],s35 offen lds
s_add_u32 m0,s29,28672
s_nop 0
buffer_load_dwordx4 v245,s[52:55],s35 offen lds
v_mfma_f32_16x16x32_bf16 v[156:159],v[212:215],v[108:111],v[156:159]
ds_read_b64_tr_b16 v[210:211],v242 offset:51200
v_mfma_f32_16x16x32_bf16 v[160:163],v[216:219],v[104:107],v[160:163]
ds_read_b64_tr_b16 v[212:213],v243 offset:49152
v_mfma_f32_16x16x32_bf16 v[164:167],v[216:219],v[108:111],v[164:167]
ds_read_b64_tr_b16 v[214:215],v243 offset:51200
s_waitcnt lgkmcnt(4)
v_mfma_f32_16x16x32_bf16 v[168:171],v[220:223],v[104:107],v[168:171]
ds_read_b64_tr_b16 v[216:217],v242 offset:53248
v_mfma_f32_16x16x32_bf16 v[172:175],v[220:223],v[108:111],v[172:175]
ds_read_b64_tr_b16 v[218:219],v242 offset:55296
ds_read_b128 v[112:115],v252 offset:49152
ds_read_b128 v[116:119],v252 offset:50176
s_waitcnt vmcnt(8)
s_barrier
s_waitcnt lgkmcnt(0)
v_mfma_f32_16x16x32_bf16 v[144:147],v[208:211],v[112:115],v[144:147]
ds_read_b64_tr_b16 v[220:221],v243 offset:53248
v_mfma_f32_16x16x32_bf16 v[148:151],v[208:211],v[116:119],v[148:151]
ds_read_b64_tr_b16 v[222:223],v243 offset:55296
v_mfma_f32_16x16x32_bf16 v[152:155],v[212:215],v[112:115],v[152:155]
ds_read_b64_tr_b16 v[208:209],v242 offset:57344
s_add_u32 m0,s29,32768
s_add_u32 s35,s35,294912
buffer_load_dwordx4 v245,s[4:7],s35 offen lds
s_add_u32 m0,s29,36864
s_nop 0
buffer_load_dwordx4 v245,s[52:55],s35 offen lds
v_mfma_f32_16x16x32_bf16 v[156:159],v[212:215],v[116:119],v[156:159]
ds_read_b64_tr_b16 v[210:211],v242 offset:59392
v_mfma_f32_16x16x32_bf16 v[160:163],v[216:219],v[112:115],v[160:163]
ds_read_b64_tr_b16 v[212:213],v243 offset:57344
v_mfma_f32_16x16x32_bf16 v[164:167],v[216:219],v[116:119],v[164:167]
ds_read_b64_tr_b16 v[214:215],v243 offset:59392
s_waitcnt lgkmcnt(4)
v_mfma_f32_16x16x32_bf16 v[168:171],v[220:223],v[112:115],v[168:171]
ds_read_b64_tr_b16 v[216:217],v242 offset:61440
v_mfma_f32_16x16x32_bf16 v[172:175],v[220:223],v[116:119],v[172:175]
ds_read_b64_tr_b16 v[218:219],v242 offset:63488
ds_read_b128 v[120:123],v252 offset:57344
ds_read_b128 v[124:127],v252 offset:58368
s_waitcnt lgkmcnt(0)
v_mfma_f32_16x16x32_bf16 v[144:147],v[208:211],v[120:123],v[144:147]
ds_read_b64_tr_b16 v[220:221],v243 offset:61440
v_mfma_f32_16x16x32_bf16 v[148:151],v[208:211],v[124:127],v[148:151]
ds_read_b64_tr_b16 v[222:223],v243 offset:63488
v_mfma_f32_16x16x32_bf16 v[152:155],v[212:215],v[120:123],v[152:155]
ds_read_b64_tr_b16 v[208:209],v242 offset:0
s_add_u32 m0,s29,40960
s_add_u32 s35,s35,294912
buffer_load_dwordx4 v245,s[4:7],s35 offen lds
s_add_u32 m0,s29,45056
s_nop 0
buffer_load_dwordx4 v245,s[52:55],s35 offen lds
v_mfma_f32_16x16x32_bf16 v[156:159],v[212:215],v[124:127],v[156:159]
ds_read_b64_tr_b16 v[210:211],v242 offset:2048
v_mfma_f32_16x16x32_bf16 v[160:163],v[216:219],v[120:123],v[160:163]
ds_read_b64_tr_b16 v[212:213],v243 offset:0
v_mfma_f32_16x16x32_bf16 v[164:167],v[216:219],v[124:127],v[164:167]
ds_read_b64_tr_b16 v[214:215],v243 offset:2048
s_waitcnt lgkmcnt(4)
v_mfma_f32_16x16x32_bf16 v[168:171],v[220:223],v[120:123],v[168:171]
ds_read_b64_tr_b16 v[216:217],v242 offset:4096
v_mfma_f32_16x16x32_bf16 v[172:175],v[220:223],v[124:127],v[172:175]
ds_read_b64_tr_b16 v[218:219],v242 offset:6144
ds_read_b128 v[128:131],v252 offset:0
ds_read_b128 v[132:135],v252 offset:1024
s_waitcnt vmcnt(6)
s_barrier
s_waitcnt lgkmcnt(0)
v_mfma_f32_16x16x32_bf16 v[144:147],v[208:211],v[128:131],v[144:147]
ds_read_b64_tr_b16 v[220:221],v243 offset:4096
v_mfma_f32_16x16x32_bf16 v[148:151],v[208:211],v[132:135],v[148:151]
ds_read_b64_tr_b16 v[222:223],v243 offset:6144
v_mfma_f32_16x16x32_bf16 v[152:155],v[212:215],v[128:131],v[152:155]
ds_read_b64_tr_b16 v[208:209],v242 offset:8192
s_add_u32 m0,s29,49152
s_add_u32 s35,s35,294912
buffer_load_dwordx4 v245,s[4:7],s35 offen lds
s_add_u32 m0,s29,53248
s_nop 0
buffer_load_dwordx4 v245,s[52:55],s35 offen lds
v_mfma_f32_16x16x32_bf16 v[156:159],v[212:215],v[132:135],v[156:159]
ds_read_b64_tr_b16 v[210:211],v242 offset:10240
v_mfma_f32_16x16x32_bf16 v[160:163],v[216:219],v[128:131],v[160:163]
ds_read_b64_tr_b16 v[212:213],v243 offset:8192
v_mfma_f32_16x16x32_bf16 v[164:167],v[216:219],v[132:135],v[164:167]
ds_read_b64_tr_b16 v[214:215],v243 offset:10240
s_waitcnt lgkmcnt(4)
v_mfma_f32_16x16x32_bf16 v[168:171],v[220:223],v[128:131],v[168:171]
ds_read_b64_tr_b16 v[216:217],v242 offset:12288
v_mfma_f32_16x16x32_bf16 v[172:175],v[220:223],v[132:135],v[172:175]
ds_read_b64_tr_b16 v[218:219],v242 offset:14336
ds_read_b128 v[136:139],v252 offset:8192
ds_read_b128 v[140:143],v252 offset:9216
s_waitcnt lgkmcnt(0)
v_mfma_f32_16x16x32_bf16 v[144:147],v[208:211],v[136:139],v[144:147]
ds_read_b64_tr_b16 v[220:221],v243 offset:12288
v_mfma_f32_16x16x32_bf16 v[148:151],v[208:211],v[140:143],v[148:151]
ds_read_b64_tr_b16 v[222:223],v243 offset:14336
v_mfma_f32_16x16x32_bf16 v[152:155],v[212:215],v[136:139],v[152:155]
ds_read_b64_tr_b16 v[208:209],v242 offset:16384
s_add_u32 m0,s29,57344
s_add_u32 s35,s35,294912
buffer_load_dwordx4 v245,s[4:7],s35 offen lds
s_add_u32 m0,s29,61440
s_nop 0
buffer_load_dwordx4 v245,s[52:55],s35 offen lds
v_mfma_f32_16x16x32_bf16 v[156:159],v[212:215],v[140:143],v[156:159]
ds_read_b64_tr_b16 v[210:211],v242 offset:18432
v_mfma_f32_16x16x32_bf16 v[160:163],v[216:219],v[136:139],v[160:163]
ds_read_b64_tr_b16 v[212:213],v243 offset:16384
v_mfma_f32_16x16x32_bf16 v[164:167],v[216:219],v[140:143],v[164:167]
ds_read_b64_tr_b16 v[214:215],v243 offset:18432
s_waitcnt lgkmcnt(4)
v_mfma_f32_16x16x32_bf16 v[168:171],v[220:223],v[136:139],v[168:171]
ds_read_b64_tr_b16 v[216:217],v242 offset:20480
v_mfma_f32_16x16x32_bf16 v[172:175],v[220:223],v[140:143],v[172:175]
ds_read_b64_tr_b16 v[218:219],v242 offset:22528
s_waitcnt vmcnt(6)
s_barrier
s_waitcnt lgkmcnt(4)
v_mfma_f32_16x16x32_bf16 v[176:179],v[208:211],v[0:3],0
ds_read_b64_tr_b16 v[220:221],v243 offset:20480
v_mfma_f32_16x16x32_bf16 v[180:183],v[208:211],v[4:7],0
ds_read_b64_tr_b16 v[222:223],v243 offset:22528
s_waitcnt lgkmcnt(4)
v_mfma_f32_16x16x32_bf16 v[184:187],v[212:215],v[0:3],0
ds_read_b64_tr_b16 v[208:209],v242 offset:24576
s_add_u32 m0,s29,0
s_add_u32 s35,s35,294912
buffer_load_dwordx4 v245,s[4:7],s35 offen lds
s_add_u32 m0,s29,4096
s_nop 0
buffer_load_dwordx4 v245,s[52:55],s35 offen lds
v_mfma_f32_16x16x32_bf16 v[188:191],v[212:215],v[4:7],0
ds_read_b64_tr_b16 v[210:211],v242 offset:26624
s_waitcnt lgkmcnt(4)
v_mfma_f32_16x16x32_bf16 v[192:195],v[216:219],v[0:3],0
ds_read_b64_tr_b16 v[212:213],v243 offset:24576
v_mfma_f32_16x16x32_bf16 v[196:199],v[216:219],v[4:7],0
ds_read_b64_tr_b16 v[214:215],v243 offset:26624
s_waitcnt lgkmcnt(4)
v_mfma_f32_16x16x32_bf16 v[200:203],v[220:223],v[0:3],0
ds_read_b64_tr_b16 v[216:217],v242 offset:28672
v_mfma_f32_16x16x32_bf16 v[204:207],v[220:223],v[4:7],0
ds_read_b64_tr_b16 v[218:219],v242 offset:30720
s_waitcnt lgkmcnt(4)
v_mfma_f32_16x16x32_bf16 v[176:179],v[208:211],v[8:11],v[176:179]
ds_read_b64_tr_b16 v[220:221],v243 offset:28672
v_mul_f32 v232,v144,v144
v_mfma_f32_16x16x32_bf16 v[180:183],v[208:211],v[12:15],v[180:183]
ds_read_b64_tr_b16 v[222:223],v243 offset:30720
v_mul_f32 v233,v145,v145
s_waitcnt lgkmcnt(4)
v_mfma_f32_16x16x32_bf16 v[184:187],v[212:215],v[8:11],v[184:187]
ds_read_b64_tr_b16 v[208:209],v242 offset:32768
v_mul_f32 v234,v146,v146
s_add_u32 m0,s29,8192
s_add_u32 s35,s35,294912
buffer_load_dwordx4 v245,s[4:7],s35 offen lds
s_add_u32 m0,s29,12288
s_nop 0
buffer_load_dwordx4 v245,s[52:55],s35 offen lds
v_mfma_f32_16x16x32_bf16 v[188:191],v[212:215],v[12:15],v[188:191]
ds_read_b64_tr_b16 v[210:211],v242 offset:34816
v_mul_f32 v235,v147,v147
s_waitcnt lgkmcnt(4)
v_mfma_f32_16x16x32_bf16 v[192:195],v[216:219],v[8:11],v[192:195]
ds_read_b64_tr_b16 v[212:213],v243 offset:32768
v_fma_f32 v232,v232,v237,v236
v_mfma_f32_16x16x32_bf16 v[196:199],v[216:219],v[12:15],v[196:199]
ds_read_b64_tr_b16 v[214:215],v243 offset:34816
v_fma_f32 v233,v233,v237,v236
s_waitcnt lgkmcnt(4)
v_mfma_f32_16x16x32_bf16 v[200:203],v[220:223],v[8:11],v[200:203]
ds_read_b64_tr_b16 v[216:217],v242 offset:36864
v_fma_f32 v234,v234,v237,v236
v_mfma_f32_16x16x32_bf16 v[204:207],v[220:223],v[12:15],v[204:207]
ds_read_b64_tr_b16 v[218:219],v242 offset:38912
v_fma_f32 v235,v235,v237,v236
s_waitcnt vmcnt(6)
s_barrier
s_waitcnt lgkmcnt(4)
v_mfma_f32_16x16x32_bf16 v[176:179],v[208:211],v[16:19],v[176:179]
ds_read_b64_tr_b16 v[220:221],v243 offset:36864
v_mul_f32 v232,v144,v232
v_mfma_f32_16x16x32_bf16 v[180:183],v[208:211],v[20:23],v[180:183]
ds_read_b64_tr_b16 v[222:223],v243 offset:38912
v_mul_f32 v233,v145,v233
s_waitcnt lgkmcnt(4)
v_mfma_f32_16x16x32_bf16 v[184:187],v[212:215],v[16:19],v[184:187]
ds_read_b64_tr_b16 v[208:209],v242 offset:40960
v_mul_f32 v234,v146,v234
s_add_u32 m0,s29,16384
s_add_u32 s35,s35,294912
buffer_load_dwordx4 v245,s[4:7],s35 offen lds
s_add_u32 m0,s29,20480
s_nop 0
buffer_load_dwordx4 v245,s[52:55],s35 offen lds
v_mfma_f32_16x16x32_bf16 v[188:191],v[212:215],v[20:23],v[188:191]
ds_read_b64_tr_b16 v[210:211],v242 offset:43008
v_mul_f32 v235,v147,v235
s_waitcnt lgkmcnt(4)
v_mfma_f32_16x16x32_bf16 v[192:195],v[216:219],v[16:19],v[192:195]
ds_read_b64_tr_b16 v[212:213],v243 offset:40960
v_exp_f32 v232,v232
v_mfma_f32_16x16x32_bf16 v[196:199],v[216:219],v[20:23],v[196:199]
ds_read_b64_tr_b16 v[214:215],v243 offset:43008
v_exp_f32 v233,v233
s_waitcnt lgkmcnt(4)
v_mfma_f32_16x16x32_bf16 v[200:203],v[220:223],v[16:19],v[200:203]
ds_read_b64_tr_b16 v[216:217],v242 offset:45056
v_exp_f32 v234,v234
v_mfma_f32_16x16x32_bf16 v[204:207],v[220:223],v[20:23],v[204:207]
ds_read_b64_tr_b16 v[218:219],v242 offset:47104
v_exp_f32 v235,v235
v_mul_f32 v160,v144,v160
s_waitcnt lgkmcnt(4)
v_mfma_f32_16x16x32_bf16 v[176:179],v[208:211],v[24:27],v[176:179]
ds_read_b64_tr_b16 v[220:221],v243 offset:45056
v_mul_f32 v161,v145,v161
v_mfma_f32_16x16x32_bf16 v[180:183],v[208:211],v[28:31],v[180:183]
ds_read_b64_tr_b16 v[222:223],v243 offset:47104
v_mul_f32 v162,v146,v162
s_waitcnt lgkmcnt(4)
v_mfma_f32_16x16x32_bf16 v[184:187],v[212:215],v[24:27],v[184:187]
ds_read_b64_tr_b16 v[208:209],v242 offset:49152
v_mul_f32 v163,v147,v163
s_add_u32 m0,s29,24576
s_add_u32 s35,s35,294912
buffer_load_dwordx4 v245,s[4:7],s35 offen lds
s_add_u32 m0,s29,28672
s_nop 0
buffer_load_dwordx4 v245,s[52:55],s35 offen lds
v_mfma_f32_16x16x32_bf16 v[188:191],v[212:215],v[28:31],v[188:191]
ds_read_b64_tr_b16 v[210:211],v242 offset:51200
v_fma_f32 v232,v232,v238,v238
s_waitcnt lgkmcnt(4)
v_mfma_f32_16x16x32_bf16 v[192:195],v[216:219],v[24:27],v[192:195]
ds_read_b64_tr_b16 v[212:213],v243 offset:49152
v_fma_f32 v233,v233,v238,v238
v_mfma_f32_16x16x32_bf16 v[196:199],v[216:219],v[28:31],v[196:199]
ds_read_b64_tr_b16 v[214:215],v243 offset:51200
v_fma_f32 v234,v234,v238,v238
s_waitcnt lgkmcnt(4)
v_mfma_f32_16x16x32_bf16 v[200:203],v[220:223],v[24:27],v[200:203]
ds_read_b64_tr_b16 v[216:217],v242 offset:53248
v_fma_f32 v235,v235,v238,v238
v_mfma_f32_16x16x32_bf16 v[204:207],v[220:223],v[28:31],v[204:207]
ds_read_b64_tr_b16 v[218:219],v242 offset:55296
v_rcp_f32 v232,v232
s_waitcnt vmcnt(6)
s_barrier
s_waitcnt lgkmcnt(4)
v_mfma_f32_16x16x32_bf16 v[176:179],v[208:211],v[32:35],v[176:179]
ds_read_b64_tr_b16 v[220:221],v243 offset:53248
v_rcp_f32 v233,v233
v_mfma_f32_16x16x32_bf16 v[180:183],v[208:211],v[36:39],v[180:183]
ds_read_b64_tr_b16 v[222:223],v243 offset:55296
v_rcp_f32 v234,v234
s_waitcnt lgkmcnt(4)
v_mfma_f32_16x16x32_bf16 v[184:187],v[212:215],v[32:35],v[184:187]
ds_read_b64_tr_b16 v[208:209],v242 offset:57344
v_rcp_f32 v235,v235
s_add_u32 m0,s29,32768
s_add_u32 s35,s35,294912
buffer_load_dwordx4 v245,s[4:7],s35 offen lds
s_add_u32 m0,s29,36864
s_nop 0
buffer_load_dwordx4 v245,s[52:55],s35 offen lds
v_mfma_f32_16x16x32_bf16 v[188:191],v[212:215],v[36:39],v[188:191]
ds_read_b64_tr_b16 v[210:211],v242 offset:59392
v_mul_f32 v160,v160,v232
s_waitcnt lgkmcnt(4)
v_mfma_f32_16x16x32_bf16 v[192:195],v[216:219],v[32:35],v[192:195]
ds_read_b64_tr_b16 v[212:213],v243 offset:57344
v_mul_f32 v161,v161,v233
v_mfma_f32_16x16x32_bf16 v[196:199],v[216:219],v[36:39],v[196:199]
ds_read_b64_tr_b16 v[214:215],v243 offset:59392
v_mul_f32 v162,v162,v234
s_waitcnt lgkmcnt(4)
v_mfma_f32_16x16x32_bf16 v[200:203],v[220:223],v[32:35],v[200:203]
ds_read_b64_tr_b16 v[216:217],v242 offset:61440
v_mul_f32 v163,v163,v235
v_mfma_f32_16x16x32_bf16 v[204:207],v[220:223],v[36:39],v[204:207]
ds_read_b64_tr_b16 v[218:219],v242 offset:63488
v_cvt_pk_bf16_f32 v224,v160,v161
v_cvt_pk_bf16_f32 v225,v162,v163
s_waitcnt lgkmcnt(4)
v_mfma_f32_16x16x32_bf16 v[176:179],v[208:211],v[40:43],v[176:179]
ds_read_b64_tr_b16 v[220:221],v243 offset:61440
v_mul_f32 v232,v152,v152
v_mfma_f32_16x16x32_bf16 v[180:183],v[208:211],v[44:47],v[180:183]
ds_read_b64_tr_b16 v[222:223],v243 offset:63488
v_mul_f32 v233,v153,v153
s_waitcnt lgkmcnt(4)
v_mfma_f32_16x16x32_bf16 v[184:187],v[212:215],v[40:43],v[184:187]
ds_read_b64_tr_b16 v[208:209],v242 offset:0
v_mul_f32 v234,v154,v154
s_add_u32 m0,s29,40960
s_add_u32 s35,s35,294912
buffer_load_dwordx4 v245,s[4:7],s35 offen lds
s_add_u32 m0,s29,45056
s_nop 0
buffer_load_dwordx4 v245,s[52:55],s35 offen lds
v_mfma_f32_16x16x32_bf16 v[188:191],v[212:215],v[44:47],v[188:191]
ds_read_b64_tr_b16 v[210:211],v242 offset:2048
v_mul_f32 v235,v155,v155
s_waitcnt lgkmcnt(4)
v_mfma_f32_16x16x32_bf16 v[192:195],v[216:219],v[40:43],v[192:195]
ds_read_b64_tr_b16 v[212:213],v243 offset:0
v_fma_f32 v232,v232,v237,v236
v_mfma_f32_16x16x32_bf16 v[196:199],v[216:219],v[44:47],v[196:199]
ds_read_b64_tr_b16 v[214:215],v243 offset:2048
v_fma_f32 v233,v233,v237,v236
s_waitcnt lgkmcnt(4)
v_mfma_f32_16x16x32_bf16 v[200:203],v[220:223],v[40:43],v[200:203]
ds_read_b64_tr_b16 v[216:217],v242 offset:4096
v_fma_f32 v234,v234,v237,v236
v_mfma_f32_16x16x32_bf16 v[204:207],v[220:223],v[44:47],v[204:207]
ds_read_b64_tr_b16 v[218:219],v242 offset:6144
v_fma_f32 v235,v235,v237,v236
s_waitcnt vmcnt(6)
s_barrier
s_waitcnt lgkmcnt(4)
v_mfma_f32_16x16x32_bf16 v[176:179],v[208:211],v[48:51],v[176:179]
ds_read_b64_tr_b16 v[220:221],v243 offset:4096
v_mul_f32 v232,v152,v232
v_mfma_f32_16x16x32_bf16 v[180:183],v[208:211],v[52:55],v[180:183]
ds_read_b64_tr_b16 v[222:223],v243 offset:6144
v_mul_f32 v233,v153,v233
s_waitcnt lgkmcnt(4)
v_mfma_f32_16x16x32_bf16 v[184:187],v[212:215],v[48:51],v[184:187]
ds_read_b64_tr_b16 v[208:209],v242 offset:8192
v_mul_f32 v234,v154,v234
s_add_u32 m0,s29,49152
s_add_u32 s35,s35,294912
buffer_load_dwordx4 v245,s[4:7],s35 offen lds
s_add_u32 m0,s29,53248
s_nop 0
buffer_load_dwordx4 v245,s[52:55],s35 offen lds
v_mfma_f32_16x16x32_bf16 v[188:191],v[212:215],v[52:55],v[188:191]
ds_read_b64_tr_b16 v[210:211],v242 offset:10240
v_mul_f32 v235,v155,v235
s_waitcnt lgkmcnt(4)
v_mfma_f32_16x16x32_bf16 v[192:195],v[216:219],v[48:51],v[192:195]
ds_read_b64_tr_b16 v[212:213],v243 offset:8192
v_exp_f32 v232,v232
v_mfma_f32_16x16x32_bf16 v[196:199],v[216:219],v[52:55],v[196:199]
ds_read_b64_tr_b16 v[214:215],v243 offset:10240
v_exp_f32 v233,v233
s_waitcnt lgkmcnt(4)
v_mfma_f32_16x16x32_bf16 v[200:203],v[220:223],v[48:51],v[200:203]
ds_read_b64_tr_b16 v[216:217],v242 offset:12288
v_exp_f32 v234,v234
v_mfma_f32_16x16x32_bf16 v[204:207],v[220:223],v[52:55],v[204:207]
ds_read_b64_tr_b16 v[218:219],v242 offset:14336
v_exp_f32 v235,v235
v_mul_f32 v168,v152,v168
s_waitcnt lgkmcnt(4)
v_mfma_f32_16x16x32_bf16 v[176:179],v[208:211],v[56:59],v[176:179]
ds_read_b64_tr_b16 v[220:221],v243 offset:12288
v_mul_f32 v169,v153,v169
v_mfma_f32_16x16x32_bf16 v[180:183],v[208:211],v[60:63],v[180:183]
ds_read_b64_tr_b16 v[222:223],v243 offset:14336
v_mul_f32 v170,v154,v170
s_waitcnt lgkmcnt(4)
v_mfma_f32_16x16x32_bf16 v[184:187],v[212:215],v[56:59],v[184:187]
ds_read_b64_tr_b16 v[208:209],v242 offset:16384
v_mul_f32 v171,v155,v171
s_add_u32 m0,s29,57344
s_add_u32 s35,s35,294912
buffer_load_dwordx4 v245,s[4:7],s35 offen lds
s_add_u32 m0,s29,61440
s_nop 0
buffer_load_dwordx4 v245,s[52:55],s35 offen lds
v_mfma_f32_16x16x32_bf16 v[188:191],v[212:215],v[60:63],v[188:191]
ds_read_b64_tr_b16 v[210:211],v242 offset:18432
v_fma_f32 v232,v232,v238,v238
s_waitcnt lgkmcnt(4)
v_mfma_f32_16x16x32_bf16 v[192:195],v[216:219],v[56:59],v[192:195]
ds_read_b64_tr_b16 v[212:213],v243 offset:16384
v_fma_f32 v233,v233,v238,v238
v_mfma_f32_16x16x32_bf16 v[196:199],v[216:219],v[60:63],v[196:199]
ds_read_b64_tr_b16 v[214:215],v243 offset:18432
v_fma_f32 v234,v234,v238,v238
s_waitcnt lgkmcnt(4)
v_mfma_f32_16x16x32_bf16 v[200:203],v[220:223],v[56:59],v[200:203]
ds_read_b64_tr_b16 v[216:217],v242 offset:20480
v_fma_f32 v235,v235,v238,v238
v_mfma_f32_16x16x32_bf16 v[204:207],v[220:223],v[60:63],v[204:207]
ds_read_b64_tr_b16 v[218:219],v242 offset:22528
v_rcp_f32 v232,v232
s_waitcnt vmcnt(6)
s_barrier
s_waitcnt lgkmcnt(4)
v_mfma_f32_16x16x32_bf16 v[176:179],v[208:211],v[64:67],v[176:179]
ds_read_b64_tr_b16 v[220:221],v243 offset:20480
v_rcp_f32 v233,v233
v_mfma_f32_16x16x32_bf16 v[180:183],v[208:211],v[68:71],v[180:183]
ds_read_b64_tr_b16 v[222:223],v243 offset:22528
v_rcp_f32 v234,v234
s_waitcnt lgkmcnt(4)
v_mfma_f32_16x16x32_bf16 v[184:187],v[212:215],v[64:67],v[184:187]
ds_read_b64_tr_b16 v[208:209],v242 offset:24576
v_rcp_f32 v235,v235
s_add_u32 m0,s29,0
s_add_u32 s35,s35,294912
buffer_load_dwordx4 v245,s[4:7],s35 offen lds
s_add_u32 m0,s29,4096
s_nop 0
buffer_load_dwordx4 v245,s[52:55],s35 offen lds
v_mfma_f32_16x16x32_bf16 v[188:191],v[212:215],v[68:71],v[188:191]
ds_read_b64_tr_b16 v[210:211],v242 offset:26624
v_mul_f32 v168,v168,v232
s_waitcnt lgkmcnt(4)
v_mfma_f32_16x16x32_bf16 v[192:195],v[216:219],v[64:67],v[192:195]
ds_read_b64_tr_b16 v[212:213],v243 offset:24576
v_mul_f32 v169,v169,v233
v_mfma_f32_16x16x32_bf16 v[196:199],v[216:219],v[68:71],v[196:199]
ds_read_b64_tr_b16 v[214:215],v243 offset:26624
v_mul_f32 v170,v170,v234
s_waitcnt lgkmcnt(4)
v_mfma_f32_16x16x32_bf16 v[200:203],v[220:223],v[64:67],v[200:203]
ds_read_b64_tr_b16 v[216:217],v242 offset:28672
v_mul_f32 v171,v171,v235
v_mfma_f32_16x16x32_bf16 v[204:207],v[220:223],v[68:71],v[204:207]
ds_read_b64_tr_b16 v[218:219],v242 offset:30720
v_cvt_pk_bf16_f32 v226,v168,v169
v_cvt_pk_bf16_f32 v227,v170,v171
s_waitcnt lgkmcnt(4)
v_mfma_f32_16x16x32_bf16 v[176:179],v[208:211],v[72:75],v[176:179]
ds_read_b64_tr_b16 v[220:221],v243 offset:28672
v_mul_f32 v232,v148,v148
v_mfma_f32_16x16x32_bf16 v[180:183],v[208:211],v[76:79],v[180:183]
ds_read_b64_tr_b16 v[222:223],v243 offset:30720
v_mul_f32 v233,v149,v149
s_waitcnt lgkmcnt(4)
v_mfma_f32_16x16x32_bf16 v[184:187],v[212:215],v[72:75],v[184:187]
ds_read_b64_tr_b16 v[208:209],v242 offset:32768
v_mul_f32 v234,v150,v150
s_add_u32 m0,s29,8192
s_add_u32 s35,s35,294912
buffer_load_dwordx4 v245,s[4:7],s35 offen lds
s_add_u32 m0,s29,12288
s_nop 0
buffer_load_dwordx4 v245,s[52:55],s35 offen lds
v_mfma_f32_16x16x32_bf16 v[188:191],v[212:215],v[76:79],v[188:191]
ds_read_b64_tr_b16 v[210:211],v242 offset:34816
v_mul_f32 v235,v151,v151
s_waitcnt lgkmcnt(4)
v_mfma_f32_16x16x32_bf16 v[192:195],v[216:219],v[72:75],v[192:195]
ds_read_b64_tr_b16 v[212:213],v243 offset:32768
v_fma_f32 v232,v232,v240,v239
v_mfma_f32_16x16x32_bf16 v[196:199],v[216:219],v[76:79],v[196:199]
ds_read_b64_tr_b16 v[214:215],v243 offset:34816
v_fma_f32 v233,v233,v240,v239
s_waitcnt lgkmcnt(4)
v_mfma_f32_16x16x32_bf16 v[200:203],v[220:223],v[72:75],v[200:203]
ds_read_b64_tr_b16 v[216:217],v242 offset:36864
v_fma_f32 v234,v234,v240,v239
v_mfma_f32_16x16x32_bf16 v[204:207],v[220:223],v[76:79],v[204:207]
ds_read_b64_tr_b16 v[218:219],v242 offset:38912
v_fma_f32 v235,v235,v240,v239
s_waitcnt vmcnt(6)
s_barrier
s_waitcnt lgkmcnt(4)
v_mfma_f32_16x16x32_bf16 v[176:179],v[208:211],v[80:83],v[176:179]
ds_read_b64_tr_b16 v[220:221],v243 offset:36864
v_mul_f32 v232,v148,v232
v_mfma_f32_16x16x32_bf16 v[180:183],v[208:211],v[84:87],v[180:183]
ds_read_b64_tr_b16 v[222:223],v243 offset:38912
v_mul_f32 v233,v149,v233
s_waitcnt lgkmcnt(4)
v_mfma_f32_16x16x32_bf16 v[184:187],v[212:215],v[80:83],v[184:187]
ds_read_b64_tr_b16 v[208:209],v242 offset:40960
v_mul_f32 v234,v150,v234
s_add_u32 m0,s29,16384
s_add_u32 s35,s35,294912
buffer_load_dwordx4 v245,s[4:7],s35 offen lds
s_add_u32 m0,s29,20480
s_nop 0
buffer_load_dwordx4 v245,s[52:55],s35 offen lds
v_mfma_f32_16x16x32_bf16 v[188:191],v[212:215],v[84:87],v[188:191]
ds_read_b64_tr_b16 v[210:211],v242 offset:43008
v_mul_f32 v235,v151,v235
s_waitcnt lgkmcnt(4)
v_mfma_f32_16x16x32_bf16 v[192:195],v[216:219],v[80:83],v[192:195]
ds_read_b64_tr_b16 v[212:213],v243 offset:40960
v_exp_f32 v232,v232
v_mfma_f32_16x16x32_bf16 v[196:199],v[216:219],v[84:87],v[196:199]
ds_read_b64_tr_b16 v[214:215],v243 offset:43008
v_exp_f32 v233,v233
s_waitcnt lgkmcnt(4)
v_mfma_f32_16x16x32_bf16 v[200:203],v[220:223],v[80:83],v[200:203]
ds_read_b64_tr_b16 v[216:217],v242 offset:45056
v_exp_f32 v234,v234
v_mfma_f32_16x16x32_bf16 v[204:207],v[220:223],v[84:87],v[204:207]
ds_read_b64_tr_b16 v[218:219],v242 offset:47104
v_exp_f32 v235,v235
v_mul_f32 v164,v148,v164
s_waitcnt lgkmcnt(4)
v_mfma_f32_16x16x32_bf16 v[176:179],v[208:211],v[88:91],v[176:179]
ds_read_b64_tr_b16 v[220:221],v243 offset:45056
v_mul_f32 v165,v149,v165
v_mfma_f32_16x16x32_bf16 v[180:183],v[208:211],v[92:95],v[180:183]
ds_read_b64_tr_b16 v[222:223],v243 offset:47104
v_mul_f32 v166,v150,v166
s_waitcnt lgkmcnt(4)
v_mfma_f32_16x16x32_bf16 v[184:187],v[212:215],v[88:91],v[184:187]
ds_read_b64_tr_b16 v[208:209],v242 offset:49152
v_mul_f32 v167,v151,v167
s_add_u32 m0,s29,24576
s_add_u32 s35,s35,294912
buffer_load_dwordx4 v245,s[4:7],s35 offen lds
s_add_u32 m0,s29,28672
s_nop 0
buffer_load_dwordx4 v245,s[52:55],s35 offen lds
v_mfma_f32_16x16x32_bf16 v[188:191],v[212:215],v[92:95],v[188:191]
ds_read_b64_tr_b16 v[210:211],v242 offset:51200
v_fma_f32 v232,v232,v241,v241
s_waitcnt lgkmcnt(4)
v_mfma_f32_16x16x32_bf16 v[192:195],v[216:219],v[88:91],v[192:195]
ds_read_b64_tr_b16 v[212:213],v243 offset:49152
v_fma_f32 v233,v233,v241,v241
v_mfma_f32_16x16x32_bf16 v[196:199],v[216:219],v[92:95],v[196:199]
ds_read_b64_tr_b16 v[214:215],v243 offset:51200
v_fma_f32 v234,v234,v241,v241
s_waitcnt lgkmcnt(4)
v_mfma_f32_16x16x32_bf16 v[200:203],v[220:223],v[88:91],v[200:203]
ds_read_b64_tr_b16 v[216:217],v242 offset:53248
v_fma_f32 v235,v235,v241,v241
v_mfma_f32_16x16x32_bf16 v[204:207],v[220:223],v[92:95],v[204:207]
ds_read_b64_tr_b16 v[218:219],v242 offset:55296
v_rcp_f32 v232,v232
s_waitcnt vmcnt(6)
s_barrier
s_waitcnt lgkmcnt(4)
v_mfma_f32_16x16x32_bf16 v[176:179],v[208:211],v[96:99],v[176:179]
ds_read_b64_tr_b16 v[220:221],v243 offset:53248
v_rcp_f32 v233,v233
v_mfma_f32_16x16x32_bf16 v[180:183],v[208:211],v[100:103],v[180:183]
ds_read_b64_tr_b16 v[222:223],v243 offset:55296
v_rcp_f32 v234,v234
s_waitcnt lgkmcnt(4)
v_mfma_f32_16x16x32_bf16 v[184:187],v[212:215],v[96:99],v[184:187]
ds_read_b64_tr_b16 v[208:209],v242 offset:57344
v_rcp_f32 v235,v235
s_add_u32 m0,s29,32768
s_add_u32 s37,s32,2
s_and_b32 s37,s37,3
s_lshl_b32 s37,s37,7
s_lshl_b32 s43,s33,1
s_add_u32 s35,s43,s37
buffer_load_dwordx4 v245,s[4:7],s35 offen lds
s_add_u32 m0,s29,36864
s_nop 0
buffer_load_dwordx4 v245,s[52:55],s35 offen lds
v_mfma_f32_16x16x32_bf16 v[188:191],v[212:215],v[100:103],v[188:191]
ds_read_b64_tr_b16 v[210:211],v242 offset:59392
v_mul_f32 v164,v164,v232
s_waitcnt lgkmcnt(4)
v_mfma_f32_16x16x32_bf16 v[192:195],v[216:219],v[96:99],v[192:195]
ds_read_b64_tr_b16 v[212:213],v243 offset:57344
v_mul_f32 v165,v165,v233
v_mfma_f32_16x16x32_bf16 v[196:199],v[216:219],v[100:103],v[196:199]
ds_read_b64_tr_b16 v[214:215],v243 offset:59392
v_mul_f32 v166,v166,v234
s_waitcnt lgkmcnt(4)
v_mfma_f32_16x16x32_bf16 v[200:203],v[220:223],v[96:99],v[200:203]
ds_read_b64_tr_b16 v[216:217],v242 offset:61440
v_mul_f32 v167,v167,v235
v_mfma_f32_16x16x32_bf16 v[204:207],v[220:223],v[100:103],v[204:207]
ds_read_b64_tr_b16 v[218:219],v242 offset:63488
v_cvt_pk_bf16_f32 v228,v164,v165
v_cvt_pk_bf16_f32 v229,v166,v167
s_waitcnt lgkmcnt(4)
v_mfma_f32_16x16x32_bf16 v[176:179],v[208:211],v[104:107],v[176:179]
ds_read_b64_tr_b16 v[220:221],v243 offset:61440
v_mul_f32 v232,v156,v156
v_mfma_f32_16x16x32_bf16 v[180:183],v[208:211],v[108:111],v[180:183]
ds_read_b64_tr_b16 v[222:223],v243 offset:63488
v_mul_f32 v233,v157,v157
s_waitcnt lgkmcnt(4)
v_mfma_f32_16x16x32_bf16 v[184:187],v[212:215],v[104:107],v[184:187]
ds_read_b64_tr_b16 v[208:209],v242 offset:0
v_mul_f32 v234,v158,v158
s_add_u32 m0,s29,40960
s_add_u32 s35,s35,294912
buffer_load_dwordx4 v245,s[4:7],s35 offen lds
s_add_u32 m0,s29,45056
s_nop 0
buffer_load_dwordx4 v245,s[52:55],s35 offen lds
v_mfma_f32_16x16x32_bf16 v[188:191],v[212:215],v[108:111],v[188:191]
ds_read_b64_tr_b16 v[210:211],v242 offset:2048
v_mul_f32 v235,v159,v159
s_waitcnt lgkmcnt(4)
v_mfma_f32_16x16x32_bf16 v[192:195],v[216:219],v[104:107],v[192:195]
ds_read_b64_tr_b16 v[212:213],v243 offset:0
v_fma_f32 v232,v232,v240,v239
v_mfma_f32_16x16x32_bf16 v[196:199],v[216:219],v[108:111],v[196:199]
ds_read_b64_tr_b16 v[214:215],v243 offset:2048
v_fma_f32 v233,v233,v240,v239
s_waitcnt lgkmcnt(4)
v_mfma_f32_16x16x32_bf16 v[200:203],v[220:223],v[104:107],v[200:203]
ds_read_b64_tr_b16 v[216:217],v242 offset:4096
v_fma_f32 v234,v234,v240,v239
v_mfma_f32_16x16x32_bf16 v[204:207],v[220:223],v[108:111],v[204:207]
ds_read_b64_tr_b16 v[218:219],v242 offset:6144
v_fma_f32 v235,v235,v240,v239
s_waitcnt vmcnt(6)
s_barrier
s_waitcnt lgkmcnt(4)
v_mfma_f32_16x16x32_bf16 v[176:179],v[208:211],v[112:115],v[176:179]
ds_read_b64_tr_b16 v[220:221],v243 offset:4096
v_mul_f32 v232,v156,v232
v_mfma_f32_16x16x32_bf16 v[180:183],v[208:211],v[116:119],v[180:183]
ds_read_b64_tr_b16 v[222:223],v243 offset:6144
v_mul_f32 v233,v157,v233
s_waitcnt lgkmcnt(4)
v_mfma_f32_16x16x32_bf16 v[184:187],v[212:215],v[112:115],v[184:187]
ds_read_b64_tr_b16 v[208:209],v242 offset:8192
v_mul_f32 v234,v158,v234
s_add_u32 m0,s29,49152
s_add_u32 s35,s35,294912
buffer_load_dwordx4 v245,s[4:7],s35 offen lds
s_add_u32 m0,s29,53248
s_nop 0
buffer_load_dwordx4 v245,s[52:55],s35 offen lds
v_mfma_f32_16x16x32_bf16 v[188:191],v[212:215],v[116:119],v[188:191]
ds_read_b64_tr_b16 v[210:211],v242 offset:10240
v_mul_f32 v235,v159,v235
s_waitcnt lgkmcnt(4)
v_mfma_f32_16x16x32_bf16 v[192:195],v[216:219],v[112:115],v[192:195]
ds_read_b64_tr_b16 v[212:213],v243 offset:8192
v_exp_f32 v232,v232
v_mfma_f32_16x16x32_bf16 v[196:199],v[216:219],v[116:119],v[196:199]
ds_read_b64_tr_b16 v[214:215],v243 offset:10240
v_exp_f32 v233,v233
s_waitcnt lgkmcnt(4)
v_mfma_f32_16x16x32_bf16 v[200:203],v[220:223],v[112:115],v[200:203]
ds_read_b64_tr_b16 v[216:217],v242 offset:12288
v_exp_f32 v234,v234
v_mfma_f32_16x16x32_bf16 v[204:207],v[220:223],v[116:119],v[204:207]
ds_read_b64_tr_b16 v[218:219],v242 offset:14336
v_exp_f32 v235,v235
v_mul_f32 v172,v156,v172
s_waitcnt lgkmcnt(4)
v_mfma_f32_16x16x32_bf16 v[176:179],v[208:211],v[120:123],v[176:179]
ds_read_b64_tr_b16 v[220:221],v243 offset:12288
v_mul_f32 v173,v157,v173
v_mfma_f32_16x16x32_bf16 v[180:183],v[208:211],v[124:127],v[180:183]
ds_read_b64_tr_b16 v[222:223],v243 offset:14336
v_mul_f32 v174,v158,v174
s_waitcnt lgkmcnt(4)
v_mfma_f32_16x16x32_bf16 v[184:187],v[212:215],v[120:123],v[184:187]
ds_read_b64_tr_b16 v[208:209],v242 offset:16384
v_mul_f32 v175,v159,v175
s_add_u32 m0,s29,57344
s_add_u32 s35,s35,294912
buffer_load_dwordx4 v245,s[4:7],s35 offen lds
s_add_u32 m0,s29,61440
s_nop 0
buffer_load_dwordx4 v245,s[52:55],s35 offen lds
v_mfma_f32_16x16x32_bf16 v[188:191],v[212:215],v[124:127],v[188:191]
ds_read_b64_tr_b16 v[210:211],v242 offset:18432
v_fma_f32 v232,v232,v241,v241
s_waitcnt lgkmcnt(4)
v_mfma_f32_16x16x32_bf16 v[192:195],v[216:219],v[120:123],v[192:195]
ds_read_b64_tr_b16 v[212:213],v243 offset:16384
v_fma_f32 v233,v233,v241,v241
v_mfma_f32_16x16x32_bf16 v[196:199],v[216:219],v[124:127],v[196:199]
ds_read_b64_tr_b16 v[214:215],v243 offset:18432
v_fma_f32 v234,v234,v241,v241
s_waitcnt lgkmcnt(4)
v_mfma_f32_16x16x32_bf16 v[200:203],v[220:223],v[120:123],v[200:203]
ds_read_b64_tr_b16 v[216:217],v242 offset:20480
v_fma_f32 v235,v235,v241,v241
v_mfma_f32_16x16x32_bf16 v[204:207],v[220:223],v[124:127],v[204:207]
ds_read_b64_tr_b16 v[218:219],v242 offset:22528
v_rcp_f32 v232,v232
s_waitcnt vmcnt(6)
s_barrier
s_waitcnt lgkmcnt(4)
v_mfma_f32_16x16x32_bf16 v[176:179],v[208:211],v[128:131],v[176:179]
ds_read_b64_tr_b16 v[220:221],v243 offset:20480
v_rcp_f32 v233,v233
v_mfma_f32_16x16x32_bf16 v[180:183],v[208:211],v[132:135],v[180:183]
ds_read_b64_tr_b16 v[222:223],v243 offset:22528
v_rcp_f32 v234,v234
s_waitcnt lgkmcnt(4)
v_mfma_f32_16x16x32_bf16 v[184:187],v[212:215],v[128:131],v[184:187]
ds_read_b64_tr_b16 v[208:209],v242 offset:24576
v_rcp_f32 v235,v235
s_add_u32 m0,s29,0
s_add_u32 s35,s35,294912
buffer_load_dwordx4 v245,s[4:7],s35 offen lds
s_add_u32 m0,s29,4096
s_nop 0
buffer_load_dwordx4 v245,s[52:55],s35 offen lds
v_mfma_f32_16x16x32_bf16 v[188:191],v[212:215],v[132:135],v[188:191]
ds_read_b64_tr_b16 v[210:211],v242 offset:26624
v_mul_f32 v172,v172,v232
s_waitcnt lgkmcnt(4)
v_mfma_f32_16x16x32_bf16 v[192:195],v[216:219],v[128:131],v[192:195]
ds_read_b64_tr_b16 v[212:213],v243 offset:24576
v_mul_f32 v173,v173,v233
v_mfma_f32_16x16x32_bf16 v[196:199],v[216:219],v[132:135],v[196:199]
ds_read_b64_tr_b16 v[214:215],v243 offset:26624
v_mul_f32 v174,v174,v234
s_waitcnt lgkmcnt(4)
v_mfma_f32_16x16x32_bf16 v[200:203],v[220:223],v[128:131],v[200:203]
ds_read_b64_tr_b16 v[216:217],v242 offset:28672
v_mul_f32 v175,v175,v235
v_mfma_f32_16x16x32_bf16 v[204:207],v[220:223],v[132:135],v[204:207]
ds_read_b64_tr_b16 v[218:219],v242 offset:30720
v_cvt_pk_bf16_f32 v230,v172,v173
v_cvt_pk_bf16_f32 v231,v174,v175
s_waitcnt lgkmcnt(4)
v_mfma_f32_16x16x32_bf16 v[176:179],v[208:211],v[136:139],v[176:179]
ds_read_b64_tr_b16 v[220:221],v243 offset:28672
v_mfma_f32_16x16x32_bf16 v[180:183],v[208:211],v[140:143],v[180:183]
ds_read_b64_tr_b16 v[222:223],v243 offset:30720
ds_write_b128 v253,v[224:227] offset:0
s_waitcnt lgkmcnt(5)
v_mfma_f32_16x16x32_bf16 v[184:187],v[212:215],v[136:139],v[184:187]
ds_read_b64_tr_b16 v[208:209],v242 offset:32768
ds_write_b128 v253,v[228:231] offset:1024
s_add_u32 m0,s29,8192
s_add_u32 s35,s35,294912
buffer_load_dwordx4 v245,s[4:7],s35 offen lds
s_add_u32 m0,s29,12288
s_nop 0
buffer_load_dwordx4 v245,s[52:55],s35 offen lds
v_mfma_f32_16x16x32_bf16 v[188:191],v[212:215],v[140:143],v[188:191]
ds_read_b64_tr_b16 v[210:211],v242 offset:34816
s_lshl_b32 s40,s42,11
s_waitcnt lgkmcnt(6)
v_mfma_f32_16x16x32_bf16 v[192:195],v[216:219],v[136:139],v[192:195]
ds_read_b64_tr_b16 v[212:213],v243 offset:32768
s_add_u32 s40,s40,0
v_mfma_f32_16x16x32_bf16 v[196:199],v[216:219],v[140:143],v[196:199]
ds_read_b64_tr_b16 v[214:215],v243 offset:34816
s_add_u32 s40,s40,s93
s_waitcnt lgkmcnt(6)
v_mfma_f32_16x16x32_bf16 v[200:203],v[220:223],v[136:139],v[200:203]
ds_read_b64_tr_b16 v[216:217],v242 offset:36864
buffer_store_dwordx4 v[224:227],v254,s[68:71],s40 offen offset:0 sc1
v_mfma_f32_16x16x32_bf16 v[204:207],v[220:223],v[140:143],v[204:207]
ds_read_b64_tr_b16 v[218:219],v242 offset:38912
buffer_store_dwordx4 v[228:231],v254,s[68:71],s40 offen offset:1024 sc1
s_waitcnt vmcnt(8) lgkmcnt(5)
s_barrier
s_waitcnt lgkmcnt(4)
v_mfma_f32_16x16x32_bf16 v[144:147],v[208:211],v[0:3],0
ds_read_b64_tr_b16 v[220:221],v243 offset:36864
v_mfma_f32_16x16x32_bf16 v[148:151],v[208:211],v[4:7],0
ds_read_b64_tr_b16 v[222:223],v243 offset:38912
s_waitcnt lgkmcnt(4)
v_mfma_f32_16x16x32_bf16 v[152:155],v[212:215],v[0:3],0
ds_read_b64_tr_b16 v[208:209],v242 offset:40960
s_add_u32 m0,s29,16384
s_add_u32 s35,s35,294912
buffer_load_dwordx4 v245,s[4:7],s35 offen lds
s_add_u32 m0,s29,20480
s_nop 0
buffer_load_dwordx4 v245,s[52:55],s35 offen lds
v_mfma_f32_16x16x32_bf16 v[156:159],v[212:215],v[4:7],0
ds_read_b64_tr_b16 v[210:211],v242 offset:43008
s_waitcnt lgkmcnt(4)
v_mfma_f32_16x16x32_bf16 v[160:163],v[216:219],v[0:3],0
ds_read_b64_tr_b16 v[212:213],v243 offset:40960
v_mfma_f32_16x16x32_bf16 v[164:167],v[216:219],v[4:7],0
ds_read_b64_tr_b16 v[214:215],v243 offset:43008
s_waitcnt lgkmcnt(4)
v_mfma_f32_16x16x32_bf16 v[168:171],v[220:223],v[0:3],0
ds_read_b64_tr_b16 v[216:217],v242 offset:45056
v_mfma_f32_16x16x32_bf16 v[172:175],v[220:223],v[4:7],0
ds_read_b64_tr_b16 v[218:219],v242 offset:47104
s_waitcnt lgkmcnt(4)
v_mfma_f32_16x16x32_bf16 v[144:147],v[208:211],v[8:11],v[144:147]
ds_read_b64_tr_b16 v[220:221],v243 offset:45056
v_mul_f32 v232,v176,v176
v_mfma_f32_16x16x32_bf16 v[148:151],v[208:211],v[12:15],v[148:151]
ds_read_b64_tr_b16 v[222:223],v243 offset:47104
v_mul_f32 v233,v177,v177
s_waitcnt lgkmcnt(4)
v_mfma_f32_16x16x32_bf16 v[152:155],v[212:215],v[8:11],v[152:155]
ds_read_b64_tr_b16 v[208:209],v242 offset:49152
v_mul_f32 v234,v178,v178
s_add_u32 m0,s29,24576
s_add_u32 s35,s35,294912
buffer_load_dwordx4 v245,s[4:7],s35 offen lds
s_add_u32 m0,s29,28672
s_nop 0
buffer_load_dwordx4 v245,s[52:55],s35 offen lds
v_mfma_f32_16x16x32_bf16 v[156:159],v[212:215],v[12:15],v[156:159]
ds_read_b64_tr_b16 v[210:211],v242 offset:51200
v_mul_f32 v235,v179,v179
s_waitcnt lgkmcnt(4)
v_mfma_f32_16x16x32_bf16 v[160:163],v[216:219],v[8:11],v[160:163]
ds_read_b64_tr_b16 v[212:213],v243 offset:49152
v_fma_f32 v232,v232,v237,v236
v_mfma_f32_16x16x32_bf16 v[164:167],v[216:219],v[12:15],v[164:167]
ds_read_b64_tr_b16 v[214:215],v243 offset:51200
v_fma_f32 v233,v233,v237,v236
s_waitcnt lgkmcnt(4)
v_mfma_f32_16x16x32_bf16 v[168:171],v[220:223],v[8:11],v[168:171]
ds_read_b64_tr_b16 v[216:217],v242 offset:53248
v_fma_f32 v234,v234,v237,v236
v_mfma_f32_16x16x32_bf16 v[172:175],v[220:223],v[12:15],v[172:175]
ds_read_b64_tr_b16 v[218:219],v242 offset:55296
v_fma_f32 v235,v235,v237,v236
s_waitcnt vmcnt(8)
s_barrier
s_waitcnt lgkmcnt(4)
v_mfma_f32_16x16x32_bf16 v[144:147],v[208:211],v[16:19],v[144:147]
ds_read_b64_tr_b16 v[220:221],v243 offset:53248
v_mul_f32 v232,v176,v232
v_mfma_f32_16x16x32_bf16 v[148:151],v[208:211],v[20:23],v[148:151]
ds_read_b64_tr_b16 v[222:223],v243 offset:55296
v_mul_f32 v233,v177,v233
s_waitcnt lgkmcnt(4)
v_mfma_f32_16x16x32_bf16 v[152:155],v[212:215],v[16:19],v[152:155]
ds_read_b64_tr_b16 v[208:209],v242 offset:57344
v_mul_f32 v234,v178,v234
s_add_u32 m0,s29,32768
s_add_u32 s35,s35,294912
buffer_load_dwordx4 v245,s[4:7],s35 offen lds
s_add_u32 m0,s29,36864
s_nop 0
buffer_load_dwordx4 v245,s[52:55],s35 offen lds
v_mfma_f32_16x16x32_bf16 v[156:159],v[212:215],v[20:23],v[156:159]
ds_read_b64_tr_b16 v[210:211],v242 offset:59392
v_mul_f32 v235,v179,v235
s_waitcnt lgkmcnt(4)
v_mfma_f32_16x16x32_bf16 v[160:163],v[216:219],v[16:19],v[160:163]
ds_read_b64_tr_b16 v[212:213],v243 offset:57344
v_exp_f32 v232,v232
v_mfma_f32_16x16x32_bf16 v[164:167],v[216:219],v[20:23],v[164:167]
ds_read_b64_tr_b16 v[214:215],v243 offset:59392
v_exp_f32 v233,v233
s_waitcnt lgkmcnt(4)
v_mfma_f32_16x16x32_bf16 v[168:171],v[220:223],v[16:19],v[168:171]
ds_read_b64_tr_b16 v[216:217],v242 offset:61440
v_exp_f32 v234,v234
v_mfma_f32_16x16x32_bf16 v[172:175],v[220:223],v[20:23],v[172:175]
ds_read_b64_tr_b16 v[218:219],v242 offset:63488
v_exp_f32 v235,v235
v_mul_f32 v192,v176,v192
s_waitcnt lgkmcnt(4)
v_mfma_f32_16x16x32_bf16 v[144:147],v[208:211],v[24:27],v[144:147]
ds_read_b64_tr_b16 v[220:221],v243 offset:61440
v_mul_f32 v193,v177,v193
v_mfma_f32_16x16x32_bf16 v[148:151],v[208:211],v[28:31],v[148:151]
ds_read_b64_tr_b16 v[222:223],v243 offset:63488
v_mul_f32 v194,v178,v194
s_waitcnt lgkmcnt(4)
v_mfma_f32_16x16x32_bf16 v[152:155],v[212:215],v[24:27],v[152:155]
ds_read_b64_tr_b16 v[208:209],v242 offset:0
v_mul_f32 v195,v179,v195
s_add_u32 m0,s29,40960
s_add_u32 s35,s35,294912
buffer_load_dwordx4 v245,s[4:7],s35 offen lds
s_add_u32 m0,s29,45056
s_nop 0
buffer_load_dwordx4 v245,s[52:55],s35 offen lds
v_mfma_f32_16x16x32_bf16 v[156:159],v[212:215],v[28:31],v[156:159]
ds_read_b64_tr_b16 v[210:211],v242 offset:2048
v_fma_f32 v232,v232,v238,v238
s_waitcnt lgkmcnt(4)
v_mfma_f32_16x16x32_bf16 v[160:163],v[216:219],v[24:27],v[160:163]
ds_read_b64_tr_b16 v[212:213],v243 offset:0
v_fma_f32 v233,v233,v238,v238
v_mfma_f32_16x16x32_bf16 v[164:167],v[216:219],v[28:31],v[164:167]
ds_read_b64_tr_b16 v[214:215],v243 offset:2048
v_fma_f32 v234,v234,v238,v238
s_waitcnt lgkmcnt(4)
v_mfma_f32_16x16x32_bf16 v[168:171],v[220:223],v[24:27],v[168:171]
ds_read_b64_tr_b16 v[216:217],v242 offset:4096
v_fma_f32 v235,v235,v238,v238
v_mfma_f32_16x16x32_bf16 v[172:175],v[220:223],v[28:31],v[172:175]
ds_read_b64_tr_b16 v[218:219],v242 offset:6144
v_rcp_f32 v232,v232
s_waitcnt vmcnt(6)
s_barrier
s_waitcnt lgkmcnt(4)
v_mfma_f32_16x16x32_bf16 v[144:147],v[208:211],v[32:35],v[144:147]
ds_read_b64_tr_b16 v[220:221],v243 offset:4096
v_rcp_f32 v233,v233
v_mfma_f32_16x16x32_bf16 v[148:151],v[208:211],v[36:39],v[148:151]
ds_read_b64_tr_b16 v[222:223],v243 offset:6144
v_rcp_f32 v234,v234
s_waitcnt lgkmcnt(4)
v_mfma_f32_16x16x32_bf16 v[152:155],v[212:215],v[32:35],v[152:155]
ds_read_b64_tr_b16 v[208:209],v242 offset:8192
v_rcp_f32 v235,v235
s_add_u32 m0,s29,49152
s_add_u32 s35,s35,294912
buffer_load_dwordx4 v245,s[4:7],s35 offen lds
s_add_u32 m0,s29,53248
s_nop 0
buffer_load_dwordx4 v245,s[52:55],s35 offen lds
v_mfma_f32_16x16x32_bf16 v[156:159],v[212:215],v[36:39],v[156:159]
ds_read_b64_tr_b16 v[210:211],v242 offset:10240
v_mul_f32 v192,v192,v232
s_waitcnt lgkmcnt(4)
v_mfma_f32_16x16x32_bf16 v[160:163],v[216:219],v[32:35],v[160:163]
ds_read_b64_tr_b16 v[212:213],v243 offset:8192
v_mul_f32 v193,v193,v233
v_mfma_f32_16x16x32_bf16 v[164:167],v[216:219],v[36:39],v[164:167]
ds_read_b64_tr_b16 v[214:215],v243 offset:10240
v_mul_f32 v194,v194,v234
s_waitcnt lgkmcnt(4)
v_mfma_f32_16x16x32_bf16 v[168:171],v[220:223],v[32:35],v[168:171]
ds_read_b64_tr_b16 v[216:217],v242 offset:12288
v_mul_f32 v195,v195,v235
v_mfma_f32_16x16x32_bf16 v[172:175],v[220:223],v[36:39],v[172:175]
ds_read_b64_tr_b16 v[218:219],v242 offset:14336
v_cvt_pk_bf16_f32 v224,v192,v193
v_cvt_pk_bf16_f32 v225,v194,v195
s_waitcnt lgkmcnt(4)
v_mfma_f32_16x16x32_bf16 v[144:147],v[208:211],v[40:43],v[144:147]
ds_read_b64_tr_b16 v[220:221],v243 offset:12288
v_mul_f32 v232,v184,v184
v_mfma_f32_16x16x32_bf16 v[148:151],v[208:211],v[44:47],v[148:151]
ds_read_b64_tr_b16 v[222:223],v243 offset:14336
v_mul_f32 v233,v185,v185
s_waitcnt lgkmcnt(4)
v_mfma_f32_16x16x32_bf16 v[152:155],v[212:215],v[40:43],v[152:155]
ds_read_b64_tr_b16 v[208:209],v242 offset:16384
v_mul_f32 v234,v186,v186
s_add_u32 m0,s29,57344
s_add_u32 s35,s35,294912
buffer_load_dwordx4 v245,s[4:7],s35 offen lds
s_add_u32 m0,s29,61440
s_nop 0
buffer_load_dwordx4 v245,s[52:55],s35 offen lds
v_mfma_f32_16x16x32_bf16 v[156:159],v[212:215],v[44:47],v[156:159]
ds_read_b64_tr_b16 v[210:211],v242 offset:18432
v_mul_f32 v235,v187,v187
s_waitcnt lgkmcnt(4)
v_mfma_f32_16x16x32_bf16 v[160:163],v[216:219],v[40:43],v[160:163]
ds_read_b64_tr_b16 v[212:213],v243 offset:16384
v_fma_f32 v232,v232,v237,v236
v_mfma_f32_16x16x32_bf16 v[164:167],v[216:219],v[44:47],v[164:167]
ds_read_b64_tr_b16 v[214:215],v243 offset:18432
v_fma_f32 v233,v233,v237,v236
s_waitcnt lgkmcnt(4)
v_mfma_f32_16x16x32_bf16 v[168:171],v[220:223],v[40:43],v[168:171]
ds_read_b64_tr_b16 v[216:217],v242 offset:20480
v_fma_f32 v234,v234,v237,v236
v_mfma_f32_16x16x32_bf16 v[172:175],v[220:223],v[44:47],v[172:175]
ds_read_b64_tr_b16 v[218:219],v242 offset:22528
v_fma_f32 v235,v235,v237,v236
s_waitcnt vmcnt(6)
s_barrier
s_waitcnt lgkmcnt(4)
v_mfma_f32_16x16x32_bf16 v[144:147],v[208:211],v[48:51],v[144:147]
ds_read_b64_tr_b16 v[220:221],v243 offset:20480
v_mul_f32 v232,v184,v232
v_mfma_f32_16x16x32_bf16 v[148:151],v[208:211],v[52:55],v[148:151]
ds_read_b64_tr_b16 v[222:223],v243 offset:22528
v_mul_f32 v233,v185,v233
s_waitcnt lgkmcnt(4)
v_mfma_f32_16x16x32_bf16 v[152:155],v[212:215],v[48:51],v[152:155]
ds_read_b64_tr_b16 v[208:209],v242 offset:24576
v_mul_f32 v234,v186,v234
s_add_u32 m0,s29,0
s_add_u32 s35,s35,294912
buffer_load_dwordx4 v245,s[4:7],s35 offen lds
s_add_u32 m0,s29,4096
s_nop 0
buffer_load_dwordx4 v245,s[52:55],s35 offen lds
v_mfma_f32_16x16x32_bf16 v[156:159],v[212:215],v[52:55],v[156:159]
ds_read_b64_tr_b16 v[210:211],v242 offset:26624
v_mul_f32 v235,v187,v235
s_waitcnt lgkmcnt(4)
v_mfma_f32_16x16x32_bf16 v[160:163],v[216:219],v[48:51],v[160:163]
ds_read_b64_tr_b16 v[212:213],v243 offset:24576
v_exp_f32 v232,v232
v_mfma_f32_16x16x32_bf16 v[164:167],v[216:219],v[52:55],v[164:167]
ds_read_b64_tr_b16 v[214:215],v243 offset:26624
v_exp_f32 v233,v233
s_waitcnt lgkmcnt(4)
v_mfma_f32_16x16x32_bf16 v[168:171],v[220:223],v[48:51],v[168:171]
ds_read_b64_tr_b16 v[216:217],v242 offset:28672
v_exp_f32 v234,v234
v_mfma_f32_16x16x32_bf16 v[172:175],v[220:223],v[52:55],v[172:175]
ds_read_b64_tr_b16 v[218:219],v242 offset:30720
v_exp_f32 v235,v235
v_mul_f32 v200,v184,v200
s_waitcnt lgkmcnt(4)
v_mfma_f32_16x16x32_bf16 v[144:147],v[208:211],v[56:59],v[144:147]
ds_read_b64_tr_b16 v[220:221],v243 offset:28672
v_mul_f32 v201,v185,v201
v_mfma_f32_16x16x32_bf16 v[148:151],v[208:211],v[60:63],v[148:151]
ds_read_b64_tr_b16 v[222:223],v243 offset:30720
v_mul_f32 v202,v186,v202
s_waitcnt lgkmcnt(4)
v_mfma_f32_16x16x32_bf16 v[152:155],v[212:215],v[56:59],v[152:155]
ds_read_b64_tr_b16 v[208:209],v242 offset:32768
v_mul_f32 v203,v187,v203
s_add_u32 m0,s29,8192
s_add_u32 s35,s35,294912
buffer_load_dwordx4 v245,s[4:7],s35 offen lds
s_add_u32 m0,s29,12288
s_nop 0
buffer_load_dwordx4 v245,s[52:55],s35 offen lds
v_mfma_f32_16x16x32_bf16 v[156:159],v[212:215],v[60:63],v[156:159]
ds_read_b64_tr_b16 v[210:211],v242 offset:34816
v_fma_f32 v232,v232,v238,v238
s_waitcnt lgkmcnt(4)
v_mfma_f32_16x16x32_bf16 v[160:163],v[216:219],v[56:59],v[160:163]
ds_read_b64_tr_b16 v[212:213],v243 offset:32768
v_fma_f32 v233,v233,v238,v238
v_mfma_f32_16x16x32_bf16 v[164:167],v[216:219],v[60:63],v[164:167]
ds_read_b64_tr_b16 v[214:215],v243 offset:34816
v_fma_f32 v234,v234,v238,v238
s_waitcnt lgkmcnt(4)
v_mfma_f32_16x16x32_bf16 v[168:171],v[220:223],v[56:59],v[168:171]
ds_read_b64_tr_b16 v[216:217],v242 offset:36864
v_fma_f32 v235,v235,v238,v238
v_mfma_f32_16x16x32_bf16 v[172:175],v[220:223],v[60:63],v[172:175]
ds_read_b64_tr_b16 v[218:219],v242 offset:38912
v_rcp_f32 v232,v232
s_waitcnt vmcnt(6)
s_barrier
s_waitcnt lgkmcnt(4)
v_mfma_f32_16x16x32_bf16 v[144:147],v[208:211],v[64:67],v[144:147]
ds_read_b64_tr_b16 v[220:221],v243 offset:36864
v_rcp_f32 v233,v233
v_mfma_f32_16x16x32_bf16 v[148:151],v[208:211],v[68:71],v[148:151]
ds_read_b64_tr_b16 v[222:223],v243 offset:38912
v_rcp_f32 v234,v234
s_waitcnt lgkmcnt(4)
v_mfma_f32_16x16x32_bf16 v[152:155],v[212:215],v[64:67],v[152:155]
ds_read_b64_tr_b16 v[208:209],v242 offset:40960
v_rcp_f32 v235,v235
s_add_u32 m0,s29,16384
s_add_u32 s35,s35,294912
buffer_load_dwordx4 v245,s[4:7],s35 offen lds
s_add_u32 m0,s29,20480
s_nop 0
buffer_load_dwordx4 v245,s[52:55],s35 offen lds
v_mfma_f32_16x16x32_bf16 v[156:159],v[212:215],v[68:71],v[156:159]
ds_read_b64_tr_b16 v[210:211],v242 offset:43008
v_mul_f32 v200,v200,v232
s_waitcnt lgkmcnt(4)
v_mfma_f32_16x16x32_bf16 v[160:163],v[216:219],v[64:67],v[160:163]
ds_read_b64_tr_b16 v[212:213],v243 offset:40960
v_mul_f32 v201,v201,v233
v_mfma_f32_16x16x32_bf16 v[164:167],v[216:219],v[68:71],v[164:167]
ds_read_b64_tr_b16 v[214:215],v243 offset:43008
v_mul_f32 v202,v202,v234
s_waitcnt lgkmcnt(4)
v_mfma_f32_16x16x32_bf16 v[168:171],v[220:223],v[64:67],v[168:171]
ds_read_b64_tr_b16 v[216:217],v242 offset:45056
v_mul_f32 v203,v203,v235
v_mfma_f32_16x16x32_bf16 v[172:175],v[220:223],v[68:71],v[172:175]
ds_read_b64_tr_b16 v[218:219],v242 offset:47104
v_cvt_pk_bf16_f32 v226,v200,v201
v_cvt_pk_bf16_f32 v227,v202,v203
s_waitcnt lgkmcnt(4)
v_mfma_f32_16x16x32_bf16 v[144:147],v[208:211],v[72:75],v[144:147]
ds_read_b64_tr_b16 v[220:221],v243 offset:45056
v_mul_f32 v232,v180,v180
v_mfma_f32_16x16x32_bf16 v[148:151],v[208:211],v[76:79],v[148:151]
ds_read_b64_tr_b16 v[222:223],v243 offset:47104
v_mul_f32 v233,v181,v181
s_waitcnt lgkmcnt(4)
v_mfma_f32_16x16x32_bf16 v[152:155],v[212:215],v[72:75],v[152:155]
ds_read_b64_tr_b16 v[208:209],v242 offset:49152
v_mul_f32 v234,v182,v182
s_add_u32 m0,s29,24576
s_add_u32 s35,s35,294912
buffer_load_dwordx4 v245,s[4:7],s35 offen lds
s_add_u32 m0,s29,28672
s_nop 0
buffer_load_dwordx4 v245,s[52:55],s35 offen lds
v_mfma_f32_16x16x32_bf16 v[156:159],v[212:215],v[76:79],v[156:159]
ds_read_b64_tr_b16 v[210:211],v242 offset:51200
v_mul_f32 v235,v183,v183
s_waitcnt lgkmcnt(4)
v_mfma_f32_16x16x32_bf16 v[160:163],v[216:219],v[72:75],v[160:163]
ds_read_b64_tr_b16 v[212:213],v243 offset:49152
v_fma_f32 v232,v232,v240,v239
v_mfma_f32_16x16x32_bf16 v[164:167],v[216:219],v[76:79],v[164:167]
ds_read_b64_tr_b16 v[214:215],v243 offset:51200
v_fma_f32 v233,v233,v240,v239
s_waitcnt lgkmcnt(4)
v_mfma_f32_16x16x32_bf16 v[168:171],v[220:223],v[72:75],v[168:171]
ds_read_b64_tr_b16 v[216:217],v242 offset:53248
v_fma_f32 v234,v234,v240,v239
v_mfma_f32_16x16x32_bf16 v[172:175],v[220:223],v[76:79],v[172:175]
ds_read_b64_tr_b16 v[218:219],v242 offset:55296
v_fma_f32 v235,v235,v240,v239
s_waitcnt vmcnt(6)
s_barrier
s_waitcnt lgkmcnt(4)
v_mfma_f32_16x16x32_bf16 v[144:147],v[208:211],v[80:83],v[144:147]
ds_read_b64_tr_b16 v[220:221],v243 offset:53248
v_mul_f32 v232,v180,v232
v_mfma_f32_16x16x32_bf16 v[148:151],v[208:211],v[84:87],v[148:151]
ds_read_b64_tr_b16 v[222:223],v243 offset:55296
v_mul_f32 v233,v181,v233
s_waitcnt lgkmcnt(4)
v_mfma_f32_16x16x32_bf16 v[152:155],v[212:215],v[80:83],v[152:155]
ds_read_b64_tr_b16 v[208:209],v242 offset:57344
v_mul_f32 v234,v182,v234
s_add_u32 m0,s29,32768
s_add_u32 s35,s35,294912
buffer_load_dwordx4 v245,s[4:7],s35 offen lds
s_add_u32 m0,s29,36864
s_nop 0
buffer_load_dwordx4 v245,s[52:55],s35 offen lds
v_mfma_f32_16x16x32_bf16 v[156:159],v[212:215],v[84:87],v[156:159]
ds_read_b64_tr_b16 v[210:211],v242 offset:59392
v_mul_f32 v235,v183,v235
s_waitcnt lgkmcnt(4)
v_mfma_f32_16x16x32_bf16 v[160:163],v[216:219],v[80:83],v[160:163]
ds_read_b64_tr_b16 v[212:213],v243 offset:57344
v_exp_f32 v232,v232
v_mfma_f32_16x16x32_bf16 v[164:167],v[216:219],v[84:87],v[164:167]
ds_read_b64_tr_b16 v[214:215],v243 offset:59392
v_exp_f32 v233,v233
s_waitcnt lgkmcnt(4)
v_mfma_f32_16x16x32_bf16 v[168:171],v[220:223],v[80:83],v[168:171]
ds_read_b64_tr_b16 v[216:217],v242 offset:61440
v_exp_f32 v234,v234
v_mfma_f32_16x16x32_bf16 v[172:175],v[220:223],v[84:87],v[172:175]
ds_read_b64_tr_b16 v[218:219],v242 offset:63488
v_exp_f32 v235,v235
v_mul_f32 v196,v180,v196
s_waitcnt lgkmcnt(4)
v_mfma_f32_16x16x32_bf16 v[144:147],v[208:211],v[88:91],v[144:147]
ds_read_b64_tr_b16 v[220:221],v243 offset:61440
v_mul_f32 v197,v181,v197
v_mfma_f32_16x16x32_bf16 v[148:151],v[208:211],v[92:95],v[148:151]
ds_read_b64_tr_b16 v[222:223],v243 offset:63488
v_mul_f32 v198,v182,v198
s_waitcnt lgkmcnt(4)
v_mfma_f32_16x16x32_bf16 v[152:155],v[212:215],v[88:91],v[152:155]
ds_read_b64_tr_b16 v[208:209],v242 offset:0
v_mul_f32 v199,v183,v199
s_add_u32 m0,s29,40960
s_add_u32 s35,s35,294912
buffer_load_dwordx4 v245,s[4:7],s35 offen lds
s_add_u32 m0,s29,45056
s_nop 0
buffer_load_dwordx4 v245,s[52:55],s35 offen lds
v_mfma_f32_16x16x32_bf16 v[156:159],v[212:215],v[92:95],v[156:159]
ds_read_b64_tr_b16 v[210:211],v242 offset:2048
v_fma_f32 v232,v232,v241,v241
s_waitcnt lgkmcnt(4)
v_mfma_f32_16x16x32_bf16 v[160:163],v[216:219],v[88:91],v[160:163]
ds_read_b64_tr_b16 v[212:213],v243 offset:0
v_fma_f32 v233,v233,v241,v241
v_mfma_f32_16x16x32_bf16 v[164:167],v[216:219],v[92:95],v[164:167]
ds_read_b64_tr_b16 v[214:215],v243 offset:2048
v_fma_f32 v234,v234,v241,v241
s_waitcnt lgkmcnt(4)
v_mfma_f32_16x16x32_bf16 v[168:171],v[220:223],v[88:91],v[168:171]
ds_read_b64_tr_b16 v[216:217],v242 offset:4096
v_fma_f32 v235,v235,v241,v241
v_mfma_f32_16x16x32_bf16 v[172:175],v[220:223],v[92:95],v[172:175]
ds_read_b64_tr_b16 v[218:219],v242 offset:6144
v_rcp_f32 v232,v232
s_waitcnt vmcnt(6)
s_barrier
s_waitcnt lgkmcnt(4)
v_mfma_f32_16x16x32_bf16 v[144:147],v[208:211],v[96:99],v[144:147]
ds_read_b64_tr_b16 v[220:221],v243 offset:4096
v_rcp_f32 v233,v233
v_mfma_f32_16x16x32_bf16 v[148:151],v[208:211],v[100:103],v[148:151]
ds_read_b64_tr_b16 v[222:223],v243 offset:6144
v_rcp_f32 v234,v234
s_waitcnt lgkmcnt(4)
v_mfma_f32_16x16x32_bf16 v[152:155],v[212:215],v[96:99],v[152:155]
ds_read_b64_tr_b16 v[208:209],v242 offset:8192
v_rcp_f32 v235,v235
s_add_u32 m0,s29,49152
s_add_u32 s37,s32,3
s_and_b32 s37,s37,3
s_lshl_b32 s37,s37,7
s_lshl_b32 s43,s33,1
s_add_u32 s35,s43,s37
buffer_load_dwordx4 v245,s[4:7],s35 offen lds
s_add_u32 m0,s29,53248
s_nop 0
buffer_load_dwordx4 v245,s[52:55],s35 offen lds
v_mfma_f32_16x16x32_bf16 v[156:159],v[212:215],v[100:103],v[156:159]
ds_read_b64_tr_b16 v[210:211],v242 offset:10240
v_mul_f32 v196,v196,v232
s_waitcnt lgkmcnt(4)
v_mfma_f32_16x16x32_bf16 v[160:163],v[216:219],v[96:99],v[160:163]
ds_read_b64_tr_b16 v[212:213],v243 offset:8192
v_mul_f32 v197,v197,v233
v_mfma_f32_16x16x32_bf16 v[164:167],v[216:219],v[100:103],v[164:167]
ds_read_b64_tr_b16 v[214:215],v243 offset:10240
v_mul_f32 v198,v198,v234
s_waitcnt lgkmcnt(4)
v_mfma_f32_16x16x32_bf16 v[168:171],v[220:223],v[96:99],v[168:171]
ds_read_b64_tr_b16 v[216:217],v242 offset:12288
v_mul_f32 v199,v199,v235
v_mfma_f32_16x16x32_bf16 v[172:175],v[220:223],v[100:103],v[172:175]
ds_read_b64_tr_b16 v[218:219],v242 offset:14336
v_cvt_pk_bf16_f32 v228,v196,v197
v_cvt_pk_bf16_f32 v229,v198,v199
s_waitcnt lgkmcnt(4)
v_mfma_f32_16x16x32_bf16 v[144:147],v[208:211],v[104:107],v[144:147]
ds_read_b64_tr_b16 v[220:221],v243 offset:12288
v_mul_f32 v232,v188,v188
v_mfma_f32_16x16x32_bf16 v[148:151],v[208:211],v[108:111],v[148:151]
ds_read_b64_tr_b16 v[222:223],v243 offset:14336
v_mul_f32 v233,v189,v189
s_waitcnt lgkmcnt(4)
v_mfma_f32_16x16x32_bf16 v[152:155],v[212:215],v[104:107],v[152:155]
ds_read_b64_tr_b16 v[208:209],v242 offset:16384
v_mul_f32 v234,v190,v190
s_add_u32 m0,s29,57344
s_add_u32 s35,s35,294912
buffer_load_dwordx4 v245,s[4:7],s35 offen lds
s_add_u32 m0,s29,61440
s_nop 0
buffer_load_dwordx4 v245,s[52:55],s35 offen lds
v_mfma_f32_16x16x32_bf16 v[156:159],v[212:215],v[108:111],v[156:159]
ds_read_b64_tr_b16 v[210:211],v242 offset:18432
v_mul_f32 v235,v191,v191
s_waitcnt lgkmcnt(4)
v_mfma_f32_16x16x32_bf16 v[160:163],v[216:219],v[104:107],v[160:163]
ds_read_b64_tr_b16 v[212:213],v243 offset:16384
v_fma_f32 v232,v232,v240,v239
v_mfma_f32_16x16x32_bf16 v[164:167],v[216:219],v[108:111],v[164:167]
ds_read_b64_tr_b16 v[214:215],v243 offset:18432
v_fma_f32 v233,v233,v240,v239
s_waitcnt lgkmcnt(4)
v_mfma_f32_16x16x32_bf16 v[168:171],v[220:223],v[104:107],v[168:171]
ds_read_b64_tr_b16 v[216:217],v242 offset:20480
v_fma_f32 v234,v234,v240,v239
v_mfma_f32_16x16x32_bf16 v[172:175],v[220:223],v[108:111],v[172:175]
ds_read_b64_tr_b16 v[218:219],v242 offset:22528
v_fma_f32 v235,v235,v240,v239
s_waitcnt vmcnt(6)
s_barrier
s_waitcnt lgkmcnt(4)
v_mfma_f32_16x16x32_bf16 v[144:147],v[208:211],v[112:115],v[144:147]
ds_read_b64_tr_b16 v[220:221],v243 offset:20480
v_mul_f32 v232,v188,v232
v_mfma_f32_16x16x32_bf16 v[148:151],v[208:211],v[116:119],v[148:151]
ds_read_b64_tr_b16 v[222:223],v243 offset:22528
v_mul_f32 v233,v189,v233
s_waitcnt lgkmcnt(4)
v_mfma_f32_16x16x32_bf16 v[152:155],v[212:215],v[112:115],v[152:155]
ds_read_b64_tr_b16 v[208:209],v242 offset:24576
v_mul_f32 v234,v190,v234
s_add_u32 m0,s29,0
s_add_u32 s35,s35,294912
buffer_load_dwordx4 v245,s[4:7],s35 offen lds
s_add_u32 m0,s29,4096
s_nop 0
buffer_load_dwordx4 v245,s[52:55],s35 offen lds
v_mfma_f32_16x16x32_bf16 v[156:159],v[212:215],v[116:119],v[156:159]
ds_read_b64_tr_b16 v[210:211],v242 offset:26624
v_mul_f32 v235,v191,v235
s_waitcnt lgkmcnt(4)
v_mfma_f32_16x16x32_bf16 v[160:163],v[216:219],v[112:115],v[160:163]
ds_read_b64_tr_b16 v[212:213],v243 offset:24576
v_exp_f32 v232,v232
v_mfma_f32_16x16x32_bf16 v[164:167],v[216:219],v[116:119],v[164:167]
ds_read_b64_tr_b16 v[214:215],v243 offset:26624
v_exp_f32 v233,v233
s_waitcnt lgkmcnt(4)
v_mfma_f32_16x16x32_bf16 v[168:171],v[220:223],v[112:115],v[168:171]
ds_read_b64_tr_b16 v[216:217],v242 offset:28672
v_exp_f32 v234,v234
v_mfma_f32_16x16x32_bf16 v[172:175],v[220:223],v[116:119],v[172:175]
ds_read_b64_tr_b16 v[218:219],v242 offset:30720
v_exp_f32 v235,v235
v_mul_f32 v204,v188,v204
s_waitcnt lgkmcnt(4)
v_mfma_f32_16x16x32_bf16 v[144:147],v[208:211],v[120:123],v[144:147]
ds_read_b64_tr_b16 v[220:221],v243 offset:28672
v_mul_f32 v205,v189,v205
v_mfma_f32_16x16x32_bf16 v[148:151],v[208:211],v[124:127],v[148:151]
ds_read_b64_tr_b16 v[222:223],v243 offset:30720
v_mul_f32 v206,v190,v206
s_waitcnt lgkmcnt(4)
v_mfma_f32_16x16x32_bf16 v[152:155],v[212:215],v[120:123],v[152:155]
ds_read_b64_tr_b16 v[208:209],v242 offset:32768
v_mul_f32 v207,v191,v207
s_add_u32 m0,s29,8192
s_add_u32 s35,s35,294912
buffer_load_dwordx4 v245,s[4:7],s35 offen lds
s_add_u32 m0,s29,12288
s_nop 0
buffer_load_dwordx4 v245,s[52:55],s35 offen lds
v_mfma_f32_16x16x32_bf16 v[156:159],v[212:215],v[124:127],v[156:159]
ds_read_b64_tr_b16 v[210:211],v242 offset:34816
v_fma_f32 v232,v232,v241,v241
s_waitcnt lgkmcnt(4)
v_mfma_f32_16x16x32_bf16 v[160:163],v[216:219],v[120:123],v[160:163]
ds_read_b64_tr_b16 v[212:213],v243 offset:32768
v_fma_f32 v233,v233,v241,v241
v_mfma_f32_16x16x32_bf16 v[164:167],v[216:219],v[124:127],v[164:167]
ds_read_b64_tr_b16 v[214:215],v243 offset:34816
v_fma_f32 v234,v234,v241,v241
s_waitcnt lgkmcnt(4)
v_mfma_f32_16x16x32_bf16 v[168:171],v[220:223],v[120:123],v[168:171]
ds_read_b64_tr_b16 v[216:217],v242 offset:36864
v_fma_f32 v235,v235,v241,v241
v_mfma_f32_16x16x32_bf16 v[172:175],v[220:223],v[124:127],v[172:175]
ds_read_b64_tr_b16 v[218:219],v242 offset:38912
v_rcp_f32 v232,v232
s_waitcnt vmcnt(6)
s_barrier
s_waitcnt lgkmcnt(4)
v_mfma_f32_16x16x32_bf16 v[144:147],v[208:211],v[128:131],v[144:147]
ds_read_b64_tr_b16 v[220:221],v243 offset:36864
v_rcp_f32 v233,v233
v_mfma_f32_16x16x32_bf16 v[148:151],v[208:211],v[132:135],v[148:151]
ds_read_b64_tr_b16 v[222:223],v243 offset:38912
v_rcp_f32 v234,v234
s_waitcnt lgkmcnt(4)
v_mfma_f32_16x16x32_bf16 v[152:155],v[212:215],v[128:131],v[152:155]
ds_read_b64_tr_b16 v[208:209],v242 offset:40960
v_rcp_f32 v235,v235
s_add_u32 m0,s29,16384
s_add_u32 s35,s35,294912
buffer_load_dwordx4 v245,s[4:7],s35 offen lds
s_add_u32 m0,s29,20480
s_nop 0
buffer_load_dwordx4 v245,s[52:55],s35 offen lds
v_mfma_f32_16x16x32_bf16 v[156:159],v[212:215],v[132:135],v[156:159]
ds_read_b64_tr_b16 v[210:211],v242 offset:43008
v_mul_f32 v204,v204,v232
s_waitcnt lgkmcnt(4)
v_mfma_f32_16x16x32_bf16 v[160:163],v[216:219],v[128:131],v[160:163]
ds_read_b64_tr_b16 v[212:213],v243 offset:40960
v_mul_f32 v205,v205,v233
v_mfma_f32_16x16x32_bf16 v[164:167],v[216:219],v[132:135],v[164:167]
ds_read_b64_tr_b16 v[214:215],v243 offset:43008
v_mul_f32 v206,v206,v234
s_waitcnt lgkmcnt(4)
v_mfma_f32_16x16x32_bf16 v[168:171],v[220:223],v[128:131],v[168:171]
ds_read_b64_tr_b16 v[216:217],v242 offset:45056
v_mul_f32 v207,v207,v235
v_mfma_f32_16x16x32_bf16 v[172:175],v[220:223],v[132:135],v[172:175]
ds_read_b64_tr_b16 v[218:219],v242 offset:47104
v_cvt_pk_bf16_f32 v230,v204,v205
v_cvt_pk_bf16_f32 v231,v206,v207
s_waitcnt lgkmcnt(4)
v_mfma_f32_16x16x32_bf16 v[144:147],v[208:211],v[136:139],v[144:147]
ds_read_b64_tr_b16 v[220:221],v243 offset:45056
v_mfma_f32_16x16x32_bf16 v[148:151],v[208:211],v[140:143],v[148:151]
ds_read_b64_tr_b16 v[222:223],v243 offset:47104
ds_write_b128 v253,v[224:227] offset:4096
s_waitcnt lgkmcnt(5)
v_mfma_f32_16x16x32_bf16 v[152:155],v[212:215],v[136:139],v[152:155]
ds_read_b64_tr_b16 v[208:209],v242 offset:49152
ds_write_b128 v253,v[228:231] offset:5120
s_add_u32 m0,s29,24576
s_add_u32 s35,s35,294912
buffer_load_dwordx4 v245,s[4:7],s35 offen lds
s_add_u32 m0,s29,28672
s_nop 0
buffer_load_dwordx4 v245,s[52:55],s35 offen lds
v_mfma_f32_16x16x32_bf16 v[156:159],v[212:215],v[140:143],v[156:159]
ds_read_b64_tr_b16 v[210:211],v242 offset:51200
s_lshl_b32 s40,s42,11
s_waitcnt lgkmcnt(6)
v_mfma_f32_16x16x32_bf16 v[160:163],v[216:219],v[136:139],v[160:163]
ds_read_b64_tr_b16 v[212:213],v243 offset:49152
s_add_u32 s40,s40,4096
v_mfma_f32_16x16x32_bf16 v[164:167],v[216:219],v[140:143],v[164:167]
ds_read_b64_tr_b16 v[214:215],v243 offset:51200
s_add_u32 s40,s40,s93
s_waitcnt lgkmcnt(6)
v_mfma_f32_16x16x32_bf16 v[168:171],v[220:223],v[136:139],v[168:171]
ds_read_b64_tr_b16 v[216:217],v242 offset:53248
buffer_store_dwordx4 v[224:227],v254,s[68:71],s40 offen offset:0 sc1
v_mfma_f32_16x16x32_bf16 v[172:175],v[220:223],v[140:143],v[172:175]
ds_read_b64_tr_b16 v[218:219],v242 offset:55296
buffer_store_dwordx4 v[228:231],v254,s[68:71],s40 offen offset:1024 sc1
s_waitcnt vmcnt(8) lgkmcnt(5)
s_barrier
s_waitcnt lgkmcnt(4)
v_mfma_f32_16x16x32_bf16 v[176:179],v[208:211],v[0:3],0
ds_read_b64_tr_b16 v[220:221],v243 offset:53248
v_mfma_f32_16x16x32_bf16 v[180:183],v[208:211],v[4:7],0
ds_read_b64_tr_b16 v[222:223],v243 offset:55296
s_waitcnt lgkmcnt(4)
v_mfma_f32_16x16x32_bf16 v[184:187],v[212:215],v[0:3],0
ds_read_b64_tr_b16 v[208:209],v242 offset:57344
s_add_u32 m0,s29,32768
s_add_u32 s35,s35,294912
buffer_load_dwordx4 v245,s[4:7],s35 offen lds
s_add_u32 m0,s29,36864
s_nop 0
buffer_load_dwordx4 v245,s[52:55],s35 offen lds
v_mfma_f32_16x16x32_bf16 v[188:191],v[212:215],v[4:7],0
ds_read_b64_tr_b16 v[210:211],v242 offset:59392
s_waitcnt lgkmcnt(4)
v_mfma_f32_16x16x32_bf16 v[192:195],v[216:219],v[0:3],0
ds_read_b64_tr_b16 v[212:213],v243 offset:57344
v_mfma_f32_16x16x32_bf16 v[196:199],v[216:219],v[4:7],0
ds_read_b64_tr_b16 v[214:215],v243 offset:59392
s_waitcnt lgkmcnt(4)
v_mfma_f32_16x16x32_bf16 v[200:203],v[220:223],v[0:3],0
ds_read_b64_tr_b16 v[216:217],v242 offset:61440
v_mfma_f32_16x16x32_bf16 v[204:207],v[220:223],v[4:7],0
ds_read_b64_tr_b16 v[218:219],v242 offset:63488
s_waitcnt lgkmcnt(4)
v_mfma_f32_16x16x32_bf16 v[176:179],v[208:211],v[8:11],v[176:179]
ds_read_b64_tr_b16 v[220:221],v243 offset:61440
v_mul_f32 v232,v144,v144
v_mfma_f32_16x16x32_bf16 v[180:183],v[208:211],v[12:15],v[180:183]
ds_read_b64_tr_b16 v[222:223],v243 offset:63488
v_mul_f32 v233,v145,v145
s_waitcnt lgkmcnt(4)
v_mfma_f32_16x16x32_bf16 v[184:187],v[212:215],v[8:11],v[184:187]
ds_read_b64_tr_b16 v[208:209],v242 offset:0
v_mul_f32 v234,v146,v146
s_add_u32 m0,s29,40960
s_add_u32 s35,s35,294912
buffer_load_dwordx4 v245,s[4:7],s35 offen lds
s_add_u32 m0,s29,45056
s_nop 0
buffer_load_dwordx4 v245,s[52:55],s35 offen lds
v_mfma_f32_16x16x32_bf16 v[188:191],v[212:215],v[12:15],v[188:191]
ds_read_b64_tr_b16 v[210:211],v242 offset:2048
v_mul_f32 v235,v147,v147
s_waitcnt lgkmcnt(4)
v_mfma_f32_16x16x32_bf16 v[192:195],v[216:219],v[8:11],v[192:195]
ds_read_b64_tr_b16 v[212:213],v243 offset:0
v_fma_f32 v232,v232,v237,v236
v_mfma_f32_16x16x32_bf16 v[196:199],v[216:219],v[12:15],v[196:199]
ds_read_b64_tr_b16 v[214:215],v243 offset:2048
v_fma_f32 v233,v233,v237,v236
s_waitcnt lgkmcnt(4)
v_mfma_f32_16x16x32_bf16 v[200:203],v[220:223],v[8:11],v[200:203]
ds_read_b64_tr_b16 v[216:217],v242 offset:4096
v_fma_f32 v234,v234,v237,v236
v_mfma_f32_16x16x32_bf16 v[204:207],v[220:223],v[12:15],v[204:207]
ds_read_b64_tr_b16 v[218:219],v242 offset:6144
v_fma_f32 v235,v235,v237,v236
s_waitcnt vmcnt(8)
s_barrier
s_waitcnt lgkmcnt(4)
v_mfma_f32_16x16x32_bf16 v[176:179],v[208:211],v[16:19],v[176:179]
ds_read_b64_tr_b16 v[220:221],v243 offset:4096
v_mul_f32 v232,v144,v232
v_mfma_f32_16x16x32_bf16 v[180:183],v[208:211],v[20:23],v[180:183]
ds_read_b64_tr_b16 v[222:223],v243 offset:6144
v_mul_f32 v233,v145,v233
s_waitcnt lgkmcnt(4)
v_mfma_f32_16x16x32_bf16 v[184:187],v[212:215],v[16:19],v[184:187]
ds_read_b64_tr_b16 v[208:209],v242 offset:8192
v_mul_f32 v234,v146,v234
s_add_u32 m0,s29,49152
s_add_u32 s35,s35,294912
buffer_load_dwordx4 v245,s[4:7],s35 offen lds
s_add_u32 m0,s29,53248
s_nop 0
buffer_load_dwordx4 v245,s[52:55],s35 offen lds
v_mfma_f32_16x16x32_bf16 v[188:191],v[212:215],v[20:23],v[188:191]
ds_read_b64_tr_b16 v[210:211],v242 offset:10240
v_mul_f32 v235,v147,v235
s_waitcnt lgkmcnt(4)
v_mfma_f32_16x16x32_bf16 v[192:195],v[216:219],v[16:19],v[192:195]
ds_read_b64_tr_b16 v[212:213],v243 offset:8192
v_exp_f32 v232,v232
v_mfma_f32_16x16x32_bf16 v[196:199],v[216:219],v[20:23],v[196:199]
ds_read_b64_tr_b16 v[214:215],v243 offset:10240
v_exp_f32 v233,v233
s_waitcnt lgkmcnt(4)
v_mfma_f32_16x16x32_bf16 v[200:203],v[220:223],v[16:19],v[200:203]
ds_read_b64_tr_b16 v[216:217],v242 offset:12288
v_exp_f32 v234,v234
v_mfma_f32_16x16x32_bf16 v[204:207],v[220:223],v[20:23],v[204:207]
ds_read_b64_tr_b16 v[218:219],v242 offset:14336
v_exp_f32 v235,v235
v_mul_f32 v160,v144,v160
s_waitcnt lgkmcnt(4)
v_mfma_f32_16x16x32_bf16 v[176:179],v[208:211],v[24:27],v[176:179]
ds_read_b64_tr_b16 v[220:221],v243 offset:12288
v_mul_f32 v161,v145,v161
v_mfma_f32_16x16x32_bf16 v[180:183],v[208:211],v[28:31],v[180:183]
ds_read_b64_tr_b16 v[222:223],v243 offset:14336
v_mul_f32 v162,v146,v162
s_waitcnt lgkmcnt(4)
v_mfma_f32_16x16x32_bf16 v[184:187],v[212:215],v[24:27],v[184:187]
ds_read_b64_tr_b16 v[208:209],v242 offset:16384
v_mul_f32 v163,v147,v163
s_add_u32 m0,s29,57344
s_add_u32 s35,s35,294912
buffer_load_dwordx4 v245,s[4:7],s35 offen lds
s_add_u32 m0,s29,61440
s_nop 0
buffer_load_dwordx4 v245,s[52:55],s35 offen lds
v_mfma_f32_16x16x32_bf16 v[188:191],v[212:215],v[28:31],v[188:191]
ds_read_b64_tr_b16 v[210:211],v242 offset:18432
v_fma_f32 v232,v232,v238,v238
s_waitcnt lgkmcnt(4)
v_mfma_f32_16x16x32_bf16 v[192:195],v[216:219],v[24:27],v[192:195]
ds_read_b64_tr_b16 v[212:213],v243 offset:16384
v_fma_f32 v233,v233,v238,v238
v_mfma_f32_16x16x32_bf16 v[196:199],v[216:219],v[28:31],v[196:199]
ds_read_b64_tr_b16 v[214:215],v243 offset:18432
v_fma_f32 v234,v234,v238,v238
s_waitcnt lgkmcnt(4)
v_mfma_f32_16x16x32_bf16 v[200:203],v[220:223],v[24:27],v[200:203]
ds_read_b64_tr_b16 v[216:217],v242 offset:20480
v_fma_f32 v235,v235,v238,v238
v_mfma_f32_16x16x32_bf16 v[204:207],v[220:223],v[28:31],v[204:207]
ds_read_b64_tr_b16 v[218:219],v242 offset:22528
v_rcp_f32 v232,v232
s_waitcnt vmcnt(6)
s_barrier
s_waitcnt lgkmcnt(4)
v_mfma_f32_16x16x32_bf16 v[176:179],v[208:211],v[32:35],v[176:179]
ds_read_b64_tr_b16 v[220:221],v243 offset:20480
v_rcp_f32 v233,v233
v_mfma_f32_16x16x32_bf16 v[180:183],v[208:211],v[36:39],v[180:183]
ds_read_b64_tr_b16 v[222:223],v243 offset:22528
v_rcp_f32 v234,v234
s_waitcnt lgkmcnt(4)
v_mfma_f32_16x16x32_bf16 v[184:187],v[212:215],v[32:35],v[184:187]
ds_read_b64_tr_b16 v[208:209],v242 offset:24576
v_rcp_f32 v235,v235
s_add_u32 m0,s29,0
s_add_u32 s35,s35,294912
buffer_load_dwordx4 v245,s[4:7],s35 offen lds
s_add_u32 m0,s29,4096
s_nop 0
buffer_load_dwordx4 v245,s[52:55],s35 offen lds
v_mfma_f32_16x16x32_bf16 v[188:191],v[212:215],v[36:39],v[188:191]
ds_read_b64_tr_b16 v[210:211],v242 offset:26624
v_mul_f32 v160,v160,v232
s_waitcnt lgkmcnt(4)
v_mfma_f32_16x16x32_bf16 v[192:195],v[216:219],v[32:35],v[192:195]
ds_read_b64_tr_b16 v[212:213],v243 offset:24576
v_mul_f32 v161,v161,v233
v_mfma_f32_16x16x32_bf16 v[196:199],v[216:219],v[36:39],v[196:199]
ds_read_b64_tr_b16 v[214:215],v243 offset:26624
v_mul_f32 v162,v162,v234
s_waitcnt lgkmcnt(4)
v_mfma_f32_16x16x32_bf16 v[200:203],v[220:223],v[32:35],v[200:203]
ds_read_b64_tr_b16 v[216:217],v242 offset:28672
v_mul_f32 v163,v163,v235
v_mfma_f32_16x16x32_bf16 v[204:207],v[220:223],v[36:39],v[204:207]
ds_read_b64_tr_b16 v[218:219],v242 offset:30720
v_cvt_pk_bf16_f32 v224,v160,v161
v_cvt_pk_bf16_f32 v225,v162,v163
s_waitcnt lgkmcnt(4)
v_mfma_f32_16x16x32_bf16 v[176:179],v[208:211],v[40:43],v[176:179]
ds_read_b64_tr_b16 v[220:221],v243 offset:28672
v_mul_f32 v232,v152,v152
v_mfma_f32_16x16x32_bf16 v[180:183],v[208:211],v[44:47],v[180:183]
ds_read_b64_tr_b16 v[222:223],v243 offset:30720
v_mul_f32 v233,v153,v153
s_waitcnt lgkmcnt(4)
v_mfma_f32_16x16x32_bf16 v[184:187],v[212:215],v[40:43],v[184:187]
ds_read_b64_tr_b16 v[208:209],v242 offset:32768
v_mul_f32 v234,v154,v154
s_add_u32 m0,s29,8192
s_add_u32 s35,s35,294912
buffer_load_dwordx4 v245,s[4:7],s35 offen lds
s_add_u32 m0,s29,12288
s_nop 0
buffer_load_dwordx4 v245,s[52:55],s35 offen lds
v_mfma_f32_16x16x32_bf16 v[188:191],v[212:215],v[44:47],v[188:191]
ds_read_b64_tr_b16 v[210:211],v242 offset:34816
v_mul_f32 v235,v155,v155
s_waitcnt lgkmcnt(4)
v_mfma_f32_16x16x32_bf16 v[192:195],v[216:219],v[40:43],v[192:195]
ds_read_b64_tr_b16 v[212:213],v243 offset:32768
v_fma_f32 v232,v232,v237,v236
v_mfma_f32_16x16x32_bf16 v[196:199],v[216:219],v[44:47],v[196:199]
ds_read_b64_tr_b16 v[214:215],v243 offset:34816
v_fma_f32 v233,v233,v237,v236
s_waitcnt lgkmcnt(4)
v_mfma_f32_16x16x32_bf16 v[200:203],v[220:223],v[40:43],v[200:203]
ds_read_b64_tr_b16 v[216:217],v242 offset:36864
v_fma_f32 v234,v234,v237,v236
v_mfma_f32_16x16x32_bf16 v[204:207],v[220:223],v[44:47],v[204:207]
ds_read_b64_tr_b16 v[218:219],v242 offset:38912
v_fma_f32 v235,v235,v237,v236
s_waitcnt vmcnt(6)
s_barrier
s_waitcnt lgkmcnt(4)
v_mfma_f32_16x16x32_bf16 v[176:179],v[208:211],v[48:51],v[176:179]
ds_read_b64_tr_b16 v[220:221],v243 offset:36864
v_mul_f32 v232,v152,v232
v_mfma_f32_16x16x32_bf16 v[180:183],v[208:211],v[52:55],v[180:183]
ds_read_b64_tr_b16 v[222:223],v243 offset:38912
v_mul_f32 v233,v153,v233
s_waitcnt lgkmcnt(4)
v_mfma_f32_16x16x32_bf16 v[184:187],v[212:215],v[48:51],v[184:187]
ds_read_b64_tr_b16 v[208:209],v242 offset:40960
v_mul_f32 v234,v154,v234
s_add_u32 m0,s29,16384
s_add_u32 s35,s35,294912
buffer_load_dwordx4 v245,s[4:7],s35 offen lds
s_add_u32 m0,s29,20480
s_nop 0
buffer_load_dwordx4 v245,s[52:55],s35 offen lds
v_mfma_f32_16x16x32_bf16 v[188:191],v[212:215],v[52:55],v[188:191]
ds_read_b64_tr_b16 v[210:211],v242 offset:43008
v_mul_f32 v235,v155,v235
s_waitcnt lgkmcnt(4)
v_mfma_f32_16x16x32_bf16 v[192:195],v[216:219],v[48:51],v[192:195]
ds_read_b64_tr_b16 v[212:213],v243 offset:40960
v_exp_f32 v232,v232
v_mfma_f32_16x16x32_bf16 v[196:199],v[216:219],v[52:55],v[196:199]
ds_read_b64_tr_b16 v[214:215],v243 offset:43008
v_exp_f32 v233,v233
s_waitcnt lgkmcnt(4)
v_mfma_f32_16x16x32_bf16 v[200:203],v[220:223],v[48:51],v[200:203]
ds_read_b64_tr_b16 v[216:217],v242 offset:45056
v_exp_f32 v234,v234
v_mfma_f32_16x16x32_bf16 v[204:207],v[220:223],v[52:55],v[204:207]
ds_read_b64_tr_b16 v[218:219],v242 offset:47104
v_exp_f32 v235,v235
v_mul_f32 v168,v152,v168
s_waitcnt lgkmcnt(4)
v_mfma_f32_16x16x32_bf16 v[176:179],v[208:211],v[56:59],v[176:179]
ds_read_b64_tr_b16 v[220:221],v243 offset:45056
v_mul_f32 v169,v153,v169
v_mfma_f32_16x16x32_bf16 v[180:183],v[208:211],v[60:63],v[180:183]
ds_read_b64_tr_b16 v[222:223],v243 offset:47104
v_mul_f32 v170,v154,v170
s_waitcnt lgkmcnt(4)
v_mfma_f32_16x16x32_bf16 v[184:187],v[212:215],v[56:59],v[184:187]
ds_read_b64_tr_b16 v[208:209],v242 offset:49152
v_mul_f32 v171,v155,v171
s_add_u32 m0,s29,24576
s_add_u32 s35,s35,294912
buffer_load_dwordx4 v245,s[4:7],s35 offen lds
s_add_u32 m0,s29,28672
s_nop 0
buffer_load_dwordx4 v245,s[52:55],s35 offen lds
v_mfma_f32_16x16x32_bf16 v[188:191],v[212:215],v[60:63],v[188:191]
ds_read_b64_tr_b16 v[210:211],v242 offset:51200
v_fma_f32 v232,v232,v238,v238
s_waitcnt lgkmcnt(4)
v_mfma_f32_16x16x32_bf16 v[192:195],v[216:219],v[56:59],v[192:195]
ds_read_b64_tr_b16 v[212:213],v243 offset:49152
v_fma_f32 v233,v233,v238,v238
v_mfma_f32_16x16x32_bf16 v[196:199],v[216:219],v[60:63],v[196:199]
ds_read_b64_tr_b16 v[214:215],v243 offset:51200
v_fma_f32 v234,v234,v238,v238
s_waitcnt lgkmcnt(4)
v_mfma_f32_16x16x32_bf16 v[200:203],v[220:223],v[56:59],v[200:203]
ds_read_b64_tr_b16 v[216:217],v242 offset:53248
v_fma_f32 v235,v235,v238,v238
v_mfma_f32_16x16x32_bf16 v[204:207],v[220:223],v[60:63],v[204:207]
ds_read_b64_tr_b16 v[218:219],v242 offset:55296
v_rcp_f32 v232,v232
s_waitcnt vmcnt(6)
s_barrier
s_waitcnt lgkmcnt(4)
v_mfma_f32_16x16x32_bf16 v[176:179],v[208:211],v[64:67],v[176:179]
ds_read_b64_tr_b16 v[220:221],v243 offset:53248
v_rcp_f32 v233,v233
v_mfma_f32_16x16x32_bf16 v[180:183],v[208:211],v[68:71],v[180:183]
ds_read_b64_tr_b16 v[222:223],v243 offset:55296
v_rcp_f32 v234,v234
s_waitcnt lgkmcnt(4)
v_mfma_f32_16x16x32_bf16 v[184:187],v[212:215],v[64:67],v[184:187]
ds_read_b64_tr_b16 v[208:209],v242 offset:57344
v_rcp_f32 v235,v235
s_add_u32 m0,s29,32768
s_add_u32 s35,s35,294912
buffer_load_dwordx4 v245,s[4:7],s35 offen lds
s_add_u32 m0,s29,36864
s_nop 0
buffer_load_dwordx4 v245,s[52:55],s35 offen lds
v_mfma_f32_16x16x32_bf16 v[188:191],v[212:215],v[68:71],v[188:191]
ds_read_b64_tr_b16 v[210:211],v242 offset:59392
v_mul_f32 v168,v168,v232
s_waitcnt lgkmcnt(4)
v_mfma_f32_16x16x32_bf16 v[192:195],v[216:219],v[64:67],v[192:195]
ds_read_b64_tr_b16 v[212:213],v243 offset:57344
v_mul_f32 v169,v169,v233
v_mfma_f32_16x16x32_bf16 v[196:199],v[216:219],v[68:71],v[196:199]
ds_read_b64_tr_b16 v[214:215],v243 offset:59392
v_mul_f32 v170,v170,v234
s_waitcnt lgkmcnt(4)
v_mfma_f32_16x16x32_bf16 v[200:203],v[220:223],v[64:67],v[200:203]
ds_read_b64_tr_b16 v[216:217],v242 offset:61440
v_mul_f32 v171,v171,v235
v_mfma_f32_16x16x32_bf16 v[204:207],v[220:223],v[68:71],v[204:207]
ds_read_b64_tr_b16 v[218:219],v242 offset:63488
v_cvt_pk_bf16_f32 v226,v168,v169
v_cvt_pk_bf16_f32 v227,v170,v171
s_waitcnt lgkmcnt(4)
v_mfma_f32_16x16x32_bf16 v[176:179],v[208:211],v[72:75],v[176:179]
ds_read_b64_tr_b16 v[220:221],v243 offset:61440
v_mul_f32 v232,v148,v148
v_mfma_f32_16x16x32_bf16 v[180:183],v[208:211],v[76:79],v[180:183]
ds_read_b64_tr_b16 v[222:223],v243 offset:63488
v_mul_f32 v233,v149,v149
s_waitcnt lgkmcnt(4)
v_mfma_f32_16x16x32_bf16 v[184:187],v[212:215],v[72:75],v[184:187]
ds_read_b64_tr_b16 v[208:209],v242 offset:0
v_mul_f32 v234,v150,v150
s_add_u32 m0,s29,40960
s_add_u32 s35,s35,294912
buffer_load_dwordx4 v245,s[4:7],s35 offen lds
s_add_u32 m0,s29,45056
s_nop 0
buffer_load_dwordx4 v245,s[52:55],s35 offen lds
v_mfma_f32_16x16x32_bf16 v[188:191],v[212:215],v[76:79],v[188:191]
ds_read_b64_tr_b16 v[210:211],v242 offset:2048
v_mul_f32 v235,v151,v151
s_waitcnt lgkmcnt(4)
v_mfma_f32_16x16x32_bf16 v[192:195],v[216:219],v[72:75],v[192:195]
ds_read_b64_tr_b16 v[212:213],v243 offset:0
v_fma_f32 v232,v232,v240,v239
v_mfma_f32_16x16x32_bf16 v[196:199],v[216:219],v[76:79],v[196:199]
ds_read_b64_tr_b16 v[214:215],v243 offset:2048
v_fma_f32 v233,v233,v240,v239
s_waitcnt lgkmcnt(4)
v_mfma_f32_16x16x32_bf16 v[200:203],v[220:223],v[72:75],v[200:203]
ds_read_b64_tr_b16 v[216:217],v242 offset:4096
v_fma_f32 v234,v234,v240,v239
v_mfma_f32_16x16x32_bf16 v[204:207],v[220:223],v[76:79],v[204:207]
ds_read_b64_tr_b16 v[218:219],v242 offset:6144
v_fma_f32 v235,v235,v240,v239
s_waitcnt vmcnt(6)
s_barrier
s_waitcnt lgkmcnt(4)
v_mfma_f32_16x16x32_bf16 v[176:179],v[208:211],v[80:83],v[176:179]
ds_read_b64_tr_b16 v[220:221],v243 offset:4096
v_mul_f32 v232,v148,v232
v_mfma_f32_16x16x32_bf16 v[180:183],v[208:211],v[84:87],v[180:183]
ds_read_b64_tr_b16 v[222:223],v243 offset:6144
v_mul_f32 v233,v149,v233
s_waitcnt lgkmcnt(4)
v_mfma_f32_16x16x32_bf16 v[184:187],v[212:215],v[80:83],v[184:187]
ds_read_b64_tr_b16 v[208:209],v242 offset:8192
v_mul_f32 v234,v150,v234
s_add_u32 m0,s29,49152
s_add_u32 s35,s35,294912
buffer_load_dwordx4 v245,s[4:7],s35 offen lds
s_add_u32 m0,s29,53248
s_nop 0
buffer_load_dwordx4 v245,s[52:55],s35 offen lds
v_mfma_f32_16x16x32_bf16 v[188:191],v[212:215],v[84:87],v[188:191]
ds_read_b64_tr_b16 v[210:211],v242 offset:10240
v_mul_f32 v235,v151,v235
s_waitcnt lgkmcnt(4)
v_mfma_f32_16x16x32_bf16 v[192:195],v[216:219],v[80:83],v[192:195]
ds_read_b64_tr_b16 v[212:213],v243 offset:8192
v_exp_f32 v232,v232
v_mfma_f32_16x16x32_bf16 v[196:199],v[216:219],v[84:87],v[196:199]
ds_read_b64_tr_b16 v[214:215],v243 offset:10240
v_exp_f32 v233,v233
s_waitcnt lgkmcnt(4)
v_mfma_f32_16x16x32_bf16 v[200:203],v[220:223],v[80:83],v[200:203]
ds_read_b64_tr_b16 v[216:217],v242 offset:12288
v_exp_f32 v234,v234
v_mfma_f32_16x16x32_bf16 v[204:207],v[220:223],v[84:87],v[204:207]
ds_read_b64_tr_b16 v[218:219],v242 offset:14336
v_exp_f32 v235,v235
v_mul_f32 v164,v148,v164
s_waitcnt lgkmcnt(4)
v_mfma_f32_16x16x32_bf16 v[176:179],v[208:211],v[88:91],v[176:179]
ds_read_b64_tr_b16 v[220:221],v243 offset:12288
v_mul_f32 v165,v149,v165
v_mfma_f32_16x16x32_bf16 v[180:183],v[208:211],v[92:95],v[180:183]
ds_read_b64_tr_b16 v[222:223],v243 offset:14336
v_mul_f32 v166,v150,v166
s_waitcnt lgkmcnt(4)
v_mfma_f32_16x16x32_bf16 v[184:187],v[212:215],v[88:91],v[184:187]
ds_read_b64_tr_b16 v[208:209],v242 offset:16384
v_mul_f32 v167,v151,v167
s_add_u32 m0,s29,57344
s_add_u32 s35,s35,294912
buffer_load_dwordx4 v245,s[4:7],s35 offen lds
s_add_u32 m0,s29,61440
s_nop 0
buffer_load_dwordx4 v245,s[52:55],s35 offen lds
v_mfma_f32_16x16x32_bf16 v[188:191],v[212:215],v[92:95],v[188:191]
ds_read_b64_tr_b16 v[210:211],v242 offset:18432
v_fma_f32 v232,v232,v241,v241
s_waitcnt lgkmcnt(4)
v_mfma_f32_16x16x32_bf16 v[192:195],v[216:219],v[88:91],v[192:195]
ds_read_b64_tr_b16 v[212:213],v243 offset:16384
v_fma_f32 v233,v233,v241,v241
v_mfma_f32_16x16x32_bf16 v[196:199],v[216:219],v[92:95],v[196:199]
ds_read_b64_tr_b16 v[214:215],v243 offset:18432
v_fma_f32 v234,v234,v241,v241
s_waitcnt lgkmcnt(4)
v_mfma_f32_16x16x32_bf16 v[200:203],v[220:223],v[88:91],v[200:203]
ds_read_b64_tr_b16 v[216:217],v242 offset:20480
v_fma_f32 v235,v235,v241,v241
v_mfma_f32_16x16x32_bf16 v[204:207],v[220:223],v[92:95],v[204:207]
ds_read_b64_tr_b16 v[218:219],v242 offset:22528
v_rcp_f32 v232,v232
s_waitcnt vmcnt(6)
s_barrier
s_waitcnt lgkmcnt(4)
v_mfma_f32_16x16x32_bf16 v[176:179],v[208:211],v[96:99],v[176:179]
ds_read_b64_tr_b16 v[220:221],v243 offset:20480
v_rcp_f32 v233,v233
v_mfma_f32_16x16x32_bf16 v[180:183],v[208:211],v[100:103],v[180:183]
ds_read_b64_tr_b16 v[222:223],v243 offset:22528
v_rcp_f32 v234,v234
s_waitcnt lgkmcnt(4)
v_mfma_f32_16x16x32_bf16 v[184:187],v[212:215],v[96:99],v[184:187]
ds_read_b64_tr_b16 v[208:209],v242 offset:24576
v_rcp_f32 v235,v235
s_add_u32 m0,s29,0
s_lshl_b32 s35,s34,1
buffer_load_dwordx4 v246,s[4:7],s35 offen lds
s_add_u32 m0,s29,4096
s_nop 0
buffer_load_dwordx4 v246,s[52:55],s35 offen lds
v_mfma_f32_16x16x32_bf16 v[188:191],v[212:215],v[100:103],v[188:191]
ds_read_b64_tr_b16 v[210:211],v242 offset:26624
v_mul_f32 v164,v164,v232
s_waitcnt lgkmcnt(4)
v_mfma_f32_16x16x32_bf16 v[192:195],v[216:219],v[96:99],v[192:195]
ds_read_b64_tr_b16 v[212:213],v243 offset:24576
v_mul_f32 v165,v165,v233
v_mfma_f32_16x16x32_bf16 v[196:199],v[216:219],v[100:103],v[196:199]
ds_read_b64_tr_b16 v[214:215],v243 offset:26624
v_mul_f32 v166,v166,v234
s_waitcnt lgkmcnt(4)
v_mfma_f32_16x16x32_bf16 v[200:203],v[220:223],v[96:99],v[200:203]
ds_read_b64_tr_b16 v[216:217],v242 offset:28672
v_mul_f32 v167,v167,v235
v_mfma_f32_16x16x32_bf16 v[204:207],v[220:223],v[100:103],v[204:207]
ds_read_b64_tr_b16 v[218:219],v242 offset:30720
v_cvt_pk_bf16_f32 v228,v164,v165
v_cvt_pk_bf16_f32 v229,v166,v167
s_waitcnt lgkmcnt(4)
v_mfma_f32_16x16x32_bf16 v[176:179],v[208:211],v[104:107],v[176:179]
ds_read_b64_tr_b16 v[220:221],v243 offset:28672
v_mul_f32 v232,v156,v156
v_mfma_f32_16x16x32_bf16 v[180:183],v[208:211],v[108:111],v[180:183]
ds_read_b64_tr_b16 v[222:223],v243 offset:30720
v_mul_f32 v233,v157,v157
s_waitcnt lgkmcnt(4)
v_mfma_f32_16x16x32_bf16 v[184:187],v[212:215],v[104:107],v[184:187]
ds_read_b64_tr_b16 v[208:209],v242 offset:32768
v_mul_f32 v234,v158,v158
s_add_u32 m0,s29,8192
s_add_u32 s35,s35,589824
buffer_load_dwordx4 v246,s[4:7],s35 offen lds
s_add_u32 m0,s29,12288
s_nop 0
buffer_load_dwordx4 v246,s[52:55],s35 offen lds
v_mfma_f32_16x16x32_bf16 v[188:191],v[212:215],v[108:111],v[188:191]
ds_read_b64_tr_b16 v[210:211],v242 offset:34816
v_mul_f32 v235,v159,v159
s_waitcnt lgkmcnt(4)
v_mfma_f32_16x16x32_bf16 v[192:195],v[216:219],v[104:107],v[192:195]
ds_read_b64_tr_b16 v[212:213],v243 offset:32768
v_fma_f32 v232,v232,v240,v239
v_mfma_f32_16x16x32_bf16 v[196:199],v[216:219],v[108:111],v[196:199]
ds_read_b64_tr_b16 v[214:215],v243 offset:34816
v_fma_f32 v233,v233,v240,v239
s_waitcnt lgkmcnt(4)
v_mfma_f32_16x16x32_bf16 v[200:203],v[220:223],v[104:107],v[200:203]
ds_read_b64_tr_b16 v[216:217],v242 offset:36864
v_fma_f32 v234,v234,v240,v239
v_mfma_f32_16x16x32_bf16 v[204:207],v[220:223],v[108:111],v[204:207]
ds_read_b64_tr_b16 v[218:219],v242 offset:38912
v_fma_f32 v235,v235,v240,v239
s_waitcnt vmcnt(6)
s_barrier
s_waitcnt lgkmcnt(4)
v_mfma_f32_16x16x32_bf16 v[176:179],v[208:211],v[112:115],v[176:179]
ds_read_b64_tr_b16 v[220:221],v243 offset:36864
v_mul_f32 v232,v156,v232
v_mfma_f32_16x16x32_bf16 v[180:183],v[208:211],v[116:119],v[180:183]
ds_read_b64_tr_b16 v[222:223],v243 offset:38912
v_mul_f32 v233,v157,v233
s_waitcnt lgkmcnt(4)
v_mfma_f32_16x16x32_bf16 v[184:187],v[212:215],v[112:115],v[184:187]
ds_read_b64_tr_b16 v[208:209],v242 offset:40960
v_mul_f32 v234,v158,v234
s_add_u32 m0,s29,16384
s_add_u32 s35,s35,589824
buffer_load_dwordx4 v246,s[4:7],s35 offen lds
s_add_u32 m0,s29,20480
s_nop 0
buffer_load_dwordx4 v246,s[52:55],s35 offen lds
v_mfma_f32_16x16x32_bf16 v[188:191],v[212:215],v[116:119],v[188:191]
ds_read_b64_tr_b16 v[210:211],v242 offset:43008
v_mul_f32 v235,v159,v235
s_waitcnt lgkmcnt(4)
v_mfma_f32_16x16x32_bf16 v[192:195],v[216:219],v[112:115],v[192:195]
ds_read_b64_tr_b16 v[212:213],v243 offset:40960
v_exp_f32 v232,v232
v_mfma_f32_16x16x32_bf16 v[196:199],v[216:219],v[116:119],v[196:199]
ds_read_b64_tr_b16 v[214:215],v243 offset:43008
v_exp_f32 v233,v233
s_waitcnt lgkmcnt(4)
v_mfma_f32_16x16x32_bf16 v[200:203],v[220:223],v[112:115],v[200:203]
ds_read_b64_tr_b16 v[216:217],v242 offset:45056
v_exp_f32 v234,v234
v_mfma_f32_16x16x32_bf16 v[204:207],v[220:223],v[116:119],v[204:207]
ds_read_b64_tr_b16 v[218:219],v242 offset:47104
v_exp_f32 v235,v235
v_mul_f32 v172,v156,v172
s_waitcnt lgkmcnt(4)
v_mfma_f32_16x16x32_bf16 v[176:179],v[208:211],v[120:123],v[176:179]
ds_read_b64_tr_b16 v[220:221],v243 offset:45056
v_mul_f32 v173,v157,v173
v_mfma_f32_16x16x32_bf16 v[180:183],v[208:211],v[124:127],v[180:183]
ds_read_b64_tr_b16 v[222:223],v243 offset:47104
v_mul_f32 v174,v158,v174
s_waitcnt lgkmcnt(4)
v_mfma_f32_16x16x32_bf16 v[184:187],v[212:215],v[120:123],v[184:187]
ds_read_b64_tr_b16 v[208:209],v242 offset:49152
v_mul_f32 v175,v159,v175
s_add_u32 m0,s29,24576
s_add_u32 s35,s35,589824
buffer_load_dwordx4 v246,s[4:7],s35 offen lds
s_add_u32 m0,s29,28672
s_nop 0
buffer_load_dwordx4 v246,s[52:55],s35 offen lds
v_mfma_f32_16x16x32_bf16 v[188:191],v[212:215],v[124:127],v[188:191]
ds_read_b64_tr_b16 v[210:211],v242 offset:51200
v_fma_f32 v232,v232,v241,v241
s_waitcnt lgkmcnt(4)
v_mfma_f32_16x16x32_bf16 v[192:195],v[216:219],v[120:123],v[192:195]
ds_read_b64_tr_b16 v[212:213],v243 offset:49152
v_fma_f32 v233,v233,v241,v241
v_mfma_f32_16x16x32_bf16 v[196:199],v[216:219],v[124:127],v[196:199]
ds_read_b64_tr_b16 v[214:215],v243 offset:51200
v_fma_f32 v234,v234,v241,v241
s_waitcnt lgkmcnt(4)
v_mfma_f32_16x16x32_bf16 v[200:203],v[220:223],v[120:123],v[200:203]
ds_read_b64_tr_b16 v[216:217],v242 offset:53248
v_fma_f32 v235,v235,v241,v241
v_mfma_f32_16x16x32_bf16 v[204:207],v[220:223],v[124:127],v[204:207]
ds_read_b64_tr_b16 v[218:219],v242 offset:55296
v_rcp_f32 v232,v232
s_waitcnt vmcnt(6)
s_barrier
s_waitcnt lgkmcnt(4)
v_mfma_f32_16x16x32_bf16 v[176:179],v[208:211],v[128:131],v[176:179]
ds_read_b64_tr_b16 v[220:221],v243 offset:53248
v_rcp_f32 v233,v233
v_mfma_f32_16x16x32_bf16 v[180:183],v[208:211],v[132:135],v[180:183]
ds_read_b64_tr_b16 v[222:223],v243 offset:55296
v_rcp_f32 v234,v234
s_waitcnt lgkmcnt(4)
v_mfma_f32_16x16x32_bf16 v[184:187],v[212:215],v[128:131],v[184:187]
ds_read_b64_tr_b16 v[208:209],v242 offset:57344
v_rcp_f32 v235,v235
s_add_u32 m0,s29,32768
s_add_u32 s35,s35,589824
buffer_load_dwordx4 v246,s[4:7],s35 offen lds
s_add_u32 m0,s29,36864
s_nop 0
buffer_load_dwordx4 v246,s[52:55],s35 offen lds
v_mfma_f32_16x16x32_bf16 v[188:191],v[212:215],v[132:135],v[188:191]
ds_read_b64_tr_b16 v[210:211],v242 offset:59392
v_mul_f32 v172,v172,v232
s_waitcnt lgkmcnt(4)
v_mfma_f32_16x16x32_bf16 v[192:195],v[216:219],v[128:131],v[192:195]
ds_read_b64_tr_b16 v[212:213],v243 offset:57344
v_mul_f32 v173,v173,v233
v_mfma_f32_16x16x32_bf16 v[196:199],v[216:219],v[132:135],v[196:199]
ds_read_b64_tr_b16 v[214:215],v243 offset:59392
v_mul_f32 v174,v174,v234
s_waitcnt lgkmcnt(4)
v_mfma_f32_16x16x32_bf16 v[200:203],v[220:223],v[128:131],v[200:203]
ds_read_b64_tr_b16 v[216:217],v242 offset:61440
v_mul_f32 v175,v175,v235
v_mfma_f32_16x16x32_bf16 v[204:207],v[220:223],v[132:135],v[204:207]
ds_read_b64_tr_b16 v[218:219],v242 offset:63488
v_cvt_pk_bf16_f32 v230,v172,v173
v_cvt_pk_bf16_f32 v231,v174,v175
s_waitcnt lgkmcnt(4)
v_mfma_f32_16x16x32_bf16 v[176:179],v[208:211],v[136:139],v[176:179]
ds_read_b64_tr_b16 v[220:221],v243 offset:61440
v_mfma_f32_16x16x32_bf16 v[180:183],v[208:211],v[140:143],v[180:183]
ds_read_b64_tr_b16 v[222:223],v243 offset:63488
ds_write_b128 v253,v[224:227] offset:8192
s_waitcnt lgkmcnt(5)
v_mfma_f32_16x16x32_bf16 v[184:187],v[212:215],v[136:139],v[184:187]
ds_read_b64_tr_b16 v[208:209],v244 offset:0
ds_write_b128 v253,v[228:231] offset:9216
s_add_u32 m0,s29,40960
s_add_u32 s35,s35,589824
buffer_load_dwordx4 v246,s[4:7],s35 offen lds
s_add_u32 m0,s29,45056
s_nop 0
buffer_load_dwordx4 v246,s[52:55],s35 offen lds
v_mfma_f32_16x16x32_bf16 v[188:191],v[212:215],v[140:143],v[188:191]
ds_read_b64_tr_b16 v[210:211],v244 offset:1024
s_lshl_b32 s40,s42,11
s_waitcnt lgkmcnt(6)
v_mfma_f32_16x16x32_bf16 v[192:195],v[216:219],v[136:139],v[192:195]
ds_read_b64_tr_b16 v[212:213],v244 offset:4096
s_add_u32 s40,s40,8192
v_mfma_f32_16x16x32_bf16 v[196:199],v[216:219],v[140:143],v[196:199]
ds_read_b64_tr_b16 v[214:215],v244 offset:5120
s_add_u32 s40,s40,s93
s_waitcnt lgkmcnt(6)
v_mfma_f32_16x16x32_bf16 v[200:203],v[220:223],v[136:139],v[200:203]
ds_read_b64_tr_b16 v[216:217],v244 offset:2048
buffer_store_dwordx4 v[224:227],v254,s[68:71],s40 offen offset:0 sc1
v_mfma_f32_16x16x32_bf16 v[204:207],v[220:223],v[140:143],v[204:207]
ds_read_b64_tr_b16 v[218:219],v244 offset:3072
buffer_store_dwordx4 v[228:231],v254,s[68:71],s40 offen offset:1024 sc1
s_waitcnt vmcnt(8) lgkmcnt(5)
s_barrier
s_waitcnt lgkmcnt(4)
v_mfma_f32_16x16x32_bf16 v[144:147],v[208:211],v[0:3],0
ds_read_b64_tr_b16 v[220:221],v244 offset:6144
v_mul_f32 v232,v176,v176
v_mul_f32 v233,v177,v177
v_mfma_f32_16x16x32_bf16 v[148:151],v[208:211],v[4:7],0
ds_read_b64_tr_b16 v[222:223],v244 offset:7168
v_mul_f32 v234,v178,v178
v_mul_f32 v235,v179,v179
s_waitcnt lgkmcnt(4)
v_mfma_f32_16x16x32_bf16 v[160:163],v[212:215],v[0:3],0
ds_read_b64_tr_b16 v[208:209],v244 offset:8192
v_fma_f32 v232,v232,v237,v236
v_fma_f32 v233,v233,v237,v236
s_add_u32 m0,s29,49152
s_add_u32 s35,s35,589824
buffer_load_dwordx4 v246,s[4:7],s35 offen lds
s_add_u32 m0,s29,53248
s_nop 0
buffer_load_dwordx4 v246,s[52:55],s35 offen lds
v_mfma_f32_16x16x32_bf16 v[164:167],v[212:215],v[4:7],0
ds_read_b64_tr_b16 v[210:211],v244 offset:9216
v_fma_f32 v234,v234,v237,v236
v_fma_f32 v235,v235,v237,v236
s_waitcnt lgkmcnt(4)
v_mfma_f32_16x16x32_bf16 v[144:147],v[216:219],v[8:11],v[144:147]
ds_read_b64_tr_b16 v[212:213],v244 offset:12288
v_mul_f32 v232,v176,v232
v_mul_f32 v233,v177,v233
v_mfma_f32_16x16x32_bf16 v[148:151],v[216:219],v[12:15],v[148:151]
ds_read_b64_tr_b16 v[214:215],v244 offset:13312
v_mul_f32 v234,v178,v234
v_mul_f32 v235,v179,v235
s_waitcnt lgkmcnt(4)
v_mfma_f32_16x16x32_bf16 v[160:163],v[220:223],v[8:11],v[160:163]
ds_read_b64_tr_b16 v[216:217],v244 offset:10240
v_exp_f32 v232,v232
v_exp_f32 v233,v233
v_mfma_f32_16x16x32_bf16 v[164:167],v[220:223],v[12:15],v[164:167]
ds_read_b64_tr_b16 v[218:219],v244 offset:11264
v_exp_f32 v234,v234
v_exp_f32 v235,v235
v_mul_f32 v192,v176,v192
s_waitcnt lgkmcnt(4)
v_mfma_f32_16x16x32_bf16 v[144:147],v[208:211],v[16:19],v[144:147]
ds_read_b64_tr_b16 v[220:221],v244 offset:14336
v_lshrrev_b32 v251,4,v255
s_lshl_b32 s44,s41,2
v_add_u32 v251,s44,v251
v_and_b32 v252,7,v251
v_mfma_f32_16x16x32_bf16 v[148:151],v[208:211],v[20:23],v[148:151]
ds_read_b64_tr_b16 v[222:223],v244 offset:15360
v_lshlrev_b32 v252,1,v252
v_and_b32 v245,15,v255
v_xor_b32 v245,v252,v245
v_mul_u32_u24 v251,1152,v251
v_lshl_add_u32 v245,v245,4,v251
s_waitcnt lgkmcnt(4)
v_mfma_f32_16x16x32_bf16 v[160:163],v[212:215],v[16:19],v[160:163]
ds_read_b64_tr_b16 v[208:209],v244 offset:16384
v_lshrrev_b32 v0,4,v255
v_bfe_u32 v1,v255,2,2
v_lshl_add_u32 v0,v0,2,v1
v_and_b32 v1,7,v0
s_lshl_b32 s40,s42,2
s_add_u32 m0,s29,57344
s_add_u32 s35,s35,589824
buffer_load_dwordx4 v246,s[4:7],s35 offen lds
s_add_u32 m0,s29,61440
s_nop 0
buffer_load_dwordx4 v246,s[52:55],s35 offen lds
v_mfma_f32_16x16x32_bf16 v[164:167],v[212:215],v[20:23],v[164:167]
ds_read_b64_tr_b16 v[210:211],v244 offset:17408
v_xor_b32 v1,s40,v1
v_lshlrev_b32 v0,8,v0
v_and_b32 v2,3,v255
v_lshl_add_u32 v0,v2,3,v0
v_lshl_add_u32 v242,v1,5,v0
s_waitcnt lgkmcnt(4)
v_mfma_f32_16x16x32_bf16 v[144:147],v[216:219],v[24:27],v[144:147]
ds_read_b64_tr_b16 v[212:213],v244 offset:20480
v_xor_b32 v243,32,v242
v_xor_b32 v248,64,v242
v_xor_b32 v249,96,v242
v_mul_f32 v193,v177,v193
v_mul_f32 v194,v178,v194
v_mfma_f32_16x16x32_bf16 v[148:151],v[216:219],v[28:31],v[148:151]
ds_read_b64_tr_b16 v[214:215],v244 offset:21504
v_mul_f32 v195,v179,v195
v_fma_f32 v232,v232,v238,v238
v_fma_f32 v233,v233,v238,v238
v_fma_f32 v234,v234,v238,v238
v_fma_f32 v235,v235,v238,v238
s_waitcnt lgkmcnt(4)
v_mfma_f32_16x16x32_bf16 v[160:163],v[220:223],v[24:27],v[160:163]
ds_read_b64_tr_b16 v[216:217],v244 offset:18432
v_rcp_f32 v232,v232
v_rcp_f32 v233,v233
v_rcp_f32 v234,v234
v_rcp_f32 v235,v235
v_mul_f32 v192,v192,v232
v_mfma_f32_16x16x32_bf16 v[164:167],v[220:223],v[28:31],v[164:167]
ds_read_b64_tr_b16 v[218:219],v244 offset:19456
v_mul_f32 v193,v193,v233
v_mul_f32 v194,v194,v234
v_mul_f32 v195,v195,v235
v_cvt_pk_bf16_f32 v224,v192,v193
v_cvt_pk_bf16_f32 v225,v194,v195
s_waitcnt vmcnt(8)
s_barrier
s_waitcnt lgkmcnt(4)
v_mfma_f32_16x16x32_bf16 v[144:147],v[208:211],v[32:35],v[144:147]
ds_read_b64_tr_b16 v[220:221],v244 offset:22528
ds_read_b128 v[0:3],v247 offset:0
ds_read_b128 v[4:7],v247 offset:1024
v_mul_f32 v232,v184,v184
v_mfma_f32_16x16x32_bf16 v[148:151],v[208:211],v[36:39],v[148:151]
ds_read_b64_tr_b16 v[222:223],v244 offset:23552
v_mul_f32 v233,v185,v185
v_mul_f32 v234,v186,v186
s_waitcnt lgkmcnt(6)
v_mfma_f32_16x16x32_bf16 v[160:163],v[212:215],v[32:35],v[160:163]
ds_read_b64_tr_b16 v[208:209],v244 offset:24576
v_mul_f32 v235,v187,v187
v_fma_f32 v232,v232,v237,v236
s_add_u32 m0,s29,0
s_add_u32 s35,s35,589824
buffer_load_dwordx4 v246,s[4:7],s35 offen lds
s_add_u32 m0,s29,4096
s_nop 0
buffer_load_dwordx4 v246,s[52:55],s35 offen lds
v_mfma_f32_16x16x32_bf16 v[164:167],v[212:215],v[36:39],v[164:167]
ds_read_b64_tr_b16 v[210:211],v244 offset:25600
v_fma_f32 v233,v233,v237,v236
v_fma_f32 v234,v234,v237,v236
v_fma_f32 v235,v235,v237,v236
s_waitcnt lgkmcnt(6)
v_mfma_f32_16x16x32_bf16 v[144:147],v[216:219],v[40:43],v[144:147]
ds_read_b64_tr_b16 v[212:213],v244 offset:28672
v_mul_f32 v232,v184,v232
v_mul_f32 v233,v185,v233
v_mfma_f32_16x16x32_bf16 v[148:151],v[216:219],v[44:47],v[148:151]
ds_read_b64_tr_b16 v[214:215],v244 offset:29696
v_mul_f32 v234,v186,v234
v_mul_f32 v235,v187,v235
s_waitcnt lgkmcnt(4)
v_mfma_f32_16x16x32_bf16 v[160:163],v[220:223],v[40:43],v[160:163]
ds_read_b64_tr_b16 v[216:217],v244 offset:26624
v_exp_f32 v232,v232
v_exp_f32 v233,v233
v_mfma_f32_16x16x32_bf16 v[164:167],v[220:223],v[44:47],v[164:167]
ds_read_b64_tr_b16 v[218:219],v244 offset:27648
v_exp_f32 v234,v234
v_exp_f32 v235,v235
v_mul_f32 v200,v184,v200
s_waitcnt lgkmcnt(4)
v_mfma_f32_16x16x32_bf16 v[144:147],v[208:211],v[48:51],v[144:147]
ds_read_b64_tr_b16 v[220:221],v244 offset:30720
ds_read_b128 v[8:11],v247 offset:2048
ds_read_b128 v[12:15],v247 offset:3072
v_mul_f32 v201,v185,v201
v_mfma_f32_16x16x32_bf16 v[148:151],v[208:211],v[52:55],v[148:151]
ds_read_b64_tr_b16 v[222:223],v244 offset:31744
v_mul_f32 v202,v186,v202
v_mul_f32 v203,v187,v203
s_waitcnt lgkmcnt(6)
v_mfma_f32_16x16x32_bf16 v[160:163],v[212:215],v[48:51],v[160:163]
ds_read_b64_tr_b16 v[208:209],v244 offset:32768
v_fma_f32 v232,v232,v238,v238
v_fma_f32 v233,v233,v238,v238
s_add_u32 m0,s29,8192
s_add_u32 s35,s46,s90
buffer_load_dwordx4 v245,s[8:11],s35 offen lds
s_add_u32 m0,s29,12288
s_add_u32 s45,s35,18432
buffer_load_dwordx4 v245,s[8:11],s45 offen lds
v_mfma_f32_16x16x32_bf16 v[164:167],v[212:215],v[52:55],v[164:167]
ds_read_b64_tr_b16 v[210:211],v244 offset:33792
v_fma_f32 v234,v234,v238,v238
v_fma_f32 v235,v235,v238,v238
v_rcp_f32 v232,v232
s_waitcnt lgkmcnt(6)
v_mfma_f32_16x16x32_bf16 v[144:147],v[216:219],v[56:59],v[144:147]
ds_read_b64_tr_b16 v[212:213],v244 offset:36864
v_rcp_f32 v233,v233
v_rcp_f32 v234,v234
v_mfma_f32_16x16x32_bf16 v[148:151],v[216:219],v[60:63],v[148:151]
ds_read_b64_tr_b16 v[214:215],v244 offset:37888
v_rcp_f32 v235,v235
v_mul_f32 v200,v200,v232
s_waitcnt lgkmcnt(4)
v_mfma_f32_16x16x32_bf16 v[160:163],v[220:223],v[56:59],v[160:163]
ds_read_b64_tr_b16 v[216:217],v244 offset:34816
v_mul_f32 v201,v201,v233
v_mul_f32 v202,v202,v234
v_mfma_f32_16x16x32_bf16 v[164:167],v[220:223],v[60:63],v[164:167]
ds_read_b64_tr_b16 v[218:219],v244 offset:35840
v_mul_f32 v203,v203,v235
v_cvt_pk_bf16_f32 v226,v200,v201
v_cvt_pk_bf16_f32 v227,v202,v203
s_waitcnt vmcnt(6)
s_barrier
s_lshl_b32 s40,s2,9
s_add_u32 s40,s40,0
v_mov_b32 v252,1
buffer_store_dword v252,off,s[64:67],s40 sc1
s_waitcnt lgkmcnt(4)
v_mfma_f32_16x16x32_bf16 v[144:147],v[208:211],v[64:67],v[144:147]
ds_read_b64_tr_b16 v[220:221],v244 offset:38912
ds_read_b128 v[16:19],v247 offset:4096
ds_read_b128 v[20:23],v247 offset:5120
v_mul_f32 v232,v180,v180
v_mfma_f32_16x16x32_bf16 v[148:151],v[208:211],v[68:71],v[148:151]
ds_read_b64_tr_b16 v[222:223],v244 offset:39936
v_mul_f32 v233,v181,v181
v_mul_f32 v234,v182,v182
s_waitcnt lgkmcnt(6)
v_mfma_f32_16x16x32_bf16 v[160:163],v[212:215],v[64:67],v[160:163]
ds_read_b64_tr_b16 v[208:209],v244 offset:40960
v_mul_f32 v235,v183,v183
v_fma_f32 v232,v232,v240,v239
s_add_u32 m0,s29,16384
s_add_u32 s35,s46,s90
s_add_u32 s35,s35,36864
buffer_load_dwordx4 v245,s[8:11],s35 offen lds
s_add_u32 m0,s29,20480
s_add_u32 s45,s35,18432
buffer_load_dwordx4 v245,s[8:11],s45 offen lds
v_mfma_f32_16x16x32_bf16 v[164:167],v[212:215],v[68:71],v[164:167]
ds_read_b64_tr_b16 v[210:211],v244 offset:41984
v_fma_f32 v233,v233,v240,v239
v_fma_f32 v234,v234,v240,v239
v_fma_f32 v235,v235,v240,v239
s_waitcnt lgkmcnt(6)
v_mfma_f32_16x16x32_bf16 v[144:147],v[216:219],v[72:75],v[144:147]
ds_read_b64_tr_b16 v[212:213],v244 offset:45056
v_mul_f32 v232,v180,v232
v_mul_f32 v233,v181,v233
v_mfma_f32_16x16x32_bf16 v[148:151],v[216:219],v[76:79],v[148:151]
ds_read_b64_tr_b16 v[214:215],v244 offset:46080
v_mul_f32 v234,v182,v234
v_mul_f32 v235,v183,v235
s_waitcnt lgkmcnt(4)
v_mfma_f32_16x16x32_bf16 v[160:163],v[220:223],v[72:75],v[160:163]
ds_read_b64_tr_b16 v[216:217],v244 offset:43008
v_exp_f32 v232,v232
v_exp_f32 v233,v233
v_mfma_f32_16x16x32_bf16 v[164:167],v[220:223],v[76:79],v[164:167]
ds_read_b64_tr_b16 v[218:219],v244 offset:44032
v_exp_f32 v234,v234
v_exp_f32 v235,v235
v_mul_f32 v196,v180,v196
s_waitcnt lgkmcnt(4)
v_mfma_f32_16x16x32_bf16 v[144:147],v[208:211],v[80:83],v[144:147]
ds_read_b64_tr_b16 v[220:221],v244 offset:47104
ds_read_b128 v[24:27],v247 offset:6144
ds_read_b128 v[28:31],v247 offset:7168
v_mul_f32 v197,v181,v197
v_mfma_f32_16x16x32_bf16 v[148:151],v[208:211],v[84:87],v[148:151]
ds_read_b64_tr_b16 v[222:223],v244 offset:48128
v_mul_f32 v198,v182,v198
v_mul_f32 v199,v183,v199
s_waitcnt lgkmcnt(6)
v_mfma_f32_16x16x32_bf16 v[160:163],v[212:215],v[80:83],v[160:163]
ds_read_b64_tr_b16 v[208:209],v244 offset:49152
v_fma_f32 v232,v232,v241,v241
v_fma_f32 v233,v233,v241,v241
s_add_u32 m0,s29,24576
s_add_u32 s35,s47,s90
buffer_load_dwordx4 v245,s[8:11],s35 offen lds
s_add_u32 m0,s29,28672
s_add_u32 s45,s35,18432
buffer_load_dwordx4 v245,s[8:11],s45 offen lds
v_mfma_f32_16x16x32_bf16 v[164:167],v[212:215],v[84:87],v[164:167]
ds_read_b64_tr_b16 v[210:211],v244 offset:50176
v_fma_f32 v234,v234,v241,v241
v_fma_f32 v235,v235,v241,v241
v_rcp_f32 v232,v232
s_waitcnt lgkmcnt(6)
v_mfma_f32_16x16x32_bf16 v[144:147],v[216:219],v[88:91],v[144:147]
ds_read_b64_tr_b16 v[212:213],v244 offset:53248
v_rcp_f32 v233,v233
v_rcp_f32 v234,v234
v_mfma_f32_16x16x32_bf16 v[148:151],v[216:219],v[92:95],v[148:151]
ds_read_b64_tr_b16 v[214:215],v244 offset:54272
v_rcp_f32 v235,v235
v_mul_f32 v196,v196,v232
s_waitcnt lgkmcnt(4)
v_mfma_f32_16x16x32_bf16 v[160:163],v[220:223],v[88:91],v[160:163]
ds_read_b64_tr_b16 v[216:217],v244 offset:51200
v_mul_f32 v197,v197,v233
v_mul_f32 v198,v198,v234
v_mfma_f32_16x16x32_bf16 v[164:167],v[220:223],v[92:95],v[164:167]
ds_read_b64_tr_b16 v[218:219],v244 offset:52224
v_mul_f32 v199,v199,v235
v_cvt_pk_bf16_f32 v228,v196,v197
v_cvt_pk_bf16_f32 v229,v198,v199
s_waitcnt vmcnt(7)
s_barrier
s_waitcnt lgkmcnt(4)
v_mfma_f32_16x16x32_bf16 v[144:147],v[208:211],v[96:99],v[144:147]
ds_read_b64_tr_b16 v[220:221],v244 offset:55296
ds_read_b128 v[32:35],v247 offset:8192
ds_read_b128 v[36:39],v247 offset:9216
v_mul_f32 v232,v188,v188
v_mfma_f32_16x16x32_bf16 v[148:151],v[208:211],v[100:103],v[148:151]
ds_read_b64_tr_b16 v[222:223],v244 offset:56320
v_mul_f32 v233,v189,v189
v_mul_f32 v234,v190,v190
s_waitcnt lgkmcnt(6)
v_mfma_f32_16x16x32_bf16 v[160:163],v[212:215],v[96:99],v[160:163]
ds_read_b64_tr_b16 v[208:209],v244 offset:57344
v_mul_f32 v235,v191,v191
v_fma_f32 v232,v232,v240,v239
s_add_u32 m0,s29,32768
s_add_u32 s35,s47,s90
s_add_u32 s35,s35,36864
buffer_load_dwordx4 v245,s[8:11],s35 offen lds
s_add_u32 m0,s29,36864
s_add_u32 s45,s35,18432
buffer_load_dwordx4 v245,s[8:11],s45 offen lds
v_mfma_f32_16x16x32_bf16 v[164:167],v[212:215],v[100:103],v[164:167]
ds_read_b64_tr_b16 v[210:211],v244 offset:58368
v_fma_f32 v233,v233,v240,v239
v_fma_f32 v234,v234,v240,v239
v_fma_f32 v235,v235,v240,v239
s_waitcnt lgkmcnt(6)
v_mfma_f32_16x16x32_bf16 v[144:147],v[216:219],v[104:107],v[144:147]
ds_read_b64_tr_b16 v[212:213],v244 offset:61440
v_mul_f32 v232,v188,v232
v_mul_f32 v233,v189,v233
v_mfma_f32_16x16x32_bf16 v[148:151],v[216:219],v[108:111],v[148:151]
ds_read_b64_tr_b16 v[214:215],v244 offset:62464
v_mul_f32 v234,v190,v234
v_mul_f32 v235,v191,v235
s_waitcnt lgkmcnt(4)
v_mfma_f32_16x16x32_bf16 v[160:163],v[220:223],v[104:107],v[160:163]
ds_read_b64_tr_b16 v[216:217],v244 offset:59392
v_exp_f32 v232,v232
v_exp_f32 v233,v233
v_mfma_f32_16x16x32_bf16 v[164:167],v[220:223],v[108:111],v[164:167]
ds_read_b64_tr_b16 v[218:219],v244 offset:60416
v_exp_f32 v234,v234
v_exp_f32 v235,v235
v_mul_f32 v204,v188,v204
s_waitcnt lgkmcnt(4)
v_mfma_f32_16x16x32_bf16 v[144:147],v[208:211],v[112:115],v[144:147]
ds_read_b64_tr_b16 v[220:221],v244 offset:63488
ds_read_b128 v[40:43],v247 offset:10240
ds_read_b128 v[44:47],v247 offset:11264
v_mul_f32 v205,v189,v205
v_mfma_f32_16x16x32_bf16 v[148:151],v[208:211],v[116:119],v[148:151]
ds_read_b64_tr_b16 v[222:223],v244 offset:64512
v_mul_f32 v206,v190,v206
v_mul_f32 v207,v191,v207
s_waitcnt lgkmcnt(6)
v_mfma_f32_16x16x32_bf16 v[160:163],v[212:215],v[112:115],v[160:163]
ds_read_b64_tr_b16 v[208:209],v244 offset:0
v_fma_f32 v232,v232,v241,v241
v_fma_f32 v233,v233,v241,v241
s_add_u32 m0,s29,40960
s_add_u32 s35,s48,s90
buffer_load_dwordx4 v245,s[8:11],s35 offen lds
s_add_u32 m0,s29,45056
s_add_u32 s45,s35,18432
buffer_load_dwordx4 v245,s[8:11],s45 offen lds
v_mfma_f32_16x16x32_bf16 v[164:167],v[212:215],v[116:119],v[164:167]
ds_read_b64_tr_b16 v[210:211],v244 offset:1024
v_fma_f32 v234,v234,v241,v241
v_fma_f32 v235,v235,v241,v241
v_rcp_f32 v232,v232
s_waitcnt lgkmcnt(6)
v_mfma_f32_16x16x32_bf16 v[144:147],v[216:219],v[120:123],v[144:147]
ds_read_b64_tr_b16 v[212:213],v244 offset:4096
v_rcp_f32 v233,v233
v_rcp_f32 v234,v234
v_mfma_f32_16x16x32_bf16 v[148:151],v[216:219],v[124:127],v[148:151]
ds_read_b64_tr_b16 v[214:215],v244 offset:5120
v_rcp_f32 v235,v235
v_mul_f32 v204,v204,v232
s_waitcnt lgkmcnt(4)
v_mfma_f32_16x16x32_bf16 v[160:163],v[220:223],v[120:123],v[160:163]
ds_read_b64_tr_b16 v[216:217],v244 offset:2048
v_mul_f32 v205,v205,v233
v_mul_f32 v206,v206,v234
v_mfma_f32_16x16x32_bf16 v[164:167],v[220:223],v[124:127],v[164:167]
ds_read_b64_tr_b16 v[218:219],v244 offset:3072
v_mul_f32 v207,v207,v235
v_cvt_pk_bf16_f32 v230,v204,v205
v_cvt_pk_bf16_f32 v231,v206,v207
s_waitcnt vmcnt(6)
s_barrier
s_waitcnt lgkmcnt(4)
v_mfma_f32_16x16x32_bf16 v[144:147],v[208:211],v[128:131],v[144:147]
ds_read_b64_tr_b16 v[220:221],v244 offset:6144
v_mfma_f32_16x16x32_bf16 v[148:151],v[208:211],v[132:135],v[148:151]
ds_read_b64_tr_b16 v[222:223],v244 offset:7168
ds_write_b128 v253,v[224:227] offset:12288
s_waitcnt lgkmcnt(5)
v_mfma_f32_16x16x32_bf16 v[160:163],v[212:215],v[128:131],v[160:163]
ds_read_b64_tr_b16 v[208:209],v242 offset:8192
ds_write_b128 v253,v[228:231] offset:13312
s_add_u32 m0,s29,49152
s_add_u32 s35,s48,s90
s_add_u32 s35,s35,36864
buffer_load_dwordx4 v245,s[8:11],s35 offen lds
s_add_u32 m0,s29,53248
s_add_u32 s45,s35,18432
buffer_load_dwordx4 v245,s[8:11],s45 offen lds
v_mfma_f32_16x16x32_bf16 v[164:167],v[212:215],v[132:135],v[164:167]
ds_read_b64_tr_b16 v[210:211],v242 offset:12288
s_lshl_b32 s40,s42,11
s_waitcnt lgkmcnt(6)
v_mfma_f32_16x16x32_bf16 v[144:147],v[216:219],v[136:139],v[144:147]
ds_read_b64_tr_b16 v[212:213],v243 offset:8192
s_add_u32 s40,s40,12288
v_mfma_f32_16x16x32_bf16 v[148:151],v[216:219],v[140:143],v[148:151]
ds_read_b64_tr_b16 v[214:215],v243 offset:12288
s_add_u32 s40,s40,s93
s_waitcnt lgkmcnt(6)
v_mfma_f32_16x16x32_bf16 v[160:163],v[220:223],v[136:139],v[160:163]
ds_read_b64_tr_b16 v[216:217],v248 offset:8192
buffer_store_dwordx4 v[224:227],v254,s[68:71],s40 offen offset:0 sc1
v_mfma_f32_16x16x32_bf16 v[164:167],v[220:223],v[140:143],v[164:167]
ds_read_b64_tr_b16 v[218:219],v248 offset:12288
buffer_store_dwordx4 v[228:231],v254,s[68:71],s40 offen offset:1024 sc1
s_waitcnt lgkmcnt(4)
v_mfma_f32_16x16x32_bf16 v[176:179],v[208:211],v[0:3],0
ds_read_b64_tr_b16 v[220:221],v249 offset:8192
v_mul_f32 v232,v144,v144
v_mfma_f32_16x16x32_bf16 v[180:183],v[208:211],v[4:7],0
ds_read_b64_tr_b16 v[222:223],v249 offset:12288
v_mul_f32 v233,v145,v145
v_mul_f32 v234,v146,v146
s_waitcnt lgkmcnt(4)
v_mfma_f32_16x16x32_bf16 v[184:187],v[212:215],v[0:3],0
ds_read_b64_tr_b16 v[208:209],v242 offset:16384
v_mul_f32 v235,v147,v147
s_add_u32 m0,s29,57344
s_add_u32 s35,s49,s90
buffer_load_dwordx4 v245,s[8:11],s35 offen lds
s_add_u32 m0,s29,61440
s_add_u32 s45,s35,18432
buffer_load_dwordx4 v245,s[8:11],s45 offen lds
v_mfma_f32_16x16x32_bf16 v[188:191],v[212:215],v[4:7],0
ds_read_b64_tr_b16 v[210:211],v242 offset:20480
v_fma_f32 v232,v232,v237,v236
v_fma_f32 v233,v233,v237,v236
s_waitcnt lgkmcnt(4)
v_mfma_f32_16x16x32_bf16 v[192:195],v[216:219],v[0:3],0
ds_read_b64_tr_b16 v[212:213],v243 offset:16384
v_fma_f32 v234,v234,v237,v236
v_fma_f32 v235,v235,v237,v236
v_mfma_f32_16x16x32_bf16 v[196:199],v[216:219],v[4:7],0
ds_read_b64_tr_b16 v[214:215],v243 offset:20480
v_mul_f32 v232,v144,v232
s_waitcnt lgkmcnt(4)
v_mfma_f32_16x16x32_bf16 v[200:203],v[220:223],v[0:3],0
ds_read_b64_tr_b16 v[216:217],v248 offset:16384
v_mul_f32 v233,v145,v233
v_mul_f32 v234,v146,v234
v_mfma_f32_16x16x32_bf16 v[204:207],v[220:223],v[4:7],0
ds_read_b64_tr_b16 v[218:219],v248 offset:20480
v_mul_f32 v235,v147,v235
v_exp_f32 v232,v232
s_waitcnt vmcnt(8)
s_barrier
s_waitcnt lgkmcnt(4)
v_mfma_f32_16x16x32_bf16 v[176:179],v[208:211],v[8:11],v[176:179]
ds_read_b64_tr_b16 v[220:221],v249 offset:16384
ds_read_b128 v[48:51],v247 offset:12288
ds_read_b128 v[52:55],v247 offset:13312
ds_read_b128 v[56:59],v247 offset:14336
ds_read_b128 v[60:63],v247 offset:15360
v_mfma_f32_16x16x32_bf16 v[180:183],v[208:211],v[12:15],v[180:183]
ds_read_b64_tr_b16 v[222:223],v249 offset:20480
v_exp_f32 v233,v233
v_exp_f32 v234,v234
s_waitcnt lgkmcnt(8)
v_mfma_f32_16x16x32_bf16 v[184:187],v[212:215],v[8:11],v[184:187]
ds_read_b64_tr_b16 v[208:209],v242 offset:24576
v_exp_f32 v235,v235
v_mul_f32 v160,v144,v160
s_add_u32 m0,s29,0
s_add_u32 s35,s49,s90
s_add_u32 s35,s35,36864
buffer_load_dwordx4 v245,s[8:11],s35 offen lds
s_add_u32 m0,s29,4096
s_add_u32 s45,s35,18432
buffer_load_dwordx4 v245,s[8:11],s45 offen lds
v_mfma_f32_16x16x32_bf16 v[188:191],v[212:215],v[12:15],v[188:191]
ds_read_b64_tr_b16 v[210:211],v242 offset:28672
v_mul_f32 v161,v145,v161
v_mul_f32 v162,v146,v162
s_waitcnt lgkmcnt(8)
v_mfma_f32_16x16x32_bf16 v[192:195],v[216:219],v[8:11],v[192:195]
ds_read_b64_tr_b16 v[212:213],v243 offset:24576
v_mul_f32 v163,v147,v163
v_fma_f32 v232,v232,v238,v238
v_mfma_f32_16x16x32_bf16 v[196:199],v[216:219],v[12:15],v[196:199]
ds_read_b64_tr_b16 v[214:215],v243 offset:28672
v_fma_f32 v233,v233,v238,v238
v_fma_f32 v234,v234,v238,v238
s_waitcnt lgkmcnt(4)
v_mfma_f32_16x16x32_bf16 v[200:203],v[220:223],v[8:11],v[200:203]
ds_read_b64_tr_b16 v[216:217],v248 offset:24576
v_fma_f32 v235,v235,v238,v238
v_rcp_f32 v232,v232
v_mfma_f32_16x16x32_bf16 v[204:207],v[220:223],v[12:15],v[204:207]
ds_read_b64_tr_b16 v[218:219],v248 offset:28672
v_rcp_f32 v233,v233
v_rcp_f32 v234,v234
s_waitcnt lgkmcnt(4)
v_mfma_f32_16x16x32_bf16 v[176:179],v[208:211],v[16:19],v[176:179]
ds_read_b64_tr_b16 v[220:221],v249 offset:24576
v_rcp_f32 v235,v235
v_mfma_f32_16x16x32_bf16 v[180:183],v[208:211],v[20:23],v[180:183]
ds_read_b64_tr_b16 v[222:223],v249 offset:28672
v_mul_f32 v160,v160,v232
v_mul_f32 v161,v161,v233
s_waitcnt lgkmcnt(4)
v_mfma_f32_16x16x32_bf16 v[184:187],v[212:215],v[16:19],v[184:187]
ds_read_b64_tr_b16 v[208:209],v242 offset:32768
v_mul_f32 v162,v162,v234
s_add_u32 m0,s29,8192
s_add_u32 s35,s88,s90
buffer_load_dwordx4 v245,s[8:11],s35 offen lds
s_add_u32 m0,s29,12288
s_add_u32 s45,s35,18432
buffer_load_dwordx4 v245,s[8:11],s45 offen lds
v_mfma_f32_16x16x32_bf16 v[188:191],v[212:215],v[20:23],v[188:191]
ds_read_b64_tr_b16 v[210:211],v242 offset:36864
v_mul_f32 v163,v163,v235
v_cvt_pk_bf16_f32 v224,v160,v161
s_waitcnt lgkmcnt(4)
v_mfma_f32_16x16x32_bf16 v[192:195],v[216:219],v[16:19],v[192:195]
ds_read_b64_tr_b16 v[212:213],v243 offset:32768
v_cvt_pk_bf16_f32 v225,v162,v163
v_mul_f32 v232,v148,v148
v_mfma_f32_16x16x32_bf16 v[196:199],v[216:219],v[20:23],v[196:199]
ds_read_b64_tr_b16 v[214:215],v243 offset:36864
v_mul_f32 v233,v149,v149
s_waitcnt lgkmcnt(4)
v_mfma_f32_16x16x32_bf16 v[200:203],v[220:223],v[16:19],v[200:203]
ds_read_b64_tr_b16 v[216:217],v248 offset:32768
v_mul_f32 v234,v150,v150
v_mul_f32 v235,v151,v151
v_mfma_f32_16x16x32_bf16 v[204:207],v[220:223],v[20:23],v[204:207]
ds_read_b64_tr_b16 v[218:219],v248 offset:36864
v_fma_f32 v232,v232,v240,v239
v_fma_f32 v233,v233,v240,v239
s_waitcnt vmcnt(8)
s_barrier
s_waitcnt lgkmcnt(4)
v_mfma_f32_16x16x32_bf16 v[176:179],v[208:211],v[24:27],v[176:179]
ds_read_b64_tr_b16 v[220:221],v249 offset:32768
v_fma_f32 v234,v234,v240,v239
v_mfma_f32_16x16x32_bf16 v[180:183],v[208:211],v[28:31],v[180:183]
ds_read_b64_tr_b16 v[222:223],v249 offset:36864
v_fma_f32 v235,v235,v240,v239
v_mul_f32 v232,v148,v232
s_waitcnt lgkmcnt(4)
v_mfma_f32_16x16x32_bf16 v[184:187],v[212:215],v[24:27],v[184:187]
ds_read_b64_tr_b16 v[208:209],v242 offset:40960
v_mul_f32 v233,v149,v233
v_mul_f32 v234,v150,v234
s_add_u32 m0,s29,16384
s_add_u32 s35,s46,s91
buffer_load_dwordx4 v245,s[8:11],s35 offen lds
s_add_u32 m0,s29,20480
s_add_u32 s45,s35,18432
buffer_load_dwordx4 v245,s[8:11],s45 offen lds
v_mfma_f32_16x16x32_bf16 v[188:191],v[212:215],v[28:31],v[188:191]
ds_read_b64_tr_b16 v[210:211],v242 offset:45056
v_mul_f32 v235,v151,v235
v_exp_f32 v232,v232
s_waitcnt lgkmcnt(4)
v_mfma_f32_16x16x32_bf16 v[192:195],v[216:219],v[24:27],v[192:195]
ds_read_b64_tr_b16 v[212:213],v243 offset:40960
v_exp_f32 v233,v233
v_mfma_f32_16x16x32_bf16 v[196:199],v[216:219],v[28:31],v[196:199]
ds_read_b64_tr_b16 v[214:215],v243 offset:45056
v_exp_f32 v234,v234
v_exp_f32 v235,v235
s_waitcnt lgkmcnt(4)
v_mfma_f32_16x16x32_bf16 v[200:203],v[220:223],v[24:27],v[200:203]
ds_read_b64_tr_b16 v[216:217],v248 offset:40960
v_mul_f32 v164,v148,v164
v_mul_f32 v165,v149,v165
v_mfma_f32_16x16x32_bf16 v[204:207],v[220:223],v[28:31],v[204:207]
ds_read_b64_tr_b16 v[218:219],v248 offset:45056
v_mul_f32 v166,v150,v166
v_mul_f32 v167,v151,v167
s_waitcnt lgkmcnt(4)
v_mfma_f32_16x16x32_bf16 v[176:179],v[208:211],v[32:35],v[176:179]
ds_read_b64_tr_b16 v[220:221],v249 offset:40960
v_fma_f32 v232,v232,v241,v241
v_mfma_f32_16x16x32_bf16 v[180:183],v[208:211],v[36:39],v[180:183]
ds_read_b64_tr_b16 v[222:223],v249 offset:45056
v_fma_f32 v233,v233,v241,v241
v_fma_f32 v234,v234,v241,v241
s_waitcnt lgkmcnt(4)
v_mfma_f32_16x16x32_bf16 v[184:187],v[212:215],v[32:35],v[184:187]
ds_read_b64_tr_b16 v[208:209],v242 offset:49152
v_fma_f32 v235,v235,v241,v241
v_rcp_f32 v232,v232
s_add_u32 m0,s29,24576
s_add_u32 s35,s46,s91
s_add_u32 s35,s35,36864
buffer_load_dwordx4 v245,s[8:11],s35 offen lds
s_add_u32 m0,s29,28672
s_add_u32 s45,s35,18432
buffer_load_dwordx4 v245,s[8:11],s45 offen lds
v_mfma_f32_16x16x32_bf16 v[188:191],v[212:215],v[36:39],v[188:191]
ds_read_b64_tr_b16 v[210:211],v242 offset:53248
v_rcp_f32 v233,v233
v_rcp_f32 v234,v234
s_waitcnt lgkmcnt(4)
v_mfma_f32_16x16x32_bf16 v[192:195],v[216:219],v[32:35],v[192:195]
ds_read_b64_tr_b16 v[212:213],v243 offset:49152
v_rcp_f32 v235,v235
v_mfma_f32_16x16x32_bf16 v[196:199],v[216:219],v[36:39],v[196:199]
ds_read_b64_tr_b16 v[214:215],v243 offset:53248
v_mul_f32 v164,v164,v232
v_mul_f32 v165,v165,v233
s_waitcnt lgkmcnt(4)
v_mfma_f32_16x16x32_bf16 v[200:203],v[220:223],v[32:35],v[200:203]
ds_read_b64_tr_b16 v[216:217],v248 offset:49152
v_mul_f32 v166,v166,v234
v_mul_f32 v167,v167,v235
v_mfma_f32_16x16x32_bf16 v[204:207],v[220:223],v[36:39],v[204:207]
ds_read_b64_tr_b16 v[218:219],v248 offset:53248
v_cvt_pk_bf16_f32 v228,v164,v165
v_cvt_pk_bf16_f32 v229,v166,v167
s_waitcnt vmcnt(6)
s_barrier
s_waitcnt lgkmcnt(4)
v_mfma_f32_16x16x32_bf16 v[176:179],v[208:211],v[40:43],v[176:179]
ds_read_b64_tr_b16 v[220:221],v249 offset:49152
v_mfma_f32_16x16x32_bf16 v[180:183],v[208:211],v[44:47],v[180:183]
ds_read_b64_tr_b16 v[222:223],v249 offset:53248
s_lshl_b32 s40,s42,3
s_waitcnt lgkmcnt(4)
v_mfma_f32_16x16x32_bf16 v[184:187],v[212:215],v[40:43],v[184:187]
ds_read_b64_tr_b16 v[208:209],v242 offset:57344
s_add_u32 m0,s29,32768
s_add_u32 s35,s47,s91
buffer_load_dwordx4 v245,s[8:11],s35 offen lds
s_add_u32 m0,s29,36864
s_add_u32 s45,s35,18432
buffer_load_dwordx4 v245,s[8:11],s45 offen lds
v_mfma_f32_16x16x32_bf16 v[188:191],v[212:215],v[44:47],v[188:191]
ds_read_b64_tr_b16 v[210:211],v242 offset:61440
v_add_u32 v232,s40,v247
s_waitcnt lgkmcnt(4)
v_mfma_f32_16x16x32_bf16 v[192:195],v[216:219],v[40:43],v[192:195]
ds_read_b64_tr_b16 v[212:213],v243 offset:57344
v_mfma_f32_16x16x32_bf16 v[196:199],v[216:219],v[44:47],v[196:199]
ds_read_b64_tr_b16 v[214:215],v243 offset:61440
ds_write_b64 v232,v[224:225] offset:16384
s_waitcnt lgkmcnt(5)
v_mfma_f32_16x16x32_bf16 v[200:203],v[220:223],v[40:43],v[200:203]
ds_read_b64_tr_b16 v[216:217],v248 offset:57344
v_mfma_f32_16x16x32_bf16 v[204:207],v[220:223],v[44:47],v[204:207]
ds_read_b64_tr_b16 v[218:219],v248 offset:61440
ds_write_b64 v232,v[228:229] offset:17408
s_waitcnt lgkmcnt(6)
v_mfma_f32_16x16x32_bf16 v[176:179],v[208:211],v[48:51],v[176:179]
ds_read_b64_tr_b16 v[220:221],v249 offset:57344
v_mfma_f32_16x16x32_bf16 v[180:183],v[208:211],v[52:55],v[180:183]
ds_read_b64_tr_b16 v[222:223],v249 offset:61440
s_waitcnt lgkmcnt(6)
v_mfma_f32_16x16x32_bf16 v[184:187],v[212:215],v[48:51],v[184:187]
ds_read_b64_tr_b16 v[208:209],v242 offset:0
s_add_u32 m0,s29,40960
s_add_u32 s35,s47,s91
s_add_u32 s35,s35,36864
buffer_load_dwordx4 v245,s[8:11],s35 offen lds
s_add_u32 m0,s29,45056
s_add_u32 s45,s35,18432
buffer_load_dwordx4 v245,s[8:11],s45 offen lds
v_mfma_f32_16x16x32_bf16 v[188:191],v[212:215],v[52:55],v[188:191]
ds_read_b64_tr_b16 v[210:211],v242 offset:4096
s_waitcnt lgkmcnt(5)
v_mfma_f32_16x16x32_bf16 v[192:195],v[216:219],v[48:51],v[192:195]
ds_read_b64_tr_b16 v[212:213],v243 offset:0
v_mfma_f32_16x16x32_bf16 v[196:199],v[216:219],v[52:55],v[196:199]
ds_read_b64_tr_b16 v[214:215],v243 offset:4096
s_waitcnt lgkmcnt(4)
v_mfma_f32_16x16x32_bf16 v[200:203],v[220:223],v[48:51],v[200:203]
ds_read_b64_tr_b16 v[216:217],v248 offset:0
v_mfma_f32_16x16x32_bf16 v[204:207],v[220:223],v[52:55],v[204:207]
ds_read_b64_tr_b16 v[218:219],v248 offset:4096
s_waitcnt vmcnt(6)
s_barrier
s_waitcnt lgkmcnt(4)
v_mfma_f32_16x16x32_bf16 v[176:179],v[208:211],v[56:59],v[176:179]
ds_read_b64_tr_b16 v[220:221],v249 offset:0
v_mfma_f32_16x16x32_bf16 v[180:183],v[208:211],v[60:63],v[180:183]
ds_read_b64_tr_b16 v[222:223],v249 offset:4096
s_waitcnt lgkmcnt(4)
v_mfma_f32_16x16x32_bf16 v[184:187],v[212:215],v[56:59],v[184:187]
ds_read_b64_tr_b16 v[208:209],v242 offset:8192
s_add_u32 m0,s29,49152
s_add_u32 s35,s48,s91
buffer_load_dwordx4 v245,s[8:11],s35 offen lds
s_add_u32 m0,s29,53248
s_add_u32 s45,s35,18432
buffer_load_dwordx4 v245,s[8:11],s45 offen lds
v_mfma_f32_16x16x32_bf16 v[188:191],v[212:215],v[60:63],v[188:191]
ds_read_b64_tr_b16 v[210:211],v242 offset:12288
s_waitcnt lgkmcnt(4)
v_mfma_f32_16x16x32_bf16 v[192:195],v[216:219],v[56:59],v[192:195]
ds_read_b64_tr_b16 v[212:213],v243 offset:8192
v_mfma_f32_16x16x32_bf16 v[196:199],v[216:219],v[60:63],v[196:199]
ds_read_b64_tr_b16 v[214:215],v243 offset:12288
s_waitcnt lgkmcnt(4)
v_mfma_f32_16x16x32_bf16 v[200:203],v[220:223],v[56:59],v[200:203]
ds_read_b64_tr_b16 v[216:217],v248 offset:8192
v_mfma_f32_16x16x32_bf16 v[204:207],v[220:223],v[60:63],v[204:207]
ds_read_b64_tr_b16 v[218:219],v248 offset:12288
ds_read_b128 v[64:67],v247 offset:16384
ds_read_b128 v[68:71],v247 offset:17408
s_waitcnt lgkmcnt(0)
v_mfma_f32_16x16x32_bf16 v[176:179],v[208:211],v[64:67],v[176:179]
ds_read_b64_tr_b16 v[220:221],v249 offset:8192
v_lshrrev_b32 v136,2,v255
v_mfma_f32_16x16x32_bf16 v[180:183],v[208:211],v[68:71],v[180:183]
ds_read_b64_tr_b16 v[222:223],v249 offset:12288
v_bfe_u32 v137,v255,4,1
v_mfma_f32_16x16x32_bf16 v[184:187],v[212:215],v[64:67],v[184:187]
ds_read_b64_tr_b16 v[208:209],v242 offset:16384
v_lshlrev_b32 v137,1,v137
s_add_u32 m0,s29,57344
s_add_u32 s35,s48,s91
s_add_u32 s35,s35,36864
buffer_load_dwordx4 v245,s[8:11],s35 offen lds
s_add_u32 m0,s29,61440
s_add_u32 s45,s35,18432
buffer_load_dwordx4 v245,s[8:11],s45 offen lds
v_mfma_f32_16x16x32_bf16 v[188:191],v[212:215],v[68:71],v[188:191]
ds_read_b64_tr_b16 v[210:211],v242 offset:20480
v_and_b32 v138,3,v255
v_mfma_f32_16x16x32_bf16 v[192:195],v[216:219],v[64:67],v[192:195]
ds_read_b64_tr_b16 v[212:213],v243 offset:16384
v_xor_b32 v138,v137,v138
v_mfma_f32_16x16x32_bf16 v[196:199],v[216:219],v[68:71],v[196:199]
ds_read_b64_tr_b16 v[214:215],v243 offset:20480
s_lshl_b32 s44,s41,4
s_waitcnt lgkmcnt(4)
v_mfma_f32_16x16x32_bf16 v[200:203],v[220:223],v[64:67],v[200:203]
ds_read_b64_tr_b16 v[216:217],v248 offset:16384
v_add_u32 v136,s44,v136
v_mfma_f32_16x16x32_bf16 v[204:207],v[220:223],v[68:71],v[204:207]
ds_read_b64_tr_b16 v[218:219],v248 offset:20480
v_mul_u32_u24 v136,1152,v136
v_lshl_add_u32 v246,v138,4,v136
s_waitcnt vmcnt(6)
s_barrier
s_waitcnt lgkmcnt(4)
v_mfma_f32_16x16x32_bf16 v[144:147],v[208:211],v[0:3],0
ds_read_b64_tr_b16 v[220:221],v249 offset:16384
v_mfma_f32_16x16x32_bf16 v[148:151],v[208:211],v[4:7],0
ds_read_b64_tr_b16 v[222:223],v249 offset:20480
s_waitcnt lgkmcnt(4)
v_mfma_f32_16x16x32_bf16 v[152:155],v[212:215],v[0:3],0
ds_read_b64_tr_b16 v[208:209],v242 offset:24576
s_add_u32 m0,s29,0
s_add_u32 s35,s49,s91
buffer_load_dwordx4 v245,s[8:11],s35 offen lds
s_add_u32 m0,s29,4096
s_add_u32 s45,s35,18432
buffer_load_dwordx4 v245,s[8:11],s45 offen lds
v_mfma_f32_16x16x32_bf16 v[156:159],v[212:215],v[4:7],0
ds_read_b64_tr_b16 v[210:211],v242 offset:28672
s_waitcnt lgkmcnt(4)
v_mfma_f32_16x16x32_bf16 v[160:163],v[216:219],v[0:3],0
ds_read_b64_tr_b16 v[212:213],v243 offset:24576
v_mfma_f32_16x16x32_bf16 v[164:167],v[216:219],v[4:7],0
ds_read_b64_tr_b16 v[214:215],v243 offset:28672
s_waitcnt lgkmcnt(4)
v_mfma_f32_16x16x32_bf16 v[168:171],v[220:223],v[0:3],0
ds_read_b64_tr_b16 v[216:217],v248 offset:24576
v_mfma_f32_16x16x32_bf16 v[172:175],v[220:223],v[4:7],0
ds_read_b64_tr_b16 v[218:219],v248 offset:28672
s_waitcnt lgkmcnt(4)
v_mfma_f32_16x16x32_bf16 v[144:147],v[208:211],v[8:11],v[144:147]
ds_read_b64_tr_b16 v[220:221],v249 offset:24576
v_mfma_f32_16x16x32_bf16 v[148:151],v[208:211],v[12:15],v[148:151]
ds_read_b64_tr_b16 v[222:223],v249 offset:28672
s_waitcnt lgkmcnt(4)
v_mfma_f32_16x16x32_bf16 v[152:155],v[212:215],v[8:11],v[152:155]
ds_read_b64_tr_b16 v[208:209],v242 offset:32768
s_add_u32 m0,s29,8192
s_add_u32 s35,s49,s91
s_add_u32 s35,s35,36864
buffer_load_dwordx4 v245,s[8:11],s35 offen lds
s_add_u32 m0,s29,12288
s_add_u32 s45,s35,18432
buffer_load_dwordx4 v245,s[8:11],s45 offen lds
v_mfma_f32_16x16x32_bf16 v[156:159],v[212:215],v[12:15],v[156:159]
ds_read_b64_tr_b16 v[210:211],v242 offset:36864
s_waitcnt lgkmcnt(4)
v_mfma_f32_16x16x32_bf16 v[160:163],v[216:219],v[8:11],v[160:163]
ds_read_b64_tr_b16 v[212:213],v243 offset:32768
v_mfma_f32_16x16x32_bf16 v[164:167],v[216:219],v[12:15],v[164:167]
ds_read_b64_tr_b16 v[214:215],v243 offset:36864
s_waitcnt lgkmcnt(4)
v_mfma_f32_16x16x32_bf16 v[168:171],v[220:223],v[8:11],v[168:171]
ds_read_b64_tr_b16 v[216:217],v248 offset:32768
v_mfma_f32_16x16x32_bf16 v[172:175],v[220:223],v[12:15],v[172:175]
ds_read_b64_tr_b16 v[218:219],v248 offset:36864
s_waitcnt vmcnt(6)
s_barrier
s_waitcnt lgkmcnt(4)
v_mfma_f32_16x16x32_bf16 v[144:147],v[208:211],v[16:19],v[144:147]
ds_read_b64_tr_b16 v[220:221],v249 offset:32768
v_mfma_f32_16x16x32_bf16 v[148:151],v[208:211],v[20:23],v[148:151]
ds_read_b64_tr_b16 v[222:223],v249 offset:36864
s_waitcnt lgkmcnt(4)
v_mfma_f32_16x16x32_bf16 v[152:155],v[212:215],v[16:19],v[152:155]
ds_read_b64_tr_b16 v[208:209],v242 offset:40960
s_add_u32 m0,s29,16384
s_add_u32 s35,s88,s91
buffer_load_dwordx4 v245,s[8:11],s35 offen lds
s_add_u32 m0,s29,20480
s_add_u32 s45,s35,18432
buffer_load_dwordx4 v245,s[8:11],s45 offen lds
v_mfma_f32_16x16x32_bf16 v[156:159],v[212:215],v[20:23],v[156:159]
ds_read_b64_tr_b16 v[210:211],v242 offset:45056
s_waitcnt lgkmcnt(4)
v_mfma_f32_16x16x32_bf16 v[160:163],v[216:219],v[16:19],v[160:163]
ds_read_b64_tr_b16 v[212:213],v243 offset:40960
v_mfma_f32_16x16x32_bf16 v[164:167],v[216:219],v[20:23],v[164:167]
ds_read_b64_tr_b16 v[214:215],v243 offset:45056
s_waitcnt lgkmcnt(4)
v_mfma_f32_16x16x32_bf16 v[168:171],v[220:223],v[16:19],v[168:171]
ds_read_b64_tr_b16 v[216:217],v248 offset:40960
v_mfma_f32_16x16x32_bf16 v[172:175],v[220:223],v[20:23],v[172:175]
ds_read_b64_tr_b16 v[218:219],v248 offset:45056
s_waitcnt lgkmcnt(4)
v_mfma_f32_16x16x32_bf16 v[144:147],v[208:211],v[24:27],v[144:147]
ds_read_b64_tr_b16 v[220:221],v249 offset:40960
v_mfma_f32_16x16x32_bf16 v[148:151],v[208:211],v[28:31],v[148:151]
ds_read_b64_tr_b16 v[222:223],v249 offset:45056
s_waitcnt lgkmcnt(4)
v_mfma_f32_16x16x32_bf16 v[152:155],v[212:215],v[24:27],v[152:155]
ds_read_b64_tr_b16 v[208:209],v242 offset:49152
s_add_u32 m0,s29,24576
s_add_u32 s35,s46,s92
buffer_load_dwordx4 v246,s[8:11],s35 offen lds
s_add_u32 m0,s29,28672
s_add_u32 s45,s47,s92
buffer_load_dwordx4 v246,s[8:11],s45 offen lds
v_mfma_f32_16x16x32_bf16 v[156:159],v[212:215],v[28:31],v[156:159]
ds_read_b64_tr_b16 v[210:211],v242 offset:53248
s_waitcnt lgkmcnt(4)
v_mfma_f32_16x16x32_bf16 v[160:163],v[216:219],v[24:27],v[160:163]
ds_read_b64_tr_b16 v[212:213],v243 offset:49152
v_mfma_f32_16x16x32_bf16 v[164:167],v[216:219],v[28:31],v[164:167]
ds_read_b64_tr_b16 v[214:215],v243 offset:53248
s_waitcnt lgkmcnt(4)
v_mfma_f32_16x16x32_bf16 v[168:171],v[220:223],v[24:27],v[168:171]
ds_read_b64_tr_b16 v[216:217],v248 offset:49152
v_mfma_f32_16x16x32_bf16 v[172:175],v[220:223],v[28:31],v[172:175]
ds_read_b64_tr_b16 v[218:219],v248 offset:53248
s_waitcnt vmcnt(6)
s_barrier
s_lshl_b32 s40,s2,9
s_add_u32 s40,s40,128
v_mov_b32 v253,1
buffer_store_dword v253,off,s[64:67],s40 sc1
s_waitcnt lgkmcnt(4)
v_mfma_f32_16x16x32_bf16 v[144:147],v[208:211],v[32:35],v[144:147]
ds_read_b64_tr_b16 v[220:221],v249 offset:49152
v_mfma_f32_16x16x32_bf16 v[148:151],v[208:211],v[36:39],v[148:151]
ds_read_b64_tr_b16 v[222:223],v249 offset:53248
s_waitcnt lgkmcnt(4)
v_mfma_f32_16x16x32_bf16 v[152:155],v[212:215],v[32:35],v[152:155]
ds_read_b64_tr_b16 v[208:209],v242 offset:57344
s_add_u32 m0,s29,32768
s_add_u32 s35,s48,s92
buffer_load_dwordx4 v246,s[8:11],s35 offen lds
s_add_u32 m0,s29,36864
s_add_u32 s45,s49,s92
buffer_load_dwordx4 v246,s[8:11],s45 offen lds
v_mfma_f32_16x16x32_bf16 v[156:159],v[212:215],v[36:39],v[156:159]
ds_read_b64_tr_b16 v[210:211],v242 offset:61440
s_waitcnt lgkmcnt(4)
v_mfma_f32_16x16x32_bf16 v[160:163],v[216:219],v[32:35],v[160:163]
ds_read_b64_tr_b16 v[212:213],v243 offset:57344
v_mfma_f32_16x16x32_bf16 v[164:167],v[216:219],v[36:39],v[164:167]
ds_read_b64_tr_b16 v[214:215],v243 offset:61440
s_waitcnt lgkmcnt(4)
v_mfma_f32_16x16x32_bf16 v[168:171],v[220:223],v[32:35],v[168:171]
ds_read_b64_tr_b16 v[216:217],v248 offset:57344
v_mfma_f32_16x16x32_bf16 v[172:175],v[220:223],v[36:39],v[172:175]
ds_read_b64_tr_b16 v[218:219],v248 offset:61440
s_waitcnt lgkmcnt(4)
v_mfma_f32_16x16x32_bf16 v[144:147],v[208:211],v[40:43],v[144:147]
ds_read_b64_tr_b16 v[220:221],v249 offset:57344
v_mfma_f32_16x16x32_bf16 v[148:151],v[208:211],v[44:47],v[148:151]
ds_read_b64_tr_b16 v[222:223],v249 offset:61440
s_waitcnt lgkmcnt(4)
v_mfma_f32_16x16x32_bf16 v[152:155],v[212:215],v[40:43],v[152:155]
ds_read_b64_tr_b16 v[208:209],v242 offset:0
s_add_u32 m0,s29,40960
s_add_u32 s35,s88,s92
buffer_load_dwordx4 v246,s[8:11],s35 offen lds
v_mfma_f32_16x16x32_bf16 v[156:159],v[212:215],v[44:47],v[156:159]
ds_read_b64_tr_b16 v[210:211],v242 offset:4096
s_waitcnt lgkmcnt(4)
v_mfma_f32_16x16x32_bf16 v[160:163],v[216:219],v[40:43],v[160:163]
ds_read_b64_tr_b16 v[212:213],v243 offset:0
v_mfma_f32_16x16x32_bf16 v[164:167],v[216:219],v[44:47],v[164:167]
ds_read_b64_tr_b16 v[214:215],v243 offset:4096
s_waitcnt lgkmcnt(4)
v_mfma_f32_16x16x32_bf16 v[168:171],v[220:223],v[40:43],v[168:171]
ds_read_b64_tr_b16 v[216:217],v248 offset:0
v_mfma_f32_16x16x32_bf16 v[172:175],v[220:223],v[44:47],v[172:175]
ds_read_b64_tr_b16 v[218:219],v248 offset:4096
s_waitcnt vmcnt(6)
s_barrier
s_waitcnt lgkmcnt(4)
v_mfma_f32_16x16x32_bf16 v[144:147],v[208:211],v[48:51],v[144:147]
ds_read_b64_tr_b16 v[220:221],v249 offset:0
v_mfma_f32_16x16x32_bf16 v[148:151],v[208:211],v[52:55],v[148:151]
ds_read_b64_tr_b16 v[222:223],v249 offset:4096
s_waitcnt lgkmcnt(4)
v_mfma_f32_16x16x32_bf16 v[152:155],v[212:215],v[48:51],v[152:155]
ds_read_b64_tr_b16 v[208:209],v242 offset:8192
s_add_u32 m0,s29,49152
s_add_u32 s35,s84,s90
buffer_load_dwordx4 v245,s[8:11],s35 offen lds
s_add_u32 m0,s29,53248
s_add_u32 s45,s35,18432
buffer_load_dwordx4 v245,s[8:11],s45 offen lds
v_mfma_f32_16x16x32_bf16 v[156:159],v[212:215],v[52:55],v[156:159]
ds_read_b64_tr_b16 v[210:211],v242 offset:12288
s_waitcnt lgkmcnt(4)
v_mfma_f32_16x16x32_bf16 v[160:163],v[216:219],v[48:51],v[160:163]
ds_read_b64_tr_b16 v[212:213],v243 offset:8192
v_mfma_f32_16x16x32_bf16 v[164:167],v[216:219],v[52:55],v[164:167]
ds_read_b64_tr_b16 v[214:215],v243 offset:12288
s_waitcnt lgkmcnt(4)
v_mfma_f32_16x16x32_bf16 v[168:171],v[220:223],v[48:51],v[168:171]
ds_read_b64_tr_b16 v[216:217],v248 offset:8192
v_mfma_f32_16x16x32_bf16 v[172:175],v[220:223],v[52:55],v[172:175]
ds_read_b64_tr_b16 v[218:219],v248 offset:12288
s_waitcnt lgkmcnt(4)
v_mfma_f32_16x16x32_bf16 v[144:147],v[208:211],v[56:59],v[144:147]
ds_read_b64_tr_b16 v[220:221],v249 offset:8192
v_mfma_f32_16x16x32_bf16 v[148:151],v[208:211],v[60:63],v[148:151]
ds_read_b64_tr_b16 v[222:223],v249 offset:12288
s_waitcnt lgkmcnt(4)
v_mfma_f32_16x16x32_bf16 v[152:155],v[212:215],v[56:59],v[152:155]
ds_read_b64_tr_b16 v[208:209],v242 offset:16384
s_add_u32 m0,s29,57344
s_add_u32 s35,s84,s90
s_add_u32 s35,s35,36864
buffer_load_dwordx4 v245,s[8:11],s35 offen lds
s_add_u32 m0,s29,61440
s_add_u32 s45,s35,18432
buffer_load_dwordx4 v245,s[8:11],s45 offen lds
v_mfma_f32_16x16x32_bf16 v[156:159],v[212:215],v[60:63],v[156:159]
ds_read_b64_tr_b16 v[210:211],v242 offset:20480
s_waitcnt lgkmcnt(4)
v_mfma_f32_16x16x32_bf16 v[160:163],v[216:219],v[56:59],v[160:163]
ds_read_b64_tr_b16 v[212:213],v243 offset:16384
v_mfma_f32_16x16x32_bf16 v[164:167],v[216:219],v[60:63],v[164:167]
ds_read_b64_tr_b16 v[214:215],v243 offset:20480
s_waitcnt lgkmcnt(4)
v_mfma_f32_16x16x32_bf16 v[168:171],v[220:223],v[56:59],v[168:171]
ds_read_b64_tr_b16 v[216:217],v248 offset:16384
v_mfma_f32_16x16x32_bf16 v[172:175],v[220:223],v[60:63],v[172:175]
ds_read_b64_tr_b16 v[218:219],v248 offset:20480
s_waitcnt vmcnt(5)
s_barrier
s_waitcnt lgkmcnt(4)
v_mfma_f32_16x16x32_bf16 v[144:147],v[208:211],v[64:67],v[144:147]
ds_read_b64_tr_b16 v[220:221],v249 offset:16384
v_mfma_f32_16x16x32_bf16 v[148:151],v[208:211],v[68:71],v[148:151]
ds_read_b64_tr_b16 v[222:223],v249 offset:20480
s_waitcnt lgkmcnt(4)
v_mfma_f32_16x16x32_bf16 v[152:155],v[212:215],v[64:67],v[152:155]
ds_read_b64_tr_b16 v[208:209],v244 offset:24576
s_add_u32 m0,s29,0
s_add_u32 s35,s85,s90
buffer_load_dwordx4 v245,s[8:11],s35 offen lds
s_add_u32 m0,s29,4096
s_add_u32 s45,s35,18432
buffer_load_dwordx4 v245,s[8:11],s45 offen lds
v_mfma_f32_16x16x32_bf16 v[156:159],v[212:215],v[68:71],v[156:159]
ds_read_b64_tr_b16 v[210:211],v244 offset:25600
s_waitcnt lgkmcnt(4)
v_mfma_f32_16x16x32_bf16 v[160:163],v[216:219],v[64:67],v[160:163]
ds_read_b64_tr_b16 v[212:213],v244 offset:26624
v_mfma_f32_16x16x32_bf16 v[164:167],v[216:219],v[68:71],v[164:167]
ds_read_b64_tr_b16 v[214:215],v244 offset:27648
s_waitcnt lgkmcnt(4)
v_mfma_f32_16x16x32_bf16 v[168:171],v[220:223],v[64:67],v[168:171]
ds_read_b64_tr_b16 v[216:217],v244 offset:28672
v_mfma_f32_16x16x32_bf16 v[172:175],v[220:223],v[68:71],v[172:175]
ds_read_b64_tr_b16 v[218:219],v244 offset:29696
s_waitcnt lgkmcnt(4)
v_mfma_f32_16x16x32_bf16 v[232:235],v[208:211],v[0:3],0
ds_read_b64_tr_b16 v[220:221],v244 offset:30720
v_mfma_f32_16x16x32_bf16 v[236:239],v[208:211],v[4:7],0
ds_read_b64_tr_b16 v[222:223],v244 offset:31744
s_waitcnt lgkmcnt(4)
v_mfma_f32_16x16x32_bf16 v[232:235],v[212:215],v[8:11],v[232:235]
ds_read_b64_tr_b16 v[208:209],v244 offset:32768
s_add_u32 m0,s29,8192
s_add_u32 s35,s85,s90
s_add_u32 s35,s35,36864
buffer_load_dwordx4 v245,s[8:11],s35 offen lds
s_add_u32 m0,s29,12288
s_add_u32 s45,s35,18432
buffer_load_dwordx4 v245,s[8:11],s45 offen lds
v_mfma_f32_16x16x32_bf16 v[236:239],v[212:215],v[12:15],v[236:239]
ds_read_b64_tr_b16 v[210:211],v244 offset:33792
s_waitcnt lgkmcnt(4)
v_mfma_f32_16x16x32_bf16 v[232:235],v[216:219],v[16:19],v[232:235]
ds_read_b64_tr_b16 v[212:213],v244 offset:34816
v_mfma_f32_16x16x32_bf16 v[236:239],v[216:219],v[20:23],v[236:239]
ds_read_b64_tr_b16 v[214:215],v244 offset:35840
s_waitcnt lgkmcnt(4)
v_mfma_f32_16x16x32_bf16 v[232:235],v[220:223],v[24:27],v[232:235]
ds_read_b64_tr_b16 v[216:217],v244 offset:36864
v_mfma_f32_16x16x32_bf16 v[236:239],v[220:223],v[28:31],v[236:239]
ds_read_b64_tr_b16 v[218:219],v244 offset:37888
s_waitcnt vmcnt(6)
s_barrier
s_waitcnt lgkmcnt(4)
v_mfma_f32_16x16x32_bf16 v[232:235],v[208:211],v[32:35],v[232:235]
ds_read_b64_tr_b16 v[220:221],v244 offset:38912
v_mfma_f32_16x16x32_bf16 v[236:239],v[208:211],v[36:39],v[236:239]
ds_read_b64_tr_b16 v[222:223],v244 offset:39936
s_waitcnt lgkmcnt(4)
v_mfma_f32_16x16x32_bf16 v[232:235],v[212:215],v[40:43],v[232:235]
ds_read_b64_tr_b16 v[208:209],v244 offset:40960
ds_read_b128 v[72:75],v247 offset:0
ds_read_b128 v[76:79],v247 offset:1024
s_add_u32 m0,s29,16384
s_add_u32 s35,s86,s90
buffer_load_dwordx4 v245,s[8:11],s35 offen lds
s_add_u32 m0,s29,20480
s_add_u32 s45,s35,18432
buffer_load_dwordx4 v245,s[8:11],s45 offen lds
v_mfma_f32_16x16x32_bf16 v[236:239],v[212:215],v[44:47],v[236:239]
ds_read_b64_tr_b16 v[210:211],v244 offset:41984
s_waitcnt lgkmcnt(6)
v_mfma_f32_16x16x32_bf16 v[232:235],v[216:219],v[48:51],v[232:235]
ds_read_b64_tr_b16 v[212:213],v242 offset:49152
v_mfma_f32_16x16x32_bf16 v[236:239],v[216:219],v[52:55],v[236:239]
ds_read_b64_tr_b16 v[214:215],v242 offset:53248
ds_read_b128 v[80:83],v247 offset:2048
ds_read_b128 v[84:87],v247 offset:3072
s_waitcnt lgkmcnt(8)
v_mfma_f32_16x16x32_bf16 v[232:235],v[220:223],v[56:59],v[232:235]
ds_read_b64_tr_b16 v[216:217],v243 offset:49152
v_mfma_f32_16x16x32_bf16 v[236:239],v[220:223],v[60:63],v[236:239]
ds_read_b64_tr_b16 v[218:219],v243 offset:53248
ds_read_b128 v[88:91],v247 offset:4096
ds_read_b128 v[92:95],v247 offset:5120
s_waitcnt lgkmcnt(8)
v_mfma_f32_16x16x32_bf16 v[232:235],v[208:211],v[64:67],v[232:235]
ds_read_b64_tr_b16 v[220:221],v248 offset:49152
ds_read_b128 v[96:99],v247 offset:6144
ds_read_b128 v[100:103],v247 offset:7168
v_mfma_f32_16x16x32_bf16 v[236:239],v[208:211],v[68:71],v[236:239]
ds_read_b64_tr_b16 v[222:223],v248 offset:53248
ds_read_b128 v[104:107],v247 offset:8192
ds_read_b128 v[108:111],v247 offset:9216
ds_read_b128 v[112:115],v247 offset:10240
ds_read_b128 v[116:119],v247 offset:11264
s_add_u32 m0,s29,24576
s_add_u32 s35,s86,s90
s_add_u32 s35,s35,36864
buffer_load_dwordx4 v245,s[8:11],s35 offen lds
s_add_u32 m0,s29,28672
s_add_u32 s45,s35,18432
buffer_load_dwordx4 v245,s[8:11],s45 offen lds
s_waitcnt vmcnt(6)
s_barrier
s_waitcnt lgkmcnt(14)
v_mfma_f32_16x16x32_bf16 v[176:179],v[212:215],v[72:75],v[176:179]
ds_read_b64_tr_b16 v[208:209],v249 offset:49152
v_mfma_f32_16x16x32_bf16 v[180:183],v[212:215],v[76:79],v[180:183]
ds_read_b64_tr_b16 v[210:211],v249 offset:53248
s_waitcnt lgkmcnt(12)
v_mfma_f32_16x16x32_bf16 v[184:187],v[216:219],v[72:75],v[184:187]
ds_read_b64_tr_b16 v[212:213],v242 offset:57344
s_add_u32 m0,s29,32768
s_add_u32 s35,s84,s91
buffer_load_dwordx4 v245,s[8:11],s35 offen lds
s_add_u32 m0,s29,36864
s_add_u32 s45,s35,18432
buffer_load_dwordx4 v245,s[8:11],s45 offen lds
v_mfma_f32_16x16x32_bf16 v[188:191],v[216:219],v[76:79],v[188:191]
ds_read_b64_tr_b16 v[214:215],v242 offset:61440
s_waitcnt lgkmcnt(8)
v_mfma_f32_16x16x32_bf16 v[192:195],v[220:223],v[72:75],v[192:195]
ds_read_b64_tr_b16 v[216:217],v243 offset:57344
v_mfma_f32_16x16x32_bf16 v[196:199],v[220:223],v[76:79],v[196:199]
ds_read_b64_tr_b16 v[218:219],v243 offset:61440
s_waitcnt lgkmcnt(4)
v_mfma_f32_16x16x32_bf16 v[200:203],v[208:211],v[72:75],v[200:203]
ds_read_b64_tr_b16 v[220:221],v248 offset:57344
v_mfma_f32_16x16x32_bf16 v[204:207],v[208:211],v[76:79],v[204:207]
ds_read_b64_tr_b16 v[222:223],v248 offset:61440
s_waitcnt lgkmcnt(4)
v_mfma_f32_16x16x32_bf16 v[176:179],v[212:215],v[80:83],v[176:179]
ds_read_b64_tr_b16 v[208:209],v249 offset:57344
v_mfma_f32_16x16x32_bf16 v[180:183],v[212:215],v[84:87],v[180:183]
ds_read_b64_tr_b16 v[210:211],v249 offset:61440
s_waitcnt lgkmcnt(4)
v_mfma_f32_16x16x32_bf16 v[184:187],v[216:219],v[80:83],v[184:187]
ds_read_b64_tr_b16 v[212:213],v242 offset:0
s_add_u32 m0,s29,40960
s_add_u32 s35,s84,s91
s_add_u32 s35,s35,36864
buffer_load_dwordx4 v245,s[8:11],s35 offen lds
s_add_u32 m0,s29,45056
s_add_u32 s45,s35,18432
buffer_load_dwordx4 v245,s[8:11],s45 offen lds
v_mfma_f32_16x16x32_bf16 v[188:191],v[216:219],v[84:87],v[188:191]
ds_read_b64_tr_b16 v[214:215],v242 offset:4096
s_waitcnt lgkmcnt(4)
v_mfma_f32_16x16x32_bf16 v[192:195],v[220:223],v[80:83],v[192:195]
ds_read_b64_tr_b16 v[216:217],v243 offset:0
v_mfma_f32_16x16x32_bf16 v[196:199],v[220:223],v[84:87],v[196:199]
ds_read_b64_tr_b16 v[218:219],v243 offset:4096
s_waitcnt lgkmcnt(4)
v_mfma_f32_16x16x32_bf16 v[200:203],v[208:211],v[80:83],v[200:203]
ds_read_b64_tr_b16 v[220:221],v248 offset:0
v_mfma_f32_16x16x32_bf16 v[204:207],v[208:211],v[84:87],v[204:207]
ds_read_b64_tr_b16 v[222:223],v248 offset:4096
s_waitcnt vmcnt(6)
s_barrier
s_waitcnt lgkmcnt(4)
v_mfma_f32_16x16x32_bf16 v[176:179],v[212:215],v[88:91],v[176:179]
ds_read_b64_tr_b16 v[208:209],v249 offset:0
v_mfma_f32_16x16x32_bf16 v[180:183],v[212:215],v[92:95],v[180:183]
ds_read_b64_tr_b16 v[210:211],v249 offset:4096
s_waitcnt lgkmcnt(4)
v_mfma_f32_16x16x32_bf16 v[184:187],v[216:219],v[88:91],v[184:187]
ds_read_b64_tr_b16 v[212:213],v242 offset:8192
s_add_u32 m0,s29,49152
s_add_u32 s35,s85,s91
buffer_load_dwordx4 v245,s[8:11],s35 offen lds
s_add_u32 m0,s29,53248
s_add_u32 s45,s35,18432
buffer_load_dwordx4 v245,s[8:11],s45 offen lds
v_mfma_f32_16x16x32_bf16 v[188:191],v[216:219],v[92:95],v[188:191]
ds_read_b64_tr_b16 v[214:215],v242 offset:12288
s_waitcnt lgkmcnt(4)
v_mfma_f32_16x16x32_bf16 v[192:195],v[220:223],v[88:91],v[192:195]
ds_read_b64_tr_b16 v[216:217],v243 offset:8192
v_mfma_f32_16x16x32_bf16 v[196:199],v[220:223],v[92:95],v[196:199]
ds_read_b64_tr_b16 v[218:219],v243 offset:12288
s_waitcnt lgkmcnt(4)
v_mfma_f32_16x16x32_bf16 v[200:203],v[208:211],v[88:91],v[200:203]
ds_read_b64_tr_b16 v[220:221],v248 offset:8192
v_mfma_f32_16x16x32_bf16 v[204:207],v[208:211],v[92:95],v[204:207]
ds_read_b64_tr_b16 v[222:223],v248 offset:12288
s_waitcnt lgkmcnt(4)
v_mfma_f32_16x16x32_bf16 v[176:179],v[212:215],v[96:99],v[176:179]
ds_read_b64_tr_b16 v[208:209],v249 offset:8192
v_mfma_f32_16x16x32_bf16 v[180:183],v[212:215],v[100:103],v[180:183]
ds_read_b64_tr_b16 v[210:211],v249 offset:12288
s_waitcnt lgkmcnt(4)
v_mfma_f32_16x16x32_bf16 v[184:187],v[216:219],v[96:99],v[184:187]
ds_read_b64_tr_b16 v[212:213],v242 offset:16384
s_add_u32 m0,s29,57344
s_add_u32 s35,s87,s90
buffer_load_dwordx4 v245,s[8:11],s35 offen lds
s_add_u32 m0,s29,61440
s_add_u32 s45,s35,18432
buffer_load_dwordx4 v245,s[8:11],s45 offen lds
v_mfma_f32_16x16x32_bf16 v[188:191],v[216:219],v[100:103],v[188:191]
ds_read_b64_tr_b16 v[214:215],v242 offset:20480
s_waitcnt lgkmcnt(4)
v_mfma_f32_16x16x32_bf16 v[192:195],v[220:223],v[96:99],v[192:195]
ds_read_b64_tr_b16 v[216:217],v243 offset:16384
v_mfma_f32_16x16x32_bf16 v[196:199],v[220:223],v[100:103],v[196:199]
ds_read_b64_tr_b16 v[218:219],v243 offset:20480
s_waitcnt lgkmcnt(4)
v_mfma_f32_16x16x32_bf16 v[200:203],v[208:211],v[96:99],v[200:203]
ds_read_b64_tr_b16 v[220:221],v248 offset:16384
v_mfma_f32_16x16x32_bf16 v[204:207],v[208:211],v[100:103],v[204:207]
ds_read_b64_tr_b16 v[222:223],v248 offset:20480
s_waitcnt vmcnt(6)
s_barrier
s_waitcnt lgkmcnt(4)
v_mfma_f32_16x16x32_bf16 v[176:179],v[212:215],v[104:107],v[176:179]
ds_read_b64_tr_b16 v[208:209],v249 offset:16384
v_mfma_f32_16x16x32_bf16 v[180:183],v[212:215],v[108:111],v[180:183]
ds_read_b64_tr_b16 v[210:211],v249 offset:20480
s_waitcnt lgkmcnt(4)
v_mfma_f32_16x16x32_bf16 v[184:187],v[216:219],v[104:107],v[184:187]
ds_read_b64_tr_b16 v[212:213],v242 offset:24576
s_add_u32 m0,s29,0
s_add_u32 s35,s87,s90
s_add_u32 s35,s35,36864
buffer_load_dwordx4 v245,s[8:11],s35 offen lds
s_add_u32 m0,s29,4096
s_add_u32 s45,s35,18432
buffer_load_dwordx4 v245,s[8:11],s45 offen lds
v_mfma_f32_16x16x32_bf16 v[188:191],v[216:219],v[108:111],v[188:191]
ds_read_b64_tr_b16 v[214:215],v242 offset:28672
s_waitcnt lgkmcnt(4)
v_mfma_f32_16x16x32_bf16 v[192:195],v[220:223],v[104:107],v[192:195]
ds_read_b64_tr_b16 v[216:217],v243 offset:24576
v_mfma_f32_16x16x32_bf16 v[196:199],v[220:223],v[108:111],v[196:199]
ds_read_b64_tr_b16 v[218:219],v243 offset:28672
s_waitcnt lgkmcnt(4)
v_mfma_f32_16x16x32_bf16 v[200:203],v[208:211],v[104:107],v[200:203]
ds_read_b64_tr_b16 v[220:221],v248 offset:24576
v_mfma_f32_16x16x32_bf16 v[204:207],v[208:211],v[108:111],v[204:207]
ds_read_b64_tr_b16 v[222:223],v248 offset:28672
s_waitcnt lgkmcnt(4)
v_mfma_f32_16x16x32_bf16 v[176:179],v[212:215],v[112:115],v[176:179]
ds_read_b64_tr_b16 v[208:209],v249 offset:24576
v_mfma_f32_16x16x32_bf16 v[180:183],v[212:215],v[116:119],v[180:183]
ds_read_b64_tr_b16 v[210:211],v249 offset:28672
s_waitcnt lgkmcnt(4)
v_mfma_f32_16x16x32_bf16 v[184:187],v[216:219],v[112:115],v[184:187]
ds_read_b64_tr_b16 v[212:213],v242 offset:32768
s_add_u32 m0,s29,8192
s_add_u32 s35,s89,s90
buffer_load_dwordx4 v245,s[8:11],s35 offen lds
s_add_u32 m0,s29,12288
s_add_u32 s45,s35,18432
buffer_load_dwordx4 v245,s[8:11],s45 offen lds
v_mfma_f32_16x16x32_bf16 v[188:191],v[216:219],v[116:119],v[188:191]
ds_read_b64_tr_b16 v[214:215],v242 offset:36864
s_waitcnt lgkmcnt(4)
v_mfma_f32_16x16x32_bf16 v[192:195],v[220:223],v[112:115],v[192:195]
ds_read_b64_tr_b16 v[216:217],v243 offset:32768
v_mfma_f32_16x16x32_bf16 v[196:199],v[220:223],v[116:119],v[196:199]
ds_read_b64_tr_b16 v[218:219],v243 offset:36864
s_waitcnt lgkmcnt(4)
v_mfma_f32_16x16x32_bf16 v[200:203],v[208:211],v[112:115],v[200:203]
ds_read_b64_tr_b16 v[220:221],v248 offset:32768
v_mfma_f32_16x16x32_bf16 v[204:207],v[208:211],v[116:119],v[204:207]
ds_read_b64_tr_b16 v[222:223],v248 offset:36864
s_waitcnt vmcnt(6)
s_barrier
s_waitcnt lgkmcnt(4)
v_mfma_f32_16x16x32_bf16 v[144:147],v[212:215],v[72:75],v[144:147]
ds_read_b64_tr_b16 v[208:209],v249 offset:32768
v_mfma_f32_16x16x32_bf16 v[148:151],v[212:215],v[76:79],v[148:151]
ds_read_b64_tr_b16 v[210:211],v249 offset:36864
s_waitcnt lgkmcnt(4)
v_mfma_f32_16x16x32_bf16 v[152:155],v[216:219],v[72:75],v[152:155]
ds_read_b64_tr_b16 v[212:213],v242 offset:40960
ds_read_b128 v[120:123],v247 offset:12288
ds_read_b128 v[124:127],v247 offset:13312
s_add_u32 m0,s29,16384
s_add_u32 s35,s85,s91
s_add_u32 s35,s35,36864
buffer_load_dwordx4 v245,s[8:11],s35 offen lds
s_add_u32 m0,s29,20480
s_add_u32 s45,s35,18432
buffer_load_dwordx4 v245,s[8:11],s45 offen lds
v_mfma_f32_16x16x32_bf16 v[156:159],v[216:219],v[76:79],v[156:159]
ds_read_b64_tr_b16 v[214:215],v242 offset:45056
s_waitcnt lgkmcnt(6)
v_mfma_f32_16x16x32_bf16 v[160:163],v[220:223],v[72:75],v[160:163]
ds_read_b64_tr_b16 v[216:217],v243 offset:40960
v_mfma_f32_16x16x32_bf16 v[164:167],v[220:223],v[76:79],v[164:167]
ds_read_b64_tr_b16 v[218:219],v243 offset:45056
ds_read_b128 v[128:131],v247 offset:14336
ds_read_b128 v[132:135],v247 offset:15360
s_waitcnt lgkmcnt(8)
v_mfma_f32_16x16x32_bf16 v[168:171],v[208:211],v[72:75],v[168:171]
ds_read_b64_tr_b16 v[220:221],v248 offset:40960
v_mfma_f32_16x16x32_bf16 v[172:175],v[208:211],v[76:79],v[172:175]
ds_read_b64_tr_b16 v[222:223],v248 offset:45056
ds_read_b128 v[136:139],v247 offset:16384
ds_read_b128 v[140:143],v247 offset:17408
s_waitcnt lgkmcnt(8)
v_mfma_f32_16x16x32_bf16 v[144:147],v[212:215],v[80:83],v[144:147]
ds_read_b64_tr_b16 v[208:209],v249 offset:40960
v_mfma_f32_16x16x32_bf16 v[148:151],v[212:215],v[84:87],v[148:151]
ds_read_b64_tr_b16 v[210:211],v249 offset:45056
s_waitcnt lgkmcnt(8)
v_mfma_f32_16x16x32_bf16 v[152:155],v[216:219],v[80:83],v[152:155]
ds_read_b64_tr_b16 v[212:213],v242 offset:49152
s_add_u32 m0,s29,24576
s_add_u32 s35,s86,s91
buffer_load_dwordx4 v245,s[8:11],s35 offen lds
s_add_u32 m0,s29,28672
s_add_u32 s45,s35,18432
buffer_load_dwordx4 v245,s[8:11],s45 offen lds
v_mfma_f32_16x16x32_bf16 v[156:159],v[216:219],v[84:87],v[156:159]
ds_read_b64_tr_b16 v[214:215],v242 offset:53248
s_waitcnt lgkmcnt(6)
v_mfma_f32_16x16x32_bf16 v[160:163],v[220:223],v[80:83],v[160:163]
ds_read_b64_tr_b16 v[216:217],v243 offset:49152
v_mfma_f32_16x16x32_bf16 v[164:167],v[220:223],v[84:87],v[164:167]
ds_read_b64_tr_b16 v[218:219],v243 offset:53248
s_waitcnt lgkmcnt(4)
v_mfma_f32_16x16x32_bf16 v[168:171],v[208:211],v[80:83],v[168:171]
ds_read_b64_tr_b16 v[220:221],v248 offset:49152
v_mfma_f32_16x16x32_bf16 v[172:175],v[208:211],v[84:87],v[172:175]
ds_read_b64_tr_b16 v[222:223],v248 offset:53248
s_waitcnt vmcnt(6)
s_barrier
s_waitcnt lgkmcnt(4)
v_mfma_f32_16x16x32_bf16 v[144:147],v[212:215],v[88:91],v[144:147]
ds_read_b64_tr_b16 v[208:209],v249 offset:49152
v_mfma_f32_16x16x32_bf16 v[148:151],v[212:215],v[92:95],v[148:151]
ds_read_b64_tr_b16 v[210:211],v249 offset:53248
s_waitcnt lgkmcnt(4)
v_mfma_f32_16x16x32_bf16 v[152:155],v[216:219],v[88:91],v[152:155]
ds_read_b64_tr_b16 v[212:213],v242 offset:57344
s_add_u32 m0,s29,32768
s_add_u32 s35,s86,s91
s_add_u32 s35,s35,36864
buffer_load_dwordx4 v245,s[8:11],s35 offen lds
s_add_u32 m0,s29,36864
s_add_u32 s45,s35,18432
buffer_load_dwordx4 v245,s[8:11],s45 offen lds
v_mfma_f32_16x16x32_bf16 v[156:159],v[216:219],v[92:95],v[156:159]
ds_read_b64_tr_b16 v[214:215],v242 offset:61440
s_waitcnt lgkmcnt(4)
v_mfma_f32_16x16x32_bf16 v[160:163],v[220:223],v[88:91],v[160:163]
ds_read_b64_tr_b16 v[216:217],v243 offset:57344
v_mfma_f32_16x16x32_bf16 v[164:167],v[220:223],v[92:95],v[164:167]
ds_read_b64_tr_b16 v[218:219],v243 offset:61440
s_waitcnt lgkmcnt(4)
v_mfma_f32_16x16x32_bf16 v[168:171],v[208:211],v[88:91],v[168:171]
ds_read_b64_tr_b16 v[220:221],v248 offset:57344
v_mfma_f32_16x16x32_bf16 v[172:175],v[208:211],v[92:95],v[172:175]
ds_read_b64_tr_b16 v[222:223],v248 offset:61440
s_waitcnt lgkmcnt(4)
v_mfma_f32_16x16x32_bf16 v[176:179],v[212:215],v[120:123],v[176:179]
ds_read_b64_tr_b16 v[208:209],v249 offset:57344
v_mfma_f32_16x16x32_bf16 v[180:183],v[212:215],v[124:127],v[180:183]
ds_read_b64_tr_b16 v[210:211],v249 offset:61440
s_waitcnt lgkmcnt(4)
v_mfma_f32_16x16x32_bf16 v[184:187],v[216:219],v[120:123],v[184:187]
ds_read_b64_tr_b16 v[212:213],v242 offset:0
s_add_u32 m0,s29,40960
s_add_u32 s35,s87,s91
buffer_load_dwordx4 v245,s[8:11],s35 offen lds
s_add_u32 m0,s29,45056
s_add_u32 s45,s35,18432
buffer_load_dwordx4 v245,s[8:11],s45 offen lds
v_mfma_f32_16x16x32_bf16 v[188:191],v[216:219],v[124:127],v[188:191]
ds_read_b64_tr_b16 v[214:215],v242 offset:4096
s_waitcnt lgkmcnt(4)
v_mfma_f32_16x16x32_bf16 v[192:195],v[220:223],v[120:123],v[192:195]
ds_read_b64_tr_b16 v[216:217],v243 offset:0
v_mfma_f32_16x16x32_bf16 v[196:199],v[220:223],v[124:127],v[196:199]
ds_read_b64_tr_b16 v[218:219],v243 offset:4096
s_waitcnt lgkmcnt(4)
v_mfma_f32_16x16x32_bf16 v[200:203],v[208:211],v[120:123],v[200:203]
ds_read_b64_tr_b16 v[220:221],v248 offset:0
v_mfma_f32_16x16x32_bf16 v[204:207],v[208:211],v[124:127],v[204:207]
ds_read_b64_tr_b16 v[222:223],v248 offset:4096
s_waitcnt vmcnt(6)
s_barrier
s_waitcnt lgkmcnt(4)
v_mfma_f32_16x16x32_bf16 v[176:179],v[212:215],v[128:131],v[176:179]
ds_read_b64_tr_b16 v[208:209],v249 offset:0
v_mfma_f32_16x16x32_bf16 v[180:183],v[212:215],v[132:135],v[180:183]
ds_read_b64_tr_b16 v[210:211],v249 offset:4096
s_waitcnt lgkmcnt(4)
v_mfma_f32_16x16x32_bf16 v[184:187],v[216:219],v[128:131],v[184:187]
ds_read_b64_tr_b16 v[212:213],v242 offset:8192
s_add_u32 m0,s29,49152
s_add_u32 s35,s87,s91
s_add_u32 s35,s35,36864
buffer_load_dwordx4 v245,s[8:11],s35 offen lds
s_add_u32 m0,s29,53248
s_add_u32 s45,s35,18432
buffer_load_dwordx4 v245,s[8:11],s45 offen lds
v_mfma_f32_16x16x32_bf16 v[188:191],v[216:219],v[132:135],v[188:191]
ds_read_b64_tr_b16 v[214:215],v242 offset:12288
s_waitcnt lgkmcnt(4)
v_mfma_f32_16x16x32_bf16 v[192:195],v[220:223],v[128:131],v[192:195]
ds_read_b64_tr_b16 v[216:217],v243 offset:8192
v_mfma_f32_16x16x32_bf16 v[196:199],v[220:223],v[132:135],v[196:199]
ds_read_b64_tr_b16 v[218:219],v243 offset:12288
s_waitcnt lgkmcnt(4)
v_mfma_f32_16x16x32_bf16 v[200:203],v[208:211],v[128:131],v[200:203]
ds_read_b64_tr_b16 v[220:221],v248 offset:8192
v_mfma_f32_16x16x32_bf16 v[204:207],v[208:211],v[132:135],v[204:207]
ds_read_b64_tr_b16 v[222:223],v248 offset:12288
s_waitcnt lgkmcnt(4)
v_mfma_f32_16x16x32_bf16 v[176:179],v[212:215],v[136:139],v[176:179]
ds_read_b64_tr_b16 v[208:209],v249 offset:8192
v_mfma_f32_16x16x32_bf16 v[180:183],v[212:215],v[140:143],v[180:183]
ds_read_b64_tr_b16 v[210:211],v249 offset:12288
s_waitcnt lgkmcnt(4)
v_mfma_f32_16x16x32_bf16 v[184:187],v[216:219],v[136:139],v[184:187]
ds_read_b64_tr_b16 v[212:213],v242 offset:16384
s_add_u32 m0,s29,57344
s_add_u32 s35,s89,s91
buffer_load_dwordx4 v245,s[8:11],s35 offen lds
s_add_u32 m0,s29,61440
s_add_u32 s45,s35,18432
buffer_load_dwordx4 v245,s[8:11],s45 offen lds
v_mfma_f32_16x16x32_bf16 v[188:191],v[216:219],v[140:143],v[188:191]
ds_read_b64_tr_b16 v[214:215],v242 offset:20480
s_waitcnt lgkmcnt(4)
v_mfma_f32_16x16x32_bf16 v[192:195],v[220:223],v[136:139],v[192:195]
ds_read_b64_tr_b16 v[216:217],v243 offset:16384
v_mfma_f32_16x16x32_bf16 v[196:199],v[220:223],v[140:143],v[196:199]
ds_read_b64_tr_b16 v[218:219],v243 offset:20480
s_waitcnt lgkmcnt(4)
v_mfma_f32_16x16x32_bf16 v[200:203],v[208:211],v[136:139],v[200:203]
ds_read_b64_tr_b16 v[220:221],v248 offset:16384
v_mfma_f32_16x16x32_bf16 v[204:207],v[208:211],v[140:143],v[204:207]
ds_read_b64_tr_b16 v[222:223],v248 offset:20480
s_waitcnt vmcnt(6)
s_barrier
s_waitcnt lgkmcnt(4)
v_mfma_f32_16x16x32_bf16 v[144:147],v[212:215],v[96:99],v[144:147]
ds_read_b64_tr_b16 v[208:209],v249 offset:16384
v_mfma_f32_16x16x32_bf16 v[148:151],v[212:215],v[100:103],v[148:151]
ds_read_b64_tr_b16 v[210:211],v249 offset:20480
s_lshl_b32 s44,s90,4
s_waitcnt lgkmcnt(4)
v_mfma_f32_16x16x32_bf16 v[152:155],v[216:219],v[96:99],v[152:155]
ds_read_b64_tr_b16 v[212:213],v242 offset:24576
s_add_u32 m0,s29,0
s_add_u32 s35,s84,s92
buffer_load_dwordx4 v246,s[8:11],s35 offen lds
s_add_u32 m0,s29,4096
s_add_u32 s45,s85,s92
buffer_load_dwordx4 v246,s[8:11],s45 offen lds
v_mfma_f32_16x16x32_bf16 v[156:159],v[216:219],v[100:103],v[156:159]
ds_read_b64_tr_b16 v[214:215],v242 offset:28672
s_lshl_b32 s40,s42,11
s_waitcnt lgkmcnt(4)
v_mfma_f32_16x16x32_bf16 v[160:163],v[220:223],v[96:99],v[160:163]
ds_read_b64_tr_b16 v[216:217],v243 offset:24576
v_mfma_f32_16x16x32_bf16 v[164:167],v[220:223],v[100:103],v[164:167]
ds_read_b64_tr_b16 v[218:219],v243 offset:28672
s_add_u32 s44,s44,s40
s_waitcnt lgkmcnt(4)
v_mfma_f32_16x16x32_bf16 v[168:171],v[208:211],v[96:99],v[168:171]
ds_read_b64_tr_b16 v[220:221],v248 offset:24576
v_mfma_f32_16x16x32_bf16 v[172:175],v[208:211],v[100:103],v[172:175]
ds_read_b64_tr_b16 v[222:223],v248 offset:28672
s_add_u32 s44,s44,s39
s_waitcnt lgkmcnt(4)
v_mfma_f32_16x16x32_bf16 v[144:147],v[212:215],v[104:107],v[144:147]
ds_read_b64_tr_b16 v[208:209],v249 offset:24576
v_mfma_f32_16x16x32_bf16 v[148:151],v[212:215],v[108:111],v[148:151]
ds_read_b64_tr_b16 v[210:211],v249 offset:28672
v_cvt_pk_bf16_f32 v224,v176,v177
s_waitcnt lgkmcnt(4)
v_mfma_f32_16x16x32_bf16 v[152:155],v[216:219],v[104:107],v[152:155]
ds_read_b64_tr_b16 v[212:213],v242 offset:32768
s_add_u32 m0,s29,8192
s_add_u32 s35,s86,s92
buffer_load_dwordx4 v246,s[8:11],s35 offen lds
s_add_u32 m0,s29,12288
s_add_u32 s45,s87,s92
buffer_load_dwordx4 v246,s[8:11],s45 offen lds
v_mfma_f32_16x16x32_bf16 v[156:159],v[216:219],v[108:111],v[156:159]
ds_read_b64_tr_b16 v[214:215],v242 offset:36864
v_cvt_pk_bf16_f32 v225,v178,v179
s_waitcnt lgkmcnt(4)
v_mfma_f32_16x16x32_bf16 v[160:163],v[220:223],v[104:107],v[160:163]
ds_read_b64_tr_b16 v[216:217],v243 offset:32768
v_mfma_f32_16x16x32_bf16 v[164:167],v[220:223],v[108:111],v[164:167]
ds_read_b64_tr_b16 v[218:219],v243 offset:36864
v_cvt_pk_bf16_f32 v226,v184,v185
s_waitcnt lgkmcnt(4)
v_mfma_f32_16x16x32_bf16 v[168:171],v[208:211],v[104:107],v[168:171]
ds_read_b64_tr_b16 v[220:221],v248 offset:32768
v_mfma_f32_16x16x32_bf16 v[172:175],v[208:211],v[108:111],v[172:175]
ds_read_b64_tr_b16 v[222:223],v248 offset:36864
v_cvt_pk_bf16_f32 v227,v186,v187
s_waitcnt vmcnt(6)
s_barrier
s_waitcnt lgkmcnt(4)
v_mfma_f32_16x16x32_bf16 v[144:147],v[212:215],v[112:115],v[144:147]
ds_read_b64_tr_b16 v[208:209],v249 offset:32768
v_mfma_f32_16x16x32_bf16 v[148:151],v[212:215],v[116:119],v[148:151]
ds_read_b64_tr_b16 v[210:211],v249 offset:36864
buffer_store_dwordx4 v[224:227],v254,s[16:19],s44 offen offset:0 sc1
s_waitcnt lgkmcnt(4)
v_mfma_f32_16x16x32_bf16 v[152:155],v[216:219],v[112:115],v[152:155]
ds_read_b64_tr_b16 v[212:213],v242 offset:40960
s_add_u32 m0,s29,16384
s_add_u32 s35,s89,s92
buffer_load_dwordx4 v246,s[8:11],s35 offen lds
v_mfma_f32_16x16x32_bf16 v[156:159],v[216:219],v[116:119],v[156:159]
ds_read_b64_tr_b16 v[214:215],v242 offset:45056
v_cvt_pk_bf16_f32 v228,v192,v193
s_waitcnt lgkmcnt(4)
v_mfma_f32_16x16x32_bf16 v[160:163],v[220:223],v[112:115],v[160:163]
ds_read_b64_tr_b16 v[216:217],v243 offset:40960
v_cvt_pk_bf16_f32 v229,v194,v195
v_mfma_f32_16x16x32_bf16 v[164:167],v[220:223],v[116:119],v[164:167]
ds_read_b64_tr_b16 v[218:219],v243 offset:45056
s_waitcnt lgkmcnt(4)
v_mfma_f32_16x16x32_bf16 v[168:171],v[208:211],v[112:115],v[168:171]
ds_read_b64_tr_b16 v[220:221],v248 offset:40960
v_cvt_pk_bf16_f32 v230,v200,v201
v_mfma_f32_16x16x32_bf16 v[172:175],v[208:211],v[116:119],v[172:175]
ds_read_b64_tr_b16 v[222:223],v248 offset:45056
v_cvt_pk_bf16_f32 v231,v202,v203
s_waitcnt lgkmcnt(4)
v_mfma_f32_16x16x32_bf16 v[144:147],v[212:215],v[120:123],v[144:147]
ds_read_b64_tr_b16 v[208:209],v249 offset:40960
v_mfma_f32_16x16x32_bf16 v[148:151],v[212:215],v[124:127],v[148:151]
ds_read_b64_tr_b16 v[210:211],v249 offset:45056
buffer_store_dwordx4 v[228:231],v254,s[16:19],s44 offen offset:1024 sc1
s_waitcnt lgkmcnt(4)
v_mfma_f32_16x16x32_bf16 v[152:155],v[216:219],v[120:123],v[152:155]
ds_read_b64_tr_b16 v[212:213],v242 offset:49152
v_mfma_f32_16x16x32_bf16 v[156:159],v[216:219],v[124:127],v[156:159]
ds_read_b64_tr_b16 v[214:215],v242 offset:53248
v_cvt_pk_bf16_f32 v224,v180,v181
s_waitcnt lgkmcnt(4)
v_mfma_f32_16x16x32_bf16 v[160:163],v[220:223],v[120:123],v[160:163]
ds_read_b64_tr_b16 v[216:217],v243 offset:49152
v_mfma_f32_16x16x32_bf16 v[164:167],v[220:223],v[124:127],v[164:167]
ds_read_b64_tr_b16 v[218:219],v243 offset:53248
v_cvt_pk_bf16_f32 v225,v182,v183
s_waitcnt lgkmcnt(4)
v_mfma_f32_16x16x32_bf16 v[168:171],v[208:211],v[120:123],v[168:171]
ds_read_b64_tr_b16 v[220:221],v248 offset:49152
v_mfma_f32_16x16x32_bf16 v[172:175],v[208:211],v[124:127],v[172:175]
ds_read_b64_tr_b16 v[222:223],v248 offset:53248
v_cvt_pk_bf16_f32 v226,v188,v189
s_waitcnt vmcnt(5)
s_barrier
s_waitcnt lgkmcnt(4)
v_mfma_f32_16x16x32_bf16 v[144:147],v[212:215],v[128:131],v[144:147]
ds_read_b64_tr_b16 v[208:209],v249 offset:49152
v_mfma_f32_16x16x32_bf16 v[148:151],v[212:215],v[132:135],v[148:151]
ds_read_b64_tr_b16 v[210:211],v249 offset:53248
v_cvt_pk_bf16_f32 v227,v190,v191
s_waitcnt lgkmcnt(4)
v_mfma_f32_16x16x32_bf16 v[152:155],v[216:219],v[128:131],v[152:155]
ds_read_b64_tr_b16 v[212:213],v242 offset:57344
v_mfma_f32_16x16x32_bf16 v[156:159],v[216:219],v[132:135],v[156:159]
ds_read_b64_tr_b16 v[214:215],v242 offset:61440
s_add_u32 s40,s44,18432
s_waitcnt lgkmcnt(4)
v_mfma_f32_16x16x32_bf16 v[160:163],v[220:223],v[128:131],v[160:163]
ds_read_b64_tr_b16 v[216:217],v243 offset:57344
v_mfma_f32_16x16x32_bf16 v[164:167],v[220:223],v[132:135],v[164:167]
ds_read_b64_tr_b16 v[218:219],v243 offset:61440
buffer_store_dwordx4 v[224:227],v254,s[16:19],s40 offen sc1
s_waitcnt lgkmcnt(4)
v_mfma_f32_16x16x32_bf16 v[168:171],v[208:211],v[128:131],v[168:171]
ds_read_b64_tr_b16 v[220:221],v248 offset:57344
v_mfma_f32_16x16x32_bf16 v[172:175],v[208:211],v[132:135],v[172:175]
ds_read_b64_tr_b16 v[222:223],v248 offset:61440
v_cvt_pk_bf16_f32 v228,v196,v197
s_waitcnt lgkmcnt(4)
v_mfma_f32_16x16x32_bf16 v[144:147],v[212:215],v[136:139],v[144:147]
ds_read_b64_tr_b16 v[208:209],v249 offset:57344
v_mfma_f32_16x16x32_bf16 v[148:151],v[212:215],v[140:143],v[148:151]
ds_read_b64_tr_b16 v[210:211],v249 offset:61440
v_cvt_pk_bf16_f32 v229,v198,v199
s_waitcnt lgkmcnt(4)
v_mfma_f32_16x16x32_bf16 v[152:155],v[216:219],v[136:139],v[152:155]
ds_read_b64_tr_b16 v[212:213],v244 offset:0
v_mfma_f32_16x16x32_bf16 v[156:159],v[216:219],v[140:143],v[156:159]
ds_read_b64_tr_b16 v[214:215],v244 offset:1024
v_cvt_pk_bf16_f32 v230,v204,v205
s_waitcnt lgkmcnt(4)
v_mfma_f32_16x16x32_bf16 v[160:163],v[220:223],v[136:139],v[160:163]
ds_read_b64_tr_b16 v[216:217],v244 offset:2048
v_cvt_pk_bf16_f32 v231,v206,v207
v_mfma_f32_16x16x32_bf16 v[164:167],v[220:223],v[140:143],v[164:167]
ds_read_b64_tr_b16 v[218:219],v244 offset:3072
s_waitcnt lgkmcnt(4)
v_mfma_f32_16x16x32_bf16 v[168:171],v[208:211],v[136:139],v[168:171]
ds_read_b64_tr_b16 v[220:221],v244 offset:4096
s_add_u32 s40,s44,19456
v_mfma_f32_16x16x32_bf16 v[172:175],v[208:211],v[140:143],v[172:175]
ds_read_b64_tr_b16 v[222:223],v244 offset:5120
buffer_store_dwordx4 v[228:231],v254,s[16:19],s40 offen sc1
s_waitcnt vmcnt(3)
s_barrier
s_waitcnt lgkmcnt(4)
v_mfma_f32_16x16x32_bf16 v[232:235],v[212:215],v[72:75],v[232:235]
ds_read_b64_tr_b16 v[208:209],v244 offset:6144
s_lshl_b32 s44,s91,4
v_mfma_f32_16x16x32_bf16 v[236:239],v[212:215],v[76:79],v[236:239]
ds_read_b64_tr_b16 v[210:211],v244 offset:7168
s_lshl_b32 s40,s42,11
s_waitcnt lgkmcnt(4)
v_mfma_f32_16x16x32_bf16 v[232:235],v[216:219],v[80:83],v[232:235]
ds_read_b64_tr_b16 v[212:213],v244 offset:8192
s_add_u32 s44,s44,s40
v_mfma_f32_16x16x32_bf16 v[236:239],v[216:219],v[84:87],v[236:239]
ds_read_b64_tr_b16 v[214:215],v244 offset:9216
s_add_u32 s44,s44,s39
s_waitcnt lgkmcnt(4)
v_mfma_f32_16x16x32_bf16 v[232:235],v[220:223],v[88:91],v[232:235]
ds_read_b64_tr_b16 v[216:217],v244 offset:10240
v_cvt_pk_bf16_f32 v224,v144,v145
v_mfma_f32_16x16x32_bf16 v[236:239],v[220:223],v[92:95],v[236:239]
ds_read_b64_tr_b16 v[218:219],v244 offset:11264
v_cvt_pk_bf16_f32 v225,v146,v147
s_waitcnt lgkmcnt(4)
v_mfma_f32_16x16x32_bf16 v[232:235],v[208:211],v[96:99],v[232:235]
ds_read_b64_tr_b16 v[220:221],v244 offset:12288
v_cvt_pk_bf16_f32 v226,v152,v153
v_mfma_f32_16x16x32_bf16 v[236:239],v[208:211],v[100:103],v[236:239]
ds_read_b64_tr_b16 v[222:223],v244 offset:13312
v_cvt_pk_bf16_f32 v227,v154,v155
s_waitcnt lgkmcnt(4)
v_mfma_f32_16x16x32_bf16 v[232:235],v[212:215],v[104:107],v[232:235]
ds_read_b64_tr_b16 v[208:209],v244 offset:14336
buffer_store_dwordx4 v[224:227],v254,s[16:19],s44 offen offset:0 sc1
v_mfma_f32_16x16x32_bf16 v[236:239],v[212:215],v[108:111],v[236:239]
ds_read_b64_tr_b16 v[210:211],v244 offset:15360
v_cvt_pk_bf16_f32 v228,v160,v161
s_waitcnt lgkmcnt(4)
v_mfma_f32_16x16x32_bf16 v[232:235],v[216:219],v[112:115],v[232:235]
ds_read_b64_tr_b16 v[212:213],v244 offset:16384
v_cvt_pk_bf16_f32 v229,v162,v163
v_mfma_f32_16x16x32_bf16 v[236:239],v[216:219],v[116:119],v[236:239]
ds_read_b64_tr_b16 v[214:215],v244 offset:17408
v_cvt_pk_bf16_f32 v230,v168,v169
s_waitcnt lgkmcnt(4)
v_mfma_f32_16x16x32_bf16 v[232:235],v[220:223],v[120:123],v[232:235]
v_cvt_pk_bf16_f32 v231,v170,v171
v_mfma_f32_16x16x32_bf16 v[236:239],v[220:223],v[124:127],v[236:239]
buffer_store_dwordx4 v[228:231],v254,s[16:19],s44 offen offset:1024 sc1
s_waitcnt lgkmcnt(2)
v_mfma_f32_16x16x32_bf16 v[232:235],v[208:211],v[128:131],v[232:235]
v_cvt_pk_bf16_f32 v224,v148,v149
v_mfma_f32_16x16x32_bf16 v[236:239],v[208:211],v[132:135],v[236:239]
v_cvt_pk_bf16_f32 v225,v150,v151
v_cvt_pk_bf16_f32 v226,v156,v157
s_barrier
s_waitcnt lgkmcnt(0)
v_mfma_f32_16x16x32_bf16 v[232:235],v[212:215],v[136:139],v[232:235]
v_cvt_pk_bf16_f32 v227,v158,v159
s_add_u32 s40,s44,18432
buffer_store_dwordx4 v[224:227],v254,s[16:19],s40 offen sc1
v_cvt_pk_bf16_f32 v228,v164,v165
v_mfma_f32_16x16x32_bf16 v[236:239],v[212:215],v[140:143],v[236:239]
v_cvt_pk_bf16_f32 v229,v166,v167
v_cvt_pk_bf16_f32 v230,v172,v173
v_cvt_pk_bf16_f32 v231,v174,v175
s_add_u32 s40,s44,19456
buffer_store_dwordx4 v[228:231],v254,s[16:19],s40 offen sc1
s_nop 7
s_load_dwordx2 s[88:89],s[0:1],56
s_lshl_b32 s40,s42,3
s_mul_i32 s44,s41,2048
s_add_u32 s44,s44,65536
v_add_u32 v252,s44,v254
v_add_u32 v253,s40,v252
v_cvt_pk_bf16_f32 v224,v232,v233
v_cvt_pk_bf16_f32 v225,v234,v235
ds_write_b64 v253,v[224:225] offset:0
v_cvt_pk_bf16_f32 v228,v236,v237
v_cvt_pk_bf16_f32 v229,v238,v239
ds_write_b64 v253,v[228:229] offset:1024
s_waitcnt vmcnt(4)
s_waitcnt lgkmcnt(0)
s_barrier
s_lshl_b32 s40,s2,9
s_add_u32 s40,s40,384
v_mov_b32 v11,1
buffer_store_dword v11,off,s[64:67],s40 sc1
ds_read_b128 v[224:227],v252 offset:0
s_lshl_b32 s44,s92,4
s_add_u32 s44,s44,s39
s_waitcnt lgkmcnt(0)
buffer_store_dwordx4 v[224:227],v254,s[16:19],s44 offen sc1
s_and_b32 s37,s2,15
s_lshr_b32 s43,s37,1
s_lshl_b32 s40,s30,3
s_add_u32 s43,s43,s40
s_and_b32 s37,s37,1
s_and_b32 s87,s30,1
s_xor_b32 s87,s87,1
s_lshl_b32 s87,s87,2
s_add_u32 s87,s87,s37
s_add_u32 s87,s87,s41
s_xor_b32 s45,s37,1
s_lshl_b32 s45,s45,3
s_mul_i32 s37,s37,9
s_add_u32 s87,s87,s37
s_add_u32 s45,s45,s37
s_mul_i32 s85,s43,18
s_add_u32 s86,s85,s45
s_lshl_b32 s86,s86,10
s_add_u32 s85,s85,s87
s_lshl_b32 s85,s85,10
v_and_b32 v4,15,v255
v_lshrrev_b32 v5,4,v255
s_lshl_b32 s43,s43,4
v_add_u32 v6,s43,v4
v_lshlrev_b32 v7,2,v6
v_mul_u32_u24 v8,1152,v6
v_and_b32 v9,1,v5
v_lshlrev_b32 v9,5,v9
v_lshrrev_b32 v10,1,v5
v_lshl_add_u32 v9,v10,4,v9
v_add_u32 v8,v8,v9
s_lshl_b32 s43,s87,6
v_add_u32 v9,s43,v8
s_lshl_b32 s43,s45,6
v_add_u32 v10,s43,v8
v_min_u32 v12,15,v255
s_lshl_b32 s37,s30,4
v_add_u32 v12,s37,v12
v_lshlrev_b32 v12,9,v12
s_add_u32 s4,s26,6291456
s_addc_u32 s5,s27,0
s_mov_b32 s6,18874368
s_mov_b32 s7,0x20000
s_add_u32 s52,s26,4857856
s_addc_u32 s53,s27,0
s_mov_b32 s54,8192
s_mov_b32 s55,0x20000
s_waitcnt vmcnt(0) lgkmcnt(0)
s_mov_b32 s8,s88
s_mov_b32 s9,s89
s_mov_b32 s10,2359296
s_mov_b32 s11,0x20000
s_barrier
buffer_load_dword v14,v7,s[52:55],0 offen sc1
s_lshl_b32 s40,s2,9
s_add_u32 s40,s40,256
v_mov_b32 v11,1
buffer_store_dword v11,off,s[64:67],s40 sc1
s_cmp_lg_u32 s28,0
s_cbranch_scc1 ffn_kernel_nopoll
s_mov_b32 s45,0x40000
ffn_kernel_poll:
buffer_load_dword v13,v12,s[64:67],0 offen offset:256 sc1
s_waitcnt vmcnt(0)
v_cmp_ne_u32 vcc,1,v13
s_nop 3
s_cmp_eq_u64 vcc,0
s_cbranch_scc1 ffn_kernel_poll_ok
s_sub_u32 s45,s45,1
s_cmp_eq_u32 s45,0
s_cbranch_scc1 ffn_kernel_poll_ok
s_sleep 1
s_branch ffn_kernel_poll
ffn_kernel_poll_ok:
ffn_kernel_nopoll:
s_barrier
buffer_load_dwordx4 v[16:19],v254,s[12:15],s85 offen sc1
buffer_load_dwordx4 v[20:23],v254,s[4:7],s85 offen sc1
s_add_u32 s85,s85,2359296
buffer_load_dwordx4 v[24:27],v254,s[4:7],s85 offen sc1
s_add_u32 s85,s85,2359296
buffer_load_dwordx4 v[28:31],v254,s[4:7],s85 offen sc1
s_add_u32 s85,s85,2359296
buffer_load_dwordx4 v[32:35],v254,s[4:7],s85 offen sc1
s_add_u32 s85,s85,2359296
buffer_load_dwordx4 v[36:39],v254,s[4:7],s85 offen sc1
s_add_u32 s85,s85,2359296
buffer_load_dwordx4 v[40:43],v254,s[4:7],s85 offen sc1
s_add_u32 s85,s85,2359296
buffer_load_dwordx4 v[44:47],v254,s[4:7],s85 offen sc1
s_add_u32 s85,s85,2359296
buffer_load_dwordx4 v[48:51],v254,s[4:7],s85 offen sc1
s_cmp_lg_u32 s28,0
s_cbranch_scc1 ffn_kernel_nou8a
buffer_load_dwordx4 v[56:59],v254,s[12:15],s86 offen sc1
buffer_load_dwordx4 v[60:63],v254,s[4:7],s86 offen sc1
s_add_u32 s86,s86,2359296
buffer_load_dwordx4 v[64:67],v254,s[4:7],s86 offen sc1
s_add_u32 s86,s86,2359296
buffer_load_dwordx4 v[68:71],v254,s[4:7],s86 offen sc1
s_add_u32 s86,s86,2359296
buffer_load_dwordx4 v[72:75],v254,s[4:7],s86 offen sc1
s_add_u32 s86,s86,2359296
buffer_load_dwordx4 v[76:79],v254,s[4:7],s86 offen sc1
s_add_u32 s86,s86,2359296
buffer_load_dwordx4 v[80:83],v254,s[4:7],s86 offen sc1
s_add_u32 s86,s86,2359296
buffer_load_dwordx4 v[84:87],v254,s[4:7],s86 offen sc1
s_add_u32 s86,s86,2359296
buffer_load_dwordx4 v[88:91],v254,s[4:7],s86 offen sc1
ffn_kernel_nou8a:
v_mov_b32 v15,0xffff0000
s_waitcnt vmcnt(0)
v_lshlrev_b32 v108,16,v16
v_and_b32 v109,v15,v16
v_add_f32 v100,v14,v108
v_add_f32 v101,v14,v109
v_lshlrev_b32 v108,16,v17
v_and_b32 v109,v15,v17
v_add_f32 v102,v14,v108
v_add_f32 v103,v14,v109
v_lshlrev_b32 v108,16,v18
v_and_b32 v109,v15,v18
v_add_f32 v104,v14,v108
v_add_f32 v105,v14,v109
v_lshlrev_b32 v108,16,v19
v_and_b32 v109,v15,v19
v_add_f32 v106,v14,v108
v_add_f32 v107,v14,v109
v_lshlrev_b32 v108,16,v20
v_and_b32 v109,v15,v20
v_pk_add_f32 v[100:101],v[100:101],v[108:109]
v_lshlrev_b32 v110,16,v21
v_and_b32 v111,v15,v21
v_pk_add_f32 v[102:103],v[102:103],v[110:111]
v_lshlrev_b32 v108,16,v22
v_and_b32 v109,v15,v22
v_pk_add_f32 v[104:105],v[104:105],v[108:109]
v_lshlrev_b32 v110,16,v23
v_and_b32 v111,v15,v23
v_pk_add_f32 v[106:107],v[106:107],v[110:111]
v_lshlrev_b32 v108,16,v24
v_and_b32 v109,v15,v24
v_pk_add_f32 v[100:101],v[100:101],v[108:109]
v_lshlrev_b32 v110,16,v25
v_and_b32 v111,v15,v25
v_pk_add_f32 v[102:103],v[102:103],v[110:111]
v_lshlrev_b32 v108,16,v26
v_and_b32 v109,v15,v26
v_pk_add_f32 v[104:105],v[104:105],v[108:109]
v_lshlrev_b32 v110,16,v27
v_and_b32 v111,v15,v27
v_pk_add_f32 v[106:107],v[106:107],v[110:111]
v_lshlrev_b32 v108,16,v28
v_and_b32 v109,v15,v28
v_pk_add_f32 v[100:101],v[100:101],v[108:109]
v_lshlrev_b32 v110,16,v29
v_and_b32 v111,v15,v29
v_pk_add_f32 v[102:103],v[102:103],v[110:111]
v_lshlrev_b32 v108,16,v30
v_and_b32 v109,v15,v30
v_pk_add_f32 v[104:105],v[104:105],v[108:109]
v_lshlrev_b32 v110,16,v31
v_and_b32 v111,v15,v31
v_pk_add_f32 v[106:107],v[106:107],v[110:111]
v_lshlrev_b32 v108,16,v32
v_and_b32 v109,v15,v32
v_pk_add_f32 v[100:101],v[100:101],v[108:109]
v_lshlrev_b32 v110,16,v33
v_and_b32 v111,v15,v33
v_pk_add_f32 v[102:103],v[102:103],v[110:111]
v_lshlrev_b32 v108,16,v34
v_and_b32 v109,v15,v34
v_pk_add_f32 v[104:105],v[104:105],v[108:109]
v_lshlrev_b32 v110,16,v35
v_and_b32 v111,v15,v35
v_pk_add_f32 v[106:107],v[106:107],v[110:111]
v_lshlrev_b32 v108,16,v36
v_and_b32 v109,v15,v36
v_pk_add_f32 v[100:101],v[100:101],v[108:109]
v_lshlrev_b32 v110,16,v37
v_and_b32 v111,v15,v37
v_pk_add_f32 v[102:103],v[102:103],v[110:111]
v_lshlrev_b32 v108,16,v38
v_and_b32 v109,v15,v38
v_pk_add_f32 v[104:105],v[104:105],v[108:109]
v_lshlrev_b32 v110,16,v39
v_and_b32 v111,v15,v39
v_pk_add_f32 v[106:107],v[106:107],v[110:111]
v_lshlrev_b32 v108,16,v40
v_and_b32 v109,v15,v40
v_pk_add_f32 v[100:101],v[100:101],v[108:109]
v_lshlrev_b32 v110,16,v41
v_and_b32 v111,v15,v41
v_pk_add_f32 v[102:103],v[102:103],v[110:111]
v_lshlrev_b32 v108,16,v42
v_and_b32 v109,v15,v42
v_pk_add_f32 v[104:105],v[104:105],v[108:109]
v_lshlrev_b32 v110,16,v43
v_and_b32 v111,v15,v43
v_pk_add_f32 v[106:107],v[106:107],v[110:111]
v_lshlrev_b32 v108,16,v44
v_and_b32 v109,v15,v44
v_pk_add_f32 v[100:101],v[100:101],v[108:109]
v_lshlrev_b32 v110,16,v45
v_and_b32 v111,v15,v45
v_pk_add_f32 v[102:103],v[102:103],v[110:111]
v_lshlrev_b32 v108,16,v46
v_and_b32 v109,v15,v46
v_pk_add_f32 v[104:105],v[104:105],v[108:109]
v_lshlrev_b32 v110,16,v47
v_and_b32 v111,v15,v47
v_pk_add_f32 v[106:107],v[106:107],v[110:111]
v_lshlrev_b32 v108,16,v48
v_and_b32 v109,v15,v48
v_pk_add_f32 v[100:101],v[100:101],v[108:109]
v_lshlrev_b32 v110,16,v49
v_and_b32 v111,v15,v49
v_pk_add_f32 v[102:103],v[102:103],v[110:111]
v_lshlrev_b32 v108,16,v50
v_and_b32 v109,v15,v50
v_pk_add_f32 v[104:105],v[104:105],v[108:109]
v_lshlrev_b32 v110,16,v51
v_and_b32 v111,v15,v51
v_pk_add_f32 v[106:107],v[106:107],v[110:111]
v_cvt_pk_bf16_f32 v112,v100,v101
v_cvt_pk_bf16_f32 v113,v102,v103
v_cvt_pk_bf16_f32 v114,v104,v105
v_cvt_pk_bf16_f32 v115,v106,v107
s_nop 1
v_permlane16_swap_b32 v112,v114
v_permlane16_swap_b32 v113,v115
s_nop 0
buffer_store_dwordx4 v[112:115],v9,s[8:11],0 offen
s_cmp_lg_u32 s28,0
s_cbranch_scc1 ffn_kernel_nou8b
s_nop 1
v_lshlrev_b32 v108,16,v56
v_and_b32 v109,v15,v56
v_add_f32 v100,v14,v108
v_add_f32 v101,v14,v109
v_lshlrev_b32 v108,16,v57
v_and_b32 v109,v15,v57
v_add_f32 v102,v14,v108
v_add_f32 v103,v14,v109
v_lshlrev_b32 v108,16,v58
v_and_b32 v109,v15,v58
v_add_f32 v104,v14,v108
v_add_f32 v105,v14,v109
v_lshlrev_b32 v108,16,v59
v_and_b32 v109,v15,v59
v_add_f32 v106,v14,v108
v_add_f32 v107,v14,v109
v_lshlrev_b32 v108,16,v60
v_and_b32 v109,v15,v60
v_pk_add_f32 v[100:101],v[100:101],v[108:109]
v_lshlrev_b32 v110,16,v61
v_and_b32 v111,v15,v61
v_pk_add_f32 v[102:103],v[102:103],v[110:111]
v_lshlrev_b32 v108,16,v62
v_and_b32 v109,v15,v62
v_pk_add_f32 v[104:105],v[104:105],v[108:109]
v_lshlrev_b32 v110,16,v63
v_and_b32 v111,v15,v63
v_pk_add_f32 v[106:107],v[106:107],v[110:111]
v_lshlrev_b32 v108,16,v64
v_and_b32 v109,v15,v64
v_pk_add_f32 v[100:101],v[100:101],v[108:109]
v_lshlrev_b32 v110,16,v65
v_and_b32 v111,v15,v65
v_pk_add_f32 v[102:103],v[102:103],v[110:111]
v_lshlrev_b32 v108,16,v66
v_and_b32 v109,v15,v66
v_pk_add_f32 v[104:105],v[104:105],v[108:109]
v_lshlrev_b32 v110,16,v67
v_and_b32 v111,v15,v67
v_pk_add_f32 v[106:107],v[106:107],v[110:111]
v_lshlrev_b32 v108,16,v68
v_and_b32 v109,v15,v68
v_pk_add_f32 v[100:101],v[100:101],v[108:109]
v_lshlrev_b32 v110,16,v69
v_and_b32 v111,v15,v69
v_pk_add_f32 v[102:103],v[102:103],v[110:111]
v_lshlrev_b32 v108,16,v70
v_and_b32 v109,v15,v70
v_pk_add_f32 v[104:105],v[104:105],v[108:109]
v_lshlrev_b32 v110,16,v71
v_and_b32 v111,v15,v71
v_pk_add_f32 v[106:107],v[106:107],v[110:111]
v_lshlrev_b32 v108,16,v72
v_and_b32 v109,v15,v72
v_pk_add_f32 v[100:101],v[100:101],v[108:109]
v_lshlrev_b32 v110,16,v73
v_and_b32 v111,v15,v73
v_pk_add_f32 v[102:103],v[102:103],v[110:111]
v_lshlrev_b32 v108,16,v74
v_and_b32 v109,v15,v74
v_pk_add_f32 v[104:105],v[104:105],v[108:109]
v_lshlrev_b32 v110,16,v75
v_and_b32 v111,v15,v75
v_pk_add_f32 v[106:107],v[106:107],v[110:111]
v_lshlrev_b32 v108,16,v76
v_and_b32 v109,v15,v76
v_pk_add_f32 v[100:101],v[100:101],v[108:109]
v_lshlrev_b32 v110,16,v77
v_and_b32 v111,v15,v77
v_pk_add_f32 v[102:103],v[102:103],v[110:111]
v_lshlrev_b32 v108,16,v78
v_and_b32 v109,v15,v78
v_pk_add_f32 v[104:105],v[104:105],v[108:109]
v_lshlrev_b32 v110,16,v79
v_and_b32 v111,v15,v79
v_pk_add_f32 v[106:107],v[106:107],v[110:111]
v_lshlrev_b32 v108,16,v80
v_and_b32 v109,v15,v80
v_pk_add_f32 v[100:101],v[100:101],v[108:109]
v_lshlrev_b32 v110,16,v81
v_and_b32 v111,v15,v81
v_pk_add_f32 v[102:103],v[102:103],v[110:111]
v_lshlrev_b32 v108,16,v82
v_and_b32 v109,v15,v82
v_pk_add_f32 v[104:105],v[104:105],v[108:109]
v_lshlrev_b32 v110,16,v83
v_and_b32 v111,v15,v83
v_pk_add_f32 v[106:107],v[106:107],v[110:111]
v_lshlrev_b32 v108,16,v84
v_and_b32 v109,v15,v84
v_pk_add_f32 v[100:101],v[100:101],v[108:109]
v_lshlrev_b32 v110,16,v85
v_and_b32 v111,v15,v85
v_pk_add_f32 v[102:103],v[102:103],v[110:111]
v_lshlrev_b32 v108,16,v86
v_and_b32 v109,v15,v86
v_pk_add_f32 v[104:105],v[104:105],v[108:109]
v_lshlrev_b32 v110,16,v87
v_and_b32 v111,v15,v87
v_pk_add_f32 v[106:107],v[106:107],v[110:111]
v_lshlrev_b32 v108,16,v88
v_and_b32 v109,v15,v88
v_pk_add_f32 v[100:101],v[100:101],v[108:109]
v_lshlrev_b32 v110,16,v89
v_and_b32 v111,v15,v89
v_pk_add_f32 v[102:103],v[102:103],v[110:111]
v_lshlrev_b32 v108,16,v90
v_and_b32 v109,v15,v90
v_pk_add_f32 v[104:105],v[104:105],v[108:109]
v_lshlrev_b32 v110,16,v91
v_and_b32 v111,v15,v91
v_pk_add_f32 v[106:107],v[106:107],v[110:111]
v_cvt_pk_bf16_f32 v112,v100,v101
v_cvt_pk_bf16_f32 v113,v102,v103
v_cvt_pk_bf16_f32 v114,v104,v105
v_cvt_pk_bf16_f32 v115,v106,v107
s_nop 1
v_permlane16_swap_b32 v112,v114
v_permlane16_swap_b32 v113,v115
s_nop 0
buffer_store_dwordx4 v[112:115],v10,s[8:11],0 offen
ffn_kernel_nou8b:
s_endpgm
ffn_kernel_grpB:
s_cmp_lg_u32 s28,4
s_cbranch_scc1 ffn_kernel_pt_ok
v_min_u32 v8,17,v255
s_and_b32 s37,s30,1
s_mul_i32 s37,s37,9
v_add_u32 v8,s37,v8
s_lshr_b32 s37,s30,1
v_lshl_add_u32 v8,v8,3,s37
v_lshlrev_b32 v8,7,v8
s_add_u32 s64,s26,6029312
s_addc_u32 s65,s27,0
s_mov_b32 s66,32768
s_mov_b32 s67,0x20000
s_mov_b32 s45,0x40000
ffn_kernel_pt:
buffer_load_dword v9,v8,s[64:67],0 offen sc1
s_waitcnt vmcnt(0)
v_cmp_ne_u32 vcc,1,v9
s_nop 3
s_cmp_eq_u64 vcc,0
s_cbranch_scc1 ffn_kernel_pt_ok
s_sub_u32 s45,s45,1
s_cmp_lg_u32 s45,0
s_cbranch_scc1 ffn_kernel_pt
ffn_kernel_pt_ok:
s_barrier
s_mov_b32 s37,0
buffer_load_dword v16,v6,s[16:19],s37 offen sc1
s_mov_b32 s37,16384
buffer_load_dword v17,v6,s[16:19],s37 offen sc1
s_mov_b32 s37,32768
buffer_load_dword v18,v6,s[16:19],s37 offen sc1
s_mov_b32 s37,49152
buffer_load_dword v19,v6,s[16:19],s37 offen sc1
s_mov_b32 s37,65536
buffer_load_dword v20,v6,s[16:19],s37 offen sc1
s_mov_b32 s37,81920
buffer_load_dword v21,v6,s[16:19],s37 offen sc1
s_mov_b32 s37,98304
buffer_load_dword v22,v6,s[16:19],s37 offen sc1
s_mov_b32 s37,114688
buffer_load_dword v23,v6,s[16:19],s37 offen sc1
s_mov_b32 s37,131072
buffer_load_dword v24,v6,s[16:19],s37 offen sc1
s_lshr_b32 s35,s2,3
s_mul_i32 s35,s35,162
s_and_b32 s45,s41,1
s_mul_i32 s45,s45,81
s_add_u32 s35,s35,s45
s_cmp_lt_u32 s41,2
s_cselect_b32 s60,s4,s52
s_cselect_b32 s61,s5,s53
s_mov_b32 s62,5308416
s_mov_b32 s63,0x20000
s_and_b32 s45,s2,7
s_mul_i32 s45,s45,1152
v_add_u32 v10,s35,v255
v_min_u32 v10,5183,v10
v_mul_u32_u24 v11,7282,v10
v_lshrrev_b32 v11,16,v11
v_mul_u32_u24 v12,9,v11
v_sub_u32 v12,v10,v12
v_mul_u32_u24 v11,9216,v11
v_lshl_add_u32 v11,v12,7,v11
buffer_load_dword v246,v11,s[60:63],s45 offen
v_add_u32 v10,s35,v255
v_add_u32 v10,64,v10
v_min_u32 v10,5183,v10
v_mul_u32_u24 v11,7282,v10
v_lshrrev_b32 v11,16,v11
v_mul_u32_u24 v12,9,v11
v_sub_u32 v12,v10,v12
v_mul_u32_u24 v11,9216,v11
v_lshl_add_u32 v11,v12,7,v11
buffer_load_dword v246,v11,s[60:63],s45 offen
s_add_u32 s37,s32,0
s_and_b32 s37,s37,3
s_lshl_b32 s37,s37,6
s_add_u32 s37,s37,s33
s_mul_i32 s46,s37,1152
s_add_u32 s37,s32,1
s_and_b32 s37,s37,3
s_lshl_b32 s37,s37,6
s_add_u32 s37,s37,s33
s_mul_i32 s47,s37,1152
s_add_u32 s37,s32,2
s_and_b32 s37,s37,3
s_lshl_b32 s37,s37,6
s_add_u32 s37,s37,s33
s_mul_i32 s48,s37,1152
s_add_u32 s37,s32,3
s_and_b32 s37,s37,3
s_lshl_b32 s37,s37,6
s_add_u32 s37,s37,s33
s_mul_i32 s49,s37,1152
s_mul_i32 s88,s34,1152
s_xor_b32 s43,s31,1
s_mul_i32 s44,s43,288
s_and_b32 s43,s43,1
s_lshl_b32 s40,s43,5
s_add_u32 s40,s40,s44
s_xor_b32 s43,s43,1
s_lshl_b32 s43,s43,8
s_add_u32 s43,s43,s44
s_mul_i32 s89,s43,1152
s_add_u32 s37,s32,0
s_and_b32 s37,s37,3
s_lshl_b32 s37,s37,6
s_add_u32 s37,s37,s40
s_mul_i32 s84,s37,1152
s_add_u32 s37,s32,1
s_and_b32 s37,s37,3
s_lshl_b32 s37,s37,6
s_add_u32 s37,s37,s40
s_mul_i32 s85,s37,1152
s_add_u32 s37,s32,2
s_and_b32 s37,s37,3
s_lshl_b32 s37,s37,6
s_add_u32 s37,s37,s40
s_mul_i32 s86,s37,1152
s_add_u32 s37,s32,3
s_and_b32 s37,s37,3
s_lshl_b32 s37,s37,6
s_add_u32 s37,s37,s40
s_mul_i32 s87,s37,1152
s_and_b32 s43,s31,1
s_mul_i32 s44,s43,640
s_and_b32 s37,s30,1
s_lshl_b32 s37,s37,8
s_add_u32 s90,s44,s37
s_xor_b32 s37,s37,256
s_add_u32 s91,s44,s37
s_lshl_b32 s43,s43,6
s_add_u32 s92,s43,512
s_mul_i32 s93,s2,73728
s_xor_b32 s37,s2,8
s_mul_i32 s94,s37,73728
s_mul_i32 s37,s41,18432
s_add_u32 s93,s93,s37
s_add_u32 s94,s94,s37
v_bfe_u32 v3,v255,2,2
v_and_b32 v4,3,v255
v_lshl_add_u32 v5,v2,2,v3
v_bfe_u32 v6,v5,1,2
s_lshl_b32 s37,s42,1
v_xor_b32 v6,s37,v6
v_lshlrev_b32 v7,7,v5
v_lshl_add_u32 v7,v4,3,v7
v_lshl_add_u32 v242,v6,5,v7
v_xor_b32 v243,32,v242
v_and_b32 v6,1,v2
v_xor_b32 v6,s42,v6
v_lshlrev_b32 v7,6,v5
v_lshl_add_u32 v7,v4,3,v7
v_lshl_add_u32 v244,v6,5,v7
s_mul_i32 s37,s41,18432
s_add_u32 s37,s37,65536
v_add_u32 v247,s37,v254
s_lshl_b32 s37,s42,11
v_add_u32 v253,s37,v247
s_lshl_b32 s37,s41,11
s_add_u32 s37,s37,65536
v_add_u32 v252,s37,v254
s_mov_b32 s8,s24
s_mov_b32 s9,s25
s_mov_b32 s10,5308416
s_mov_b32 s11,0x20000
s_add_u32 s64,s26,5898240
s_addc_u32 s65,s27,0
s_mov_b32 s66,131072
s_mov_b32 s67,0x20000
s_add_u32 s68,s26,25165824
s_addc_u32 s69,s27,0
s_mov_b32 s70,18874368
s_mov_b32 s71,0x20000
s_waitcnt vmcnt(2)
v_add_f32 v16,v16,v17
v_add_f32 v18,v18,v19
v_add_f32 v20,v20,v21
v_add_f32 v22,v22,v23
v_add_f32 v16,v16,v18
v_add_f32 v20,v20,v22
v_add_f32 v16,v16,v20
v_add_f32 v16,v16,v24
v_mov_b32 v17,v16
s_nop 1
v_permlane32_swap_b32 v16,v17
s_nop 0
v_add_f32 v16,v16,v17
v_mov_b32 v20,v16
s_nop 1
v_permlane16_swap_b32 v16,v20
s_nop 0
v_mov_b32 v17,925353388
s_mov_b32 s95,987991609
v_fma_f32 v238,v16,s95,v17
v_rsq_f32 v16,v238
s_nop 0
s_mov_b32 s95,3222493025
v_mul_f32 v236,s95,v16
v_mul_f32 v17,v16,v16
v_mul_f32 v17,v17,v16
s_mov_b32 s95,3184710632
v_mul_f32 v237,s95,v17
v_mov_b32 v21,925353388
s_mov_b32 s95,987991609
v_fma_f32 v241,v20,s95,v21
v_rsq_f32 v20,v241
s_nop 0
s_mov_b32 s95,3222493025
v_mul_f32 v239,s95,v20
v_mul_f32 v21,v20,v20
v_mul_f32 v21,v21,v20
s_mov_b32 s95,3184710632
v_mul_f32 v240,s95,v21
s_lshr_b32 s37,s31,1
s_mul_i32 s37,s37,2359296
s_add_u32 s37,s37,6291456
s_add_u32 s16,s26,s37
s_addc_u32 s17,s27,0
s_mov_b32 s18,2359296
s_mov_b32 s19,0x20000
s_lshl_b32 s37,s30,3
s_lshl_b32 s43,s41,1
s_add_u32 s37,s37,s43
s_mul_i32 s39,s37,18432
s_barrier
ds_read_b128 v[0:3],v252 offset:0
ds_read_b128 v[4:7],v252 offset:1024
ds_read_b64_tr_b16 v[208:209],v242 offset:0
ds_read_b64_tr_b16 v[210:211],v242 offset:2048
ds_read_b64_tr_b16 v[212:213],v243 offset:0
ds_read_b64_tr_b16 v[214:215],v243 offset:2048
ds_read_b64_tr_b16 v[216:217],v242 offset:4096
ds_read_b64_tr_b16 v[218:219],v242 offset:6144
s_waitcnt lgkmcnt(4)
v_mfma_f32_16x16x32_bf16 v[144:147],v[208:211],v[0:3],0
ds_read_b64_tr_b16 v[220:221],v243 offset:4096
v_mfma_f32_16x16x32_bf16 v[148:151],v[208:211],v[4:7],0
ds_read_b64_tr_b16 v[222:223],v243 offset:6144
s_waitcnt lgkmcnt(4)
v_mfma_f32_16x16x32_bf16 v[152:155],v[212:215],v[0:3],0
ds_read_b64_tr_b16 v[208:209],v242 offset:8192
v_mfma_f32_16x16x32_bf16 v[156:159],v[212:215],v[4:7],0
ds_read_b64_tr_b16 v[210:211],v242 offset:10240
s_waitcnt lgkmcnt(4)
v_mfma_f32_16x16x32_bf16 v[160:163],v[216:219],v[0:3],0
ds_read_b64_tr_b16 v[212:213],v243 offset:8192
v_mfma_f32_16x16x32_bf16 v[164:167],v[216:219],v[4:7],0
ds_read_b64_tr_b16 v[214:215],v243 offset:10240
s_waitcnt lgkmcnt(4)
v_mfma_f32_16x16x32_bf16 v[168:171],v[220:223],v[0:3],0
ds_read_b64_tr_b16 v[216:217],v242 offset:12288
v_mfma_f32_16x16x32_bf16 v[172:175],v[220:223],v[4:7],0
ds_read_b64_tr_b16 v[218:219],v242 offset:14336
ds_read_b128 v[8:11],v252 offset:8192
ds_read_b128 v[12:15],v252 offset:9216
s_waitcnt lgkmcnt(0)
v_mfma_f32_16x16x32_bf16 v[144:147],v[208:211],v[8:11],v[144:147]
ds_read_b64_tr_b16 v[220:221],v243 offset:12288
v_mfma_f32_16x16x32_bf16 v[148:151],v[208:211],v[12:15],v[148:151]
ds_read_b64_tr_b16 v[222:223],v243 offset:14336
v_mfma_f32_16x16x32_bf16 v[152:155],v[212:215],v[8:11],v[152:155]
ds_read_b64_tr_b16 v[208:209],v242 offset:16384
v_mfma_f32_16x16x32_bf16 v[156:159],v[212:215],v[12:15],v[156:159]
ds_read_b64_tr_b16 v[210:211],v242 offset:18432
v_mfma_f32_16x16x32_bf16 v[160:163],v[216:219],v[8:11],v[160:163]
ds_read_b64_tr_b16 v[212:213],v243 offset:16384
v_mfma_f32_16x16x32_bf16 v[164:167],v[216:219],v[12:15],v[164:167]
ds_read_b64_tr_b16 v[214:215],v243 offset:18432
s_waitcnt lgkmcnt(4)
v_mfma_f32_16x16x32_bf16 v[168:171],v[220:223],v[8:11],v[168:171]
ds_read_b64_tr_b16 v[216:217],v242 offset:20480
v_mfma_f32_16x16x32_bf16 v[172:175],v[220:223],v[12:15],v[172:175]
ds_read_b64_tr_b16 v[218:219],v242 offset:22528
ds_read_b128 v[16:19],v252 offset:16384
ds_read_b128 v[20:23],v252 offset:17408
s_barrier
s_waitcnt lgkmcnt(0)
v_mfma_f32_16x16x32_bf16 v[144:147],v[208:211],v[16:19],v[144:147]
ds_read_b64_tr_b16 v[220:221],v243 offset:20480
v_mfma_f32_16x16x32_bf16 v[148:151],v[208:211],v[20:23],v[148:151]
ds_read_b64_tr_b16 v[222:223],v243 offset:22528
v_mfma_f32_16x16x32_bf16 v[152:155],v[212:215],v[16:19],v[152:155]
ds_read_b64_tr_b16 v[208:209],v242 offset:24576
v_mfma_f32_16x16x32_bf16 v[156:159],v[212:215],v[20:23],v[156:159]
ds_read_b64_tr_b16 v[210:211],v242 offset:26624
v_mfma_f32_16x16x32_bf16 v[160:163],v[216:219],v[16:19],v[160:163]
ds_read_b64_tr_b16 v[212:213],v243 offset:24576
v_mfma_f32_16x16x32_bf16 v[164:167],v[216:219],v[20:23],v[164:167]
ds_read_b64_tr_b16 v[214:215],v243 offset:26624
s_waitcnt lgkmcnt(4)
v_mfma_f32_16x16x32_bf16 v[168:171],v[220:223],v[16:19],v[168:171]
ds_read_b64_tr_b16 v[216:217],v242 offset:28672
v_mfma_f32_16x16x32_bf16 v[172:175],v[220:223],v[20:23],v[172:175]
ds_read_b64_tr_b16 v[218:219],v242 offset:30720
ds_read_b128 v[24:27],v252 offset:24576
ds_read_b128 v[28:31],v252 offset:25600
s_waitcnt lgkmcnt(0)
v_mfma_f32_16x16x32_bf16 v[144:147],v[208:211],v[24:27],v[144:147]
ds_read_b64_tr_b16 v[220:221],v243 offset:28672
v_mfma_f32_16x16x32_bf16 v[148:151],v[208:211],v[28:31],v[148:151]
ds_read_b64_tr_b16 v[222:223],v243 offset:30720
v_mfma_f32_16x16x32_bf16 v[152:155],v[212:215],v[24:27],v[152:155]
ds_read_b64_tr_b16 v[208:209],v242 offset:32768
v_mfma_f32_16x16x32_bf16 v[156:159],v[212:215],v[28:31],v[156:159]
ds_read_b64_tr_b16 v[210:211],v242 offset:34816
v_mfma_f32_16x16x32_bf16 v[160:163],v[216:219],v[24:27],v[160:163]
ds_read_b64_tr_b16 v[212:213],v243 offset:32768
v_mfma_f32_16x16x32_bf16 v[164:167],v[216:219],v[28:31],v[164:167]
ds_read_b64_tr_b16 v[214:215],v243 offset:34816
s_waitcnt lgkmcnt(4)
v_mfma_f32_16x16x32_bf16 v[168:171],v[220:223],v[24:27],v[168:171]
ds_read_b64_tr_b16 v[216:217],v242 offset:36864
v_mfma_f32_16x16x32_bf16 v[172:175],v[220:223],v[28:31],v[172:175]
ds_read_b64_tr_b16 v[218:219],v242 offset:38912
ds_read_b128 v[32:35],v252 offset:32768
ds_read_b128 v[36:39],v252 offset:33792
s_barrier
s_waitcnt lgkmcnt(0)
v_mfma_f32_16x16x32_bf16 v[144:147],v[208:211],v[32:35],v[144:147]
ds_read_b64_tr_b16 v[220:221],v243 offset:36864
v_mfma_f32_16x16x32_bf16 v[148:151],v[208:211],v[36:39],v[148:151]
ds_read_b64_tr_b16 v[222:223],v243 offset:38912
v_mfma_f32_16x16x32_bf16 v[152:155],v[212:215],v[32:35],v[152:155]
ds_read_b64_tr_b16 v[208:209],v242 offset:40960
v_mfma_f32_16x16x32_bf16 v[156:159],v[212:215],v[36:39],v[156:159]
ds_read_b64_tr_b16 v[210:211],v242 offset:43008
v_mfma_f32_16x16x32_bf16 v[160:163],v[216:219],v[32:35],v[160:163]
ds_read_b64_tr_b16 v[212:213],v243 offset:40960
v_mfma_f32_16x16x32_bf16 v[164:167],v[216:219],v[36:39],v[164:167]
ds_read_b64_tr_b16 v[214:215],v243 offset:43008
s_waitcnt lgkmcnt(4)
v_mfma_f32_16x16x32_bf16 v[168:171],v[220:223],v[32:35],v[168:171]
ds_read_b64_tr_b16 v[216:217],v242 offset:45056
v_mfma_f32_16x16x32_bf16 v[172:175],v[220:223],v[36:39],v[172:175]
ds_read_b64_tr_b16 v[218:219],v242 offset:47104
ds_read_b128 v[40:43],v252 offset:40960
ds_read_b128 v[44:47],v252 offset:41984
s_waitcnt lgkmcnt(0)
v_mfma_f32_16x16x32_bf16 v[144:147],v[208:211],v[40:43],v[144:147]
ds_read_b64_tr_b16 v[220:221],v243 offset:45056
v_mfma_f32_16x16x32_bf16 v[148:151],v[208:211],v[44:47],v[148:151]
ds_read_b64_tr_b16 v[222:223],v243 offset:47104
v_mfma_f32_16x16x32_bf16 v[152:155],v[212:215],v[40:43],v[152:155]
ds_read_b64_tr_b16 v[208:209],v242 offset:49152
v_mfma_f32_16x16x32_bf16 v[156:159],v[212:215],v[44:47],v[156:159]
ds_read_b64_tr_b16 v[210:211],v242 offset:51200
v_mfma_f32_16x16x32_bf16 v[160:163],v[216:219],v[40:43],v[160:163]
ds_read_b64_tr_b16 v[212:213],v243 offset:49152
v_mfma_f32_16x16x32_bf16 v[164:167],v[216:219],v[44:47],v[164:167]
ds_read_b64_tr_b16 v[214:215],v243 offset:51200
s_waitcnt lgkmcnt(4)
v_mfma_f32_16x16x32_bf16 v[168:171],v[220:223],v[40:43],v[168:171]
ds_read_b64_tr_b16 v[216:217],v242 offset:53248
v_mfma_f32_16x16x32_bf16 v[172:175],v[220:223],v[44:47],v[172:175]
ds_read_b64_tr_b16 v[218:219],v242 offset:55296
ds_read_b128 v[48:51],v252 offset:49152
ds_read_b128 v[52:55],v252 offset:50176
s_barrier
s_waitcnt lgkmcnt(0)
v_mfma_f32_16x16x32_bf16 v[144:147],v[208:211],v[48:51],v[144:147]
ds_read_b64_tr_b16 v[220:221],v243 offset:53248
v_mfma_f32_16x16x32_bf16 v[148:151],v[208:211],v[52:55],v[148:151]
ds_read_b64_tr_b16 v[222:223],v243 offset:55296
v_mfma_f32_16x16x32_bf16 v[152:155],v[212:215],v[48:51],v[152:155]
ds_read_b64_tr_b16 v[208:209],v242 offset:57344
v_mfma_f32_16x16x32_bf16 v[156:159],v[212:215],v[52:55],v[156:159]
ds_read_b64_tr_b16 v[210:211],v242 offset:59392
v_mfma_f32_16x16x32_bf16 v[160:163],v[216:219],v[48:51],v[160:163]
ds_read_b64_tr_b16 v[212:213],v243 offset:57344
v_mfma_f32_16x16x32_bf16 v[164:167],v[216:219],v[52:55],v[164:167]
ds_read_b64_tr_b16 v[214:215],v243 offset:59392
s_waitcnt lgkmcnt(4)
v_mfma_f32_16x16x32_bf16 v[168:171],v[220:223],v[48:51],v[168:171]
ds_read_b64_tr_b16 v[216:217],v242 offset:61440
v_mfma_f32_16x16x32_bf16 v[172:175],v[220:223],v[52:55],v[172:175]
ds_read_b64_tr_b16 v[218:219],v242 offset:63488
ds_read_b128 v[56:59],v252 offset:57344
ds_read_b128 v[60:63],v252 offset:58368
s_waitcnt lgkmcnt(0)
v_mfma_f32_16x16x32_bf16 v[144:147],v[208:211],v[56:59],v[144:147]
ds_read_b64_tr_b16 v[220:221],v243 offset:61440
v_mfma_f32_16x16x32_bf16 v[148:151],v[208:211],v[60:63],v[148:151]
ds_read_b64_tr_b16 v[222:223],v243 offset:63488
v_mfma_f32_16x16x32_bf16 v[152:155],v[212:215],v[56:59],v[152:155]
ds_read_b64_tr_b16 v[208:209],v242 offset:0
v_mfma_f32_16x16x32_bf16 v[156:159],v[212:215],v[60:63],v[156:159]
ds_read_b64_tr_b16 v[210:211],v242 offset:2048
v_mfma_f32_16x16x32_bf16 v[160:163],v[216:219],v[56:59],v[160:163]
ds_read_b64_tr_b16 v[212:213],v243 offset:0
v_mfma_f32_16x16x32_bf16 v[164:167],v[216:219],v[60:63],v[164:167]
ds_read_b64_tr_b16 v[214:215],v243 offset:2048
s_waitcnt lgkmcnt(4)
v_mfma_f32_16x16x32_bf16 v[168:171],v[220:223],v[56:59],v[168:171]
ds_read_b64_tr_b16 v[216:217],v242 offset:4096
v_mfma_f32_16x16x32_bf16 v[172:175],v[220:223],v[60:63],v[172:175]
ds_read_b64_tr_b16 v[218:219],v242 offset:6144
ds_read_b128 v[64:67],v252 offset:0
ds_read_b128 v[68:71],v252 offset:1024
s_barrier
s_waitcnt lgkmcnt(0)
v_mfma_f32_16x16x32_bf16 v[144:147],v[208:211],v[64:67],v[144:147]
ds_read_b64_tr_b16 v[220:221],v243 offset:4096
v_mfma_f32_16x16x32_bf16 v[148:151],v[208:211],v[68:71],v[148:151]
ds_read_b64_tr_b16 v[222:223],v243 offset:6144
v_mfma_f32_16x16x32_bf16 v[152:155],v[212:215],v[64:67],v[152:155]
ds_read_b64_tr_b16 v[208:209],v242 offset:8192
v_mfma_f32_16x16x32_bf16 v[156:159],v[212:215],v[68:71],v[156:159]
ds_read_b64_tr_b16 v[210:211],v242 offset:10240
v_mfma_f32_16x16x32_bf16 v[160:163],v[216:219],v[64:67],v[160:163]
ds_read_b64_tr_b16 v[212:213],v243 offset:8192
v_mfma_f32_16x16x32_bf16 v[164:167],v[216:219],v[68:71],v[164:167]
ds_read_b64_tr_b16 v[214:215],v243 offset:10240
s_waitcnt lgkmcnt(4)
v_mfma_f32_16x16x32_bf16 v[168:171],v[220:223],v[64:67],v[168:171]
ds_read_b64_tr_b16 v[216:217],v242 offset:12288
v_mfma_f32_16x16x32_bf16 v[172:175],v[220:223],v[68:71],v[172:175]
ds_read_b64_tr_b16 v[218:219],v242 offset:14336
ds_read_b128 v[72:75],v252 offset:8192
ds_read_b128 v[76:79],v252 offset:9216
s_waitcnt lgkmcnt(0)
v_mfma_f32_16x16x32_bf16 v[144:147],v[208:211],v[72:75],v[144:147]
ds_read_b64_tr_b16 v[220:221],v243 offset:12288
v_mfma_f32_16x16x32_bf16 v[148:151],v[208:211],v[76:79],v[148:151]
ds_read_b64_tr_b16 v[222:223],v243 offset:14336
v_mfma_f32_16x16x32_bf16 v[152:155],v[212:215],v[72:75],v[152:155]
ds_read_b64_tr_b16 v[208:209],v242 offset:16384
v_mfma_f32_16x16x32_bf16 v[156:159],v[212:215],v[76:79],v[156:159]
ds_read_b64_tr_b16 v[210:211],v242 offset:18432
v_mfma_f32_16x16x32_bf16 v[160:163],v[216:219],v[72:75],v[160:163]
ds_read_b64_tr_b16 v[212:213],v243 offset:16384
v_mfma_f32_16x16x32_bf16 v[164:167],v[216:219],v[76:79],v[164:167]
ds_read_b64_tr_b16 v[214:215],v243 offset:18432
s_waitcnt lgkmcnt(4)
v_mfma_f32_16x16x32_bf16 v[168:171],v[220:223],v[72:75],v[168:171]
ds_read_b64_tr_b16 v[216:217],v242 offset:20480
v_mfma_f32_16x16x32_bf16 v[172:175],v[220:223],v[76:79],v[172:175]
ds_read_b64_tr_b16 v[218:219],v242 offset:22528
ds_read_b128 v[80:83],v252 offset:16384
ds_read_b128 v[84:87],v252 offset:17408
s_barrier
s_waitcnt lgkmcnt(0)
v_mfma_f32_16x16x32_bf16 v[144:147],v[208:211],v[80:83],v[144:147]
ds_read_b64_tr_b16 v[220:221],v243 offset:20480
v_mfma_f32_16x16x32_bf16 v[148:151],v[208:211],v[84:87],v[148:151]
ds_read_b64_tr_b16 v[222:223],v243 offset:22528
v_mfma_f32_16x16x32_bf16 v[152:155],v[212:215],v[80:83],v[152:155]
ds_read_b64_tr_b16 v[208:209],v242 offset:24576
v_mfma_f32_16x16x32_bf16 v[156:159],v[212:215],v[84:87],v[156:159]
ds_read_b64_tr_b16 v[210:211],v242 offset:26624
v_mfma_f32_16x16x32_bf16 v[160:163],v[216:219],v[80:83],v[160:163]
ds_read_b64_tr_b16 v[212:213],v243 offset:24576
v_mfma_f32_16x16x32_bf16 v[164:167],v[216:219],v[84:87],v[164:167]
ds_read_b64_tr_b16 v[214:215],v243 offset:26624
s_waitcnt lgkmcnt(4)
v_mfma_f32_16x16x32_bf16 v[168:171],v[220:223],v[80:83],v[168:171]
ds_read_b64_tr_b16 v[216:217],v242 offset:28672
v_mfma_f32_16x16x32_bf16 v[172:175],v[220:223],v[84:87],v[172:175]
ds_read_b64_tr_b16 v[218:219],v242 offset:30720
ds_read_b128 v[88:91],v252 offset:24576
ds_read_b128 v[92:95],v252 offset:25600
s_waitcnt lgkmcnt(0)
v_mfma_f32_16x16x32_bf16 v[144:147],v[208:211],v[88:91],v[144:147]
ds_read_b64_tr_b16 v[220:221],v243 offset:28672
v_mfma_f32_16x16x32_bf16 v[148:151],v[208:211],v[92:95],v[148:151]
ds_read_b64_tr_b16 v[222:223],v243 offset:30720
v_mfma_f32_16x16x32_bf16 v[152:155],v[212:215],v[88:91],v[152:155]
ds_read_b64_tr_b16 v[208:209],v242 offset:32768
v_mfma_f32_16x16x32_bf16 v[156:159],v[212:215],v[92:95],v[156:159]
ds_read_b64_tr_b16 v[210:211],v242 offset:34816
v_mfma_f32_16x16x32_bf16 v[160:163],v[216:219],v[88:91],v[160:163]
ds_read_b64_tr_b16 v[212:213],v243 offset:32768
v_mfma_f32_16x16x32_bf16 v[164:167],v[216:219],v[92:95],v[164:167]
ds_read_b64_tr_b16 v[214:215],v243 offset:34816
s_waitcnt lgkmcnt(4)
v_mfma_f32_16x16x32_bf16 v[168:171],v[220:223],v[88:91],v[168:171]
ds_read_b64_tr_b16 v[216:217],v242 offset:36864
v_mfma_f32_16x16x32_bf16 v[172:175],v[220:223],v[92:95],v[172:175]
ds_read_b64_tr_b16 v[218:219],v242 offset:38912
ds_read_b128 v[96:99],v252 offset:32768
ds_read_b128 v[100:103],v252 offset:33792
s_barrier
s_waitcnt lgkmcnt(0)
v_mfma_f32_16x16x32_bf16 v[144:147],v[208:211],v[96:99],v[144:147]
ds_read_b64_tr_b16 v[220:221],v243 offset:36864
v_mfma_f32_16x16x32_bf16 v[148:151],v[208:211],v[100:103],v[148:151]
ds_read_b64_tr_b16 v[222:223],v243 offset:38912
v_mfma_f32_16x16x32_bf16 v[152:155],v[212:215],v[96:99],v[152:155]
ds_read_b64_tr_b16 v[208:209],v242 offset:40960
v_mfma_f32_16x16x32_bf16 v[156:159],v[212:215],v[100:103],v[156:159]
ds_read_b64_tr_b16 v[210:211],v242 offset:43008
v_mfma_f32_16x16x32_bf16 v[160:163],v[216:219],v[96:99],v[160:163]
ds_read_b64_tr_b16 v[212:213],v243 offset:40960
v_mfma_f32_16x16x32_bf16 v[164:167],v[216:219],v[100:103],v[164:167]
ds_read_b64_tr_b16 v[214:215],v243 offset:43008
s_waitcnt lgkmcnt(4)
v_mfma_f32_16x16x32_bf16 v[168:171],v[220:223],v[96:99],v[168:171]
ds_read_b64_tr_b16 v[216:217],v242 offset:45056
v_mfma_f32_16x16x32_bf16 v[172:175],v[220:223],v[100:103],v[172:175]
ds_read_b64_tr_b16 v[218:219],v242 offset:47104
ds_read_b128 v[104:107],v252 offset:40960
ds_read_b128 v[108:111],v252 offset:41984
s_waitcnt lgkmcnt(0)
v_mfma_f32_16x16x32_bf16 v[144:147],v[208:211],v[104:107],v[144:147]
ds_read_b64_tr_b16 v[220:221],v243 offset:45056
v_mfma_f32_16x16x32_bf16 v[148:151],v[208:211],v[108:111],v[148:151]
ds_read_b64_tr_b16 v[222:223],v243 offset:47104
v_mfma_f32_16x16x32_bf16 v[152:155],v[212:215],v[104:107],v[152:155]
ds_read_b64_tr_b16 v[208:209],v242 offset:49152
v_mfma_f32_16x16x32_bf16 v[156:159],v[212:215],v[108:111],v[156:159]
ds_read_b64_tr_b16 v[210:211],v242 offset:51200
v_mfma_f32_16x16x32_bf16 v[160:163],v[216:219],v[104:107],v[160:163]
ds_read_b64_tr_b16 v[212:213],v243 offset:49152
v_mfma_f32_16x16x32_bf16 v[164:167],v[216:219],v[108:111],v[164:167]
ds_read_b64_tr_b16 v[214:215],v243 offset:51200
s_waitcnt lgkmcnt(4)
v_mfma_f32_16x16x32_bf16 v[168:171],v[220:223],v[104:107],v[168:171]
ds_read_b64_tr_b16 v[216:217],v242 offset:53248
v_mfma_f32_16x16x32_bf16 v[172:175],v[220:223],v[108:111],v[172:175]
ds_read_b64_tr_b16 v[218:219],v242 offset:55296
ds_read_b128 v[112:115],v252 offset:49152
ds_read_b128 v[116:119],v252 offset:50176
s_barrier
s_waitcnt lgkmcnt(0)
v_mfma_f32_16x16x32_bf16 v[144:147],v[208:211],v[112:115],v[144:147]
ds_read_b64_tr_b16 v[220:221],v243 offset:53248
v_mfma_f32_16x16x32_bf16 v[148:151],v[208:211],v[116:119],v[148:151]
ds_read_b64_tr_b16 v[222:223],v243 offset:55296
v_mfma_f32_16x16x32_bf16 v[152:155],v[212:215],v[112:115],v[152:155]
ds_read_b64_tr_b16 v[208:209],v242 offset:57344
v_mfma_f32_16x16x32_bf16 v[156:159],v[212:215],v[116:119],v[156:159]
ds_read_b64_tr_b16 v[210:211],v242 offset:59392
v_mfma_f32_16x16x32_bf16 v[160:163],v[216:219],v[112:115],v[160:163]
ds_read_b64_tr_b16 v[212:213],v243 offset:57344
v_mfma_f32_16x16x32_bf16 v[164:167],v[216:219],v[116:119],v[164:167]
ds_read_b64_tr_b16 v[214:215],v243 offset:59392
s_waitcnt lgkmcnt(4)
v_mfma_f32_16x16x32_bf16 v[168:171],v[220:223],v[112:115],v[168:171]
ds_read_b64_tr_b16 v[216:217],v242 offset:61440
v_mfma_f32_16x16x32_bf16 v[172:175],v[220:223],v[116:119],v[172:175]
ds_read_b64_tr_b16 v[218:219],v242 offset:63488
ds_read_b128 v[120:123],v252 offset:57344
ds_read_b128 v[124:127],v252 offset:58368
s_waitcnt lgkmcnt(0)
v_mfma_f32_16x16x32_bf16 v[144:147],v[208:211],v[120:123],v[144:147]
ds_read_b64_tr_b16 v[220:221],v243 offset:61440
v_mfma_f32_16x16x32_bf16 v[148:151],v[208:211],v[124:127],v[148:151]
ds_read_b64_tr_b16 v[222:223],v243 offset:63488
v_mfma_f32_16x16x32_bf16 v[152:155],v[212:215],v[120:123],v[152:155]
ds_read_b64_tr_b16 v[208:209],v242 offset:0
v_mfma_f32_16x16x32_bf16 v[156:159],v[212:215],v[124:127],v[156:159]
ds_read_b64_tr_b16 v[210:211],v242 offset:2048
v_mfma_f32_16x16x32_bf16 v[160:163],v[216:219],v[120:123],v[160:163]
ds_read_b64_tr_b16 v[212:213],v243 offset:0
v_mfma_f32_16x16x32_bf16 v[164:167],v[216:219],v[124:127],v[164:167]
ds_read_b64_tr_b16 v[214:215],v243 offset:2048
s_waitcnt lgkmcnt(4)
v_mfma_f32_16x16x32_bf16 v[168:171],v[220:223],v[120:123],v[168:171]
ds_read_b64_tr_b16 v[216:217],v242 offset:4096
v_mfma_f32_16x16x32_bf16 v[172:175],v[220:223],v[124:127],v[172:175]
ds_read_b64_tr_b16 v[218:219],v242 offset:6144
ds_read_b128 v[128:131],v252 offset:0
ds_read_b128 v[132:135],v252 offset:1024
s_barrier
s_waitcnt lgkmcnt(0)
v_mfma_f32_16x16x32_bf16 v[144:147],v[208:211],v[128:131],v[144:147]
ds_read_b64_tr_b16 v[220:221],v243 offset:4096
v_mfma_f32_16x16x32_bf16 v[148:151],v[208:211],v[132:135],v[148:151]
ds_read_b64_tr_b16 v[222:223],v243 offset:6144
v_mfma_f32_16x16x32_bf16 v[152:155],v[212:215],v[128:131],v[152:155]
ds_read_b64_tr_b16 v[208:209],v242 offset:8192
v_mfma_f32_16x16x32_bf16 v[156:159],v[212:215],v[132:135],v[156:159]
ds_read_b64_tr_b16 v[210:211],v242 offset:10240
v_mfma_f32_16x16x32_bf16 v[160:163],v[216:219],v[128:131],v[160:163]
ds_read_b64_tr_b16 v[212:213],v243 offset:8192
v_mfma_f32_16x16x32_bf16 v[164:167],v[216:219],v[132:135],v[164:167]
ds_read_b64_tr_b16 v[214:215],v243 offset:10240
s_waitcnt lgkmcnt(4)
v_mfma_f32_16x16x32_bf16 v[168:171],v[220:223],v[128:131],v[168:171]
ds_read_b64_tr_b16 v[216:217],v242 offset:12288
v_mfma_f32_16x16x32_bf16 v[172:175],v[220:223],v[132:135],v[172:175]
ds_read_b64_tr_b16 v[218:219],v242 offset:14336
ds_read_b128 v[136:139],v252 offset:8192
ds_read_b128 v[140:143],v252 offset:9216
s_waitcnt lgkmcnt(0)
v_mfma_f32_16x16x32_bf16 v[144:147],v[208:211],v[136:139],v[144:147]
ds_read_b64_tr_b16 v[220:221],v243 offset:12288
v_mfma_f32_16x16x32_bf16 v[148:151],v[208:211],v[140:143],v[148:151]
ds_read_b64_tr_b16 v[222:223],v243 offset:14336
v_mfma_f32_16x16x32_bf16 v[152:155],v[212:215],v[136:139],v[152:155]
ds_read_b64_tr_b16 v[208:209],v242 offset:16384
v_mfma_f32_16x16x32_bf16 v[156:159],v[212:215],v[140:143],v[156:159]
ds_read_b64_tr_b16 v[210:211],v242 offset:18432
v_mfma_f32_16x16x32_bf16 v[160:163],v[216:219],v[136:139],v[160:163]
ds_read_b64_tr_b16 v[212:213],v243 offset:16384
v_mfma_f32_16x16x32_bf16 v[164:167],v[216:219],v[140:143],v[164:167]
ds_read_b64_tr_b16 v[214:215],v243 offset:18432
s_waitcnt lgkmcnt(4)
v_mfma_f32_16x16x32_bf16 v[168:171],v[220:223],v[136:139],v[168:171]
ds_read_b64_tr_b16 v[216:217],v242 offset:20480
v_mfma_f32_16x16x32_bf16 v[172:175],v[220:223],v[140:143],v[172:175]
ds_read_b64_tr_b16 v[218:219],v242 offset:22528
s_barrier
s_waitcnt lgkmcnt(4)
v_mfma_f32_16x16x32_bf16 v[176:179],v[208:211],v[0:3],0
ds_read_b64_tr_b16 v[220:221],v243 offset:20480
v_mfma_f32_16x16x32_bf16 v[180:183],v[208:211],v[4:7],0
ds_read_b64_tr_b16 v[222:223],v243 offset:22528
s_waitcnt lgkmcnt(4)
v_mfma_f32_16x16x32_bf16 v[184:187],v[212:215],v[0:3],0
ds_read_b64_tr_b16 v[208:209],v242 offset:24576
v_mfma_f32_16x16x32_bf16 v[188:191],v[212:215],v[4:7],0
ds_read_b64_tr_b16 v[210:211],v242 offset:26624
s_waitcnt lgkmcnt(4)
v_mfma_f32_16x16x32_bf16 v[192:195],v[216:219],v[0:3],0
ds_read_b64_tr_b16 v[212:213],v243 offset:24576
v_mfma_f32_16x16x32_bf16 v[196:199],v[216:219],v[4:7],0
ds_read_b64_tr_b16 v[214:215],v243 offset:26624
s_waitcnt lgkmcnt(4)
v_mfma_f32_16x16x32_bf16 v[200:203],v[220:223],v[0:3],0
ds_read_b64_tr_b16 v[216:217],v242 offset:28672
v_mfma_f32_16x16x32_bf16 v[204:207],v[220:223],v[4:7],0
ds_read_b64_tr_b16 v[218:219],v242 offset:30720
s_waitcnt lgkmcnt(4)
v_mfma_f32_16x16x32_bf16 v[176:179],v[208:211],v[8:11],v[176:179]
ds_read_b64_tr_b16 v[220:221],v243 offset:28672
v_mul_f32 v232,v144,v144
v_mfma_f32_16x16x32_bf16 v[180:183],v[208:211],v[12:15],v[180:183]
ds_read_b64_tr_b16 v[222:223],v243 offset:30720
v_mul_f32 v233,v145,v145
s_waitcnt lgkmcnt(4)
v_mfma_f32_16x16x32_bf16 v[184:187],v[212:215],v[8:11],v[184:187]
ds_read_b64_tr_b16 v[208:209],v242 offset:32768
v_mul_f32 v234,v146,v146
v_mfma_f32_16x16x32_bf16 v[188:191],v[212:215],v[12:15],v[188:191]
ds_read_b64_tr_b16 v[210:211],v242 offset:34816
v_mul_f32 v235,v147,v147
s_waitcnt lgkmcnt(4)
v_mfma_f32_16x16x32_bf16 v[192:195],v[216:219],v[8:11],v[192:195]
ds_read_b64_tr_b16 v[212:213],v243 offset:32768
v_fma_f32 v232,v232,v237,v236
v_mfma_f32_16x16x32_bf16 v[196:199],v[216:219],v[12:15],v[196:199]
ds_read_b64_tr_b16 v[214:215],v243 offset:34816
v_fma_f32 v233,v233,v237,v236
s_waitcnt lgkmcnt(4)
v_mfma_f32_16x16x32_bf16 v[200:203],v[220:223],v[8:11],v[200:203]
ds_read_b64_tr_b16 v[216:217],v242 offset:36864
v_fma_f32 v234,v234,v237,v236
v_mfma_f32_16x16x32_bf16 v[204:207],v[220:223],v[12:15],v[204:207]
ds_read_b64_tr_b16 v[218:219],v242 offset:38912
v_fma_f32 v235,v235,v237,v236
s_barrier
s_waitcnt lgkmcnt(4)
v_mfma_f32_16x16x32_bf16 v[176:179],v[208:211],v[16:19],v[176:179]
ds_read_b64_tr_b16 v[220:221],v243 offset:36864
v_mul_f32 v232,v144,v232
v_mfma_f32_16x16x32_bf16 v[180:183],v[208:211],v[20:23],v[180:183]
ds_read_b64_tr_b16 v[222:223],v243 offset:38912
v_mul_f32 v233,v145,v233
s_waitcnt lgkmcnt(4)
v_mfma_f32_16x16x32_bf16 v[184:187],v[212:215],v[16:19],v[184:187]
ds_read_b64_tr_b16 v[208:209],v242 offset:40960
v_mul_f32 v234,v146,v234
v_mfma_f32_16x16x32_bf16 v[188:191],v[212:215],v[20:23],v[188:191]
ds_read_b64_tr_b16 v[210:211],v242 offset:43008
v_mul_f32 v235,v147,v235
s_waitcnt lgkmcnt(4)
v_mfma_f32_16x16x32_bf16 v[192:195],v[216:219],v[16:19],v[192:195]
ds_read_b64_tr_b16 v[212:213],v243 offset:40960
v_exp_f32 v232,v232
v_mfma_f32_16x16x32_bf16 v[196:199],v[216:219],v[20:23],v[196:199]
ds_read_b64_tr_b16 v[214:215],v243 offset:43008
v_exp_f32 v233,v233
s_waitcnt lgkmcnt(4)
v_mfma_f32_16x16x32_bf16 v[200:203],v[220:223],v[16:19],v[200:203]
ds_read_b64_tr_b16 v[216:217],v242 offset:45056
v_exp_f32 v234,v234
v_mfma_f32_16x16x32_bf16 v[204:207],v[220:223],v[20:23],v[204:207]
ds_read_b64_tr_b16 v[218:219],v242 offset:47104
v_exp_f32 v235,v235
v_mul_f32 v160,v144,v160
s_waitcnt lgkmcnt(4)
v_mfma_f32_16x16x32_bf16 v[176:179],v[208:211],v[24:27],v[176:179]
ds_read_b64_tr_b16 v[220:221],v243 offset:45056
v_mul_f32 v161,v145,v161
v_mfma_f32_16x16x32_bf16 v[180:183],v[208:211],v[28:31],v[180:183]
ds_read_b64_tr_b16 v[222:223],v243 offset:47104
v_mul_f32 v162,v146,v162
s_waitcnt lgkmcnt(4)
v_mfma_f32_16x16x32_bf16 v[184:187],v[212:215],v[24:27],v[184:187]
ds_read_b64_tr_b16 v[208:209],v242 offset:49152
v_mul_f32 v163,v147,v163
v_mfma_f32_16x16x32_bf16 v[188:191],v[212:215],v[28:31],v[188:191]
ds_read_b64_tr_b16 v[210:211],v242 offset:51200
v_fma_f32 v232,v232,v238,v238
s_waitcnt lgkmcnt(4)
v_mfma_f32_16x16x32_bf16 v[192:195],v[216:219],v[24:27],v[192:195]
ds_read_b64_tr_b16 v[212:213],v243 offset:49152
v_fma_f32 v233,v233,v238,v238
v_mfma_f32_16x16x32_bf16 v[196:199],v[216:219],v[28:31],v[196:199]
ds_read_b64_tr_b16 v[214:215],v243 offset:51200
v_fma_f32 v234,v234,v238,v238
s_waitcnt lgkmcnt(4)
v_mfma_f32_16x16x32_bf16 v[200:203],v[220:223],v[24:27],v[200:203]
ds_read_b64_tr_b16 v[216:217],v242 offset:53248
v_fma_f32 v235,v235,v238,v238
v_mfma_f32_16x16x32_bf16 v[204:207],v[220:223],v[28:31],v[204:207]
ds_read_b64_tr_b16 v[218:219],v242 offset:55296
v_rcp_f32 v232,v232
s_barrier
s_waitcnt lgkmcnt(4)
v_mfma_f32_16x16x32_bf16 v[176:179],v[208:211],v[32:35],v[176:179]
ds_read_b64_tr_b16 v[220:221],v243 offset:53248
v_rcp_f32 v233,v233
v_mfma_f32_16x16x32_bf16 v[180:183],v[208:211],v[36:39],v[180:183]
ds_read_b64_tr_b16 v[222:223],v243 offset:55296
v_rcp_f32 v234,v234
s_waitcnt lgkmcnt(4)
v_mfma_f32_16x16x32_bf16 v[184:187],v[212:215],v[32:35],v[184:187]
ds_read_b64_tr_b16 v[208:209],v242 offset:57344
v_rcp_f32 v235,v235
v_mfma_f32_16x16x32_bf16 v[188:191],v[212:215],v[36:39],v[188:191]
ds_read_b64_tr_b16 v[210:211],v242 offset:59392
v_mul_f32 v160,v160,v232
s_waitcnt lgkmcnt(4)
v_mfma_f32_16x16x32_bf16 v[192:195],v[216:219],v[32:35],v[192:195]
ds_read_b64_tr_b16 v[212:213],v243 offset:57344
v_mul_f32 v161,v161,v233
v_mfma_f32_16x16x32_bf16 v[196:199],v[216:219],v[36:39],v[196:199]
ds_read_b64_tr_b16 v[214:215],v243 offset:59392
v_mul_f32 v162,v162,v234
s_waitcnt lgkmcnt(4)
v_mfma_f32_16x16x32_bf16 v[200:203],v[220:223],v[32:35],v[200:203]
ds_read_b64_tr_b16 v[216:217],v242 offset:61440
v_mul_f32 v163,v163,v235
v_mfma_f32_16x16x32_bf16 v[204:207],v[220:223],v[36:39],v[204:207]
ds_read_b64_tr_b16 v[218:219],v242 offset:63488
v_cvt_pk_bf16_f32 v224,v160,v161
v_cvt_pk_bf16_f32 v225,v162,v163
s_waitcnt lgkmcnt(4)
v_mfma_f32_16x16x32_bf16 v[176:179],v[208:211],v[40:43],v[176:179]
ds_read_b64_tr_b16 v[220:221],v243 offset:61440
v_mul_f32 v232,v152,v152
v_mfma_f32_16x16x32_bf16 v[180:183],v[208:211],v[44:47],v[180:183]
ds_read_b64_tr_b16 v[222:223],v243 offset:63488
v_mul_f32 v233,v153,v153
s_waitcnt lgkmcnt(4)
v_mfma_f32_16x16x32_bf16 v[184:187],v[212:215],v[40:43],v[184:187]
ds_read_b64_tr_b16 v[208:209],v242 offset:0
v_mul_f32 v234,v154,v154
v_mfma_f32_16x16x32_bf16 v[188:191],v[212:215],v[44:47],v[188:191]
ds_read_b64_tr_b16 v[210:211],v242 offset:2048
v_mul_f32 v235,v155,v155
s_waitcnt lgkmcnt(4)
v_mfma_f32_16x16x32_bf16 v[192:195],v[216:219],v[40:43],v[192:195]
ds_read_b64_tr_b16 v[212:213],v243 offset:0
v_fma_f32 v232,v232,v237,v236
v_mfma_f32_16x16x32_bf16 v[196:199],v[216:219],v[44:47],v[196:199]
ds_read_b64_tr_b16 v[214:215],v243 offset:2048
v_fma_f32 v233,v233,v237,v236
s_waitcnt lgkmcnt(4)
v_mfma_f32_16x16x32_bf16 v[200:203],v[220:223],v[40:43],v[200:203]
ds_read_b64_tr_b16 v[216:217],v242 offset:4096
v_fma_f32 v234,v234,v237,v236
v_mfma_f32_16x16x32_bf16 v[204:207],v[220:223],v[44:47],v[204:207]
ds_read_b64_tr_b16 v[218:219],v242 offset:6144
v_fma_f32 v235,v235,v237,v236
s_barrier
s_waitcnt lgkmcnt(4)
v_mfma_f32_16x16x32_bf16 v[176:179],v[208:211],v[48:51],v[176:179]
ds_read_b64_tr_b16 v[220:221],v243 offset:4096
v_mul_f32 v232,v152,v232
v_mfma_f32_16x16x32_bf16 v[180:183],v[208:211],v[52:55],v[180:183]
ds_read_b64_tr_b16 v[222:223],v243 offset:6144
v_mul_f32 v233,v153,v233
s_waitcnt lgkmcnt(4)
v_mfma_f32_16x16x32_bf16 v[184:187],v[212:215],v[48:51],v[184:187]
ds_read_b64_tr_b16 v[208:209],v242 offset:8192
v_mul_f32 v234,v154,v234
v_mfma_f32_16x16x32_bf16 v[188:191],v[212:215],v[52:55],v[188:191]
ds_read_b64_tr_b16 v[210:211],v242 offset:10240
v_mul_f32 v235,v155,v235
s_waitcnt lgkmcnt(4)
v_mfma_f32_16x16x32_bf16 v[192:195],v[216:219],v[48:51],v[192:195]
ds_read_b64_tr_b16 v[212:213],v243 offset:8192
v_exp_f32 v232,v232
v_mfma_f32_16x16x32_bf16 v[196:199],v[216:219],v[52:55],v[196:199]
ds_read_b64_tr_b16 v[214:215],v243 offset:10240
v_exp_f32 v233,v233
s_waitcnt lgkmcnt(4)
v_mfma_f32_16x16x32_bf16 v[200:203],v[220:223],v[48:51],v[200:203]
ds_read_b64_tr_b16 v[216:217],v242 offset:12288
v_exp_f32 v234,v234
v_mfma_f32_16x16x32_bf16 v[204:207],v[220:223],v[52:55],v[204:207]
ds_read_b64_tr_b16 v[218:219],v242 offset:14336
v_exp_f32 v235,v235
v_mul_f32 v168,v152,v168
s_waitcnt lgkmcnt(4)
v_mfma_f32_16x16x32_bf16 v[176:179],v[208:211],v[56:59],v[176:179]
ds_read_b64_tr_b16 v[220:221],v243 offset:12288
v_mul_f32 v169,v153,v169
v_mfma_f32_16x16x32_bf16 v[180:183],v[208:211],v[60:63],v[180:183]
ds_read_b64_tr_b16 v[222:223],v243 offset:14336
v_mul_f32 v170,v154,v170
s_waitcnt lgkmcnt(4)
v_mfma_f32_16x16x32_bf16 v[184:187],v[212:215],v[56:59],v[184:187]
ds_read_b64_tr_b16 v[208:209],v242 offset:16384
v_mul_f32 v171,v155,v171
v_mfma_f32_16x16x32_bf16 v[188:191],v[212:215],v[60:63],v[188:191]
ds_read_b64_tr_b16 v[210:211],v242 offset:18432
v_fma_f32 v232,v232,v238,v238
s_waitcnt lgkmcnt(4)
v_mfma_f32_16x16x32_bf16 v[192:195],v[216:219],v[56:59],v[192:195]
ds_read_b64_tr_b16 v[212:213],v243 offset:16384
v_fma_f32 v233,v233,v238,v238
v_mfma_f32_16x16x32_bf16 v[196:199],v[216:219],v[60:63],v[196:199]
ds_read_b64_tr_b16 v[214:215],v243 offset:18432
v_fma_f32 v234,v234,v238,v238
s_waitcnt lgkmcnt(4)
v_mfma_f32_16x16x32_bf16 v[200:203],v[220:223],v[56:59],v[200:203]
ds_read_b64_tr_b16 v[216:217],v242 offset:20480
v_fma_f32 v235,v235,v238,v238
v_mfma_f32_16x16x32_bf16 v[204:207],v[220:223],v[60:63],v[204:207]
ds_read_b64_tr_b16 v[218:219],v242 offset:22528
v_rcp_f32 v232,v232
s_barrier
s_waitcnt lgkmcnt(4)
v_mfma_f32_16x16x32_bf16 v[176:179],v[208:211],v[64:67],v[176:179]
ds_read_b64_tr_b16 v[220:221],v243 offset:20480
v_rcp_f32 v233,v233
v_mfma_f32_16x16x32_bf16 v[180:183],v[208:211],v[68:71],v[180:183]
ds_read_b64_tr_b16 v[222:223],v243 offset:22528
v_rcp_f32 v234,v234
s_waitcnt lgkmcnt(4)
v_mfma_f32_16x16x32_bf16 v[184:187],v[212:215],v[64:67],v[184:187]
ds_read_b64_tr_b16 v[208:209],v242 offset:24576
v_rcp_f32 v235,v235
v_mfma_f32_16x16x32_bf16 v[188:191],v[212:215],v[68:71],v[188:191]
ds_read_b64_tr_b16 v[210:211],v242 offset:26624
v_mul_f32 v168,v168,v232
s_waitcnt lgkmcnt(4)
v_mfma_f32_16x16x32_bf16 v[192:195],v[216:219],v[64:67],v[192:195]
ds_read_b64_tr_b16 v[212:213],v243 offset:24576
v_mul_f32 v169,v169,v233
v_mfma_f32_16x16x32_bf16 v[196:199],v[216:219],v[68:71],v[196:199]
ds_read_b64_tr_b16 v[214:215],v243 offset:26624
v_mul_f32 v170,v170,v234
s_waitcnt lgkmcnt(4)
v_mfma_f32_16x16x32_bf16 v[200:203],v[220:223],v[64:67],v[200:203]
ds_read_b64_tr_b16 v[216:217],v242 offset:28672
v_mul_f32 v171,v171,v235
v_mfma_f32_16x16x32_bf16 v[204:207],v[220:223],v[68:71],v[204:207]
ds_read_b64_tr_b16 v[218:219],v242 offset:30720
v_cvt_pk_bf16_f32 v226,v168,v169
v_cvt_pk_bf16_f32 v227,v170,v171
s_waitcnt lgkmcnt(4)
v_mfma_f32_16x16x32_bf16 v[176:179],v[208:211],v[72:75],v[176:179]
ds_read_b64_tr_b16 v[220:221],v243 offset:28672
v_mul_f32 v232,v148,v148
v_mfma_f32_16x16x32_bf16 v[180:183],v[208:211],v[76:79],v[180:183]
ds_read_b64_tr_b16 v[222:223],v243 offset:30720
v_mul_f32 v233,v149,v149
s_waitcnt lgkmcnt(4)
v_mfma_f32_16x16x32_bf16 v[184:187],v[212:215],v[72:75],v[184:187]
ds_read_b64_tr_b16 v[208:209],v242 offset:32768
v_mul_f32 v234,v150,v150
v_mfma_f32_16x16x32_bf16 v[188:191],v[212:215],v[76:79],v[188:191]
ds_read_b64_tr_b16 v[210:211],v242 offset:34816
v_mul_f32 v235,v151,v151
s_waitcnt lgkmcnt(4)
v_mfma_f32_16x16x32_bf16 v[192:195],v[216:219],v[72:75],v[192:195]
ds_read_b64_tr_b16 v[212:213],v243 offset:32768
v_fma_f32 v232,v232,v240,v239
v_mfma_f32_16x16x32_bf16 v[196:199],v[216:219],v[76:79],v[196:199]
ds_read_b64_tr_b16 v[214:215],v243 offset:34816
v_fma_f32 v233,v233,v240,v239
s_waitcnt lgkmcnt(4)
v_mfma_f32_16x16x32_bf16 v[200:203],v[220:223],v[72:75],v[200:203]
ds_read_b64_tr_b16 v[216:217],v242 offset:36864
v_fma_f32 v234,v234,v240,v239
v_mfma_f32_16x16x32_bf16 v[204:207],v[220:223],v[76:79],v[204:207]
ds_read_b64_tr_b16 v[218:219],v242 offset:38912
v_fma_f32 v235,v235,v240,v239
s_barrier
s_waitcnt lgkmcnt(4)
v_mfma_f32_16x16x32_bf16 v[176:179],v[208:211],v[80:83],v[176:179]
ds_read_b64_tr_b16 v[220:221],v243 offset:36864
v_mul_f32 v232,v148,v232
v_mfma_f32_16x16x32_bf16 v[180:183],v[208:211],v[84:87],v[180:183]
ds_read_b64_tr_b16 v[222:223],v243 offset:38912
v_mul_f32 v233,v149,v233
s_waitcnt lgkmcnt(4)
v_mfma_f32_16x16x32_bf16 v[184:187],v[212:215],v[80:83],v[184:187]
ds_read_b64_tr_b16 v[208:209],v242 offset:40960
v_mul_f32 v234,v150,v234
v_mfma_f32_16x16x32_bf16 v[188:191],v[212:215],v[84:87],v[188:191]
ds_read_b64_tr_b16 v[210:211],v242 offset:43008
v_mul_f32 v235,v151,v235
s_waitcnt lgkmcnt(4)
v_mfma_f32_16x16x32_bf16 v[192:195],v[216:219],v[80:83],v[192:195]
ds_read_b64_tr_b16 v[212:213],v243 offset:40960
v_exp_f32 v232,v232
v_mfma_f32_16x16x32_bf16 v[196:199],v[216:219],v[84:87],v[196:199]
ds_read_b64_tr_b16 v[214:215],v243 offset:43008
v_exp_f32 v233,v233
s_waitcnt lgkmcnt(4)
v_mfma_f32_16x16x32_bf16 v[200:203],v[220:223],v[80:83],v[200:203]
ds_read_b64_tr_b16 v[216:217],v242 offset:45056
v_exp_f32 v234,v234
v_mfma_f32_16x16x32_bf16 v[204:207],v[220:223],v[84:87],v[204:207]
ds_read_b64_tr_b16 v[218:219],v242 offset:47104
v_exp_f32 v235,v235
v_mul_f32 v164,v148,v164
s_waitcnt lgkmcnt(4)
v_mfma_f32_16x16x32_bf16 v[176:179],v[208:211],v[88:91],v[176:179]
ds_read_b64_tr_b16 v[220:221],v243 offset:45056
v_mul_f32 v165,v149,v165
v_mfma_f32_16x16x32_bf16 v[180:183],v[208:211],v[92:95],v[180:183]
ds_read_b64_tr_b16 v[222:223],v243 offset:47104
v_mul_f32 v166,v150,v166
s_waitcnt lgkmcnt(4)
v_mfma_f32_16x16x32_bf16 v[184:187],v[212:215],v[88:91],v[184:187]
ds_read_b64_tr_b16 v[208:209],v242 offset:49152
v_mul_f32 v167,v151,v167
v_mfma_f32_16x16x32_bf16 v[188:191],v[212:215],v[92:95],v[188:191]
ds_read_b64_tr_b16 v[210:211],v242 offset:51200
v_fma_f32 v232,v232,v241,v241
s_waitcnt lgkmcnt(4)
v_mfma_f32_16x16x32_bf16 v[192:195],v[216:219],v[88:91],v[192:195]
ds_read_b64_tr_b16 v[212:213],v243 offset:49152
v_fma_f32 v233,v233,v241,v241
v_mfma_f32_16x16x32_bf16 v[196:199],v[216:219],v[92:95],v[196:199]
ds_read_b64_tr_b16 v[214:215],v243 offset:51200
v_fma_f32 v234,v234,v241,v241
s_waitcnt lgkmcnt(4)
v_mfma_f32_16x16x32_bf16 v[200:203],v[220:223],v[88:91],v[200:203]
ds_read_b64_tr_b16 v[216:217],v242 offset:53248
v_fma_f32 v235,v235,v241,v241
v_mfma_f32_16x16x32_bf16 v[204:207],v[220:223],v[92:95],v[204:207]
ds_read_b64_tr_b16 v[218:219],v242 offset:55296
v_rcp_f32 v232,v232
s_barrier
s_waitcnt lgkmcnt(4)
v_mfma_f32_16x16x32_bf16 v[176:179],v[208:211],v[96:99],v[176:179]
ds_read_b64_tr_b16 v[220:221],v243 offset:53248
v_rcp_f32 v233,v233
v_mfma_f32_16x16x32_bf16 v[180:183],v[208:211],v[100:103],v[180:183]
ds_read_b64_tr_b16 v[222:223],v243 offset:55296
v_rcp_f32 v234,v234
s_waitcnt lgkmcnt(4)
v_mfma_f32_16x16x32_bf16 v[184:187],v[212:215],v[96:99],v[184:187]
ds_read_b64_tr_b16 v[208:209],v242 offset:57344
v_rcp_f32 v235,v235
v_mfma_f32_16x16x32_bf16 v[188:191],v[212:215],v[100:103],v[188:191]
ds_read_b64_tr_b16 v[210:211],v242 offset:59392
v_mul_f32 v164,v164,v232
s_waitcnt lgkmcnt(4)
v_mfma_f32_16x16x32_bf16 v[192:195],v[216:219],v[96:99],v[192:195]
ds_read_b64_tr_b16 v[212:213],v243 offset:57344
v_mul_f32 v165,v165,v233
v_mfma_f32_16x16x32_bf16 v[196:199],v[216:219],v[100:103],v[196:199]
ds_read_b64_tr_b16 v[214:215],v243 offset:59392
v_mul_f32 v166,v166,v234
s_waitcnt lgkmcnt(4)
v_mfma_f32_16x16x32_bf16 v[200:203],v[220:223],v[96:99],v[200:203]
ds_read_b64_tr_b16 v[216:217],v242 offset:61440
v_mul_f32 v167,v167,v235
v_mfma_f32_16x16x32_bf16 v[204:207],v[220:223],v[100:103],v[204:207]
ds_read_b64_tr_b16 v[218:219],v242 offset:63488
v_cvt_pk_bf16_f32 v228,v164,v165
v_cvt_pk_bf16_f32 v229,v166,v167
s_waitcnt lgkmcnt(4)
v_mfma_f32_16x16x32_bf16 v[176:179],v[208:211],v[104:107],v[176:179]
ds_read_b64_tr_b16 v[220:221],v243 offset:61440
v_mul_f32 v232,v156,v156
v_mfma_f32_16x16x32_bf16 v[180:183],v[208:211],v[108:111],v[180:183]
ds_read_b64_tr_b16 v[222:223],v243 offset:63488
v_mul_f32 v233,v157,v157
s_waitcnt lgkmcnt(4)
v_mfma_f32_16x16x32_bf16 v[184:187],v[212:215],v[104:107],v[184:187]
ds_read_b64_tr_b16 v[208:209],v242 offset:0
v_mul_f32 v234,v158,v158
v_mfma_f32_16x16x32_bf16 v[188:191],v[212:215],v[108:111],v[188:191]
ds_read_b64_tr_b16 v[210:211],v242 offset:2048
v_mul_f32 v235,v159,v159
s_waitcnt lgkmcnt(4)
v_mfma_f32_16x16x32_bf16 v[192:195],v[216:219],v[104:107],v[192:195]
ds_read_b64_tr_b16 v[212:213],v243 offset:0
v_fma_f32 v232,v232,v240,v239
v_mfma_f32_16x16x32_bf16 v[196:199],v[216:219],v[108:111],v[196:199]
ds_read_b64_tr_b16 v[214:215],v243 offset:2048
v_fma_f32 v233,v233,v240,v239
s_waitcnt lgkmcnt(4)
v_mfma_f32_16x16x32_bf16 v[200:203],v[220:223],v[104:107],v[200:203]
ds_read_b64_tr_b16 v[216:217],v242 offset:4096
v_fma_f32 v234,v234,v240,v239
v_mfma_f32_16x16x32_bf16 v[204:207],v[220:223],v[108:111],v[204:207]
ds_read_b64_tr_b16 v[218:219],v242 offset:6144
v_fma_f32 v235,v235,v240,v239
s_barrier
s_waitcnt lgkmcnt(4)
v_mfma_f32_16x16x32_bf16 v[176:179],v[208:211],v[112:115],v[176:179]
ds_read_b64_tr_b16 v[220:221],v243 offset:4096
v_mul_f32 v232,v156,v232
v_mfma_f32_16x16x32_bf16 v[180:183],v[208:211],v[116:119],v[180:183]
ds_read_b64_tr_b16 v[222:223],v243 offset:6144
v_mul_f32 v233,v157,v233
s_waitcnt lgkmcnt(4)
v_mfma_f32_16x16x32_bf16 v[184:187],v[212:215],v[112:115],v[184:187]
ds_read_b64_tr_b16 v[208:209],v242 offset:8192
v_mul_f32 v234,v158,v234
v_mfma_f32_16x16x32_bf16 v[188:191],v[212:215],v[116:119],v[188:191]
ds_read_b64_tr_b16 v[210:211],v242 offset:10240
v_mul_f32 v235,v159,v235
s_waitcnt lgkmcnt(4)
v_mfma_f32_16x16x32_bf16 v[192:195],v[216:219],v[112:115],v[192:195]
ds_read_b64_tr_b16 v[212:213],v243 offset:8192
v_exp_f32 v232,v232
v_mfma_f32_16x16x32_bf16 v[196:199],v[216:219],v[116:119],v[196:199]
ds_read_b64_tr_b16 v[214:215],v243 offset:10240
v_exp_f32 v233,v233
s_waitcnt lgkmcnt(4)
v_mfma_f32_16x16x32_bf16 v[200:203],v[220:223],v[112:115],v[200:203]
ds_read_b64_tr_b16 v[216:217],v242 offset:12288
v_exp_f32 v234,v234
v_mfma_f32_16x16x32_bf16 v[204:207],v[220:223],v[116:119],v[204:207]
ds_read_b64_tr_b16 v[218:219],v242 offset:14336
v_exp_f32 v235,v235
v_mul_f32 v172,v156,v172
s_waitcnt lgkmcnt(4)
v_mfma_f32_16x16x32_bf16 v[176:179],v[208:211],v[120:123],v[176:179]
ds_read_b64_tr_b16 v[220:221],v243 offset:12288
v_mul_f32 v173,v157,v173
v_mfma_f32_16x16x32_bf16 v[180:183],v[208:211],v[124:127],v[180:183]
ds_read_b64_tr_b16 v[222:223],v243 offset:14336
v_mul_f32 v174,v158,v174
s_waitcnt lgkmcnt(4)
v_mfma_f32_16x16x32_bf16 v[184:187],v[212:215],v[120:123],v[184:187]
ds_read_b64_tr_b16 v[208:209],v242 offset:16384
v_mul_f32 v175,v159,v175
v_mfma_f32_16x16x32_bf16 v[188:191],v[212:215],v[124:127],v[188:191]
ds_read_b64_tr_b16 v[210:211],v242 offset:18432
v_fma_f32 v232,v232,v241,v241
s_waitcnt lgkmcnt(4)
v_mfma_f32_16x16x32_bf16 v[192:195],v[216:219],v[120:123],v[192:195]
ds_read_b64_tr_b16 v[212:213],v243 offset:16384
v_fma_f32 v233,v233,v241,v241
v_mfma_f32_16x16x32_bf16 v[196:199],v[216:219],v[124:127],v[196:199]
ds_read_b64_tr_b16 v[214:215],v243 offset:18432
v_fma_f32 v234,v234,v241,v241
s_waitcnt lgkmcnt(4)
v_mfma_f32_16x16x32_bf16 v[200:203],v[220:223],v[120:123],v[200:203]
ds_read_b64_tr_b16 v[216:217],v242 offset:20480
v_fma_f32 v235,v235,v241,v241
v_mfma_f32_16x16x32_bf16 v[204:207],v[220:223],v[124:127],v[204:207]
ds_read_b64_tr_b16 v[218:219],v242 offset:22528
v_rcp_f32 v232,v232
s_barrier
s_waitcnt lgkmcnt(4)
v_mfma_f32_16x16x32_bf16 v[176:179],v[208:211],v[128:131],v[176:179]
ds_read_b64_tr_b16 v[220:221],v243 offset:20480
v_rcp_f32 v233,v233
v_mfma_f32_16x16x32_bf16 v[180:183],v[208:211],v[132:135],v[180:183]
ds_read_b64_tr_b16 v[222:223],v243 offset:22528
v_rcp_f32 v234,v234
s_waitcnt lgkmcnt(4)
v_mfma_f32_16x16x32_bf16 v[184:187],v[212:215],v[128:131],v[184:187]
ds_read_b64_tr_b16 v[208:209],v242 offset:24576
v_rcp_f32 v235,v235
v_mfma_f32_16x16x32_bf16 v[188:191],v[212:215],v[132:135],v[188:191]
ds_read_b64_tr_b16 v[210:211],v242 offset:26624
v_mul_f32 v172,v172,v232
s_waitcnt lgkmcnt(4)
v_mfma_f32_16x16x32_bf16 v[192:195],v[216:219],v[128:131],v[192:195]
ds_read_b64_tr_b16 v[212:213],v243 offset:24576
v_mul_f32 v173,v173,v233
v_mfma_f32_16x16x32_bf16 v[196:199],v[216:219],v[132:135],v[196:199]
ds_read_b64_tr_b16 v[214:215],v243 offset:26624
v_mul_f32 v174,v174,v234
s_waitcnt lgkmcnt(4)
v_mfma_f32_16x16x32_bf16 v[200:203],v[220:223],v[128:131],v[200:203]
ds_read_b64_tr_b16 v[216:217],v242 offset:28672
v_mul_f32 v175,v175,v235
v_mfma_f32_16x16x32_bf16 v[204:207],v[220:223],v[132:135],v[204:207]
ds_read_b64_tr_b16 v[218:219],v242 offset:30720
v_cvt_pk_bf16_f32 v230,v172,v173
v_cvt_pk_bf16_f32 v231,v174,v175
s_waitcnt lgkmcnt(4)
v_mfma_f32_16x16x32_bf16 v[176:179],v[208:211],v[136:139],v[176:179]
ds_read_b64_tr_b16 v[220:221],v243 offset:28672
v_mfma_f32_16x16x32_bf16 v[180:183],v[208:211],v[140:143],v[180:183]
ds_read_b64_tr_b16 v[222:223],v243 offset:30720
ds_write_b128 v253,v[224:227] offset:0
s_waitcnt lgkmcnt(5)
v_mfma_f32_16x16x32_bf16 v[184:187],v[212:215],v[136:139],v[184:187]
ds_read_b64_tr_b16 v[208:209],v242 offset:32768
ds_write_b128 v253,v[228:231] offset:1024
v_mfma_f32_16x16x32_bf16 v[188:191],v[212:215],v[140:143],v[188:191]
ds_read_b64_tr_b16 v[210:211],v242 offset:34816
s_lshl_b32 s40,s42,11
s_waitcnt lgkmcnt(6)
v_mfma_f32_16x16x32_bf16 v[192:195],v[216:219],v[136:139],v[192:195]
ds_read_b64_tr_b16 v[212:213],v243 offset:32768
s_add_u32 s40,s40,0
v_mfma_f32_16x16x32_bf16 v[196:199],v[216:219],v[140:143],v[196:199]
ds_read_b64_tr_b16 v[214:215],v243 offset:34816
s_add_u32 s40,s40,s93
s_waitcnt lgkmcnt(6)
v_mfma_f32_16x16x32_bf16 v[200:203],v[220:223],v[136:139],v[200:203]
ds_read_b64_tr_b16 v[216:217],v242 offset:36864
buffer_store_dwordx4 v[224:227],v254,s[68:71],s40 offen offset:0 sc1
v_mfma_f32_16x16x32_bf16 v[204:207],v[220:223],v[140:143],v[204:207]
ds_read_b64_tr_b16 v[218:219],v242 offset:38912
buffer_store_dwordx4 v[228:231],v254,s[68:71],s40 offen offset:1024 sc1
s_waitcnt lgkmcnt(5)
s_barrier
s_waitcnt lgkmcnt(4)
v_mfma_f32_16x16x32_bf16 v[144:147],v[208:211],v[0:3],0
ds_read_b64_tr_b16 v[220:221],v243 offset:36864
v_mfma_f32_16x16x32_bf16 v[148:151],v[208:211],v[4:7],0
ds_read_b64_tr_b16 v[222:223],v243 offset:38912
s_waitcnt lgkmcnt(4)
v_mfma_f32_16x16x32_bf16 v[152:155],v[212:215],v[0:3],0
ds_read_b64_tr_b16 v[208:209],v242 offset:40960
v_mfma_f32_16x16x32_bf16 v[156:159],v[212:215],v[4:7],0
ds_read_b64_tr_b16 v[210:211],v242 offset:43008
s_waitcnt lgkmcnt(4)
v_mfma_f32_16x16x32_bf16 v[160:163],v[216:219],v[0:3],0
ds_read_b64_tr_b16 v[212:213],v243 offset:40960
v_mfma_f32_16x16x32_bf16 v[164:167],v[216:219],v[4:7],0
ds_read_b64_tr_b16 v[214:215],v243 offset:43008
s_waitcnt lgkmcnt(4)
v_mfma_f32_16x16x32_bf16 v[168:171],v[220:223],v[0:3],0
ds_read_b64_tr_b16 v[216:217],v242 offset:45056
v_mfma_f32_16x16x32_bf16 v[172:175],v[220:223],v[4:7],0
ds_read_b64_tr_b16 v[218:219],v242 offset:47104
s_waitcnt lgkmcnt(4)
v_mfma_f32_16x16x32_bf16 v[144:147],v[208:211],v[8:11],v[144:147]
ds_read_b64_tr_b16 v[220:221],v243 offset:45056
v_mul_f32 v232,v176,v176
v_mfma_f32_16x16x32_bf16 v[148:151],v[208:211],v[12:15],v[148:151]
ds_read_b64_tr_b16 v[222:223],v243 offset:47104
v_mul_f32 v233,v177,v177
s_waitcnt lgkmcnt(4)
v_mfma_f32_16x16x32_bf16 v[152:155],v[212:215],v[8:11],v[152:155]
ds_read_b64_tr_b16 v[208:209],v242 offset:49152
v_mul_f32 v234,v178,v178
v_mfma_f32_16x16x32_bf16 v[156:159],v[212:215],v[12:15],v[156:159]
ds_read_b64_tr_b16 v[210:211],v242 offset:51200
v_mul_f32 v235,v179,v179
s_waitcnt lgkmcnt(4)
v_mfma_f32_16x16x32_bf16 v[160:163],v[216:219],v[8:11],v[160:163]
ds_read_b64_tr_b16 v[212:213],v243 offset:49152
v_fma_f32 v232,v232,v237,v236
v_mfma_f32_16x16x32_bf16 v[164:167],v[216:219],v[12:15],v[164:167]
ds_read_b64_tr_b16 v[214:215],v243 offset:51200
v_fma_f32 v233,v233,v237,v236
s_waitcnt lgkmcnt(4)
v_mfma_f32_16x16x32_bf16 v[168:171],v[220:223],v[8:11],v[168:171]
ds_read_b64_tr_b16 v[216:217],v242 offset:53248
v_fma_f32 v234,v234,v237,v236
v_mfma_f32_16x16x32_bf16 v[172:175],v[220:223],v[12:15],v[172:175]
ds_read_b64_tr_b16 v[218:219],v242 offset:55296
v_fma_f32 v235,v235,v237,v236
s_barrier
s_waitcnt lgkmcnt(4)
v_mfma_f32_16x16x32_bf16 v[144:147],v[208:211],v[16:19],v[144:147]
ds_read_b64_tr_b16 v[220:221],v243 offset:53248
v_mul_f32 v232,v176,v232
v_mfma_f32_16x16x32_bf16 v[148:151],v[208:211],v[20:23],v[148:151]
ds_read_b64_tr_b16 v[222:223],v243 offset:55296
v_mul_f32 v233,v177,v233
s_waitcnt lgkmcnt(4)
v_mfma_f32_16x16x32_bf16 v[152:155],v[212:215],v[16:19],v[152:155]
ds_read_b64_tr_b16 v[208:209],v242 offset:57344
v_mul_f32 v234,v178,v234
v_mfma_f32_16x16x32_bf16 v[156:159],v[212:215],v[20:23],v[156:159]
ds_read_b64_tr_b16 v[210:211],v242 offset:59392
v_mul_f32 v235,v179,v235
s_waitcnt lgkmcnt(4)
v_mfma_f32_16x16x32_bf16 v[160:163],v[216:219],v[16:19],v[160:163]
ds_read_b64_tr_b16 v[212:213],v243 offset:57344
v_exp_f32 v232,v232
v_mfma_f32_16x16x32_bf16 v[164:167],v[216:219],v[20:23],v[164:167]
ds_read_b64_tr_b16 v[214:215],v243 offset:59392
v_exp_f32 v233,v233
s_waitcnt lgkmcnt(4)
v_mfma_f32_16x16x32_bf16 v[168:171],v[220:223],v[16:19],v[168:171]
ds_read_b64_tr_b16 v[216:217],v242 offset:61440
v_exp_f32 v234,v234
v_mfma_f32_16x16x32_bf16 v[172:175],v[220:223],v[20:23],v[172:175]
ds_read_b64_tr_b16 v[218:219],v242 offset:63488
v_exp_f32 v235,v235
v_mul_f32 v192,v176,v192
s_waitcnt lgkmcnt(4)
v_mfma_f32_16x16x32_bf16 v[144:147],v[208:211],v[24:27],v[144:147]
ds_read_b64_tr_b16 v[220:221],v243 offset:61440
v_mul_f32 v193,v177,v193
v_mfma_f32_16x16x32_bf16 v[148:151],v[208:211],v[28:31],v[148:151]
ds_read_b64_tr_b16 v[222:223],v243 offset:63488
v_mul_f32 v194,v178,v194
s_waitcnt lgkmcnt(4)
v_mfma_f32_16x16x32_bf16 v[152:155],v[212:215],v[24:27],v[152:155]
ds_read_b64_tr_b16 v[208:209],v242 offset:0
v_mul_f32 v195,v179,v195
v_mfma_f32_16x16x32_bf16 v[156:159],v[212:215],v[28:31],v[156:159]
ds_read_b64_tr_b16 v[210:211],v242 offset:2048
v_fma_f32 v232,v232,v238,v238
s_waitcnt lgkmcnt(4)
v_mfma_f32_16x16x32_bf16 v[160:163],v[216:219],v[24:27],v[160:163]
ds_read_b64_tr_b16 v[212:213],v243 offset:0
v_fma_f32 v233,v233,v238,v238
v_mfma_f32_16x16x32_bf16 v[164:167],v[216:219],v[28:31],v[164:167]
ds_read_b64_tr_b16 v[214:215],v243 offset:2048
v_fma_f32 v234,v234,v238,v238
s_waitcnt lgkmcnt(4)
v_mfma_f32_16x16x32_bf16 v[168:171],v[220:223],v[24:27],v[168:171]
ds_read_b64_tr_b16 v[216:217],v242 offset:4096
v_fma_f32 v235,v235,v238,v238
v_mfma_f32_16x16x32_bf16 v[172:175],v[220:223],v[28:31],v[172:175]
ds_read_b64_tr_b16 v[218:219],v242 offset:6144
v_rcp_f32 v232,v232
s_barrier
s_waitcnt lgkmcnt(4)
v_mfma_f32_16x16x32_bf16 v[144:147],v[208:211],v[32:35],v[144:147]
ds_read_b64_tr_b16 v[220:221],v243 offset:4096
v_rcp_f32 v233,v233
v_mfma_f32_16x16x32_bf16 v[148:151],v[208:211],v[36:39],v[148:151]
ds_read_b64_tr_b16 v[222:223],v243 offset:6144
v_rcp_f32 v234,v234
s_waitcnt lgkmcnt(4)
v_mfma_f32_16x16x32_bf16 v[152:155],v[212:215],v[32:35],v[152:155]
ds_read_b64_tr_b16 v[208:209],v242 offset:8192
v_rcp_f32 v235,v235
s_lshr_b32 s35,s2,3
s_mul_i32 s35,s35,20736
s_and_b32 s45,s2,7
s_mul_i32 s45,s45,663552
s_add_u32 s35,s35,s45
s_lshl_b32 s45,s41,13
s_add_u32 s35,s35,s45
v_lshlrev_b32 v245,7,v255
buffer_load_dword v246,v245,s[8:11],s35 offen
v_mfma_f32_16x16x32_bf16 v[156:159],v[212:215],v[36:39],v[156:159]
ds_read_b64_tr_b16 v[210:211],v242 offset:10240
v_mul_f32 v192,v192,v232
s_waitcnt lgkmcnt(4)
v_mfma_f32_16x16x32_bf16 v[160:163],v[216:219],v[32:35],v[160:163]
ds_read_b64_tr_b16 v[212:213],v243 offset:8192
v_mul_f32 v193,v193,v233
v_mfma_f32_16x16x32_bf16 v[164:167],v[216:219],v[36:39],v[164:167]
ds_read_b64_tr_b16 v[214:215],v243 offset:10240
v_mul_f32 v194,v194,v234
s_waitcnt lgkmcnt(4)
v_mfma_f32_16x16x32_bf16 v[168:171],v[220:223],v[32:35],v[168:171]
ds_read_b64_tr_b16 v[216:217],v242 offset:12288
v_mul_f32 v195,v195,v235
v_mfma_f32_16x16x32_bf16 v[172:175],v[220:223],v[36:39],v[172:175]
ds_read_b64_tr_b16 v[218:219],v242 offset:14336
v_cvt_pk_bf16_f32 v224,v192,v193
v_cvt_pk_bf16_f32 v225,v194,v195
s_waitcnt lgkmcnt(4)
v_mfma_f32_16x16x32_bf16 v[144:147],v[208:211],v[40:43],v[144:147]
ds_read_b64_tr_b16 v[220:221],v243 offset:12288
v_mul_f32 v232,v184,v184
v_mfma_f32_16x16x32_bf16 v[148:151],v[208:211],v[44:47],v[148:151]
ds_read_b64_tr_b16 v[222:223],v243 offset:14336
v_mul_f32 v233,v185,v185
s_waitcnt lgkmcnt(4)
v_mfma_f32_16x16x32_bf16 v[152:155],v[212:215],v[40:43],v[152:155]
ds_read_b64_tr_b16 v[208:209],v242 offset:16384
v_mul_f32 v234,v186,v186
v_mfma_f32_16x16x32_bf16 v[156:159],v[212:215],v[44:47],v[156:159]
ds_read_b64_tr_b16 v[210:211],v242 offset:18432
v_mul_f32 v235,v187,v187
s_waitcnt lgkmcnt(4)
v_mfma_f32_16x16x32_bf16 v[160:163],v[216:219],v[40:43],v[160:163]
ds_read_b64_tr_b16 v[212:213],v243 offset:16384
v_fma_f32 v232,v232,v237,v236
v_mfma_f32_16x16x32_bf16 v[164:167],v[216:219],v[44:47],v[164:167]
ds_read_b64_tr_b16 v[214:215],v243 offset:18432
v_fma_f32 v233,v233,v237,v236
s_waitcnt lgkmcnt(4)
v_mfma_f32_16x16x32_bf16 v[168:171],v[220:223],v[40:43],v[168:171]
ds_read_b64_tr_b16 v[216:217],v242 offset:20480
v_fma_f32 v234,v234,v237,v236
v_mfma_f32_16x16x32_bf16 v[172:175],v[220:223],v[44:47],v[172:175]
ds_read_b64_tr_b16 v[218:219],v242 offset:22528
v_fma_f32 v235,v235,v237,v236
s_barrier
s_waitcnt lgkmcnt(4)
v_mfma_f32_16x16x32_bf16 v[144:147],v[208:211],v[48:51],v[144:147]
ds_read_b64_tr_b16 v[220:221],v243 offset:20480
v_mul_f32 v232,v184,v232
v_mfma_f32_16x16x32_bf16 v[148:151],v[208:211],v[52:55],v[148:151]
ds_read_b64_tr_b16 v[222:223],v243 offset:22528
v_mul_f32 v233,v185,v233
s_waitcnt lgkmcnt(4)
v_mfma_f32_16x16x32_bf16 v[152:155],v[212:215],v[48:51],v[152:155]
ds_read_b64_tr_b16 v[208:209],v242 offset:24576
v_mul_f32 v234,v186,v234
v_mfma_f32_16x16x32_bf16 v[156:159],v[212:215],v[52:55],v[156:159]
ds_read_b64_tr_b16 v[210:211],v242 offset:26624
v_mul_f32 v235,v187,v235
s_waitcnt lgkmcnt(4)
v_mfma_f32_16x16x32_bf16 v[160:163],v[216:219],v[48:51],v[160:163]
ds_read_b64_tr_b16 v[212:213],v243 offset:24576
v_exp_f32 v232,v232
v_mfma_f32_16x16x32_bf16 v[164:167],v[216:219],v[52:55],v[164:167]
ds_read_b64_tr_b16 v[214:215],v243 offset:26624
v_exp_f32 v233,v233
s_waitcnt lgkmcnt(4)
v_mfma_f32_16x16x32_bf16 v[168:171],v[220:223],v[48:51],v[168:171]
ds_read_b64_tr_b16 v[216:217],v242 offset:28672
v_exp_f32 v234,v234
v_mfma_f32_16x16x32_bf16 v[172:175],v[220:223],v[52:55],v[172:175]
ds_read_b64_tr_b16 v[218:219],v242 offset:30720
v_exp_f32 v235,v235
v_mul_f32 v200,v184,v200
s_waitcnt lgkmcnt(4)
v_mfma_f32_16x16x32_bf16 v[144:147],v[208:211],v[56:59],v[144:147]
ds_read_b64_tr_b16 v[220:221],v243 offset:28672
v_mul_f32 v201,v185,v201
v_mfma_f32_16x16x32_bf16 v[148:151],v[208:211],v[60:63],v[148:151]
ds_read_b64_tr_b16 v[222:223],v243 offset:30720
v_mul_f32 v202,v186,v202
s_waitcnt lgkmcnt(4)
v_mfma_f32_16x16x32_bf16 v[152:155],v[212:215],v[56:59],v[152:155]
ds_read_b64_tr_b16 v[208:209],v242 offset:32768
v_mul_f32 v203,v187,v203
v_mfma_f32_16x16x32_bf16 v[156:159],v[212:215],v[60:63],v[156:159]
ds_read_b64_tr_b16 v[210:211],v242 offset:34816
v_fma_f32 v232,v232,v238,v238
s_waitcnt lgkmcnt(4)
v_mfma_f32_16x16x32_bf16 v[160:163],v[216:219],v[56:59],v[160:163]
ds_read_b64_tr_b16 v[212:213],v243 offset:32768
v_fma_f32 v233,v233,v238,v238
v_mfma_f32_16x16x32_bf16 v[164:167],v[216:219],v[60:63],v[164:167]
ds_read_b64_tr_b16 v[214:215],v243 offset:34816
v_fma_f32 v234,v234,v238,v238
s_waitcnt lgkmcnt(4)
v_mfma_f32_16x16x32_bf16 v[168:171],v[220:223],v[56:59],v[168:171]
ds_read_b64_tr_b16 v[216:217],v242 offset:36864
v_fma_f32 v235,v235,v238,v238
v_mfma_f32_16x16x32_bf16 v[172:175],v[220:223],v[60:63],v[172:175]
ds_read_b64_tr_b16 v[218:219],v242 offset:38912
v_rcp_f32 v232,v232
s_barrier
s_waitcnt lgkmcnt(4)
v_mfma_f32_16x16x32_bf16 v[144:147],v[208:211],v[64:67],v[144:147]
ds_read_b64_tr_b16 v[220:221],v243 offset:36864
v_rcp_f32 v233,v233
v_mfma_f32_16x16x32_bf16 v[148:151],v[208:211],v[68:71],v[148:151]
ds_read_b64_tr_b16 v[222:223],v243 offset:38912
v_rcp_f32 v234,v234
s_waitcnt lgkmcnt(4)
v_mfma_f32_16x16x32_bf16 v[152:155],v[212:215],v[64:67],v[152:155]
ds_read_b64_tr_b16 v[208:209],v242 offset:40960
v_rcp_f32 v235,v235
v_mfma_f32_16x16x32_bf16 v[156:159],v[212:215],v[68:71],v[156:159]
ds_read_b64_tr_b16 v[210:211],v242 offset:43008
v_mul_f32 v200,v200,v232
s_waitcnt lgkmcnt(4)
v_mfma_f32_16x16x32_bf16 v[160:163],v[216:219],v[64:67],v[160:163]
ds_read_b64_tr_b16 v[212:213],v243 offset:40960
v_mul_f32 v201,v201,v233
v_mfma_f32_16x16x32_bf16 v[164:167],v[216:219],v[68:71],v[164:167]
ds_read_b64_tr_b16 v[214:215],v243 offset:43008
v_mul_f32 v202,v202,v234
s_waitcnt lgkmcnt(4)
v_mfma_f32_16x16x32_bf16 v[168:171],v[220:223],v[64:67],v[168:171]
ds_read_b64_tr_b16 v[216:217],v242 offset:45056
v_mul_f32 v203,v203,v235
v_mfma_f32_16x16x32_bf16 v[172:175],v[220:223],v[68:71],v[172:175]
ds_read_b64_tr_b16 v[218:219],v242 offset:47104
v_cvt_pk_bf16_f32 v226,v200,v201
v_cvt_pk_bf16_f32 v227,v202,v203
s_waitcnt lgkmcnt(4)
v_mfma_f32_16x16x32_bf16 v[144:147],v[208:211],v[72:75],v[144:147]
ds_read_b64_tr_b16 v[220:221],v243 offset:45056
v_mul_f32 v232,v180,v180
v_mfma_f32_16x16x32_bf16 v[148:151],v[208:211],v[76:79],v[148:151]
ds_read_b64_tr_b16 v[222:223],v243 offset:47104
v_mul_f32 v233,v181,v181
s_waitcnt lgkmcnt(4)
v_mfma_f32_16x16x32_bf16 v[152:155],v[212:215],v[72:75],v[152:155]
ds_read_b64_tr_b16 v[208:209],v242 offset:49152
v_mul_f32 v234,v182,v182
v_mfma_f32_16x16x32_bf16 v[156:159],v[212:215],v[76:79],v[156:159]
ds_read_b64_tr_b16 v[210:211],v242 offset:51200
v_mul_f32 v235,v183,v183
s_waitcnt lgkmcnt(4)
v_mfma_f32_16x16x32_bf16 v[160:163],v[216:219],v[72:75],v[160:163]
ds_read_b64_tr_b16 v[212:213],v243 offset:49152
v_fma_f32 v232,v232,v240,v239
v_mfma_f32_16x16x32_bf16 v[164:167],v[216:219],v[76:79],v[164:167]
ds_read_b64_tr_b16 v[214:215],v243 offset:51200
v_fma_f32 v233,v233,v240,v239
s_waitcnt lgkmcnt(4)
v_mfma_f32_16x16x32_bf16 v[168:171],v[220:223],v[72:75],v[168:171]
ds_read_b64_tr_b16 v[216:217],v242 offset:53248
v_fma_f32 v234,v234,v240,v239
v_mfma_f32_16x16x32_bf16 v[172:175],v[220:223],v[76:79],v[172:175]
ds_read_b64_tr_b16 v[218:219],v242 offset:55296
v_fma_f32 v235,v235,v240,v239
s_barrier
s_waitcnt lgkmcnt(4)
v_mfma_f32_16x16x32_bf16 v[144:147],v[208:211],v[80:83],v[144:147]
ds_read_b64_tr_b16 v[220:221],v243 offset:53248
v_mul_f32 v232,v180,v232
v_mfma_f32_16x16x32_bf16 v[148:151],v[208:211],v[84:87],v[148:151]
ds_read_b64_tr_b16 v[222:223],v243 offset:55296
v_mul_f32 v233,v181,v233
s_waitcnt lgkmcnt(4)
v_mfma_f32_16x16x32_bf16 v[152:155],v[212:215],v[80:83],v[152:155]
ds_read_b64_tr_b16 v[208:209],v242 offset:57344
v_mul_f32 v234,v182,v234
v_mfma_f32_16x16x32_bf16 v[156:159],v[212:215],v[84:87],v[156:159]
ds_read_b64_tr_b16 v[210:211],v242 offset:59392
v_mul_f32 v235,v183,v235
s_waitcnt lgkmcnt(4)
v_mfma_f32_16x16x32_bf16 v[160:163],v[216:219],v[80:83],v[160:163]
ds_read_b64_tr_b16 v[212:213],v243 offset:57344
v_exp_f32 v232,v232
v_mfma_f32_16x16x32_bf16 v[164:167],v[216:219],v[84:87],v[164:167]
ds_read_b64_tr_b16 v[214:215],v243 offset:59392
v_exp_f32 v233,v233
s_waitcnt lgkmcnt(4)
v_mfma_f32_16x16x32_bf16 v[168:171],v[220:223],v[80:83],v[168:171]
ds_read_b64_tr_b16 v[216:217],v242 offset:61440
v_exp_f32 v234,v234
v_mfma_f32_16x16x32_bf16 v[172:175],v[220:223],v[84:87],v[172:175]
ds_read_b64_tr_b16 v[218:219],v242 offset:63488
v_exp_f32 v235,v235
v_mul_f32 v196,v180,v196
s_waitcnt lgkmcnt(4)
v_mfma_f32_16x16x32_bf16 v[144:147],v[208:211],v[88:91],v[144:147]
ds_read_b64_tr_b16 v[220:221],v243 offset:61440
v_mul_f32 v197,v181,v197
v_mfma_f32_16x16x32_bf16 v[148:151],v[208:211],v[92:95],v[148:151]
ds_read_b64_tr_b16 v[222:223],v243 offset:63488
v_mul_f32 v198,v182,v198
s_waitcnt lgkmcnt(4)
v_mfma_f32_16x16x32_bf16 v[152:155],v[212:215],v[88:91],v[152:155]
ds_read_b64_tr_b16 v[208:209],v242 offset:0
v_mul_f32 v199,v183,v199
v_mfma_f32_16x16x32_bf16 v[156:159],v[212:215],v[92:95],v[156:159]
ds_read_b64_tr_b16 v[210:211],v242 offset:2048
v_fma_f32 v232,v232,v241,v241
s_waitcnt lgkmcnt(4)
v_mfma_f32_16x16x32_bf16 v[160:163],v[216:219],v[88:91],v[160:163]
ds_read_b64_tr_b16 v[212:213],v243 offset:0
v_fma_f32 v233,v233,v241,v241
v_mfma_f32_16x16x32_bf16 v[164:167],v[216:219],v[92:95],v[164:167]
ds_read_b64_tr_b16 v[214:215],v243 offset:2048
v_fma_f32 v234,v234,v241,v241
s_waitcnt lgkmcnt(4)
v_mfma_f32_16x16x32_bf16 v[168:171],v[220:223],v[88:91],v[168:171]
ds_read_b64_tr_b16 v[216:217],v242 offset:4096
v_fma_f32 v235,v235,v241,v241
v_mfma_f32_16x16x32_bf16 v[172:175],v[220:223],v[92:95],v[172:175]
ds_read_b64_tr_b16 v[218:219],v242 offset:6144
v_rcp_f32 v232,v232
s_barrier
s_waitcnt lgkmcnt(4)
v_mfma_f32_16x16x32_bf16 v[144:147],v[208:211],v[96:99],v[144:147]
ds_read_b64_tr_b16 v[220:221],v243 offset:4096
v_rcp_f32 v233,v233
v_mfma_f32_16x16x32_bf16 v[148:151],v[208:211],v[100:103],v[148:151]
ds_read_b64_tr_b16 v[222:223],v243 offset:6144
v_rcp_f32 v234,v234
s_waitcnt lgkmcnt(4)
v_mfma_f32_16x16x32_bf16 v[152:155],v[212:215],v[96:99],v[152:155]
ds_read_b64_tr_b16 v[208:209],v242 offset:8192
v_rcp_f32 v235,v235
v_mfma_f32_16x16x32_bf16 v[156:159],v[212:215],v[100:103],v[156:159]
ds_read_b64_tr_b16 v[210:211],v242 offset:10240
v_mul_f32 v196,v196,v232
s_waitcnt lgkmcnt(4)
v_mfma_f32_16x16x32_bf16 v[160:163],v[216:219],v[96:99],v[160:163]
ds_read_b64_tr_b16 v[212:213],v243 offset:8192
v_mul_f32 v197,v197,v233
v_mfma_f32_16x16x32_bf16 v[164:167],v[216:219],v[100:103],v[164:167]
ds_read_b64_tr_b16 v[214:215],v243 offset:10240
v_mul_f32 v198,v198,v234
s_waitcnt lgkmcnt(4)
v_mfma_f32_16x16x32_bf16 v[168:171],v[220:223],v[96:99],v[168:171]
ds_read_b64_tr_b16 v[216:217],v242 offset:12288
v_mul_f32 v199,v199,v235
v_mfma_f32_16x16x32_bf16 v[172:175],v[220:223],v[100:103],v[172:175]
ds_read_b64_tr_b16 v[218:219],v242 offset:14336
v_cvt_pk_bf16_f32 v228,v196,v197
v_cvt_pk_bf16_f32 v229,v198,v199
s_waitcnt lgkmcnt(4)
v_mfma_f32_16x16x32_bf16 v[144:147],v[208:211],v[104:107],v[144:147]
ds_read_b64_tr_b16 v[220:221],v243 offset:12288
v_mul_f32 v232,v188,v188
v_mfma_f32_16x16x32_bf16 v[148:151],v[208:211],v[108:111],v[148:151]
ds_read_b64_tr_b16 v[222:223],v243 offset:14336
v_mul_f32 v233,v189,v189
s_waitcnt lgkmcnt(4)
v_mfma_f32_16x16x32_bf16 v[152:155],v[212:215],v[104:107],v[152:155]
ds_read_b64_tr_b16 v[208:209],v242 offset:16384
v_mul_f32 v234,v190,v190
v_mfma_f32_16x16x32_bf16 v[156:159],v[212:215],v[108:111],v[156:159]
ds_read_b64_tr_b16 v[210:211],v242 offset:18432
v_mul_f32 v235,v191,v191
s_waitcnt lgkmcnt(4)
v_mfma_f32_16x16x32_bf16 v[160:163],v[216:219],v[104:107],v[160:163]
ds_read_b64_tr_b16 v[212:213],v243 offset:16384
v_fma_f32 v232,v232,v240,v239
v_mfma_f32_16x16x32_bf16 v[164:167],v[216:219],v[108:111],v[164:167]
ds_read_b64_tr_b16 v[214:215],v243 offset:18432
v_fma_f32 v233,v233,v240,v239
s_waitcnt lgkmcnt(4)
v_mfma_f32_16x16x32_bf16 v[168:171],v[220:223],v[104:107],v[168:171]
ds_read_b64_tr_b16 v[216:217],v242 offset:20480
v_fma_f32 v234,v234,v240,v239
v_mfma_f32_16x16x32_bf16 v[172:175],v[220:223],v[108:111],v[172:175]
ds_read_b64_tr_b16 v[218:219],v242 offset:22528
v_fma_f32 v235,v235,v240,v239
s_barrier
s_waitcnt lgkmcnt(4)
v_mfma_f32_16x16x32_bf16 v[144:147],v[208:211],v[112:115],v[144:147]
ds_read_b64_tr_b16 v[220:221],v243 offset:20480
v_mul_f32 v232,v188,v232
v_mfma_f32_16x16x32_bf16 v[148:151],v[208:211],v[116:119],v[148:151]
ds_read_b64_tr_b16 v[222:223],v243 offset:22528
v_mul_f32 v233,v189,v233
s_waitcnt lgkmcnt(4)
v_mfma_f32_16x16x32_bf16 v[152:155],v[212:215],v[112:115],v[152:155]
ds_read_b64_tr_b16 v[208:209],v242 offset:24576
v_mul_f32 v234,v190,v234
v_mfma_f32_16x16x32_bf16 v[156:159],v[212:215],v[116:119],v[156:159]
ds_read_b64_tr_b16 v[210:211],v242 offset:26624
v_mul_f32 v235,v191,v235
s_waitcnt lgkmcnt(4)
v_mfma_f32_16x16x32_bf16 v[160:163],v[216:219],v[112:115],v[160:163]
ds_read_b64_tr_b16 v[212:213],v243 offset:24576
v_exp_f32 v232,v232
v_mfma_f32_16x16x32_bf16 v[164:167],v[216:219],v[116:119],v[164:167]
ds_read_b64_tr_b16 v[214:215],v243 offset:26624
v_exp_f32 v233,v233
s_waitcnt lgkmcnt(4)
v_mfma_f32_16x16x32_bf16 v[168:171],v[220:223],v[112:115],v[168:171]
ds_read_b64_tr_b16 v[216:217],v242 offset:28672
v_exp_f32 v234,v234
v_mfma_f32_16x16x32_bf16 v[172:175],v[220:223],v[116:119],v[172:175]
ds_read_b64_tr_b16 v[218:219],v242 offset:30720
v_exp_f32 v235,v235
v_mul_f32 v204,v188,v204
s_waitcnt lgkmcnt(4)
v_mfma_f32_16x16x32_bf16 v[144:147],v[208:211],v[120:123],v[144:147]
ds_read_b64_tr_b16 v[220:221],v243 offset:28672
v_mul_f32 v205,v189,v205
v_mfma_f32_16x16x32_bf16 v[148:151],v[208:211],v[124:127],v[148:151]
ds_read_b64_tr_b16 v[222:223],v243 offset:30720
v_mul_f32 v206,v190,v206
s_waitcnt lgkmcnt(4)
v_mfma_f32_16x16x32_bf16 v[152:155],v[212:215],v[120:123],v[152:155]
ds_read_b64_tr_b16 v[208:209],v242 offset:32768
v_mul_f32 v207,v191,v207
v_mfma_f32_16x16x32_bf16 v[156:159],v[212:215],v[124:127],v[156:159]
ds_read_b64_tr_b16 v[210:211],v242 offset:34816
v_fma_f32 v232,v232,v241,v241
s_waitcnt lgkmcnt(4)
v_mfma_f32_16x16x32_bf16 v[160:163],v[216:219],v[120:123],v[160:163]
ds_read_b64_tr_b16 v[212:213],v243 offset:32768
v_fma_f32 v233,v233,v241,v241
v_mfma_f32_16x16x32_bf16 v[164:167],v[216:219],v[124:127],v[164:167]
ds_read_b64_tr_b16 v[214:215],v243 offset:34816
v_fma_f32 v234,v234,v241,v241
s_waitcnt lgkmcnt(4)
v_mfma_f32_16x16x32_bf16 v[168:171],v[220:223],v[120:123],v[168:171]
ds_read_b64_tr_b16 v[216:217],v242 offset:36864
v_fma_f32 v235,v235,v241,v241
v_mfma_f32_16x16x32_bf16 v[172:175],v[220:223],v[124:127],v[172:175]
ds_read_b64_tr_b16 v[218:219],v242 offset:38912
v_rcp_f32 v232,v232
s_barrier
s_waitcnt lgkmcnt(4)
v_mfma_f32_16x16x32_bf16 v[144:147],v[208:211],v[128:131],v[144:147]
ds_read_b64_tr_b16 v[220:221],v243 offset:36864
v_rcp_f32 v233,v233
v_mfma_f32_16x16x32_bf16 v[148:151],v[208:211],v[132:135],v[148:151]
ds_read_b64_tr_b16 v[222:223],v243 offset:38912
v_rcp_f32 v234,v234
s_waitcnt lgkmcnt(4)
v_mfma_f32_16x16x32_bf16 v[152:155],v[212:215],v[128:131],v[152:155]
ds_read_b64_tr_b16 v[208:209],v242 offset:40960
v_rcp_f32 v235,v235
v_mfma_f32_16x16x32_bf16 v[156:159],v[212:215],v[132:135],v[156:159]
ds_read_b64_tr_b16 v[210:211],v242 offset:43008
v_mul_f32 v204,v204,v232
s_waitcnt lgkmcnt(4)
v_mfma_f32_16x16x32_bf16 v[160:163],v[216:219],v[128:131],v[160:163]
ds_read_b64_tr_b16 v[212:213],v243 offset:40960
v_mul_f32 v205,v205,v233
v_mfma_f32_16x16x32_bf16 v[164:167],v[216:219],v[132:135],v[164:167]
ds_read_b64_tr_b16 v[214:215],v243 offset:43008
v_mul_f32 v206,v206,v234
s_waitcnt lgkmcnt(4)
v_mfma_f32_16x16x32_bf16 v[168:171],v[220:223],v[128:131],v[168:171]
ds_read_b64_tr_b16 v[216:217],v242 offset:45056
v_mul_f32 v207,v207,v235
v_mfma_f32_16x16x32_bf16 v[172:175],v[220:223],v[132:135],v[172:175]
ds_read_b64_tr_b16 v[218:219],v242 offset:47104
v_cvt_pk_bf16_f32 v230,v204,v205
v_cvt_pk_bf16_f32 v231,v206,v207
s_waitcnt lgkmcnt(4)
v_mfma_f32_16x16x32_bf16 v[144:147],v[208:211],v[136:139],v[144:147]
ds_read_b64_tr_b16 v[220:221],v243 offset:45056
v_mfma_f32_16x16x32_bf16 v[148:151],v[208:211],v[140:143],v[148:151]
ds_read_b64_tr_b16 v[222:223],v243 offset:47104
ds_write_b128 v253,v[224:227] offset:4096
s_waitcnt lgkmcnt(5)
v_mfma_f32_16x16x32_bf16 v[152:155],v[212:215],v[136:139],v[152:155]
ds_read_b64_tr_b16 v[208:209],v242 offset:49152
ds_write_b128 v253,v[228:231] offset:5120
v_mfma_f32_16x16x32_bf16 v[156:159],v[212:215],v[140:143],v[156:159]
ds_read_b64_tr_b16 v[210:211],v242 offset:51200
s_lshl_b32 s40,s42,11
s_waitcnt lgkmcnt(6)
v_mfma_f32_16x16x32_bf16 v[160:163],v[216:219],v[136:139],v[160:163]
ds_read_b64_tr_b16 v[212:213],v243 offset:49152
s_add_u32 s40,s40,4096
v_mfma_f32_16x16x32_bf16 v[164:167],v[216:219],v[140:143],v[164:167]
ds_read_b64_tr_b16 v[214:215],v243 offset:51200
s_add_u32 s40,s40,s93
s_waitcnt lgkmcnt(6)
v_mfma_f32_16x16x32_bf16 v[168:171],v[220:223],v[136:139],v[168:171]
ds_read_b64_tr_b16 v[216:217],v242 offset:53248
buffer_store_dwordx4 v[224:227],v254,s[68:71],s40 offen offset:0 sc1
v_mfma_f32_16x16x32_bf16 v[172:175],v[220:223],v[140:143],v[172:175]
ds_read_b64_tr_b16 v[218:219],v242 offset:55296
buffer_store_dwordx4 v[228:231],v254,s[68:71],s40 offen offset:1024 sc1
s_waitcnt lgkmcnt(5)
s_barrier
s_waitcnt lgkmcnt(4)
v_mfma_f32_16x16x32_bf16 v[176:179],v[208:211],v[0:3],0
ds_read_b64_tr_b16 v[220:221],v243 offset:53248
v_mfma_f32_16x16x32_bf16 v[180:183],v[208:211],v[4:7],0
ds_read_b64_tr_b16 v[222:223],v243 offset:55296
s_waitcnt lgkmcnt(4)
v_mfma_f32_16x16x32_bf16 v[184:187],v[212:215],v[0:3],0
ds_read_b64_tr_b16 v[208:209],v242 offset:57344
v_mfma_f32_16x16x32_bf16 v[188:191],v[212:215],v[4:7],0
ds_read_b64_tr_b16 v[210:211],v242 offset:59392
s_waitcnt lgkmcnt(4)
v_mfma_f32_16x16x32_bf16 v[192:195],v[216:219],v[0:3],0
ds_read_b64_tr_b16 v[212:213],v243 offset:57344
v_mfma_f32_16x16x32_bf16 v[196:199],v[216:219],v[4:7],0
ds_read_b64_tr_b16 v[214:215],v243 offset:59392
s_waitcnt lgkmcnt(4)
v_mfma_f32_16x16x32_bf16 v[200:203],v[220:223],v[0:3],0
ds_read_b64_tr_b16 v[216:217],v242 offset:61440
v_mfma_f32_16x16x32_bf16 v[204:207],v[220:223],v[4:7],0
ds_read_b64_tr_b16 v[218:219],v242 offset:63488
s_waitcnt lgkmcnt(4)
v_mfma_f32_16x16x32_bf16 v[176:179],v[208:211],v[8:11],v[176:179]
ds_read_b64_tr_b16 v[220:221],v243 offset:61440
v_mul_f32 v232,v144,v144
v_mfma_f32_16x16x32_bf16 v[180:183],v[208:211],v[12:15],v[180:183]
ds_read_b64_tr_b16 v[222:223],v243 offset:63488
v_mul_f32 v233,v145,v145
s_waitcnt lgkmcnt(4)
v_mfma_f32_16x16x32_bf16 v[184:187],v[212:215],v[8:11],v[184:187]
ds_read_b64_tr_b16 v[208:209],v242 offset:0
v_mul_f32 v234,v146,v146
v_mfma_f32_16x16x32_bf16 v[188:191],v[212:215],v[12:15],v[188:191]
ds_read_b64_tr_b16 v[210:211],v242 offset:2048
v_mul_f32 v235,v147,v147
s_waitcnt lgkmcnt(4)
v_mfma_f32_16x16x32_bf16 v[192:195],v[216:219],v[8:11],v[192:195]
ds_read_b64_tr_b16 v[212:213],v243 offset:0
v_fma_f32 v232,v232,v237,v236
v_mfma_f32_16x16x32_bf16 v[196:199],v[216:219],v[12:15],v[196:199]
ds_read_b64_tr_b16 v[214:215],v243 offset:2048
v_fma_f32 v233,v233,v237,v236
s_waitcnt lgkmcnt(4)
v_mfma_f32_16x16x32_bf16 v[200:203],v[220:223],v[8:11],v[200:203]
ds_read_b64_tr_b16 v[216:217],v242 offset:4096
v_fma_f32 v234,v234,v237,v236
v_mfma_f32_16x16x32_bf16 v[204:207],v[220:223],v[12:15],v[204:207]
ds_read_b64_tr_b16 v[218:219],v242 offset:6144
v_fma_f32 v235,v235,v237,v236
s_barrier
s_waitcnt lgkmcnt(4)
v_mfma_f32_16x16x32_bf16 v[176:179],v[208:211],v[16:19],v[176:179]
ds_read_b64_tr_b16 v[220:221],v243 offset:4096
v_mul_f32 v232,v144,v232
v_mfma_f32_16x16x32_bf16 v[180:183],v[208:211],v[20:23],v[180:183]
ds_read_b64_tr_b16 v[222:223],v243 offset:6144
v_mul_f32 v233,v145,v233
s_waitcnt lgkmcnt(4)
v_mfma_f32_16x16x32_bf16 v[184:187],v[212:215],v[16:19],v[184:187]
ds_read_b64_tr_b16 v[208:209],v242 offset:8192
v_mul_f32 v234,v146,v234
v_mfma_f32_16x16x32_bf16 v[188:191],v[212:215],v[20:23],v[188:191]
ds_read_b64_tr_b16 v[210:211],v242 offset:10240
v_mul_f32 v235,v147,v235
s_waitcnt lgkmcnt(4)
v_mfma_f32_16x16x32_bf16 v[192:195],v[216:219],v[16:19],v[192:195]
ds_read_b64_tr_b16 v[212:213],v243 offset:8192
v_exp_f32 v232,v232
v_mfma_f32_16x16x32_bf16 v[196:199],v[216:219],v[20:23],v[196:199]
ds_read_b64_tr_b16 v[214:215],v243 offset:10240
v_exp_f32 v233,v233
s_waitcnt lgkmcnt(4)
v_mfma_f32_16x16x32_bf16 v[200:203],v[220:223],v[16:19],v[200:203]
ds_read_b64_tr_b16 v[216:217],v242 offset:12288
v_exp_f32 v234,v234
v_mfma_f32_16x16x32_bf16 v[204:207],v[220:223],v[20:23],v[204:207]
ds_read_b64_tr_b16 v[218:219],v242 offset:14336
v_exp_f32 v235,v235
v_mul_f32 v160,v144,v160
s_waitcnt lgkmcnt(4)
v_mfma_f32_16x16x32_bf16 v[176:179],v[208:211],v[24:27],v[176:179]
ds_read_b64_tr_b16 v[220:221],v243 offset:12288
v_mul_f32 v161,v145,v161
v_mfma_f32_16x16x32_bf16 v[180:183],v[208:211],v[28:31],v[180:183]
ds_read_b64_tr_b16 v[222:223],v243 offset:14336
v_mul_f32 v162,v146,v162
s_waitcnt lgkmcnt(4)
v_mfma_f32_16x16x32_bf16 v[184:187],v[212:215],v[24:27],v[184:187]
ds_read_b64_tr_b16 v[208:209],v242 offset:16384
v_mul_f32 v163,v147,v163
v_mfma_f32_16x16x32_bf16 v[188:191],v[212:215],v[28:31],v[188:191]
ds_read_b64_tr_b16 v[210:211],v242 offset:18432
v_fma_f32 v232,v232,v238,v238
s_waitcnt lgkmcnt(4)
v_mfma_f32_16x16x32_bf16 v[192:195],v[216:219],v[24:27],v[192:195]
ds_read_b64_tr_b16 v[212:213],v243 offset:16384
v_fma_f32 v233,v233,v238,v238
v_mfma_f32_16x16x32_bf16 v[196:199],v[216:219],v[28:31],v[196:199]
ds_read_b64_tr_b16 v[214:215],v243 offset:18432
v_fma_f32 v234,v234,v238,v238
s_waitcnt lgkmcnt(4)
v_mfma_f32_16x16x32_bf16 v[200:203],v[220:223],v[24:27],v[200:203]
ds_read_b64_tr_b16 v[216:217],v242 offset:20480
v_fma_f32 v235,v235,v238,v238
v_mfma_f32_16x16x32_bf16 v[204:207],v[220:223],v[28:31],v[204:207]
ds_read_b64_tr_b16 v[218:219],v242 offset:22528
v_rcp_f32 v232,v232
s_barrier
s_waitcnt lgkmcnt(4)
v_mfma_f32_16x16x32_bf16 v[176:179],v[208:211],v[32:35],v[176:179]
ds_read_b64_tr_b16 v[220:221],v243 offset:20480
v_rcp_f32 v233,v233
v_mfma_f32_16x16x32_bf16 v[180:183],v[208:211],v[36:39],v[180:183]
ds_read_b64_tr_b16 v[222:223],v243 offset:22528
v_rcp_f32 v234,v234
s_waitcnt lgkmcnt(4)
v_mfma_f32_16x16x32_bf16 v[184:187],v[212:215],v[32:35],v[184:187]
ds_read_b64_tr_b16 v[208:209],v242 offset:24576
v_rcp_f32 v235,v235
v_mfma_f32_16x16x32_bf16 v[188:191],v[212:215],v[36:39],v[188:191]
ds_read_b64_tr_b16 v[210:211],v242 offset:26624
v_mul_f32 v160,v160,v232
s_waitcnt lgkmcnt(4)
v_mfma_f32_16x16x32_bf16 v[192:195],v[216:219],v[32:35],v[192:195]
ds_read_b64_tr_b16 v[212:213],v243 offset:24576
v_mul_f32 v161,v161,v233
v_mfma_f32_16x16x32_bf16 v[196:199],v[216:219],v[36:39],v[196:199]
ds_read_b64_tr_b16 v[214:215],v243 offset:26624
v_mul_f32 v162,v162,v234
s_waitcnt lgkmcnt(4)
v_mfma_f32_16x16x32_bf16 v[200:203],v[220:223],v[32:35],v[200:203]
ds_read_b64_tr_b16 v[216:217],v242 offset:28672
v_mul_f32 v163,v163,v235
v_mfma_f32_16x16x32_bf16 v[204:207],v[220:223],v[36:39],v[204:207]
ds_read_b64_tr_b16 v[218:219],v242 offset:30720
v_cvt_pk_bf16_f32 v224,v160,v161
v_cvt_pk_bf16_f32 v225,v162,v163
s_waitcnt lgkmcnt(4)
v_mfma_f32_16x16x32_bf16 v[176:179],v[208:211],v[40:43],v[176:179]
ds_read_b64_tr_b16 v[220:221],v243 offset:28672
v_mul_f32 v232,v152,v152
v_mfma_f32_16x16x32_bf16 v[180:183],v[208:211],v[44:47],v[180:183]
ds_read_b64_tr_b16 v[222:223],v243 offset:30720
v_mul_f32 v233,v153,v153
s_waitcnt lgkmcnt(4)
v_mfma_f32_16x16x32_bf16 v[184:187],v[212:215],v[40:43],v[184:187]
ds_read_b64_tr_b16 v[208:209],v242 offset:32768
v_mul_f32 v234,v154,v154
v_mfma_f32_16x16x32_bf16 v[188:191],v[212:215],v[44:47],v[188:191]
ds_read_b64_tr_b16 v[210:211],v242 offset:34816
v_mul_f32 v235,v155,v155
s_waitcnt lgkmcnt(4)
v_mfma_f32_16x16x32_bf16 v[192:195],v[216:219],v[40:43],v[192:195]
ds_read_b64_tr_b16 v[212:213],v243 offset:32768
v_fma_f32 v232,v232,v237,v236
v_mfma_f32_16x16x32_bf16 v[196:199],v[216:219],v[44:47],v[196:199]
ds_read_b64_tr_b16 v[214:215],v243 offset:34816
v_fma_f32 v233,v233,v237,v236
s_waitcnt lgkmcnt(4)
v_mfma_f32_16x16x32_bf16 v[200:203],v[220:223],v[40:43],v[200:203]
ds_read_b64_tr_b16 v[216:217],v242 offset:36864
v_fma_f32 v234,v234,v237,v236
v_mfma_f32_16x16x32_bf16 v[204:207],v[220:223],v[44:47],v[204:207]
ds_read_b64_tr_b16 v[218:219],v242 offset:38912
v_fma_f32 v235,v235,v237,v236
s_barrier
s_waitcnt lgkmcnt(4)
v_mfma_f32_16x16x32_bf16 v[176:179],v[208:211],v[48:51],v[176:179]
ds_read_b64_tr_b16 v[220:221],v243 offset:36864
v_mul_f32 v232,v152,v232
v_mfma_f32_16x16x32_bf16 v[180:183],v[208:211],v[52:55],v[180:183]
ds_read_b64_tr_b16 v[222:223],v243 offset:38912
v_mul_f32 v233,v153,v233
s_waitcnt lgkmcnt(4)
v_mfma_f32_16x16x32_bf16 v[184:187],v[212:215],v[48:51],v[184:187]
ds_read_b64_tr_b16 v[208:209],v242 offset:40960
v_mul_f32 v234,v154,v234
v_mfma_f32_16x16x32_bf16 v[188:191],v[212:215],v[52:55],v[188:191]
ds_read_b64_tr_b16 v[210:211],v242 offset:43008
v_mul_f32 v235,v155,v235
s_waitcnt lgkmcnt(4)
v_mfma_f32_16x16x32_bf16 v[192:195],v[216:219],v[48:51],v[192:195]
ds_read_b64_tr_b16 v[212:213],v243 offset:40960
v_exp_f32 v232,v232
v_mfma_f32_16x16x32_bf16 v[196:199],v[216:219],v[52:55],v[196:199]
ds_read_b64_tr_b16 v[214:215],v243 offset:43008
v_exp_f32 v233,v233
s_waitcnt lgkmcnt(4)
v_mfma_f32_16x16x32_bf16 v[200:203],v[220:223],v[48:51],v[200:203]
ds_read_b64_tr_b16 v[216:217],v242 offset:45056
v_exp_f32 v234,v234
v_mfma_f32_16x16x32_bf16 v[204:207],v[220:223],v[52:55],v[204:207]
ds_read_b64_tr_b16 v[218:219],v242 offset:47104
v_exp_f32 v235,v235
v_mul_f32 v168,v152,v168
s_waitcnt lgkmcnt(4)
v_mfma_f32_16x16x32_bf16 v[176:179],v[208:211],v[56:59],v[176:179]
ds_read_b64_tr_b16 v[220:221],v243 offset:45056
v_mul_f32 v169,v153,v169
v_mfma_f32_16x16x32_bf16 v[180:183],v[208:211],v[60:63],v[180:183]
ds_read_b64_tr_b16 v[222:223],v243 offset:47104
v_mul_f32 v170,v154,v170
s_waitcnt lgkmcnt(4)
v_mfma_f32_16x16x32_bf16 v[184:187],v[212:215],v[56:59],v[184:187]
ds_read_b64_tr_b16 v[208:209],v242 offset:49152
v_mul_f32 v171,v155,v171
v_mfma_f32_16x16x32_bf16 v[188:191],v[212:215],v[60:63],v[188:191]
ds_read_b64_tr_b16 v[210:211],v242 offset:51200
v_fma_f32 v232,v232,v238,v238
s_waitcnt lgkmcnt(4)
v_mfma_f32_16x16x32_bf16 v[192:195],v[216:219],v[56:59],v[192:195]
ds_read_b64_tr_b16 v[212:213],v243 offset:49152
v_fma_f32 v233,v233,v238,v238
v_mfma_f32_16x16x32_bf16 v[196:199],v[216:219],v[60:63],v[196:199]
ds_read_b64_tr_b16 v[214:215],v243 offset:51200
v_fma_f32 v234,v234,v238,v238
s_waitcnt lgkmcnt(4)
v_mfma_f32_16x16x32_bf16 v[200:203],v[220:223],v[56:59],v[200:203]
ds_read_b64_tr_b16 v[216:217],v242 offset:53248
v_fma_f32 v235,v235,v238,v238
v_mfma_f32_16x16x32_bf16 v[204:207],v[220:223],v[60:63],v[204:207]
ds_read_b64_tr_b16 v[218:219],v242 offset:55296
v_rcp_f32 v232,v232
s_barrier
s_waitcnt lgkmcnt(4)
v_mfma_f32_16x16x32_bf16 v[176:179],v[208:211],v[64:67],v[176:179]
ds_read_b64_tr_b16 v[220:221],v243 offset:53248
v_rcp_f32 v233,v233
v_mfma_f32_16x16x32_bf16 v[180:183],v[208:211],v[68:71],v[180:183]
ds_read_b64_tr_b16 v[222:223],v243 offset:55296
v_rcp_f32 v234,v234
s_waitcnt lgkmcnt(4)
v_mfma_f32_16x16x32_bf16 v[184:187],v[212:215],v[64:67],v[184:187]
ds_read_b64_tr_b16 v[208:209],v242 offset:57344
v_rcp_f32 v235,v235
v_mfma_f32_16x16x32_bf16 v[188:191],v[212:215],v[68:71],v[188:191]
ds_read_b64_tr_b16 v[210:211],v242 offset:59392
v_mul_f32 v168,v168,v232
s_waitcnt lgkmcnt(4)
v_mfma_f32_16x16x32_bf16 v[192:195],v[216:219],v[64:67],v[192:195]
ds_read_b64_tr_b16 v[212:213],v243 offset:57344
v_mul_f32 v169,v169,v233
v_mfma_f32_16x16x32_bf16 v[196:199],v[216:219],v[68:71],v[196:199]
ds_read_b64_tr_b16 v[214:215],v243 offset:59392
v_mul_f32 v170,v170,v234
s_waitcnt lgkmcnt(4)
v_mfma_f32_16x16x32_bf16 v[200:203],v[220:223],v[64:67],v[200:203]
ds_read_b64_tr_b16 v[216:217],v242 offset:61440
v_mul_f32 v171,v171,v235
v_mfma_f32_16x16x32_bf16 v[204:207],v[220:223],v[68:71],v[204:207]
ds_read_b64_tr_b16 v[218:219],v242 offset:63488
v_cvt_pk_bf16_f32 v226,v168,v169
v_cvt_pk_bf16_f32 v227,v170,v171
s_waitcnt lgkmcnt(4)
v_mfma_f32_16x16x32_bf16 v[176:179],v[208:211],v[72:75],v[176:179]
ds_read_b64_tr_b16 v[220:221],v243 offset:61440
v_mul_f32 v232,v148,v148
v_mfma_f32_16x16x32_bf16 v[180:183],v[208:211],v[76:79],v[180:183]
ds_read_b64_tr_b16 v[222:223],v243 offset:63488
v_mul_f32 v233,v149,v149
s_waitcnt lgkmcnt(4)
v_mfma_f32_16x16x32_bf16 v[184:187],v[212:215],v[72:75],v[184:187]
ds_read_b64_tr_b16 v[208:209],v242 offset:0
v_mul_f32 v234,v150,v150
v_mfma_f32_16x16x32_bf16 v[188:191],v[212:215],v[76:79],v[188:191]
ds_read_b64_tr_b16 v[210:211],v242 offset:2048
v_mul_f32 v235,v151,v151
s_waitcnt lgkmcnt(4)
v_mfma_f32_16x16x32_bf16 v[192:195],v[216:219],v[72:75],v[192:195]
ds_read_b64_tr_b16 v[212:213],v243 offset:0
v_fma_f32 v232,v232,v240,v239
v_mfma_f32_16x16x32_bf16 v[196:199],v[216:219],v[76:79],v[196:199]
ds_read_b64_tr_b16 v[214:215],v243 offset:2048
v_fma_f32 v233,v233,v240,v239
s_waitcnt lgkmcnt(4)
v_mfma_f32_16x16x32_bf16 v[200:203],v[220:223],v[72:75],v[200:203]
ds_read_b64_tr_b16 v[216:217],v242 offset:4096
v_fma_f32 v234,v234,v240,v239
v_mfma_f32_16x16x32_bf16 v[204:207],v[220:223],v[76:79],v[204:207]
ds_read_b64_tr_b16 v[218:219],v242 offset:6144
v_fma_f32 v235,v235,v240,v239
s_barrier
s_waitcnt lgkmcnt(4)
v_mfma_f32_16x16x32_bf16 v[176:179],v[208:211],v[80:83],v[176:179]
ds_read_b64_tr_b16 v[220:221],v243 offset:4096
v_mul_f32 v232,v148,v232
v_mfma_f32_16x16x32_bf16 v[180:183],v[208:211],v[84:87],v[180:183]
ds_read_b64_tr_b16 v[222:223],v243 offset:6144
v_mul_f32 v233,v149,v233
s_waitcnt lgkmcnt(4)
v_mfma_f32_16x16x32_bf16 v[184:187],v[212:215],v[80:83],v[184:187]
ds_read_b64_tr_b16 v[208:209],v242 offset:8192
v_mul_f32 v234,v150,v234
v_mfma_f32_16x16x32_bf16 v[188:191],v[212:215],v[84:87],v[188:191]
ds_read_b64_tr_b16 v[210:211],v242 offset:10240
v_mul_f32 v235,v151,v235
s_waitcnt lgkmcnt(4)
v_mfma_f32_16x16x32_bf16 v[192:195],v[216:219],v[80:83],v[192:195]
ds_read_b64_tr_b16 v[212:213],v243 offset:8192
v_exp_f32 v232,v232
v_mfma_f32_16x16x32_bf16 v[196:199],v[216:219],v[84:87],v[196:199]
ds_read_b64_tr_b16 v[214:215],v243 offset:10240
v_exp_f32 v233,v233
s_waitcnt lgkmcnt(4)
v_mfma_f32_16x16x32_bf16 v[200:203],v[220:223],v[80:83],v[200:203]
ds_read_b64_tr_b16 v[216:217],v242 offset:12288
v_exp_f32 v234,v234
v_mfma_f32_16x16x32_bf16 v[204:207],v[220:223],v[84:87],v[204:207]
ds_read_b64_tr_b16 v[218:219],v242 offset:14336
v_exp_f32 v235,v235
v_mul_f32 v164,v148,v164
s_waitcnt lgkmcnt(4)
v_mfma_f32_16x16x32_bf16 v[176:179],v[208:211],v[88:91],v[176:179]
ds_read_b64_tr_b16 v[220:221],v243 offset:12288
v_mul_f32 v165,v149,v165
v_mfma_f32_16x16x32_bf16 v[180:183],v[208:211],v[92:95],v[180:183]
ds_read_b64_tr_b16 v[222:223],v243 offset:14336
v_mul_f32 v166,v150,v166
s_waitcnt lgkmcnt(4)
v_mfma_f32_16x16x32_bf16 v[184:187],v[212:215],v[88:91],v[184:187]
ds_read_b64_tr_b16 v[208:209],v242 offset:16384
v_mul_f32 v167,v151,v167
v_mfma_f32_16x16x32_bf16 v[188:191],v[212:215],v[92:95],v[188:191]
ds_read_b64_tr_b16 v[210:211],v242 offset:18432
v_fma_f32 v232,v232,v241,v241
s_waitcnt lgkmcnt(4)
v_mfma_f32_16x16x32_bf16 v[192:195],v[216:219],v[88:91],v[192:195]
ds_read_b64_tr_b16 v[212:213],v243 offset:16384
v_fma_f32 v233,v233,v241,v241
v_mfma_f32_16x16x32_bf16 v[196:199],v[216:219],v[92:95],v[196:199]
ds_read_b64_tr_b16 v[214:215],v243 offset:18432
v_fma_f32 v234,v234,v241,v241
s_waitcnt lgkmcnt(4)
v_mfma_f32_16x16x32_bf16 v[200:203],v[220:223],v[88:91],v[200:203]
ds_read_b64_tr_b16 v[216:217],v242 offset:20480
v_fma_f32 v235,v235,v241,v241
v_mfma_f32_16x16x32_bf16 v[204:207],v[220:223],v[92:95],v[204:207]
ds_read_b64_tr_b16 v[218:219],v242 offset:22528
v_rcp_f32 v232,v232
s_barrier
s_waitcnt lgkmcnt(4)
v_mfma_f32_16x16x32_bf16 v[176:179],v[208:211],v[96:99],v[176:179]
ds_read_b64_tr_b16 v[220:221],v243 offset:20480
v_rcp_f32 v233,v233
v_mfma_f32_16x16x32_bf16 v[180:183],v[208:211],v[100:103],v[180:183]
ds_read_b64_tr_b16 v[222:223],v243 offset:22528
v_rcp_f32 v234,v234
s_waitcnt lgkmcnt(4)
v_mfma_f32_16x16x32_bf16 v[184:187],v[212:215],v[96:99],v[184:187]
ds_read_b64_tr_b16 v[208:209],v242 offset:24576
v_rcp_f32 v235,v235
v_mfma_f32_16x16x32_bf16 v[188:191],v[212:215],v[100:103],v[188:191]
ds_read_b64_tr_b16 v[210:211],v242 offset:26624
v_mul_f32 v164,v164,v232
s_waitcnt lgkmcnt(4)
v_mfma_f32_16x16x32_bf16 v[192:195],v[216:219],v[96:99],v[192:195]
ds_read_b64_tr_b16 v[212:213],v243 offset:24576
v_mul_f32 v165,v165,v233
v_mfma_f32_16x16x32_bf16 v[196:199],v[216:219],v[100:103],v[196:199]
ds_read_b64_tr_b16 v[214:215],v243 offset:26624
v_mul_f32 v166,v166,v234
s_waitcnt lgkmcnt(4)
v_mfma_f32_16x16x32_bf16 v[200:203],v[220:223],v[96:99],v[200:203]
ds_read_b64_tr_b16 v[216:217],v242 offset:28672
v_mul_f32 v167,v167,v235
v_mfma_f32_16x16x32_bf16 v[204:207],v[220:223],v[100:103],v[204:207]
ds_read_b64_tr_b16 v[218:219],v242 offset:30720
v_cvt_pk_bf16_f32 v228,v164,v165
v_cvt_pk_bf16_f32 v229,v166,v167
s_waitcnt lgkmcnt(4)
v_mfma_f32_16x16x32_bf16 v[176:179],v[208:211],v[104:107],v[176:179]
ds_read_b64_tr_b16 v[220:221],v243 offset:28672
v_mul_f32 v232,v156,v156
v_mfma_f32_16x16x32_bf16 v[180:183],v[208:211],v[108:111],v[180:183]
ds_read_b64_tr_b16 v[222:223],v243 offset:30720
v_mul_f32 v233,v157,v157
s_waitcnt lgkmcnt(4)
v_mfma_f32_16x16x32_bf16 v[184:187],v[212:215],v[104:107],v[184:187]
ds_read_b64_tr_b16 v[208:209],v242 offset:32768
v_mul_f32 v234,v158,v158
v_mfma_f32_16x16x32_bf16 v[188:191],v[212:215],v[108:111],v[188:191]
ds_read_b64_tr_b16 v[210:211],v242 offset:34816
v_mul_f32 v235,v159,v159
s_waitcnt lgkmcnt(4)
v_mfma_f32_16x16x32_bf16 v[192:195],v[216:219],v[104:107],v[192:195]
ds_read_b64_tr_b16 v[212:213],v243 offset:32768
v_fma_f32 v232,v232,v240,v239
v_mfma_f32_16x16x32_bf16 v[196:199],v[216:219],v[108:111],v[196:199]
ds_read_b64_tr_b16 v[214:215],v243 offset:34816
v_fma_f32 v233,v233,v240,v239
s_waitcnt lgkmcnt(4)
v_mfma_f32_16x16x32_bf16 v[200:203],v[220:223],v[104:107],v[200:203]
ds_read_b64_tr_b16 v[216:217],v242 offset:36864
v_fma_f32 v234,v234,v240,v239
v_mfma_f32_16x16x32_bf16 v[204:207],v[220:223],v[108:111],v[204:207]
ds_read_b64_tr_b16 v[218:219],v242 offset:38912
v_fma_f32 v235,v235,v240,v239
s_barrier
s_waitcnt lgkmcnt(4)
v_mfma_f32_16x16x32_bf16 v[176:179],v[208:211],v[112:115],v[176:179]
ds_read_b64_tr_b16 v[220:221],v243 offset:36864
v_mul_f32 v232,v156,v232
v_mfma_f32_16x16x32_bf16 v[180:183],v[208:211],v[116:119],v[180:183]
ds_read_b64_tr_b16 v[222:223],v243 offset:38912
v_mul_f32 v233,v157,v233
s_waitcnt lgkmcnt(4)
v_mfma_f32_16x16x32_bf16 v[184:187],v[212:215],v[112:115],v[184:187]
ds_read_b64_tr_b16 v[208:209],v242 offset:40960
v_mul_f32 v234,v158,v234
v_mfma_f32_16x16x32_bf16 v[188:191],v[212:215],v[116:119],v[188:191]
ds_read_b64_tr_b16 v[210:211],v242 offset:43008
v_mul_f32 v235,v159,v235
s_waitcnt lgkmcnt(4)
v_mfma_f32_16x16x32_bf16 v[192:195],v[216:219],v[112:115],v[192:195]
ds_read_b64_tr_b16 v[212:213],v243 offset:40960
v_exp_f32 v232,v232
v_mfma_f32_16x16x32_bf16 v[196:199],v[216:219],v[116:119],v[196:199]
ds_read_b64_tr_b16 v[214:215],v243 offset:43008
v_exp_f32 v233,v233
s_waitcnt lgkmcnt(4)
v_mfma_f32_16x16x32_bf16 v[200:203],v[220:223],v[112:115],v[200:203]
ds_read_b64_tr_b16 v[216:217],v242 offset:45056
v_exp_f32 v234,v234
v_mfma_f32_16x16x32_bf16 v[204:207],v[220:223],v[116:119],v[204:207]
ds_read_b64_tr_b16 v[218:219],v242 offset:47104
v_exp_f32 v235,v235
v_mul_f32 v172,v156,v172
s_waitcnt lgkmcnt(4)
v_mfma_f32_16x16x32_bf16 v[176:179],v[208:211],v[120:123],v[176:179]
ds_read_b64_tr_b16 v[220:221],v243 offset:45056
v_mul_f32 v173,v157,v173
v_mfma_f32_16x16x32_bf16 v[180:183],v[208:211],v[124:127],v[180:183]
ds_read_b64_tr_b16 v[222:223],v243 offset:47104
v_mul_f32 v174,v158,v174
s_waitcnt lgkmcnt(4)
v_mfma_f32_16x16x32_bf16 v[184:187],v[212:215],v[120:123],v[184:187]
ds_read_b64_tr_b16 v[208:209],v242 offset:49152
v_mul_f32 v175,v159,v175
v_mfma_f32_16x16x32_bf16 v[188:191],v[212:215],v[124:127],v[188:191]
ds_read_b64_tr_b16 v[210:211],v242 offset:51200
v_fma_f32 v232,v232,v241,v241
s_waitcnt lgkmcnt(4)
v_mfma_f32_16x16x32_bf16 v[192:195],v[216:219],v[120:123],v[192:195]
ds_read_b64_tr_b16 v[212:213],v243 offset:49152
v_fma_f32 v233,v233,v241,v241
v_mfma_f32_16x16x32_bf16 v[196:199],v[216:219],v[124:127],v[196:199]
ds_read_b64_tr_b16 v[214:215],v243 offset:51200
v_fma_f32 v234,v234,v241,v241
s_waitcnt lgkmcnt(4)
v_mfma_f32_16x16x32_bf16 v[200:203],v[220:223],v[120:123],v[200:203]
ds_read_b64_tr_b16 v[216:217],v242 offset:53248
v_fma_f32 v235,v235,v241,v241
v_mfma_f32_16x16x32_bf16 v[204:207],v[220:223],v[124:127],v[204:207]
ds_read_b64_tr_b16 v[218:219],v242 offset:55296
v_rcp_f32 v232,v232
s_barrier
s_waitcnt lgkmcnt(4)
v_mfma_f32_16x16x32_bf16 v[176:179],v[208:211],v[128:131],v[176:179]
ds_read_b64_tr_b16 v[220:221],v243 offset:53248
v_rcp_f32 v233,v233
v_mfma_f32_16x16x32_bf16 v[180:183],v[208:211],v[132:135],v[180:183]
ds_read_b64_tr_b16 v[222:223],v243 offset:55296
v_rcp_f32 v234,v234
s_waitcnt lgkmcnt(4)
v_mfma_f32_16x16x32_bf16 v[184:187],v[212:215],v[128:131],v[184:187]
ds_read_b64_tr_b16 v[208:209],v242 offset:57344
v_rcp_f32 v235,v235
v_mfma_f32_16x16x32_bf16 v[188:191],v[212:215],v[132:135],v[188:191]
ds_read_b64_tr_b16 v[210:211],v242 offset:59392
v_mul_f32 v172,v172,v232
s_waitcnt lgkmcnt(4)
v_mfma_f32_16x16x32_bf16 v[192:195],v[216:219],v[128:131],v[192:195]
ds_read_b64_tr_b16 v[212:213],v243 offset:57344
v_mul_f32 v173,v173,v233
v_mfma_f32_16x16x32_bf16 v[196:199],v[216:219],v[132:135],v[196:199]
ds_read_b64_tr_b16 v[214:215],v243 offset:59392
v_mul_f32 v174,v174,v234
s_waitcnt lgkmcnt(4)
v_mfma_f32_16x16x32_bf16 v[200:203],v[220:223],v[128:131],v[200:203]
ds_read_b64_tr_b16 v[216:217],v242 offset:61440
v_mul_f32 v175,v175,v235
v_mfma_f32_16x16x32_bf16 v[204:207],v[220:223],v[132:135],v[204:207]
ds_read_b64_tr_b16 v[218:219],v242 offset:63488
v_cvt_pk_bf16_f32 v230,v172,v173
v_cvt_pk_bf16_f32 v231,v174,v175
s_waitcnt lgkmcnt(4)
v_mfma_f32_16x16x32_bf16 v[176:179],v[208:211],v[136:139],v[176:179]
ds_read_b64_tr_b16 v[220:221],v243 offset:61440
v_mfma_f32_16x16x32_bf16 v[180:183],v[208:211],v[140:143],v[180:183]
ds_read_b64_tr_b16 v[222:223],v243 offset:63488
ds_write_b128 v253,v[224:227] offset:8192
s_waitcnt lgkmcnt(5)
v_mfma_f32_16x16x32_bf16 v[184:187],v[212:215],v[136:139],v[184:187]
ds_read_b64_tr_b16 v[208:209],v244 offset:0
ds_write_b128 v253,v[228:231] offset:9216
v_mfma_f32_16x16x32_bf16 v[188:191],v[212:215],v[140:143],v[188:191]
ds_read_b64_tr_b16 v[210:211],v244 offset:1024
s_lshl_b32 s40,s42,11
s_waitcnt lgkmcnt(6)
v_mfma_f32_16x16x32_bf16 v[192:195],v[216:219],v[136:139],v[192:195]
ds_read_b64_tr_b16 v[212:213],v244 offset:4096
s_add_u32 s40,s40,8192
v_mfma_f32_16x16x32_bf16 v[196:199],v[216:219],v[140:143],v[196:199]
ds_read_b64_tr_b16 v[214:215],v244 offset:5120
s_add_u32 s40,s40,s93
s_waitcnt lgkmcnt(6)
v_mfma_f32_16x16x32_bf16 v[200:203],v[220:223],v[136:139],v[200:203]
ds_read_b64_tr_b16 v[216:217],v244 offset:2048
buffer_store_dwordx4 v[224:227],v254,s[68:71],s40 offen offset:0 sc1
v_mfma_f32_16x16x32_bf16 v[204:207],v[220:223],v[140:143],v[204:207]
ds_read_b64_tr_b16 v[218:219],v244 offset:3072
buffer_store_dwordx4 v[228:231],v254,s[68:71],s40 offen offset:1024 sc1
s_waitcnt lgkmcnt(5)
s_barrier
s_waitcnt lgkmcnt(4)
v_mfma_f32_16x16x32_bf16 v[144:147],v[208:211],v[0:3],0
ds_read_b64_tr_b16 v[220:221],v244 offset:6144
v_mul_f32 v232,v176,v176
v_mul_f32 v233,v177,v177
v_mfma_f32_16x16x32_bf16 v[148:151],v[208:211],v[4:7],0
ds_read_b64_tr_b16 v[222:223],v244 offset:7168
v_mul_f32 v234,v178,v178
v_mul_f32 v235,v179,v179
s_waitcnt lgkmcnt(4)
v_mfma_f32_16x16x32_bf16 v[160:163],v[212:215],v[0:3],0
ds_read_b64_tr_b16 v[208:209],v244 offset:8192
v_fma_f32 v232,v232,v237,v236
v_fma_f32 v233,v233,v237,v236
v_mfma_f32_16x16x32_bf16 v[164:167],v[212:215],v[4:7],0
ds_read_b64_tr_b16 v[210:211],v244 offset:9216
v_fma_f32 v234,v234,v237,v236
v_fma_f32 v235,v235,v237,v236
s_waitcnt lgkmcnt(4)
v_mfma_f32_16x16x32_bf16 v[144:147],v[216:219],v[8:11],v[144:147]
ds_read_b64_tr_b16 v[212:213],v244 offset:12288
v_mul_f32 v232,v176,v232
v_mul_f32 v233,v177,v233
v_mfma_f32_16x16x32_bf16 v[148:151],v[216:219],v[12:15],v[148:151]
ds_read_b64_tr_b16 v[214:215],v244 offset:13312
v_mul_f32 v234,v178,v234
v_mul_f32 v235,v179,v235
s_waitcnt lgkmcnt(4)
v_mfma_f32_16x16x32_bf16 v[160:163],v[220:223],v[8:11],v[160:163]
ds_read_b64_tr_b16 v[216:217],v244 offset:10240
v_exp_f32 v232,v232
v_exp_f32 v233,v233
v_mfma_f32_16x16x32_bf16 v[164:167],v[220:223],v[12:15],v[164:167]
ds_read_b64_tr_b16 v[218:219],v244 offset:11264
v_exp_f32 v234,v234
v_exp_f32 v235,v235
v_mul_f32 v192,v176,v192
s_waitcnt lgkmcnt(4)
v_mfma_f32_16x16x32_bf16 v[144:147],v[208:211],v[16:19],v[144:147]
ds_read_b64_tr_b16 v[220:221],v244 offset:14336
v_lshrrev_b32 v0,4,v255
v_bfe_u32 v1,v255,2,2
v_lshl_add_u32 v0,v0,2,v1
v_mfma_f32_16x16x32_bf16 v[148:151],v[208:211],v[20:23],v[148:151]
ds_read_b64_tr_b16 v[222:223],v244 offset:15360
v_and_b32 v1,7,v0
s_lshl_b32 s40,s42,2
v_xor_b32 v1,s40,v1
v_lshlrev_b32 v0,8,v0
s_waitcnt lgkmcnt(4)
v_mfma_f32_16x16x32_bf16 v[160:163],v[212:215],v[16:19],v[160:163]
ds_read_b64_tr_b16 v[208:209],v244 offset:16384
v_and_b32 v2,3,v255
v_lshl_add_u32 v0,v2,3,v0
v_lshl_add_u32 v242,v1,5,v0
v_xor_b32 v243,32,v242
v_mfma_f32_16x16x32_bf16 v[164:167],v[212:215],v[20:23],v[164:167]
ds_read_b64_tr_b16 v[210:211],v244 offset:17408
v_xor_b32 v248,64,v242
v_xor_b32 v249,96,v242
v_mul_f32 v193,v177,v193
v_mul_f32 v194,v178,v194
s_waitcnt lgkmcnt(4)
v_mfma_f32_16x16x32_bf16 v[144:147],v[216:219],v[24:27],v[144:147]
ds_read_b64_tr_b16 v[212:213],v244 offset:20480
v_mul_f32 v195,v179,v195
v_fma_f32 v232,v232,v238,v238
v_fma_f32 v233,v233,v238,v238
v_mfma_f32_16x16x32_bf16 v[148:151],v[216:219],v[28:31],v[148:151]
ds_read_b64_tr_b16 v[214:215],v244 offset:21504
v_fma_f32 v234,v234,v238,v238
v_fma_f32 v235,v235,v238,v238
v_rcp_f32 v232,v232
v_rcp_f32 v233,v233
s_waitcnt lgkmcnt(4)
v_mfma_f32_16x16x32_bf16 v[160:163],v[220:223],v[24:27],v[160:163]
ds_read_b64_tr_b16 v[216:217],v244 offset:18432
v_rcp_f32 v234,v234
v_rcp_f32 v235,v235
v_mul_f32 v192,v192,v232
v_mul_f32 v193,v193,v233
v_mfma_f32_16x16x32_bf16 v[164:167],v[220:223],v[28:31],v[164:167]
ds_read_b64_tr_b16 v[218:219],v244 offset:19456
v_mul_f32 v194,v194,v234
v_mul_f32 v195,v195,v235
v_cvt_pk_bf16_f32 v224,v192,v193
v_cvt_pk_bf16_f32 v225,v194,v195
s_barrier
s_waitcnt lgkmcnt(4)
v_mfma_f32_16x16x32_bf16 v[144:147],v[208:211],v[32:35],v[144:147]
ds_read_b64_tr_b16 v[220:221],v244 offset:22528
ds_read_b128 v[0:3],v247 offset:0
ds_read_b128 v[4:7],v247 offset:1024
v_mul_f32 v232,v184,v184
v_mfma_f32_16x16x32_bf16 v[148:151],v[208:211],v[36:39],v[148:151]
ds_read_b64_tr_b16 v[222:223],v244 offset:23552
v_mul_f32 v233,v185,v185
v_mul_f32 v234,v186,v186
s_waitcnt lgkmcnt(6)
v_mfma_f32_16x16x32_bf16 v[160:163],v[212:215],v[32:35],v[160:163]
ds_read_b64_tr_b16 v[208:209],v244 offset:24576
v_mul_f32 v235,v187,v187
v_fma_f32 v232,v232,v237,v236
v_mfma_f32_16x16x32_bf16 v[164:167],v[212:215],v[36:39],v[164:167]
ds_read_b64_tr_b16 v[210:211],v244 offset:25600
v_fma_f32 v233,v233,v237,v236
v_fma_f32 v234,v234,v237,v236
v_fma_f32 v235,v235,v237,v236
s_waitcnt lgkmcnt(6)
v_mfma_f32_16x16x32_bf16 v[144:147],v[216:219],v[40:43],v[144:147]
ds_read_b64_tr_b16 v[212:213],v244 offset:28672
v_mul_f32 v232,v184,v232
v_mul_f32 v233,v185,v233
v_mfma_f32_16x16x32_bf16 v[148:151],v[216:219],v[44:47],v[148:151]
ds_read_b64_tr_b16 v[214:215],v244 offset:29696
v_mul_f32 v234,v186,v234
v_mul_f32 v235,v187,v235
s_waitcnt lgkmcnt(4)
v_mfma_f32_16x16x32_bf16 v[160:163],v[220:223],v[40:43],v[160:163]
ds_read_b64_tr_b16 v[216:217],v244 offset:26624
v_exp_f32 v232,v232
v_exp_f32 v233,v233
v_mfma_f32_16x16x32_bf16 v[164:167],v[220:223],v[44:47],v[164:167]
ds_read_b64_tr_b16 v[218:219],v244 offset:27648
v_exp_f32 v234,v234
v_exp_f32 v235,v235
v_mul_f32 v200,v184,v200
s_waitcnt lgkmcnt(4)
v_mfma_f32_16x16x32_bf16 v[144:147],v[208:211],v[48:51],v[144:147]
ds_read_b64_tr_b16 v[220:221],v244 offset:30720
ds_read_b128 v[8:11],v247 offset:2048
ds_read_b128 v[12:15],v247 offset:3072
v_mul_f32 v201,v185,v201
v_mfma_f32_16x16x32_bf16 v[148:151],v[208:211],v[52:55],v[148:151]
ds_read_b64_tr_b16 v[222:223],v244 offset:31744
v_mul_f32 v202,v186,v202
v_mul_f32 v203,v187,v203
s_waitcnt lgkmcnt(6)
v_mfma_f32_16x16x32_bf16 v[160:163],v[212:215],v[48:51],v[160:163]
ds_read_b64_tr_b16 v[208:209],v244 offset:32768
v_fma_f32 v232,v232,v238,v238
v_fma_f32 v233,v233,v238,v238
v_mfma_f32_16x16x32_bf16 v[164:167],v[212:215],v[52:55],v[164:167]
ds_read_b64_tr_b16 v[210:211],v244 offset:33792
v_fma_f32 v234,v234,v238,v238
v_fma_f32 v235,v235,v238,v238
v_rcp_f32 v232,v232
s_waitcnt lgkmcnt(6)
v_mfma_f32_16x16x32_bf16 v[144:147],v[216:219],v[56:59],v[144:147]
ds_read_b64_tr_b16 v[212:213],v244 offset:36864
v_rcp_f32 v233,v233
v_rcp_f32 v234,v234
v_mfma_f32_16x16x32_bf16 v[148:151],v[216:219],v[60:63],v[148:151]
ds_read_b64_tr_b16 v[214:215],v244 offset:37888
v_rcp_f32 v235,v235
v_mul_f32 v200,v200,v232
s_waitcnt lgkmcnt(4)
v_mfma_f32_16x16x32_bf16 v[160:163],v[220:223],v[56:59],v[160:163]
ds_read_b64_tr_b16 v[216:217],v244 offset:34816
v_mul_f32 v201,v201,v233
v_mul_f32 v202,v202,v234
v_mfma_f32_16x16x32_bf16 v[164:167],v[220:223],v[60:63],v[164:167]
ds_read_b64_tr_b16 v[218:219],v244 offset:35840
v_mul_f32 v203,v203,v235
v_cvt_pk_bf16_f32 v226,v200,v201
v_cvt_pk_bf16_f32 v227,v202,v203
s_waitcnt vmcnt(0)
s_barrier
s_waitcnt lgkmcnt(4)
v_mfma_f32_16x16x32_bf16 v[144:147],v[208:211],v[64:67],v[144:147]
ds_read_b64_tr_b16 v[220:221],v244 offset:38912
ds_read_b128 v[16:19],v247 offset:4096
ds_read_b128 v[20:23],v247 offset:5120
v_mul_f32 v232,v180,v180
v_mfma_f32_16x16x32_bf16 v[148:151],v[208:211],v[68:71],v[148:151]
ds_read_b64_tr_b16 v[222:223],v244 offset:39936
v_mul_f32 v233,v181,v181
v_mul_f32 v234,v182,v182
s_waitcnt lgkmcnt(6)
v_mfma_f32_16x16x32_bf16 v[160:163],v[212:215],v[64:67],v[160:163]
ds_read_b64_tr_b16 v[208:209],v244 offset:40960
v_mul_f32 v235,v183,v183
v_fma_f32 v232,v232,v240,v239
v_mfma_f32_16x16x32_bf16 v[164:167],v[212:215],v[68:71],v[164:167]
ds_read_b64_tr_b16 v[210:211],v244 offset:41984
v_fma_f32 v233,v233,v240,v239
v_fma_f32 v234,v234,v240,v239
v_fma_f32 v235,v235,v240,v239
s_waitcnt lgkmcnt(6)
v_mfma_f32_16x16x32_bf16 v[144:147],v[216:219],v[72:75],v[144:147]
ds_read_b64_tr_b16 v[212:213],v244 offset:45056
v_mul_f32 v232,v180,v232
v_mul_f32 v233,v181,v233
v_mfma_f32_16x16x32_bf16 v[148:151],v[216:219],v[76:79],v[148:151]
ds_read_b64_tr_b16 v[214:215],v244 offset:46080
v_mul_f32 v234,v182,v234
v_mul_f32 v235,v183,v235
s_waitcnt lgkmcnt(4)
v_mfma_f32_16x16x32_bf16 v[160:163],v[220:223],v[72:75],v[160:163]
ds_read_b64_tr_b16 v[216:217],v244 offset:43008
v_exp_f32 v232,v232
v_exp_f32 v233,v233
v_mfma_f32_16x16x32_bf16 v[164:167],v[220:223],v[76:79],v[164:167]
ds_read_b64_tr_b16 v[218:219],v244 offset:44032
v_exp_f32 v234,v234
v_exp_f32 v235,v235
v_mul_f32 v196,v180,v196
s_waitcnt lgkmcnt(4)
v_mfma_f32_16x16x32_bf16 v[144:147],v[208:211],v[80:83],v[144:147]
ds_read_b64_tr_b16 v[220:221],v244 offset:47104
ds_read_b128 v[24:27],v247 offset:6144
ds_read_b128 v[28:31],v247 offset:7168
v_mul_f32 v197,v181,v197
v_mfma_f32_16x16x32_bf16 v[148:151],v[208:211],v[84:87],v[148:151]
ds_read_b64_tr_b16 v[222:223],v244 offset:48128
v_mul_f32 v198,v182,v198
v_mul_f32 v199,v183,v199
s_waitcnt lgkmcnt(6)
v_mfma_f32_16x16x32_bf16 v[160:163],v[212:215],v[80:83],v[160:163]
ds_read_b64_tr_b16 v[208:209],v244 offset:49152
v_fma_f32 v232,v232,v241,v241
v_fma_f32 v233,v233,v241,v241
v_mfma_f32_16x16x32_bf16 v[164:167],v[212:215],v[84:87],v[164:167]
ds_read_b64_tr_b16 v[210:211],v244 offset:50176
v_fma_f32 v234,v234,v241,v241
v_fma_f32 v235,v235,v241,v241
v_rcp_f32 v232,v232
s_waitcnt lgkmcnt(6)
v_mfma_f32_16x16x32_bf16 v[144:147],v[216:219],v[88:91],v[144:147]
ds_read_b64_tr_b16 v[212:213],v244 offset:53248
v_rcp_f32 v233,v233
v_rcp_f32 v234,v234
v_mfma_f32_16x16x32_bf16 v[148:151],v[216:219],v[92:95],v[148:151]
ds_read_b64_tr_b16 v[214:215],v244 offset:54272
v_rcp_f32 v235,v235
v_mul_f32 v196,v196,v232
s_waitcnt lgkmcnt(4)
v_mfma_f32_16x16x32_bf16 v[160:163],v[220:223],v[88:91],v[160:163]
ds_read_b64_tr_b16 v[216:217],v244 offset:51200
v_mul_f32 v197,v197,v233
v_mul_f32 v198,v198,v234
v_mfma_f32_16x16x32_bf16 v[164:167],v[220:223],v[92:95],v[164:167]
ds_read_b64_tr_b16 v[218:219],v244 offset:52224
v_mul_f32 v199,v199,v235
v_cvt_pk_bf16_f32 v228,v196,v197
v_cvt_pk_bf16_f32 v229,v198,v199
s_barrier
s_waitcnt lgkmcnt(4)
v_mfma_f32_16x16x32_bf16 v[144:147],v[208:211],v[96:99],v[144:147]
ds_read_b64_tr_b16 v[220:221],v244 offset:55296
ds_read_b128 v[32:35],v247 offset:8192
ds_read_b128 v[36:39],v247 offset:9216
v_mul_f32 v232,v188,v188
v_mfma_f32_16x16x32_bf16 v[148:151],v[208:211],v[100:103],v[148:151]
ds_read_b64_tr_b16 v[222:223],v244 offset:56320
v_mul_f32 v233,v189,v189
v_mul_f32 v234,v190,v190
s_waitcnt lgkmcnt(6)
v_mfma_f32_16x16x32_bf16 v[160:163],v[212:215],v[96:99],v[160:163]
ds_read_b64_tr_b16 v[208:209],v244 offset:57344
v_mul_f32 v235,v191,v191
v_fma_f32 v232,v232,v240,v239
v_mfma_f32_16x16x32_bf16 v[164:167],v[212:215],v[100:103],v[164:167]
ds_read_b64_tr_b16 v[210:211],v244 offset:58368
v_fma_f32 v233,v233,v240,v239
v_fma_f32 v234,v234,v240,v239
v_fma_f32 v235,v235,v240,v239
s_waitcnt lgkmcnt(6)
v_mfma_f32_16x16x32_bf16 v[144:147],v[216:219],v[104:107],v[144:147]
ds_read_b64_tr_b16 v[212:213],v244 offset:61440
v_mul_f32 v232,v188,v232
v_mul_f32 v233,v189,v233
v_mfma_f32_16x16x32_bf16 v[148:151],v[216:219],v[108:111],v[148:151]
ds_read_b64_tr_b16 v[214:215],v244 offset:62464
v_mul_f32 v234,v190,v234
v_mul_f32 v235,v191,v235
s_waitcnt lgkmcnt(4)
v_mfma_f32_16x16x32_bf16 v[160:163],v[220:223],v[104:107],v[160:163]
ds_read_b64_tr_b16 v[216:217],v244 offset:59392
v_exp_f32 v232,v232
v_exp_f32 v233,v233
v_mfma_f32_16x16x32_bf16 v[164:167],v[220:223],v[108:111],v[164:167]
ds_read_b64_tr_b16 v[218:219],v244 offset:60416
v_exp_f32 v234,v234
v_exp_f32 v235,v235
v_mul_f32 v204,v188,v204
s_waitcnt lgkmcnt(4)
v_mfma_f32_16x16x32_bf16 v[144:147],v[208:211],v[112:115],v[144:147]
ds_read_b64_tr_b16 v[220:221],v244 offset:63488
ds_read_b128 v[40:43],v247 offset:10240
ds_read_b128 v[44:47],v247 offset:11264
v_mul_f32 v205,v189,v205
v_mfma_f32_16x16x32_bf16 v[148:151],v[208:211],v[116:119],v[148:151]
ds_read_b64_tr_b16 v[222:223],v244 offset:64512
v_mul_f32 v206,v190,v206
v_mul_f32 v207,v191,v207
s_waitcnt lgkmcnt(6)
v_mfma_f32_16x16x32_bf16 v[160:163],v[212:215],v[112:115],v[160:163]
ds_read_b64_tr_b16 v[208:209],v244 offset:0
v_fma_f32 v232,v232,v241,v241
v_fma_f32 v233,v233,v241,v241
v_mfma_f32_16x16x32_bf16 v[164:167],v[212:215],v[116:119],v[164:167]
ds_read_b64_tr_b16 v[210:211],v244 offset:1024
v_fma_f32 v234,v234,v241,v241
v_fma_f32 v235,v235,v241,v241
v_rcp_f32 v232,v232
s_waitcnt lgkmcnt(6)
v_mfma_f32_16x16x32_bf16 v[144:147],v[216:219],v[120:123],v[144:147]
ds_read_b64_tr_b16 v[212:213],v244 offset:4096
v_rcp_f32 v233,v233
v_rcp_f32 v234,v234
v_mfma_f32_16x16x32_bf16 v[148:151],v[216:219],v[124:127],v[148:151]
ds_read_b64_tr_b16 v[214:215],v244 offset:5120
v_rcp_f32 v235,v235
v_mul_f32 v204,v204,v232
s_waitcnt lgkmcnt(4)
v_mfma_f32_16x16x32_bf16 v[160:163],v[220:223],v[120:123],v[160:163]
ds_read_b64_tr_b16 v[216:217],v244 offset:2048
v_mul_f32 v205,v205,v233
v_mul_f32 v206,v206,v234
v_mfma_f32_16x16x32_bf16 v[164:167],v[220:223],v[124:127],v[164:167]
ds_read_b64_tr_b16 v[218:219],v244 offset:3072
v_mul_f32 v207,v207,v235
v_cvt_pk_bf16_f32 v230,v204,v205
v_cvt_pk_bf16_f32 v231,v206,v207
s_barrier
s_waitcnt lgkmcnt(4)
v_mfma_f32_16x16x32_bf16 v[144:147],v[208:211],v[128:131],v[144:147]
ds_read_b64_tr_b16 v[220:221],v244 offset:6144
v_mfma_f32_16x16x32_bf16 v[148:151],v[208:211],v[132:135],v[148:151]
ds_read_b64_tr_b16 v[222:223],v244 offset:7168
ds_write_b128 v253,v[224:227] offset:12288
s_waitcnt lgkmcnt(5)
v_mfma_f32_16x16x32_bf16 v[160:163],v[212:215],v[128:131],v[160:163]
ds_read_b64_tr_b16 v[208:209],v242 offset:8192
ds_write_b128 v253,v[228:231] offset:13312
v_mfma_f32_16x16x32_bf16 v[164:167],v[212:215],v[132:135],v[164:167]
ds_read_b64_tr_b16 v[210:211],v242 offset:12288
s_lshl_b32 s40,s42,11
s_waitcnt lgkmcnt(6)
v_mfma_f32_16x16x32_bf16 v[144:147],v[216:219],v[136:139],v[144:147]
ds_read_b64_tr_b16 v[212:213],v243 offset:8192
s_add_u32 s40,s40,12288
v_mfma_f32_16x16x32_bf16 v[148:151],v[216:219],v[140:143],v[148:151]
ds_read_b64_tr_b16 v[214:215],v243 offset:12288
s_add_u32 s40,s40,s93
s_waitcnt lgkmcnt(6)
v_mfma_f32_16x16x32_bf16 v[160:163],v[220:223],v[136:139],v[160:163]
ds_read_b64_tr_b16 v[216:217],v248 offset:8192
buffer_store_dwordx4 v[224:227],v254,s[68:71],s40 offen offset:0 sc1
v_mfma_f32_16x16x32_bf16 v[164:167],v[220:223],v[140:143],v[164:167]
ds_read_b64_tr_b16 v[218:219],v248 offset:12288
buffer_store_dwordx4 v[228:231],v254,s[68:71],s40 offen offset:1024 sc1
s_waitcnt lgkmcnt(4)
v_mfma_f32_16x16x32_bf16 v[176:179],v[208:211],v[0:3],0
ds_read_b64_tr_b16 v[220:221],v249 offset:8192
v_mul_f32 v232,v144,v144
v_mfma_f32_16x16x32_bf16 v[180:183],v[208:211],v[4:7],0
ds_read_b64_tr_b16 v[222:223],v249 offset:12288
v_mul_f32 v233,v145,v145
v_mul_f32 v234,v146,v146
s_waitcnt lgkmcnt(4)
v_mfma_f32_16x16x32_bf16 v[184:187],v[212:215],v[0:3],0
ds_read_b64_tr_b16 v[208:209],v242 offset:16384
v_mul_f32 v235,v147,v147
v_mfma_f32_16x16x32_bf16 v[188:191],v[212:215],v[4:7],0
ds_read_b64_tr_b16 v[210:211],v242 offset:20480
v_fma_f32 v232,v232,v237,v236
v_fma_f32 v233,v233,v237,v236
s_waitcnt lgkmcnt(4)
v_mfma_f32_16x16x32_bf16 v[192:195],v[216:219],v[0:3],0
ds_read_b64_tr_b16 v[212:213],v243 offset:16384
v_fma_f32 v234,v234,v237,v236
v_fma_f32 v235,v235,v237,v236
v_mfma_f32_16x16x32_bf16 v[196:199],v[216:219],v[4:7],0
ds_read_b64_tr_b16 v[214:215],v243 offset:20480
v_mul_f32 v232,v144,v232
s_waitcnt lgkmcnt(4)
v_mfma_f32_16x16x32_bf16 v[200:203],v[220:223],v[0:3],0
ds_read_b64_tr_b16 v[216:217],v248 offset:16384
v_mul_f32 v233,v145,v233
v_mul_f32 v234,v146,v234
v_mfma_f32_16x16x32_bf16 v[204:207],v[220:223],v[4:7],0
ds_read_b64_tr_b16 v[218:219],v248 offset:20480
v_mul_f32 v235,v147,v235
v_exp_f32 v232,v232
s_barrier
s_waitcnt lgkmcnt(4)
v_mfma_f32_16x16x32_bf16 v[176:179],v[208:211],v[8:11],v[176:179]
ds_read_b64_tr_b16 v[220:221],v249 offset:16384
ds_read_b128 v[48:51],v247 offset:12288
ds_read_b128 v[52:55],v247 offset:13312
ds_read_b128 v[56:59],v247 offset:14336
ds_read_b128 v[60:63],v247 offset:15360
v_mfma_f32_16x16x32_bf16 v[180:183],v[208:211],v[12:15],v[180:183]
ds_read_b64_tr_b16 v[222:223],v249 offset:20480
v_exp_f32 v233,v233
v_exp_f32 v234,v234
s_waitcnt lgkmcnt(8)
v_mfma_f32_16x16x32_bf16 v[184:187],v[212:215],v[8:11],v[184:187]
ds_read_b64_tr_b16 v[208:209],v242 offset:24576
v_exp_f32 v235,v235
v_mul_f32 v160,v144,v160
v_mfma_f32_16x16x32_bf16 v[188:191],v[212:215],v[12:15],v[188:191]
ds_read_b64_tr_b16 v[210:211],v242 offset:28672
v_mul_f32 v161,v145,v161
v_mul_f32 v162,v146,v162
s_waitcnt lgkmcnt(8)
v_mfma_f32_16x16x32_bf16 v[192:195],v[216:219],v[8:11],v[192:195]
ds_read_b64_tr_b16 v[212:213],v243 offset:24576
v_mul_f32 v163,v147,v163
v_fma_f32 v232,v232,v238,v238
v_mfma_f32_16x16x32_bf16 v[196:199],v[216:219],v[12:15],v[196:199]
ds_read_b64_tr_b16 v[214:215],v243 offset:28672
v_fma_f32 v233,v233,v238,v238
v_fma_f32 v234,v234,v238,v238
s_waitcnt lgkmcnt(4)
v_mfma_f32_16x16x32_bf16 v[200:203],v[220:223],v[8:11],v[200:203]
ds_read_b64_tr_b16 v[216:217],v248 offset:24576
v_fma_f32 v235,v235,v238,v238
v_rcp_f32 v232,v232
v_mfma_f32_16x16x32_bf16 v[204:207],v[220:223],v[12:15],v[204:207]
ds_read_b64_tr_b16 v[218:219],v248 offset:28672
v_rcp_f32 v233,v233
v_rcp_f32 v234,v234
s_waitcnt lgkmcnt(4)
v_mfma_f32_16x16x32_bf16 v[176:179],v[208:211],v[16:19],v[176:179]
ds_read_b64_tr_b16 v[220:221],v249 offset:24576
v_rcp_f32 v235,v235
v_mfma_f32_16x16x32_bf16 v[180:183],v[208:211],v[20:23],v[180:183]
ds_read_b64_tr_b16 v[222:223],v249 offset:28672
v_mul_f32 v160,v160,v232
v_mul_f32 v161,v161,v233
s_waitcnt lgkmcnt(4)
v_mfma_f32_16x16x32_bf16 v[184:187],v[212:215],v[16:19],v[184:187]
ds_read_b64_tr_b16 v[208:209],v242 offset:32768
v_mul_f32 v162,v162,v234
v_mfma_f32_16x16x32_bf16 v[188:191],v[212:215],v[20:23],v[188:191]
ds_read_b64_tr_b16 v[210:211],v242 offset:36864
v_mul_f32 v163,v163,v235
v_cvt_pk_bf16_f32 v224,v160,v161
s_waitcnt lgkmcnt(4)
v_mfma_f32_16x16x32_bf16 v[192:195],v[216:219],v[16:19],v[192:195]
ds_read_b64_tr_b16 v[212:213],v243 offset:32768
v_cvt_pk_bf16_f32 v225,v162,v163
v_mul_f32 v232,v148,v148
v_mfma_f32_16x16x32_bf16 v[196:199],v[216:219],v[20:23],v[196:199]
ds_read_b64_tr_b16 v[214:215],v243 offset:36864
v_mul_f32 v233,v149,v149
s_waitcnt lgkmcnt(4)
v_mfma_f32_16x16x32_bf16 v[200:203],v[220:223],v[16:19],v[200:203]
ds_read_b64_tr_b16 v[216:217],v248 offset:32768
v_mul_f32 v234,v150,v150
v_mul_f32 v235,v151,v151
v_mfma_f32_16x16x32_bf16 v[204:207],v[220:223],v[20:23],v[204:207]
ds_read_b64_tr_b16 v[218:219],v248 offset:36864
v_fma_f32 v232,v232,v240,v239
v_fma_f32 v233,v233,v240,v239
s_barrier
s_waitcnt lgkmcnt(4)
v_mfma_f32_16x16x32_bf16 v[176:179],v[208:211],v[24:27],v[176:179]
ds_read_b64_tr_b16 v[220:221],v249 offset:32768
v_fma_f32 v234,v234,v240,v239
v_mfma_f32_16x16x32_bf16 v[180:183],v[208:211],v[28:31],v[180:183]
ds_read_b64_tr_b16 v[222:223],v249 offset:36864
v_fma_f32 v235,v235,v240,v239
v_mul_f32 v232,v148,v232
s_waitcnt lgkmcnt(4)
v_mfma_f32_16x16x32_bf16 v[184:187],v[212:215],v[24:27],v[184:187]
ds_read_b64_tr_b16 v[208:209],v242 offset:40960
v_mul_f32 v233,v149,v233
v_mul_f32 v234,v150,v234
v_mfma_f32_16x16x32_bf16 v[188:191],v[212:215],v[28:31],v[188:191]
ds_read_b64_tr_b16 v[210:211],v242 offset:45056
v_mul_f32 v235,v151,v235
v_exp_f32 v232,v232
s_waitcnt lgkmcnt(4)
v_mfma_f32_16x16x32_bf16 v[192:195],v[216:219],v[24:27],v[192:195]
ds_read_b64_tr_b16 v[212:213],v243 offset:40960
v_exp_f32 v233,v233
v_mfma_f32_16x16x32_bf16 v[196:199],v[216:219],v[28:31],v[196:199]
ds_read_b64_tr_b16 v[214:215],v243 offset:45056
v_exp_f32 v234,v234
v_exp_f32 v235,v235
s_waitcnt lgkmcnt(4)
v_mfma_f32_16x16x32_bf16 v[200:203],v[220:223],v[24:27],v[200:203]
ds_read_b64_tr_b16 v[216:217],v248 offset:40960
v_mul_f32 v164,v148,v164
v_mul_f32 v165,v149,v165
v_mfma_f32_16x16x32_bf16 v[204:207],v[220:223],v[28:31],v[204:207]
ds_read_b64_tr_b16 v[218:219],v248 offset:45056
v_mul_f32 v166,v150,v166
v_mul_f32 v167,v151,v167
s_waitcnt lgkmcnt(4)
v_mfma_f32_16x16x32_bf16 v[176:179],v[208:211],v[32:35],v[176:179]
ds_read_b64_tr_b16 v[220:221],v249 offset:40960
v_fma_f32 v232,v232,v241,v241
v_mfma_f32_16x16x32_bf16 v[180:183],v[208:211],v[36:39],v[180:183]
ds_read_b64_tr_b16 v[222:223],v249 offset:45056
v_fma_f32 v233,v233,v241,v241
v_fma_f32 v234,v234,v241,v241
s_waitcnt lgkmcnt(4)
v_mfma_f32_16x16x32_bf16 v[184:187],v[212:215],v[32:35],v[184:187]
ds_read_b64_tr_b16 v[208:209],v242 offset:49152
v_fma_f32 v235,v235,v241,v241
v_rcp_f32 v232,v232
v_mfma_f32_16x16x32_bf16 v[188:191],v[212:215],v[36:39],v[188:191]
ds_read_b64_tr_b16 v[210:211],v242 offset:53248
v_rcp_f32 v233,v233
v_rcp_f32 v234,v234
s_waitcnt lgkmcnt(4)
v_mfma_f32_16x16x32_bf16 v[192:195],v[216:219],v[32:35],v[192:195]
ds_read_b64_tr_b16 v[212:213],v243 offset:49152
v_rcp_f32 v235,v235
v_mfma_f32_16x16x32_bf16 v[196:199],v[216:219],v[36:39],v[196:199]
ds_read_b64_tr_b16 v[214:215],v243 offset:53248
v_mul_f32 v164,v164,v232
v_mul_f32 v165,v165,v233
s_waitcnt lgkmcnt(4)
v_mfma_f32_16x16x32_bf16 v[200:203],v[220:223],v[32:35],v[200:203]
ds_read_b64_tr_b16 v[216:217],v248 offset:49152
v_mul_f32 v166,v166,v234
v_mul_f32 v167,v167,v235
v_mfma_f32_16x16x32_bf16 v[204:207],v[220:223],v[36:39],v[204:207]
ds_read_b64_tr_b16 v[218:219],v248 offset:53248
v_cvt_pk_bf16_f32 v228,v164,v165
v_cvt_pk_bf16_f32 v229,v166,v167
s_barrier
s_waitcnt lgkmcnt(4)
v_mfma_f32_16x16x32_bf16 v[176:179],v[208:211],v[40:43],v[176:179]
ds_read_b64_tr_b16 v[220:221],v249 offset:49152
v_mfma_f32_16x16x32_bf16 v[180:183],v[208:211],v[44:47],v[180:183]
ds_read_b64_tr_b16 v[222:223],v249 offset:53248
s_lshl_b32 s40,s42,3
s_waitcnt lgkmcnt(4)
v_mfma_f32_16x16x32_bf16 v[184:187],v[212:215],v[40:43],v[184:187]
ds_read_b64_tr_b16 v[208:209],v242 offset:57344
v_mfma_f32_16x16x32_bf16 v[188:191],v[212:215],v[44:47],v[188:191]
ds_read_b64_tr_b16 v[210:211],v242 offset:61440
v_add_u32 v232,s40,v247
s_waitcnt lgkmcnt(4)
v_mfma_f32_16x16x32_bf16 v[192:195],v[216:219],v[40:43],v[192:195]
ds_read_b64_tr_b16 v[212:213],v243 offset:57344
v_mfma_f32_16x16x32_bf16 v[196:199],v[216:219],v[44:47],v[196:199]
ds_read_b64_tr_b16 v[214:215],v243 offset:61440
ds_write_b64 v232,v[224:225] offset:16384
s_waitcnt lgkmcnt(5)
v_mfma_f32_16x16x32_bf16 v[200:203],v[220:223],v[40:43],v[200:203]
ds_read_b64_tr_b16 v[216:217],v248 offset:57344
v_mfma_f32_16x16x32_bf16 v[204:207],v[220:223],v[44:47],v[204:207]
ds_read_b64_tr_b16 v[218:219],v248 offset:61440
ds_write_b64 v232,v[228:229] offset:17408
s_waitcnt lgkmcnt(6)
v_mfma_f32_16x16x32_bf16 v[176:179],v[208:211],v[48:51],v[176:179]
ds_read_b64_tr_b16 v[220:221],v249 offset:57344
v_mfma_f32_16x16x32_bf16 v[180:183],v[208:211],v[52:55],v[180:183]
ds_read_b64_tr_b16 v[222:223],v249 offset:61440
s_waitcnt lgkmcnt(6)
v_mfma_f32_16x16x32_bf16 v[184:187],v[212:215],v[48:51],v[184:187]
ds_read_b64_tr_b16 v[208:209],v242 offset:0
s_xor_b32 s35,s2,8
s_lshl_b32 s35,s35,9
s_add_u32 s35,s35,0
buffer_load_dword v246,off,s[64:67],s35 sc1
v_mfma_f32_16x16x32_bf16 v[188:191],v[212:215],v[52:55],v[188:191]
ds_read_b64_tr_b16 v[210:211],v242 offset:4096
s_waitcnt lgkmcnt(5)
v_mfma_f32_16x16x32_bf16 v[192:195],v[216:219],v[48:51],v[192:195]
ds_read_b64_tr_b16 v[212:213],v243 offset:0
v_mfma_f32_16x16x32_bf16 v[196:199],v[216:219],v[52:55],v[196:199]
ds_read_b64_tr_b16 v[214:215],v243 offset:4096
s_waitcnt lgkmcnt(4)
v_mfma_f32_16x16x32_bf16 v[200:203],v[220:223],v[48:51],v[200:203]
ds_read_b64_tr_b16 v[216:217],v248 offset:0
v_mfma_f32_16x16x32_bf16 v[204:207],v[220:223],v[52:55],v[204:207]
ds_read_b64_tr_b16 v[218:219],v248 offset:4096
s_barrier
s_waitcnt lgkmcnt(4)
v_mfma_f32_16x16x32_bf16 v[176:179],v[208:211],v[56:59],v[176:179]
ds_read_b64_tr_b16 v[220:221],v249 offset:0
v_mfma_f32_16x16x32_bf16 v[180:183],v[208:211],v[60:63],v[180:183]
ds_read_b64_tr_b16 v[222:223],v249 offset:4096
s_waitcnt lgkmcnt(4)
v_mfma_f32_16x16x32_bf16 v[184:187],v[212:215],v[56:59],v[184:187]
ds_read_b64_tr_b16 v[208:209],v242 offset:8192
v_mfma_f32_16x16x32_bf16 v[188:191],v[212:215],v[60:63],v[188:191]
ds_read_b64_tr_b16 v[210:211],v242 offset:12288
s_waitcnt lgkmcnt(4)
v_mfma_f32_16x16x32_bf16 v[192:195],v[216:219],v[56:59],v[192:195]
ds_read_b64_tr_b16 v[212:213],v243 offset:8192
v_mfma_f32_16x16x32_bf16 v[196:199],v[216:219],v[60:63],v[196:199]
ds_read_b64_tr_b16 v[214:215],v243 offset:12288
s_waitcnt lgkmcnt(4)
v_mfma_f32_16x16x32_bf16 v[200:203],v[220:223],v[56:59],v[200:203]
ds_read_b64_tr_b16 v[216:217],v248 offset:8192
v_mfma_f32_16x16x32_bf16 v[204:207],v[220:223],v[60:63],v[204:207]
ds_read_b64_tr_b16 v[218:219],v248 offset:12288
ds_read_b128 v[64:67],v247 offset:16384
ds_read_b128 v[68:71],v247 offset:17408
s_waitcnt lgkmcnt(0)
v_mfma_f32_16x16x32_bf16 v[176:179],v[208:211],v[64:67],v[176:179]
ds_read_b64_tr_b16 v[220:221],v249 offset:8192
v_mfma_f32_16x16x32_bf16 v[180:183],v[208:211],v[68:71],v[180:183]
ds_read_b64_tr_b16 v[222:223],v249 offset:12288
v_mfma_f32_16x16x32_bf16 v[184:187],v[212:215],v[64:67],v[184:187]
ds_read_b64_tr_b16 v[208:209],v242 offset:16384
v_mfma_f32_16x16x32_bf16 v[188:191],v[212:215],v[68:71],v[188:191]
ds_read_b64_tr_b16 v[210:211],v242 offset:20480
s_add_u32 s40,s93,16384
v_mfma_f32_16x16x32_bf16 v[192:195],v[216:219],v[64:67],v[192:195]
ds_read_b64_tr_b16 v[212:213],v243 offset:16384
v_mfma_f32_16x16x32_bf16 v[196:199],v[216:219],v[68:71],v[196:199]
ds_read_b64_tr_b16 v[214:215],v243 offset:20480
buffer_store_dwordx4 v[64:67],v254,s[68:71],s40 offen offset:0 sc1
s_waitcnt lgkmcnt(4)
v_mfma_f32_16x16x32_bf16 v[200:203],v[220:223],v[64:67],v[200:203]
ds_read_b64_tr_b16 v[216:217],v248 offset:16384
v_mfma_f32_16x16x32_bf16 v[204:207],v[220:223],v[68:71],v[204:207]
ds_read_b64_tr_b16 v[218:219],v248 offset:20480
buffer_store_dwordx4 v[68:71],v254,s[68:71],s40 offen offset:1024 sc1
s_waitcnt vmcnt(2)
s_mov_b32 s45,0x40000
ffn_kernel_fc0_spin:
v_readfirstlane_b32 s40,v246
s_nop 3
s_cmp_eq_u32 s40,1
s_cbranch_scc1 ffn_kernel_fc0_ok
s_sub_u32 s45,s45,1
s_cmp_eq_u32 s45,0
s_cbranch_scc1 ffn_kernel_fc0_ok
s_sleep 2
buffer_load_dword v246,off,s[64:67],s35 sc1
s_waitcnt vmcnt(0)
s_branch ffn_kernel_fc0_spin
ffn_kernel_fc0_ok:
s_barrier
s_waitcnt lgkmcnt(4)
v_mfma_f32_16x16x32_bf16 v[144:147],v[208:211],v[0:3],0
ds_read_b64_tr_b16 v[220:221],v249 offset:16384
v_mfma_f32_16x16x32_bf16 v[148:151],v[208:211],v[4:7],0
ds_read_b64_tr_b16 v[222:223],v249 offset:20480
s_waitcnt lgkmcnt(4)
v_mfma_f32_16x16x32_bf16 v[152:155],v[212:215],v[0:3],0
ds_read_b64_tr_b16 v[208:209],v242 offset:24576
s_mul_i32 s95,s41,18432
s_add_u32 m0,s95,65536
s_add_u32 s45,s94,0
buffer_load_dwordx4 v254,s[68:71],s45 offen sc1 lds
s_mul_i32 s95,s41,18432
s_add_u32 m0,s95,66560
s_add_u32 s45,s94,1024
buffer_load_dwordx4 v254,s[68:71],s45 offen sc1 lds
v_mfma_f32_16x16x32_bf16 v[156:159],v[212:215],v[4:7],0
ds_read_b64_tr_b16 v[210:211],v242 offset:28672
s_waitcnt lgkmcnt(4)
v_mfma_f32_16x16x32_bf16 v[160:163],v[216:219],v[0:3],0
ds_read_b64_tr_b16 v[212:213],v243 offset:24576
v_mfma_f32_16x16x32_bf16 v[164:167],v[216:219],v[4:7],0
ds_read_b64_tr_b16 v[214:215],v243 offset:28672
s_waitcnt lgkmcnt(4)
v_mfma_f32_16x16x32_bf16 v[168:171],v[220:223],v[0:3],0
ds_read_b64_tr_b16 v[216:217],v248 offset:24576
v_mfma_f32_16x16x32_bf16 v[172:175],v[220:223],v[4:7],0
ds_read_b64_tr_b16 v[218:219],v248 offset:28672
s_waitcnt lgkmcnt(4)
v_mfma_f32_16x16x32_bf16 v[144:147],v[208:211],v[8:11],v[144:147]
ds_read_b64_tr_b16 v[220:221],v249 offset:24576
v_mfma_f32_16x16x32_bf16 v[148:151],v[208:211],v[12:15],v[148:151]
ds_read_b64_tr_b16 v[222:223],v249 offset:28672
s_waitcnt lgkmcnt(4)
v_mfma_f32_16x16x32_bf16 v[152:155],v[212:215],v[8:11],v[152:155]
ds_read_b64_tr_b16 v[208:209],v242 offset:32768
s_mul_i32 s95,s41,18432
s_add_u32 m0,s95,67584
s_add_u32 s45,s94,2048
buffer_load_dwordx4 v254,s[68:71],s45 offen sc1 lds
s_mul_i32 s95,s41,18432
s_add_u32 m0,s95,68608
s_add_u32 s45,s94,3072
buffer_load_dwordx4 v254,s[68:71],s45 offen sc1 lds
v_mfma_f32_16x16x32_bf16 v[156:159],v[212:215],v[12:15],v[156:159]
ds_read_b64_tr_b16 v[210:211],v242 offset:36864
s_waitcnt lgkmcnt(4)
v_mfma_f32_16x16x32_bf16 v[160:163],v[216:219],v[8:11],v[160:163]
ds_read_b64_tr_b16 v[212:213],v243 offset:32768
v_mfma_f32_16x16x32_bf16 v[164:167],v[216:219],v[12:15],v[164:167]
ds_read_b64_tr_b16 v[214:215],v243 offset:36864
s_waitcnt lgkmcnt(4)
v_mfma_f32_16x16x32_bf16 v[168:171],v[220:223],v[8:11],v[168:171]
ds_read_b64_tr_b16 v[216:217],v248 offset:32768
v_mfma_f32_16x16x32_bf16 v[172:175],v[220:223],v[12:15],v[172:175]
ds_read_b64_tr_b16 v[218:219],v248 offset:36864
s_barrier
s_waitcnt lgkmcnt(4)
v_mfma_f32_16x16x32_bf16 v[144:147],v[208:211],v[16:19],v[144:147]
ds_read_b64_tr_b16 v[220:221],v249 offset:32768
v_mfma_f32_16x16x32_bf16 v[148:151],v[208:211],v[20:23],v[148:151]
ds_read_b64_tr_b16 v[222:223],v249 offset:36864
s_waitcnt lgkmcnt(4)
v_mfma_f32_16x16x32_bf16 v[152:155],v[212:215],v[16:19],v[152:155]
ds_read_b64_tr_b16 v[208:209],v242 offset:40960
s_mul_i32 s95,s41,18432
s_add_u32 m0,s95,69632
s_add_u32 s45,s94,4096
buffer_load_dwordx4 v254,s[68:71],s45 offen sc1 lds
s_mul_i32 s95,s41,18432
s_add_u32 m0,s95,70656
s_add_u32 s45,s94,5120
buffer_load_dwordx4 v254,s[68:71],s45 offen sc1 lds
v_mfma_f32_16x16x32_bf16 v[156:159],v[212:215],v[20:23],v[156:159]
ds_read_b64_tr_b16 v[210:211],v242 offset:45056
s_waitcnt lgkmcnt(4)
v_mfma_f32_16x16x32_bf16 v[160:163],v[216:219],v[16:19],v[160:163]
ds_read_b64_tr_b16 v[212:213],v243 offset:40960
v_mfma_f32_16x16x32_bf16 v[164:167],v[216:219],v[20:23],v[164:167]
ds_read_b64_tr_b16 v[214:215],v243 offset:45056
s_waitcnt lgkmcnt(4)
v_mfma_f32_16x16x32_bf16 v[168:171],v[220:223],v[16:19],v[168:171]
ds_read_b64_tr_b16 v[216:217],v248 offset:40960
v_mfma_f32_16x16x32_bf16 v[172:175],v[220:223],v[20:23],v[172:175]
ds_read_b64_tr_b16 v[218:219],v248 offset:45056
s_waitcnt lgkmcnt(4)
v_mfma_f32_16x16x32_bf16 v[144:147],v[208:211],v[24:27],v[144:147]
ds_read_b64_tr_b16 v[220:221],v249 offset:40960
v_mfma_f32_16x16x32_bf16 v[148:151],v[208:211],v[28:31],v[148:151]
ds_read_b64_tr_b16 v[222:223],v249 offset:45056
s_waitcnt lgkmcnt(4)
v_mfma_f32_16x16x32_bf16 v[152:155],v[212:215],v[24:27],v[152:155]
ds_read_b64_tr_b16 v[208:209],v242 offset:49152
s_mul_i32 s95,s41,18432
s_add_u32 m0,s95,71680
s_add_u32 s45,s94,6144
buffer_load_dwordx4 v254,s[68:71],s45 offen sc1 lds
s_mul_i32 s95,s41,18432
s_add_u32 m0,s95,72704
s_add_u32 s45,s94,7168
buffer_load_dwordx4 v254,s[68:71],s45 offen sc1 lds
v_mfma_f32_16x16x32_bf16 v[156:159],v[212:215],v[28:31],v[156:159]
ds_read_b64_tr_b16 v[210:211],v242 offset:53248
s_waitcnt lgkmcnt(4)
v_mfma_f32_16x16x32_bf16 v[160:163],v[216:219],v[24:27],v[160:163]
ds_read_b64_tr_b16 v[212:213],v243 offset:49152
v_mfma_f32_16x16x32_bf16 v[164:167],v[216:219],v[28:31],v[164:167]
ds_read_b64_tr_b16 v[214:215],v243 offset:53248
s_waitcnt lgkmcnt(4)
v_mfma_f32_16x16x32_bf16 v[168:171],v[220:223],v[24:27],v[168:171]
ds_read_b64_tr_b16 v[216:217],v248 offset:49152
v_mfma_f32_16x16x32_bf16 v[172:175],v[220:223],v[28:31],v[172:175]
ds_read_b64_tr_b16 v[218:219],v248 offset:53248
s_waitcnt vmcnt(8)
s_barrier
s_waitcnt lgkmcnt(4)
v_mfma_f32_16x16x32_bf16 v[144:147],v[208:211],v[32:35],v[144:147]
ds_read_b64_tr_b16 v[220:221],v249 offset:49152
v_mfma_f32_16x16x32_bf16 v[148:151],v[208:211],v[36:39],v[148:151]
ds_read_b64_tr_b16 v[222:223],v249 offset:53248
s_waitcnt lgkmcnt(4)
v_mfma_f32_16x16x32_bf16 v[152:155],v[212:215],v[32:35],v[152:155]
ds_read_b64_tr_b16 v[208:209],v242 offset:57344
s_mul_i32 s95,s41,18432
s_add_u32 m0,s95,73728
s_add_u32 s45,s94,8192
buffer_load_dwordx4 v254,s[68:71],s45 offen sc1 lds
s_mul_i32 s95,s41,18432
s_add_u32 m0,s95,74752
s_add_u32 s45,s94,9216
buffer_load_dwordx4 v254,s[68:71],s45 offen sc1 lds
v_mfma_f32_16x16x32_bf16 v[156:159],v[212:215],v[36:39],v[156:159]
ds_read_b64_tr_b16 v[210:211],v242 offset:61440
s_waitcnt lgkmcnt(4)
v_mfma_f32_16x16x32_bf16 v[160:163],v[216:219],v[32:35],v[160:163]
ds_read_b64_tr_b16 v[212:213],v243 offset:57344
v_mfma_f32_16x16x32_bf16 v[164:167],v[216:219],v[36:39],v[164:167]
ds_read_b64_tr_b16 v[214:215],v243 offset:61440
s_waitcnt lgkmcnt(4)
v_mfma_f32_16x16x32_bf16 v[168:171],v[220:223],v[32:35],v[168:171]
ds_read_b64_tr_b16 v[216:217],v248 offset:57344
v_mfma_f32_16x16x32_bf16 v[172:175],v[220:223],v[36:39],v[172:175]
ds_read_b64_tr_b16 v[218:219],v248 offset:61440
s_waitcnt lgkmcnt(4)
v_mfma_f32_16x16x32_bf16 v[144:147],v[208:211],v[40:43],v[144:147]
ds_read_b64_tr_b16 v[220:221],v249 offset:57344
v_mfma_f32_16x16x32_bf16 v[148:151],v[208:211],v[44:47],v[148:151]
ds_read_b64_tr_b16 v[222:223],v249 offset:61440
s_waitcnt lgkmcnt(4)
v_mfma_f32_16x16x32_bf16 v[152:155],v[212:215],v[40:43],v[152:155]
ds_read_b64_tr_b16 v[208:209],v242 offset:0
s_mul_i32 s95,s41,18432
s_add_u32 m0,s95,75776
s_add_u32 s45,s94,10240
buffer_load_dwordx4 v254,s[68:71],s45 offen sc1 lds
s_mul_i32 s95,s41,18432
s_add_u32 m0,s95,76800
s_add_u32 s45,s94,11264
buffer_load_dwordx4 v254,s[68:71],s45 offen sc1 lds
v_mfma_f32_16x16x32_bf16 v[156:159],v[212:215],v[44:47],v[156:159]
ds_read_b64_tr_b16 v[210:211],v242 offset:4096
s_waitcnt lgkmcnt(4)
v_mfma_f32_16x16x32_bf16 v[160:163],v[216:219],v[40:43],v[160:163]
ds_read_b64_tr_b16 v[212:213],v243 offset:0
v_mfma_f32_16x16x32_bf16 v[164:167],v[216:219],v[44:47],v[164:167]
ds_read_b64_tr_b16 v[214:215],v243 offset:4096
s_waitcnt lgkmcnt(4)
v_mfma_f32_16x16x32_bf16 v[168:171],v[220:223],v[40:43],v[168:171]
ds_read_b64_tr_b16 v[216:217],v248 offset:0
v_mfma_f32_16x16x32_bf16 v[172:175],v[220:223],v[44:47],v[172:175]
ds_read_b64_tr_b16 v[218:219],v248 offset:4096
s_barrier
s_waitcnt lgkmcnt(4)
v_mfma_f32_16x16x32_bf16 v[144:147],v[208:211],v[48:51],v[144:147]
ds_read_b64_tr_b16 v[220:221],v249 offset:0
v_mfma_f32_16x16x32_bf16 v[148:151],v[208:211],v[52:55],v[148:151]
ds_read_b64_tr_b16 v[222:223],v249 offset:4096
s_waitcnt lgkmcnt(4)
v_mfma_f32_16x16x32_bf16 v[152:155],v[212:215],v[48:51],v[152:155]
ds_read_b64_tr_b16 v[208:209],v242 offset:8192
v_mfma_f32_16x16x32_bf16 v[156:159],v[212:215],v[52:55],v[156:159]
ds_read_b64_tr_b16 v[210:211],v242 offset:12288
s_waitcnt lgkmcnt(4)
v_mfma_f32_16x16x32_bf16 v[160:163],v[216:219],v[48:51],v[160:163]
ds_read_b64_tr_b16 v[212:213],v243 offset:8192
v_mfma_f32_16x16x32_bf16 v[164:167],v[216:219],v[52:55],v[164:167]
ds_read_b64_tr_b16 v[214:215],v243 offset:12288
s_waitcnt lgkmcnt(4)
v_mfma_f32_16x16x32_bf16 v[168:171],v[220:223],v[48:51],v[168:171]
ds_read_b64_tr_b16 v[216:217],v248 offset:8192
v_mfma_f32_16x16x32_bf16 v[172:175],v[220:223],v[52:55],v[172:175]
ds_read_b64_tr_b16 v[218:219],v248 offset:12288
s_waitcnt lgkmcnt(4)
v_mfma_f32_16x16x32_bf16 v[144:147],v[208:211],v[56:59],v[144:147]
ds_read_b64_tr_b16 v[220:221],v249 offset:8192
v_mfma_f32_16x16x32_bf16 v[148:151],v[208:211],v[60:63],v[148:151]
ds_read_b64_tr_b16 v[222:223],v249 offset:12288
s_waitcnt lgkmcnt(4)
v_mfma_f32_16x16x32_bf16 v[152:155],v[212:215],v[56:59],v[152:155]
ds_read_b64_tr_b16 v[208:209],v242 offset:16384
v_mfma_f32_16x16x32_bf16 v[156:159],v[212:215],v[60:63],v[156:159]
ds_read_b64_tr_b16 v[210:211],v242 offset:20480
s_waitcnt lgkmcnt(4)
v_mfma_f32_16x16x32_bf16 v[160:163],v[216:219],v[56:59],v[160:163]
ds_read_b64_tr_b16 v[212:213],v243 offset:16384
v_mfma_f32_16x16x32_bf16 v[164:167],v[216:219],v[60:63],v[164:167]
ds_read_b64_tr_b16 v[214:215],v243 offset:20480
s_waitcnt lgkmcnt(4)
v_mfma_f32_16x16x32_bf16 v[168:171],v[220:223],v[56:59],v[168:171]
ds_read_b64_tr_b16 v[216:217],v248 offset:16384
v_mfma_f32_16x16x32_bf16 v[172:175],v[220:223],v[60:63],v[172:175]
ds_read_b64_tr_b16 v[218:219],v248 offset:20480
s_barrier
s_waitcnt lgkmcnt(4)
v_mfma_f32_16x16x32_bf16 v[144:147],v[208:211],v[64:67],v[144:147]
ds_read_b64_tr_b16 v[220:221],v249 offset:16384
v_mfma_f32_16x16x32_bf16 v[148:151],v[208:211],v[68:71],v[148:151]
ds_read_b64_tr_b16 v[222:223],v249 offset:20480
s_waitcnt lgkmcnt(4)
v_mfma_f32_16x16x32_bf16 v[152:155],v[212:215],v[64:67],v[152:155]
ds_read_b64_tr_b16 v[208:209],v244 offset:24576
v_mfma_f32_16x16x32_bf16 v[156:159],v[212:215],v[68:71],v[156:159]
ds_read_b64_tr_b16 v[210:211],v244 offset:25600
s_waitcnt lgkmcnt(4)
v_mfma_f32_16x16x32_bf16 v[160:163],v[216:219],v[64:67],v[160:163]
ds_read_b64_tr_b16 v[212:213],v244 offset:26624
v_mfma_f32_16x16x32_bf16 v[164:167],v[216:219],v[68:71],v[164:167]
ds_read_b64_tr_b16 v[214:215],v244 offset:27648
s_waitcnt lgkmcnt(4)
v_mfma_f32_16x16x32_bf16 v[168:171],v[220:223],v[64:67],v[168:171]
ds_read_b64_tr_b16 v[216:217],v244 offset:28672
v_mfma_f32_16x16x32_bf16 v[172:175],v[220:223],v[68:71],v[172:175]
ds_read_b64_tr_b16 v[218:219],v244 offset:29696
s_waitcnt lgkmcnt(4)
v_mfma_f32_16x16x32_bf16 v[232:235],v[208:211],v[0:3],0
ds_read_b64_tr_b16 v[220:221],v244 offset:30720
v_mfma_f32_16x16x32_bf16 v[236:239],v[208:211],v[4:7],0
ds_read_b64_tr_b16 v[222:223],v244 offset:31744
s_waitcnt lgkmcnt(4)
v_mfma_f32_16x16x32_bf16 v[232:235],v[212:215],v[8:11],v[232:235]
ds_read_b64_tr_b16 v[208:209],v244 offset:32768
s_xor_b32 s35,s2,8
s_lshl_b32 s35,s35,9
s_add_u32 s35,s35,128
buffer_load_dword v246,off,s[64:67],s35 sc1
v_mfma_f32_16x16x32_bf16 v[236:239],v[212:215],v[12:15],v[236:239]
ds_read_b64_tr_b16 v[210:211],v244 offset:33792
s_waitcnt lgkmcnt(4)
v_mfma_f32_16x16x32_bf16 v[232:235],v[216:219],v[16:19],v[232:235]
ds_read_b64_tr_b16 v[212:213],v244 offset:34816
v_mfma_f32_16x16x32_bf16 v[236:239],v[216:219],v[20:23],v[236:239]
ds_read_b64_tr_b16 v[214:215],v244 offset:35840
s_waitcnt lgkmcnt(4)
v_mfma_f32_16x16x32_bf16 v[232:235],v[220:223],v[24:27],v[232:235]
ds_read_b64_tr_b16 v[216:217],v244 offset:36864
v_mfma_f32_16x16x32_bf16 v[236:239],v[220:223],v[28:31],v[236:239]
ds_read_b64_tr_b16 v[218:219],v244 offset:37888
s_waitcnt vmcnt(1)
s_barrier
s_waitcnt lgkmcnt(4)
v_mfma_f32_16x16x32_bf16 v[232:235],v[208:211],v[32:35],v[232:235]
ds_read_b64_tr_b16 v[220:221],v244 offset:38912
v_mfma_f32_16x16x32_bf16 v[236:239],v[208:211],v[36:39],v[236:239]
ds_read_b64_tr_b16 v[222:223],v244 offset:39936
s_waitcnt lgkmcnt(4)
v_mfma_f32_16x16x32_bf16 v[232:235],v[212:215],v[40:43],v[232:235]
ds_read_b64_tr_b16 v[208:209],v244 offset:40960
ds_read_b128 v[72:75],v247 offset:0
ds_read_b128 v[76:79],v247 offset:1024
v_mfma_f32_16x16x32_bf16 v[236:239],v[212:215],v[44:47],v[236:239]
ds_read_b64_tr_b16 v[210:211],v244 offset:41984
s_waitcnt lgkmcnt(6)
v_mfma_f32_16x16x32_bf16 v[232:235],v[216:219],v[48:51],v[232:235]
ds_read_b64_tr_b16 v[212:213],v242 offset:49152
v_mfma_f32_16x16x32_bf16 v[236:239],v[216:219],v[52:55],v[236:239]
ds_read_b64_tr_b16 v[214:215],v242 offset:53248
ds_read_b128 v[80:83],v247 offset:2048
ds_read_b128 v[84:87],v247 offset:3072
s_waitcnt lgkmcnt(8)
v_mfma_f32_16x16x32_bf16 v[232:235],v[220:223],v[56:59],v[232:235]
ds_read_b64_tr_b16 v[216:217],v243 offset:49152
v_mfma_f32_16x16x32_bf16 v[236:239],v[220:223],v[60:63],v[236:239]
ds_read_b64_tr_b16 v[218:219],v243 offset:53248
ds_read_b128 v[88:91],v247 offset:4096
ds_read_b128 v[92:95],v247 offset:5120
s_waitcnt lgkmcnt(8)
v_mfma_f32_16x16x32_bf16 v[232:235],v[208:211],v[64:67],v[232:235]
ds_read_b64_tr_b16 v[220:221],v248 offset:49152
ds_read_b128 v[96:99],v247 offset:6144
ds_read_b128 v[100:103],v247 offset:7168
v_mfma_f32_16x16x32_bf16 v[236:239],v[208:211],v[68:71],v[236:239]
ds_read_b64_tr_b16 v[222:223],v248 offset:53248
ds_read_b128 v[104:107],v247 offset:8192
ds_read_b128 v[108:111],v247 offset:9216
ds_read_b128 v[112:115],v247 offset:10240
ds_read_b128 v[116:119],v247 offset:11264
s_waitcnt vmcnt(0)
s_mov_b32 s45,0x40000
ffn_kernel_fc1_spin:
v_readfirstlane_b32 s40,v246
s_nop 3
s_cmp_eq_u32 s40,1
s_cbranch_scc1 ffn_kernel_fc1_ok
s_sub_u32 s45,s45,1
s_cmp_eq_u32 s45,0
s_cbranch_scc1 ffn_kernel_fc1_ok
s_sleep 2
buffer_load_dword v246,off,s[64:67],s35 sc1
s_waitcnt vmcnt(0)
s_branch ffn_kernel_fc1_spin
ffn_kernel_fc1_ok:
s_barrier
s_waitcnt lgkmcnt(14)
v_mfma_f32_16x16x32_bf16 v[176:179],v[212:215],v[72:75],v[176:179]
ds_read_b64_tr_b16 v[208:209],v249 offset:49152
v_mfma_f32_16x16x32_bf16 v[180:183],v[212:215],v[76:79],v[180:183]
ds_read_b64_tr_b16 v[210:211],v249 offset:53248
s_waitcnt lgkmcnt(12)
v_mfma_f32_16x16x32_bf16 v[184:187],v[216:219],v[72:75],v[184:187]
ds_read_b64_tr_b16 v[212:213],v242 offset:57344
s_mul_i32 s95,s41,18432
s_add_u32 m0,s95,77824
s_add_u32 s45,s94,12288
buffer_load_dwordx4 v254,s[68:71],s45 offen sc1 lds
s_mul_i32 s95,s41,18432
s_add_u32 m0,s95,78848
s_add_u32 s45,s94,13312
buffer_load_dwordx4 v254,s[68:71],s45 offen sc1 lds
s_mul_i32 s95,s41,18432
s_add_u32 m0,s95,79872
s_add_u32 s45,s94,14336
buffer_load_dwordx4 v254,s[68:71],s45 offen sc1 lds
v_mfma_f32_16x16x32_bf16 v[188:191],v[216:219],v[76:79],v[188:191]
ds_read_b64_tr_b16 v[214:215],v242 offset:61440
s_waitcnt lgkmcnt(8)
v_mfma_f32_16x16x32_bf16 v[192:195],v[220:223],v[72:75],v[192:195]
ds_read_b64_tr_b16 v[216:217],v243 offset:57344
v_mfma_f32_16x16x32_bf16 v[196:199],v[220:223],v[76:79],v[196:199]
ds_read_b64_tr_b16 v[218:219],v243 offset:61440
s_waitcnt lgkmcnt(4)
v_mfma_f32_16x16x32_bf16 v[200:203],v[208:211],v[72:75],v[200:203]
ds_read_b64_tr_b16 v[220:221],v248 offset:57344
v_mfma_f32_16x16x32_bf16 v[204:207],v[208:211],v[76:79],v[204:207]
ds_read_b64_tr_b16 v[222:223],v248 offset:61440
s_waitcnt lgkmcnt(4)
v_mfma_f32_16x16x32_bf16 v[176:179],v[212:215],v[80:83],v[176:179]
ds_read_b64_tr_b16 v[208:209],v249 offset:57344
v_mfma_f32_16x16x32_bf16 v[180:183],v[212:215],v[84:87],v[180:183]
ds_read_b64_tr_b16 v[210:211],v249 offset:61440
s_waitcnt lgkmcnt(4)
v_mfma_f32_16x16x32_bf16 v[184:187],v[216:219],v[80:83],v[184:187]
ds_read_b64_tr_b16 v[212:213],v242 offset:0
s_mul_i32 s95,s41,18432
s_add_u32 m0,s95,80896
s_add_u32 s45,s94,15360
buffer_load_dwordx4 v254,s[68:71],s45 offen sc1 lds
s_mul_i32 s95,s41,18432
s_add_u32 m0,s95,81920
s_add_u32 s45,s94,16384
buffer_load_dwordx4 v254,s[68:71],s45 offen sc1 lds
s_mul_i32 s95,s41,18432
s_add_u32 m0,s95,82944
s_add_u32 s45,s94,17408
buffer_load_dwordx4 v254,s[68:71],s45 offen sc1 lds
v_mfma_f32_16x16x32_bf16 v[188:191],v[216:219],v[84:87],v[188:191]
ds_read_b64_tr_b16 v[214:215],v242 offset:4096
s_waitcnt lgkmcnt(4)
v_mfma_f32_16x16x32_bf16 v[192:195],v[220:223],v[80:83],v[192:195]
ds_read_b64_tr_b16 v[216:217],v243 offset:0
v_mfma_f32_16x16x32_bf16 v[196:199],v[220:223],v[84:87],v[196:199]
ds_read_b64_tr_b16 v[218:219],v243 offset:4096
s_waitcnt lgkmcnt(4)
v_mfma_f32_16x16x32_bf16 v[200:203],v[208:211],v[80:83],v[200:203]
ds_read_b64_tr_b16 v[220:221],v248 offset:0
v_mfma_f32_16x16x32_bf16 v[204:207],v[208:211],v[84:87],v[204:207]
ds_read_b64_tr_b16 v[222:223],v248 offset:4096
s_barrier
s_waitcnt lgkmcnt(4)
v_mfma_f32_16x16x32_bf16 v[176:179],v[212:215],v[88:91],v[176:179]
ds_read_b64_tr_b16 v[208:209],v249 offset:0
v_mfma_f32_16x16x32_bf16 v[180:183],v[212:215],v[92:95],v[180:183]
ds_read_b64_tr_b16 v[210:211],v249 offset:4096
s_waitcnt lgkmcnt(4)
v_mfma_f32_16x16x32_bf16 v[184:187],v[216:219],v[88:91],v[184:187]
ds_read_b64_tr_b16 v[212:213],v242 offset:8192
v_mfma_f32_16x16x32_bf16 v[188:191],v[216:219],v[92:95],v[188:191]
ds_read_b64_tr_b16 v[214:215],v242 offset:12288
s_waitcnt lgkmcnt(4)
v_mfma_f32_16x16x32_bf16 v[192:195],v[220:223],v[88:91],v[192:195]
ds_read_b64_tr_b16 v[216:217],v243 offset:8192
v_mfma_f32_16x16x32_bf16 v[196:199],v[220:223],v[92:95],v[196:199]
ds_read_b64_tr_b16 v[218:219],v243 offset:12288
s_waitcnt lgkmcnt(4)
v_mfma_f32_16x16x32_bf16 v[200:203],v[208:211],v[88:91],v[200:203]
ds_read_b64_tr_b16 v[220:221],v248 offset:8192
v_mfma_f32_16x16x32_bf16 v[204:207],v[208:211],v[92:95],v[204:207]
ds_read_b64_tr_b16 v[222:223],v248 offset:12288
s_waitcnt lgkmcnt(4)
v_mfma_f32_16x16x32_bf16 v[176:179],v[212:215],v[96:99],v[176:179]
ds_read_b64_tr_b16 v[208:209],v249 offset:8192
v_mfma_f32_16x16x32_bf16 v[180:183],v[212:215],v[100:103],v[180:183]
ds_read_b64_tr_b16 v[210:211],v249 offset:12288
s_waitcnt lgkmcnt(4)
v_mfma_f32_16x16x32_bf16 v[184:187],v[216:219],v[96:99],v[184:187]
ds_read_b64_tr_b16 v[212:213],v242 offset:16384
v_mfma_f32_16x16x32_bf16 v[188:191],v[216:219],v[100:103],v[188:191]
ds_read_b64_tr_b16 v[214:215],v242 offset:20480
s_waitcnt lgkmcnt(4)
v_mfma_f32_16x16x32_bf16 v[192:195],v[220:223],v[96:99],v[192:195]
ds_read_b64_tr_b16 v[216:217],v243 offset:16384
v_mfma_f32_16x16x32_bf16 v[196:199],v[220:223],v[100:103],v[196:199]
ds_read_b64_tr_b16 v[218:219],v243 offset:20480
s_waitcnt lgkmcnt(4)
v_mfma_f32_16x16x32_bf16 v[200:203],v[208:211],v[96:99],v[200:203]
ds_read_b64_tr_b16 v[220:221],v248 offset:16384
v_mfma_f32_16x16x32_bf16 v[204:207],v[208:211],v[100:103],v[204:207]
ds_read_b64_tr_b16 v[222:223],v248 offset:20480
s_barrier
s_waitcnt lgkmcnt(4)
v_mfma_f32_16x16x32_bf16 v[176:179],v[212:215],v[104:107],v[176:179]
ds_read_b64_tr_b16 v[208:209],v249 offset:16384
v_mfma_f32_16x16x32_bf16 v[180:183],v[212:215],v[108:111],v[180:183]
ds_read_b64_tr_b16 v[210:211],v249 offset:20480
s_waitcnt lgkmcnt(4)
v_mfma_f32_16x16x32_bf16 v[184:187],v[216:219],v[104:107],v[184:187]
ds_read_b64_tr_b16 v[212:213],v242 offset:24576
v_mfma_f32_16x16x32_bf16 v[188:191],v[216:219],v[108:111],v[188:191]
ds_read_b64_tr_b16 v[214:215],v242 offset:28672
s_waitcnt lgkmcnt(4)
v_mfma_f32_16x16x32_bf16 v[192:195],v[220:223],v[104:107],v[192:195]
ds_read_b64_tr_b16 v[216:217],v243 offset:24576
v_mfma_f32_16x16x32_bf16 v[196:199],v[220:223],v[108:111],v[196:199]
ds_read_b64_tr_b16 v[218:219],v243 offset:28672
s_waitcnt lgkmcnt(4)
v_mfma_f32_16x16x32_bf16 v[200:203],v[208:211],v[104:107],v[200:203]
ds_read_b64_tr_b16 v[220:221],v248 offset:24576
v_mfma_f32_16x16x32_bf16 v[204:207],v[208:211],v[108:111],v[204:207]
ds_read_b64_tr_b16 v[222:223],v248 offset:28672
s_waitcnt lgkmcnt(4)
v_mfma_f32_16x16x32_bf16 v[176:179],v[212:215],v[112:115],v[176:179]
ds_read_b64_tr_b16 v[208:209],v249 offset:24576
v_mfma_f32_16x16x32_bf16 v[180:183],v[212:215],v[116:119],v[180:183]
ds_read_b64_tr_b16 v[210:211],v249 offset:28672
s_waitcnt lgkmcnt(4)
v_mfma_f32_16x16x32_bf16 v[184:187],v[216:219],v[112:115],v[184:187]
ds_read_b64_tr_b16 v[212:213],v242 offset:32768
v_mfma_f32_16x16x32_bf16 v[188:191],v[216:219],v[116:119],v[188:191]
ds_read_b64_tr_b16 v[214:215],v242 offset:36864
s_waitcnt lgkmcnt(4)
v_mfma_f32_16x16x32_bf16 v[192:195],v[220:223],v[112:115],v[192:195]
ds_read_b64_tr_b16 v[216:217],v243 offset:32768
v_mfma_f32_16x16x32_bf16 v[196:199],v[220:223],v[116:119],v[196:199]
ds_read_b64_tr_b16 v[218:219],v243 offset:36864
s_waitcnt lgkmcnt(4)
v_mfma_f32_16x16x32_bf16 v[200:203],v[208:211],v[112:115],v[200:203]
ds_read_b64_tr_b16 v[220:221],v248 offset:32768
v_mfma_f32_16x16x32_bf16 v[204:207],v[208:211],v[116:119],v[204:207]
ds_read_b64_tr_b16 v[222:223],v248 offset:36864
s_waitcnt vmcnt(0)
s_barrier
s_waitcnt lgkmcnt(4)
v_mfma_f32_16x16x32_bf16 v[144:147],v[212:215],v[72:75],v[144:147]
ds_read_b64_tr_b16 v[208:209],v249 offset:32768
v_mfma_f32_16x16x32_bf16 v[148:151],v[212:215],v[76:79],v[148:151]
ds_read_b64_tr_b16 v[210:211],v249 offset:36864
s_waitcnt lgkmcnt(4)
v_mfma_f32_16x16x32_bf16 v[152:155],v[216:219],v[72:75],v[152:155]
ds_read_b64_tr_b16 v[212:213],v242 offset:40960
ds_read_b128 v[120:123],v247 offset:12288
ds_read_b128 v[124:127],v247 offset:13312
v_mfma_f32_16x16x32_bf16 v[156:159],v[216:219],v[76:79],v[156:159]
ds_read_b64_tr_b16 v[214:215],v242 offset:45056
s_waitcnt lgkmcnt(6)
v_mfma_f32_16x16x32_bf16 v[160:163],v[220:223],v[72:75],v[160:163]
ds_read_b64_tr_b16 v[216:217],v243 offset:40960
v_mfma_f32_16x16x32_bf16 v[164:167],v[220:223],v[76:79],v[164:167]
ds_read_b64_tr_b16 v[218:219],v243 offset:45056
ds_read_b128 v[128:131],v247 offset:14336
ds_read_b128 v[132:135],v247 offset:15360
s_waitcnt lgkmcnt(8)
v_mfma_f32_16x16x32_bf16 v[168:171],v[208:211],v[72:75],v[168:171]
ds_read_b64_tr_b16 v[220:221],v248 offset:40960
v_mfma_f32_16x16x32_bf16 v[172:175],v[208:211],v[76:79],v[172:175]
ds_read_b64_tr_b16 v[222:223],v248 offset:45056
ds_read_b128 v[136:139],v247 offset:16384
ds_read_b128 v[140:143],v247 offset:17408
s_waitcnt lgkmcnt(8)
v_mfma_f32_16x16x32_bf16 v[144:147],v[212:215],v[80:83],v[144:147]
ds_read_b64_tr_b16 v[208:209],v249 offset:40960
v_mfma_f32_16x16x32_bf16 v[148:151],v[212:215],v[84:87],v[148:151]
ds_read_b64_tr_b16 v[210:211],v249 offset:45056
s_waitcnt lgkmcnt(8)
v_mfma_f32_16x16x32_bf16 v[152:155],v[216:219],v[80:83],v[152:155]
ds_read_b64_tr_b16 v[212:213],v242 offset:49152
v_mfma_f32_16x16x32_bf16 v[156:159],v[216:219],v[84:87],v[156:159]
ds_read_b64_tr_b16 v[214:215],v242 offset:53248
s_waitcnt lgkmcnt(6)
v_mfma_f32_16x16x32_bf16 v[160:163],v[220:223],v[80:83],v[160:163]
ds_read_b64_tr_b16 v[216:217],v243 offset:49152
v_mfma_f32_16x16x32_bf16 v[164:167],v[220:223],v[84:87],v[164:167]
ds_read_b64_tr_b16 v[218:219],v243 offset:53248
s_waitcnt lgkmcnt(4)
v_mfma_f32_16x16x32_bf16 v[168:171],v[208:211],v[80:83],v[168:171]
ds_read_b64_tr_b16 v[220:221],v248 offset:49152
v_mfma_f32_16x16x32_bf16 v[172:175],v[208:211],v[84:87],v[172:175]
ds_read_b64_tr_b16 v[222:223],v248 offset:53248
s_barrier
s_waitcnt lgkmcnt(4)
v_mfma_f32_16x16x32_bf16 v[144:147],v[212:215],v[88:91],v[144:147]
ds_read_b64_tr_b16 v[208:209],v249 offset:49152
v_mfma_f32_16x16x32_bf16 v[148:151],v[212:215],v[92:95],v[148:151]
ds_read_b64_tr_b16 v[210:211],v249 offset:53248
s_waitcnt lgkmcnt(4)
v_mfma_f32_16x16x32_bf16 v[152:155],v[216:219],v[88:91],v[152:155]
ds_read_b64_tr_b16 v[212:213],v242 offset:57344
v_mfma_f32_16x16x32_bf16 v[156:159],v[216:219],v[92:95],v[156:159]
ds_read_b64_tr_b16 v[214:215],v242 offset:61440
s_waitcnt lgkmcnt(4)
v_mfma_f32_16x16x32_bf16 v[160:163],v[220:223],v[88:91],v[160:163]
ds_read_b64_tr_b16 v[216:217],v243 offset:57344
v_mfma_f32_16x16x32_bf16 v[164:167],v[220:223],v[92:95],v[164:167]
ds_read_b64_tr_b16 v[218:219],v243 offset:61440
s_waitcnt lgkmcnt(4)
v_mfma_f32_16x16x32_bf16 v[168:171],v[208:211],v[88:91],v[168:171]
ds_read_b64_tr_b16 v[220:221],v248 offset:57344
v_mfma_f32_16x16x32_bf16 v[172:175],v[208:211],v[92:95],v[172:175]
ds_read_b64_tr_b16 v[222:223],v248 offset:61440
s_waitcnt lgkmcnt(4)
v_mfma_f32_16x16x32_bf16 v[176:179],v[212:215],v[120:123],v[176:179]
ds_read_b64_tr_b16 v[208:209],v249 offset:57344
v_mfma_f32_16x16x32_bf16 v[180:183],v[212:215],v[124:127],v[180:183]
ds_read_b64_tr_b16 v[210:211],v249 offset:61440
s_waitcnt lgkmcnt(4)
v_mfma_f32_16x16x32_bf16 v[184:187],v[216:219],v[120:123],v[184:187]
ds_read_b64_tr_b16 v[212:213],v242 offset:0
v_mfma_f32_16x16x32_bf16 v[188:191],v[216:219],v[124:127],v[188:191]
ds_read_b64_tr_b16 v[214:215],v242 offset:4096
s_waitcnt lgkmcnt(4)
v_mfma_f32_16x16x32_bf16 v[192:195],v[220:223],v[120:123],v[192:195]
ds_read_b64_tr_b16 v[216:217],v243 offset:0
v_mfma_f32_16x16x32_bf16 v[196:199],v[220:223],v[124:127],v[196:199]
ds_read_b64_tr_b16 v[218:219],v243 offset:4096
s_waitcnt lgkmcnt(4)
v_mfma_f32_16x16x32_bf16 v[200:203],v[208:211],v[120:123],v[200:203]
ds_read_b64_tr_b16 v[220:221],v248 offset:0
v_mfma_f32_16x16x32_bf16 v[204:207],v[208:211],v[124:127],v[204:207]
ds_read_b64_tr_b16 v[222:223],v248 offset:4096
s_barrier
s_waitcnt lgkmcnt(4)
v_mfma_f32_16x16x32_bf16 v[176:179],v[212:215],v[128:131],v[176:179]
ds_read_b64_tr_b16 v[208:209],v249 offset:0
v_mfma_f32_16x16x32_bf16 v[180:183],v[212:215],v[132:135],v[180:183]
ds_read_b64_tr_b16 v[210:211],v249 offset:4096
s_waitcnt lgkmcnt(4)
v_mfma_f32_16x16x32_bf16 v[184:187],v[216:219],v[128:131],v[184:187]
ds_read_b64_tr_b16 v[212:213],v242 offset:8192
v_mfma_f32_16x16x32_bf16 v[188:191],v[216:219],v[132:135],v[188:191]
ds_read_b64_tr_b16 v[214:215],v242 offset:12288
s_waitcnt lgkmcnt(4)
v_mfma_f32_16x16x32_bf16 v[192:195],v[220:223],v[128:131],v[192:195]
ds_read_b64_tr_b16 v[216:217],v243 offset:8192
v_mfma_f32_16x16x32_bf16 v[196:199],v[220:223],v[132:135],v[196:199]
ds_read_b64_tr_b16 v[218:219],v243 offset:12288
s_waitcnt lgkmcnt(4)
v_mfma_f32_16x16x32_bf16 v[200:203],v[208:211],v[128:131],v[200:203]
ds_read_b64_tr_b16 v[220:221],v248 offset:8192
v_mfma_f32_16x16x32_bf16 v[204:207],v[208:211],v[132:135],v[204:207]
ds_read_b64_tr_b16 v[222:223],v248 offset:12288
s_waitcnt lgkmcnt(4)
v_mfma_f32_16x16x32_bf16 v[176:179],v[212:215],v[136:139],v[176:179]
ds_read_b64_tr_b16 v[208:209],v249 offset:8192
v_mfma_f32_16x16x32_bf16 v[180:183],v[212:215],v[140:143],v[180:183]
ds_read_b64_tr_b16 v[210:211],v249 offset:12288
s_waitcnt lgkmcnt(4)
v_mfma_f32_16x16x32_bf16 v[184:187],v[216:219],v[136:139],v[184:187]
ds_read_b64_tr_b16 v[212:213],v242 offset:16384
v_mfma_f32_16x16x32_bf16 v[188:191],v[216:219],v[140:143],v[188:191]
ds_read_b64_tr_b16 v[214:215],v242 offset:20480
s_waitcnt lgkmcnt(4)
v_mfma_f32_16x16x32_bf16 v[192:195],v[220:223],v[136:139],v[192:195]
ds_read_b64_tr_b16 v[216:217],v243 offset:16384
v_mfma_f32_16x16x32_bf16 v[196:199],v[220:223],v[140:143],v[196:199]
ds_read_b64_tr_b16 v[218:219],v243 offset:20480
s_waitcnt lgkmcnt(4)
v_mfma_f32_16x16x32_bf16 v[200:203],v[208:211],v[136:139],v[200:203]
ds_read_b64_tr_b16 v[220:221],v248 offset:16384
v_mfma_f32_16x16x32_bf16 v[204:207],v[208:211],v[140:143],v[204:207]
ds_read_b64_tr_b16 v[222:223],v248 offset:20480
s_barrier
s_waitcnt lgkmcnt(4)
v_mfma_f32_16x16x32_bf16 v[144:147],v[212:215],v[96:99],v[144:147]
ds_read_b64_tr_b16 v[208:209],v249 offset:16384
v_mfma_f32_16x16x32_bf16 v[148:151],v[212:215],v[100:103],v[148:151]
ds_read_b64_tr_b16 v[210:211],v249 offset:20480
s_lshl_b32 s44,s90,4
s_waitcnt lgkmcnt(4)
v_mfma_f32_16x16x32_bf16 v[152:155],v[216:219],v[96:99],v[152:155]
ds_read_b64_tr_b16 v[212:213],v242 offset:24576
v_mfma_f32_16x16x32_bf16 v[156:159],v[216:219],v[100:103],v[156:159]
ds_read_b64_tr_b16 v[214:215],v242 offset:28672
s_lshl_b32 s40,s42,11
s_waitcnt lgkmcnt(4)
v_mfma_f32_16x16x32_bf16 v[160:163],v[220:223],v[96:99],v[160:163]
ds_read_b64_tr_b16 v[216:217],v243 offset:24576
v_mfma_f32_16x16x32_bf16 v[164:167],v[220:223],v[100:103],v[164:167]
ds_read_b64_tr_b16 v[218:219],v243 offset:28672
s_add_u32 s44,s44,s40
s_waitcnt lgkmcnt(4)
v_mfma_f32_16x16x32_bf16 v[168:171],v[208:211],v[96:99],v[168:171]
ds_read_b64_tr_b16 v[220:221],v248 offset:24576
v_mfma_f32_16x16x32_bf16 v[172:175],v[208:211],v[100:103],v[172:175]
ds_read_b64_tr_b16 v[222:223],v248 offset:28672
s_add_u32 s44,s44,s39
s_waitcnt lgkmcnt(4)
v_mfma_f32_16x16x32_bf16 v[144:147],v[212:215],v[104:107],v[144:147]
ds_read_b64_tr_b16 v[208:209],v249 offset:24576
v_mfma_f32_16x16x32_bf16 v[148:151],v[212:215],v[108:111],v[148:151]
ds_read_b64_tr_b16 v[210:211],v249 offset:28672
v_cvt_pk_bf16_f32 v224,v176,v177
s_waitcnt lgkmcnt(4)
v_mfma_f32_16x16x32_bf16 v[152:155],v[216:219],v[104:107],v[152:155]
ds_read_b64_tr_b16 v[212:213],v242 offset:32768
v_mfma_f32_16x16x32_bf16 v[156:159],v[216:219],v[108:111],v[156:159]
ds_read_b64_tr_b16 v[214:215],v242 offset:36864
v_cvt_pk_bf16_f32 v225,v178,v179
s_waitcnt lgkmcnt(4)
v_mfma_f32_16x16x32_bf16 v[160:163],v[220:223],v[104:107],v[160:163]
ds_read_b64_tr_b16 v[216:217],v243 offset:32768
v_mfma_f32_16x16x32_bf16 v[164:167],v[220:223],v[108:111],v[164:167]
ds_read_b64_tr_b16 v[218:219],v243 offset:36864
v_cvt_pk_bf16_f32 v226,v184,v185
s_waitcnt lgkmcnt(4)
v_mfma_f32_16x16x32_bf16 v[168:171],v[208:211],v[104:107],v[168:171]
ds_read_b64_tr_b16 v[220:221],v248 offset:32768
v_mfma_f32_16x16x32_bf16 v[172:175],v[208:211],v[108:111],v[172:175]
ds_read_b64_tr_b16 v[222:223],v248 offset:36864
v_cvt_pk_bf16_f32 v227,v186,v187
s_barrier
s_waitcnt lgkmcnt(4)
v_mfma_f32_16x16x32_bf16 v[144:147],v[212:215],v[112:115],v[144:147]
ds_read_b64_tr_b16 v[208:209],v249 offset:32768
v_mfma_f32_16x16x32_bf16 v[148:151],v[212:215],v[116:119],v[148:151]
ds_read_b64_tr_b16 v[210:211],v249 offset:36864
buffer_store_dwordx4 v[224:227],v254,s[16:19],s44 offen offset:0 sc1
s_waitcnt lgkmcnt(4)
v_mfma_f32_16x16x32_bf16 v[152:155],v[216:219],v[112:115],v[152:155]
ds_read_b64_tr_b16 v[212:213],v242 offset:40960
v_mfma_f32_16x16x32_bf16 v[156:159],v[216:219],v[116:119],v[156:159]
ds_read_b64_tr_b16 v[214:215],v242 offset:45056
v_cvt_pk_bf16_f32 v228,v192,v193
s_waitcnt lgkmcnt(4)
v_mfma_f32_16x16x32_bf16 v[160:163],v[220:223],v[112:115],v[160:163]
ds_read_b64_tr_b16 v[216:217],v243 offset:40960
v_cvt_pk_bf16_f32 v229,v194,v195
v_mfma_f32_16x16x32_bf16 v[164:167],v[220:223],v[116:119],v[164:167]
ds_read_b64_tr_b16 v[218:219],v243 offset:45056
s_waitcnt lgkmcnt(4)
v_mfma_f32_16x16x32_bf16 v[168:171],v[208:211],v[112:115],v[168:171]
ds_read_b64_tr_b16 v[220:221],v248 offset:40960
v_cvt_pk_bf16_f32 v230,v200,v201
v_mfma_f32_16x16x32_bf16 v[172:175],v[208:211],v[116:119],v[172:175]
ds_read_b64_tr_b16 v[222:223],v248 offset:45056
v_cvt_pk_bf16_f32 v231,v202,v203
s_waitcnt lgkmcnt(4)
v_mfma_f32_16x16x32_bf16 v[144:147],v[212:215],v[120:123],v[144:147]
ds_read_b64_tr_b16 v[208:209],v249 offset:40960
v_mfma_f32_16x16x32_bf16 v[148:151],v[212:215],v[124:127],v[148:151]
ds_read_b64_tr_b16 v[210:211],v249 offset:45056
buffer_store_dwordx4 v[228:231],v254,s[16:19],s44 offen offset:1024 sc1
s_waitcnt lgkmcnt(4)
v_mfma_f32_16x16x32_bf16 v[152:155],v[216:219],v[120:123],v[152:155]
ds_read_b64_tr_b16 v[212:213],v242 offset:49152
v_mfma_f32_16x16x32_bf16 v[156:159],v[216:219],v[124:127],v[156:159]
ds_read_b64_tr_b16 v[214:215],v242 offset:53248
v_cvt_pk_bf16_f32 v224,v180,v181
s_waitcnt lgkmcnt(4)
v_mfma_f32_16x16x32_bf16 v[160:163],v[220:223],v[120:123],v[160:163]
ds_read_b64_tr_b16 v[216:217],v243 offset:49152
v_mfma_f32_16x16x32_bf16 v[164:167],v[220:223],v[124:127],v[164:167]
ds_read_b64_tr_b16 v[218:219],v243 offset:53248
v_cvt_pk_bf16_f32 v225,v182,v183
s_waitcnt lgkmcnt(4)
v_mfma_f32_16x16x32_bf16 v[168:171],v[208:211],v[120:123],v[168:171]
ds_read_b64_tr_b16 v[220:221],v248 offset:49152
v_mfma_f32_16x16x32_bf16 v[172:175],v[208:211],v[124:127],v[172:175]
ds_read_b64_tr_b16 v[222:223],v248 offset:53248
v_cvt_pk_bf16_f32 v226,v188,v189
s_barrier
s_waitcnt lgkmcnt(4)
v_mfma_f32_16x16x32_bf16 v[144:147],v[212:215],v[128:131],v[144:147]
ds_read_b64_tr_b16 v[208:209],v249 offset:49152
v_mfma_f32_16x16x32_bf16 v[148:151],v[212:215],v[132:135],v[148:151]
ds_read_b64_tr_b16 v[210:211],v249 offset:53248
v_cvt_pk_bf16_f32 v227,v190,v191
s_waitcnt lgkmcnt(4)
v_mfma_f32_16x16x32_bf16 v[152:155],v[216:219],v[128:131],v[152:155]
ds_read_b64_tr_b16 v[212:213],v242 offset:57344
v_mfma_f32_16x16x32_bf16 v[156:159],v[216:219],v[132:135],v[156:159]
ds_read_b64_tr_b16 v[214:215],v242 offset:61440
s_add_u32 s40,s44,18432
s_waitcnt lgkmcnt(4)
v_mfma_f32_16x16x32_bf16 v[160:163],v[220:223],v[128:131],v[160:163]
ds_read_b64_tr_b16 v[216:217],v243 offset:57344
v_mfma_f32_16x16x32_bf16 v[164:167],v[220:223],v[132:135],v[164:167]
ds_read_b64_tr_b16 v[218:219],v243 offset:61440
buffer_store_dwordx4 v[224:227],v254,s[16:19],s40 offen sc1
s_waitcnt lgkmcnt(4)
v_mfma_f32_16x16x32_bf16 v[168:171],v[208:211],v[128:131],v[168:171]
ds_read_b64_tr_b16 v[220:221],v248 offset:57344
v_mfma_f32_16x16x32_bf16 v[172:175],v[208:211],v[132:135],v[172:175]
ds_read_b64_tr_b16 v[222:223],v248 offset:61440
v_cvt_pk_bf16_f32 v228,v196,v197
s_waitcnt lgkmcnt(4)
v_mfma_f32_16x16x32_bf16 v[144:147],v[212:215],v[136:139],v[144:147]
ds_read_b64_tr_b16 v[208:209],v249 offset:57344
v_mfma_f32_16x16x32_bf16 v[148:151],v[212:215],v[140:143],v[148:151]
ds_read_b64_tr_b16 v[210:211],v249 offset:61440
v_cvt_pk_bf16_f32 v229,v198,v199
s_waitcnt lgkmcnt(4)
v_mfma_f32_16x16x32_bf16 v[152:155],v[216:219],v[136:139],v[152:155]
ds_read_b64_tr_b16 v[212:213],v244 offset:0
v_mfma_f32_16x16x32_bf16 v[156:159],v[216:219],v[140:143],v[156:159]
ds_read_b64_tr_b16 v[214:215],v244 offset:1024
v_cvt_pk_bf16_f32 v230,v204,v205
s_waitcnt lgkmcnt(4)
v_mfma_f32_16x16x32_bf16 v[160:163],v[220:223],v[136:139],v[160:163]
ds_read_b64_tr_b16 v[216:217],v244 offset:2048
v_cvt_pk_bf16_f32 v231,v206,v207
v_mfma_f32_16x16x32_bf16 v[164:167],v[220:223],v[140:143],v[164:167]
ds_read_b64_tr_b16 v[218:219],v244 offset:3072
s_waitcnt lgkmcnt(4)
v_mfma_f32_16x16x32_bf16 v[168:171],v[208:211],v[136:139],v[168:171]
ds_read_b64_tr_b16 v[220:221],v244 offset:4096
s_add_u32 s40,s44,19456
v_mfma_f32_16x16x32_bf16 v[172:175],v[208:211],v[140:143],v[172:175]
ds_read_b64_tr_b16 v[222:223],v244 offset:5120
buffer_store_dwordx4 v[228:231],v254,s[16:19],s40 offen sc1
s_barrier
s_waitcnt lgkmcnt(4)
v_mfma_f32_16x16x32_bf16 v[232:235],v[212:215],v[72:75],v[232:235]
ds_read_b64_tr_b16 v[208:209],v244 offset:6144
s_lshl_b32 s44,s91,4
v_mfma_f32_16x16x32_bf16 v[236:239],v[212:215],v[76:79],v[236:239]
ds_read_b64_tr_b16 v[210:211],v244 offset:7168
s_lshl_b32 s40,s42,11
s_waitcnt lgkmcnt(4)
v_mfma_f32_16x16x32_bf16 v[232:235],v[216:219],v[80:83],v[232:235]
ds_read_b64_tr_b16 v[212:213],v244 offset:8192
s_add_u32 s44,s44,s40
v_mfma_f32_16x16x32_bf16 v[236:239],v[216:219],v[84:87],v[236:239]
ds_read_b64_tr_b16 v[214:215],v244 offset:9216
s_add_u32 s44,s44,s39
s_waitcnt lgkmcnt(4)
v_mfma_f32_16x16x32_bf16 v[232:235],v[220:223],v[88:91],v[232:235]
ds_read_b64_tr_b16 v[216:217],v244 offset:10240
v_cvt_pk_bf16_f32 v224,v144,v145
v_mfma_f32_16x16x32_bf16 v[236:239],v[220:223],v[92:95],v[236:239]
ds_read_b64_tr_b16 v[218:219],v244 offset:11264
v_cvt_pk_bf16_f32 v225,v146,v147
s_waitcnt lgkmcnt(4)
v_mfma_f32_16x16x32_bf16 v[232:235],v[208:211],v[96:99],v[232:235]
ds_read_b64_tr_b16 v[220:221],v244 offset:12288
v_cvt_pk_bf16_f32 v226,v152,v153
v_mfma_f32_16x16x32_bf16 v[236:239],v[208:211],v[100:103],v[236:239]
ds_read_b64_tr_b16 v[222:223],v244 offset:13312
v_cvt_pk_bf16_f32 v227,v154,v155
s_waitcnt lgkmcnt(4)
v_mfma_f32_16x16x32_bf16 v[232:235],v[212:215],v[104:107],v[232:235]
ds_read_b64_tr_b16 v[208:209],v244 offset:14336
buffer_store_dwordx4 v[224:227],v254,s[16:19],s44 offen offset:0 sc1
v_mfma_f32_16x16x32_bf16 v[236:239],v[212:215],v[108:111],v[236:239]
ds_read_b64_tr_b16 v[210:211],v244 offset:15360
v_cvt_pk_bf16_f32 v228,v160,v161
s_waitcnt lgkmcnt(4)
v_mfma_f32_16x16x32_bf16 v[232:235],v[216:219],v[112:115],v[232:235]
ds_read_b64_tr_b16 v[212:213],v244 offset:16384
v_cvt_pk_bf16_f32 v229,v162,v163
v_mfma_f32_16x16x32_bf16 v[236:239],v[216:219],v[116:119],v[236:239]
ds_read_b64_tr_b16 v[214:215],v244 offset:17408
v_cvt_pk_bf16_f32 v230,v168,v169
s_waitcnt lgkmcnt(4)
v_mfma_f32_16x16x32_bf16 v[232:235],v[220:223],v[120:123],v[232:235]
v_cvt_pk_bf16_f32 v231,v170,v171
v_mfma_f32_16x16x32_bf16 v[236:239],v[220:223],v[124:127],v[236:239]
buffer_store_dwordx4 v[228:231],v254,s[16:19],s44 offen offset:1024 sc1
s_waitcnt lgkmcnt(2)
v_mfma_f32_16x16x32_bf16 v[232:235],v[208:211],v[128:131],v[232:235]
v_cvt_pk_bf16_f32 v224,v148,v149
v_mfma_f32_16x16x32_bf16 v[236:239],v[208:211],v[132:135],v[236:239]
v_cvt_pk_bf16_f32 v225,v150,v151
v_cvt_pk_bf16_f32 v226,v156,v157
s_barrier
s_waitcnt lgkmcnt(0)
v_mfma_f32_16x16x32_bf16 v[232:235],v[212:215],v[136:139],v[232:235]
v_cvt_pk_bf16_f32 v227,v158,v159
s_add_u32 s40,s44,18432
buffer_store_dwordx4 v[224:227],v254,s[16:19],s40 offen sc1
v_cvt_pk_bf16_f32 v228,v164,v165
v_mfma_f32_16x16x32_bf16 v[236:239],v[212:215],v[140:143],v[236:239]
v_cvt_pk_bf16_f32 v229,v166,v167
v_cvt_pk_bf16_f32 v230,v172,v173
v_cvt_pk_bf16_f32 v231,v174,v175
s_add_u32 s40,s44,19456
buffer_store_dwordx4 v[228:231],v254,s[16:19],s40 offen sc1
s_nop 7
s_load_dwordx2 s[88:89],s[0:1],56
s_lshl_b32 s40,s42,3
s_mul_i32 s44,s41,2048
s_add_u32 s44,s44,65536
v_add_u32 v252,s44,v254
v_add_u32 v253,s40,v252
v_cvt_pk_bf16_f32 v224,v232,v233
v_cvt_pk_bf16_f32 v225,v234,v235
ds_write_b64 v253,v[224:225] offset:0
v_cvt_pk_bf16_f32 v228,v236,v237
v_cvt_pk_bf16_f32 v229,v238,v239
ds_write_b64 v253,v[228:229] offset:1024
s_waitcnt vmcnt(4)
s_waitcnt lgkmcnt(0)
s_barrier
ds_read_b128 v[224:227],v252 offset:1024
s_lshl_b32 s44,s92,4
s_add_u32 s44,s44,s39
s_add_u32 s44,s44,18432
s_waitcnt lgkmcnt(0)
buffer_store_dwordx4 v[224:227],v254,s[16:19],s44 offen sc1
s_and_b32 s37,s2,15
s_lshr_b32 s43,s37,1
s_lshl_b32 s40,s30,3
s_add_u32 s43,s43,s40
s_and_b32 s37,s37,1
s_and_b32 s87,s30,1
s_lshl_b32 s87,s87,2
s_add_u32 s87,s87,s37
s_add_u32 s87,s87,s41
s_xor_b32 s45,s37,1
s_lshl_b32 s45,s45,3
s_mul_i32 s37,s37,9
s_add_u32 s87,s87,s37
s_add_u32 s45,s45,s37
s_mul_i32 s85,s43,18
s_add_u32 s86,s85,s45
s_lshl_b32 s86,s86,10
s_add_u32 s85,s85,s87
s_lshl_b32 s85,s85,10
v_and_b32 v4,15,v255
v_lshrrev_b32 v5,4,v255
s_lshl_b32 s43,s43,4
v_add_u32 v6,s43,v4
v_lshlrev_b32 v7,2,v6
v_mul_u32_u24 v8,1152,v6
v_and_b32 v9,1,v5
v_lshlrev_b32 v9,5,v9
v_lshrrev_b32 v10,1,v5
v_lshl_add_u32 v9,v10,4,v9
v_add_u32 v8,v8,v9
s_lshl_b32 s43,s87,6
v_add_u32 v9,s43,v8
s_lshl_b32 s43,s45,6
v_add_u32 v10,s43,v8
v_min_u32 v12,15,v255
s_lshl_b32 s37,s30,4
v_add_u32 v12,s37,v12
v_lshlrev_b32 v12,9,v12
s_add_u32 s4,s26,6291456
s_addc_u32 s5,s27,0
s_mov_b32 s6,18874368
s_mov_b32 s7,0x20000
s_add_u32 s52,s26,4857856
s_addc_u32 s53,s27,0
s_mov_b32 s54,8192
s_mov_b32 s55,0x20000
s_waitcnt vmcnt(0) lgkmcnt(0)
s_mov_b32 s8,s88
s_mov_b32 s9,s89
s_mov_b32 s10,2359296
s_mov_b32 s11,0x20000
s_barrier
buffer_load_dword v14,v7,s[52:55],0 offen sc1
s_mov_b32 s45,0x40000
ffn_kernel_polle:
buffer_load_dword v13,v12,s[64:67],0 offen offset:384 sc1
s_waitcnt vmcnt(0)
v_cmp_ne_u32 vcc,1,v13
s_nop 3
s_cmp_eq_u64 vcc,0
s_cbranch_scc1 ffn_kernel_polle_ok
s_sub_u32 s45,s45,1
s_cmp_eq_u32 s45,0
s_cbranch_scc1 ffn_kernel_polle_ok
s_sleep 1
s_branch ffn_kernel_polle
ffn_kernel_polle_ok:
buffer_load_dwordx4 v[16:19],v254,s[12:15],s85 offen sc1
buffer_load_dwordx4 v[20:23],v254,s[4:7],s85 offen sc1
s_add_u32 s85,s85,2359296
buffer_load_dwordx4 v[24:27],v254,s[4:7],s85 offen sc1
s_add_u32 s85,s85,2359296
buffer_load_dwordx4 v[28:31],v254,s[4:7],s85 offen sc1
s_add_u32 s85,s85,2359296
buffer_load_dwordx4 v[32:35],v254,s[4:7],s85 offen sc1
s_add_u32 s85,s85,2359296
buffer_load_dwordx4 v[36:39],v254,s[4:7],s85 offen sc1
s_add_u32 s85,s85,2359296
buffer_load_dwordx4 v[40:43],v254,s[4:7],s85 offen sc1
s_add_u32 s85,s85,2359296
buffer_load_dwordx4 v[44:47],v254,s[4:7],s85 offen sc1
s_add_u32 s85,s85,2359296
buffer_load_dwordx4 v[48:51],v254,s[4:7],s85 offen sc1
s_barrier
v_mov_b32 v15,0xffff0000
s_waitcnt vmcnt(0)
v_lshlrev_b32 v108,16,v16
v_and_b32 v109,v15,v16
v_add_f32 v100,v14,v108
v_add_f32 v101,v14,v109
v_lshlrev_b32 v108,16,v17
v_and_b32 v109,v15,v17
v_add_f32 v102,v14,v108
v_add_f32 v103,v14,v109
v_lshlrev_b32 v108,16,v18
v_and_b32 v109,v15,v18
v_add_f32 v104,v14,v108
v_add_f32 v105,v14,v109
v_lshlrev_b32 v108,16,v19
v_and_b32 v109,v15,v19
v_add_f32 v106,v14,v108
v_add_f32 v107,v14,v109
v_lshlrev_b32 v108,16,v20
v_and_b32 v109,v15,v20
v_pk_add_f32 v[100:101],v[100:101],v[108:109]
v_lshlrev_b32 v110,16,v21
v_and_b32 v111,v15,v21
v_pk_add_f32 v[102:103],v[102:103],v[110:111]
v_lshlrev_b32 v108,16,v22
v_and_b32 v109,v15,v22
v_pk_add_f32 v[104:105],v[104:105],v[108:109]
v_lshlrev_b32 v110,16,v23
v_and_b32 v111,v15,v23
v_pk_add_f32 v[106:107],v[106:107],v[110:111]
v_lshlrev_b32 v108,16,v24
v_and_b32 v109,v15,v24
v_pk_add_f32 v[100:101],v[100:101],v[108:109]
v_lshlrev_b32 v110,16,v25
v_and_b32 v111,v15,v25
v_pk_add_f32 v[102:103],v[102:103],v[110:111]
v_lshlrev_b32 v108,16,v26
v_and_b32 v109,v15,v26
v_pk_add_f32 v[104:105],v[104:105],v[108:109]
v_lshlrev_b32 v110,16,v27
v_and_b32 v111,v15,v27
v_pk_add_f32 v[106:107],v[106:107],v[110:111]
v_lshlrev_b32 v108,16,v28
v_and_b32 v109,v15,v28
v_pk_add_f32 v[100:101],v[100:101],v[108:109]
v_lshlrev_b32 v110,16,v29
v_and_b32 v111,v15,v29
v_pk_add_f32 v[102:103],v[102:103],v[110:111]
v_lshlrev_b32 v108,16,v30
v_and_b32 v109,v15,v30
v_pk_add_f32 v[104:105],v[104:105],v[108:109]
v_lshlrev_b32 v110,16,v31
v_and_b32 v111,v15,v31
v_pk_add_f32 v[106:107],v[106:107],v[110:111]
v_lshlrev_b32 v108,16,v32
v_and_b32 v109,v15,v32
v_pk_add_f32 v[100:101],v[100:101],v[108:109]
v_lshlrev_b32 v110,16,v33
v_and_b32 v111,v15,v33
v_pk_add_f32 v[102:103],v[102:103],v[110:111]
v_lshlrev_b32 v108,16,v34
v_and_b32 v109,v15,v34
v_pk_add_f32 v[104:105],v[104:105],v[108:109]
v_lshlrev_b32 v110,16,v35
v_and_b32 v111,v15,v35
v_pk_add_f32 v[106:107],v[106:107],v[110:111]
v_lshlrev_b32 v108,16,v36
v_and_b32 v109,v15,v36
v_pk_add_f32 v[100:101],v[100:101],v[108:109]
v_lshlrev_b32 v110,16,v37
v_and_b32 v111,v15,v37
v_pk_add_f32 v[102:103],v[102:103],v[110:111]
v_lshlrev_b32 v108,16,v38
v_and_b32 v109,v15,v38
v_pk_add_f32 v[104:105],v[104:105],v[108:109]
v_lshlrev_b32 v110,16,v39
v_and_b32 v111,v15,v39
v_pk_add_f32 v[106:107],v[106:107],v[110:111]
v_lshlrev_b32 v108,16,v40
v_and_b32 v109,v15,v40
v_pk_add_f32 v[100:101],v[100:101],v[108:109]
v_lshlrev_b32 v110,16,v41
v_and_b32 v111,v15,v41
v_pk_add_f32 v[102:103],v[102:103],v[110:111]
v_lshlrev_b32 v108,16,v42
v_and_b32 v109,v15,v42
v_pk_add_f32 v[104:105],v[104:105],v[108:109]
v_lshlrev_b32 v110,16,v43
v_and_b32 v111,v15,v43
v_pk_add_f32 v[106:107],v[106:107],v[110:111]
v_lshlrev_b32 v108,16,v44
v_and_b32 v109,v15,v44
v_pk_add_f32 v[100:101],v[100:101],v[108:109]
v_lshlrev_b32 v110,16,v45
v_and_b32 v111,v15,v45
v_pk_add_f32 v[102:103],v[102:103],v[110:111]
v_lshlrev_b32 v108,16,v46
v_and_b32 v109,v15,v46
v_pk_add_f32 v[104:105],v[104:105],v[108:109]
v_lshlrev_b32 v110,16,v47
v_and_b32 v111,v15,v47
v_pk_add_f32 v[106:107],v[106:107],v[110:111]
v_lshlrev_b32 v108,16,v48
v_and_b32 v109,v15,v48
v_pk_add_f32 v[100:101],v[100:101],v[108:109]
v_lshlrev_b32 v110,16,v49
v_and_b32 v111,v15,v49
v_pk_add_f32 v[102:103],v[102:103],v[110:111]
v_lshlrev_b32 v108,16,v50
v_and_b32 v109,v15,v50
v_pk_add_f32 v[104:105],v[104:105],v[108:109]
v_lshlrev_b32 v110,16,v51
v_and_b32 v111,v15,v51
v_pk_add_f32 v[106:107],v[106:107],v[110:111]
v_cvt_pk_bf16_f32 v112,v100,v101
v_cvt_pk_bf16_f32 v113,v102,v103
v_cvt_pk_bf16_f32 v114,v104,v105
v_cvt_pk_bf16_f32 v115,v106,v107
s_nop 1
v_permlane16_swap_b32 v112,v114
v_permlane16_swap_b32 v113,v115
s_nop 0
buffer_store_dwordx4 v[112:115],v9,s[8:11],0 offen
s_endpgm
ffn_kernel_done:
s_endpgm
.section .rodata,"a"
.p2align 6
.amdhsa_kernel ffn_kernel
.amdhsa_next_free_vgpr 256
.amdhsa_next_free_sgpr 100
.amdhsa_accum_offset 256
.amdhsa_group_segment_fixed_size 0
.amdhsa_kernarg_size 80
.amdhsa_user_sgpr_count 2
.amdhsa_user_sgpr_kernarg_segment_ptr 1
.amdhsa_system_sgpr_workgroup_id_x 1
.amdhsa_float_denorm_mode_32 3
.end_amdhsa_kernel
.text
ffn_kernel_end:
text_end_label:
```
